```python
import torch

def _softmax(x, axis=-1):
    return torch.softmax(x, dim=axis)
def _gelu(x):
    return torch.nn.functional.gelu(x, approximate="tanh")
def _silu(x):
    return torch.nn.functional.silu(x)
def _sigmoid(x):
    return torch.sigmoid(x)
def _layernorm(x, axis=-1, eps=1e-5):
    m = x.mean(dim=axis, keepdim=True)
    v = x.var(dim=axis, keepdim=True, unbiased=False)
    return (x - m) / torch.sqrt(v + eps)
def _scatter_add(tgt, idx, src, axis=0):
    return tgt.clone().index_add_(axis, idx, src)
def _segment_sum(src, seg, n):
    out = torch.zeros((n,) + src.shape[1:], dtype=src.dtype)
    return out.index_add_(0, seg, src)
def _pad(x, pw):
    flat = tuple(v for pair in reversed(pw) for v in pair)
    return torch.nn.functional.pad(x, flat)

kernel_name = 'standalone__mha_softmax__near_ridge'

def setup_inputs():

    _w = (lambda a: (lambda t: t.to(torch.bfloat16) if t.is_floating_point() else t)(torch.as_tensor(a)))
    B, H, Sq, Sk, D = 8, 32, 512, 512, 192
    return {
        "q": _w((lambda *s: torch.randn(*s, dtype=torch.bfloat16) * 0.8)(B, H, Sq, D)),
        "k": _w((lambda *s: torch.randn(*s, dtype=torch.bfloat16) * 0.8)(B, H, Sk, D)),
        "v": _w((lambda *s: torch.randn(*s, dtype=torch.bfloat16) * 0.05)(B, H, Sk, D)),
    }

def reference(q, k, v):
    scale = q.shape[-1] ** -0.5
    scores = torch.einsum("bhqd,bhkd->bhqk", q, k) * scale
    p = _softmax(scores, axis=-1)
    return torch.einsum("bhqk,bhkd->bhqd", p, v)
```

```asm
; @launch grid=(256,1,1) block=(256,1,1) lds=159744
.amdgcn_target "amdgcn-amd-amdhsa--gfx950"
.text
.globl standalone__mha_softmax__near_ridge_kernel
.p2align 8
.type standalone__mha_softmax__near_ridge_kernel,@function
standalone__mha_softmax__near_ridge_kernel:
  s_load_dwordx8 s[36:43], s[0:1], 0
  s_cmp_ge_u32 s2, 256
  s_cbranch_scc1 L_end
  s_getpc_b64 s[98:99]
L_pc:
  s_bfe_u32 s31, s2, 0x30003
  s_lshl_b32 s31, s31, 13
  s_add_u32 s98, s98, L_main-L_pc
  s_addc_u32 s99, s99, 0
  v_lshl_add_u32 v4, v0, 5, s31
  global_load_dword v250, v4, s[98:99]
  v_lshrrev_b32 v4, 6, v0
  v_and_b32 v1, 63, v0
  v_readfirstlane_b32 s29, v4
  v_and_b32 v2, 15, v1
  v_lshrrev_b32 v3, 4, v1
  s_and_b32 s31, s2, 7
  s_lshr_b32 s32, s2, 3
  s_lshl_b32 s31, s31, 4
  s_lshr_b32 s33, s32, 1
  s_add_u32 s31, s31, s33
  s_and_b32 s32, s32, 1
  s_mov_b32 s82, 0x66000000
  s_mov_b32 s83, 0x88777777
  s_getreg_b32 s84, hwreg(HW_REG_XCC_ID, 0, 1)
  s_cmp_eq_u32 s84, 0
  s_cselect_b32 s82, s82, 0x00000000
  s_cselect_b32 s83, s83, 0x44444400
  s_lshl_b32 s84, s31, 2
  s_lshr_b64 s[82:83], s[82:83], s84
  s_and_b32 s84, s82, 15
  s_cselect_b64 vcc, -1, 0
  s_getreg_b32 s83, hwreg(HW_REG_XCC_ID, 0, 3)
  s_lshl_b32 s83, s83, 2
  s_lshr_b32 s83, 0x32231001, s83
  s_and_b32 s83, s83, 15
  s_sub_u32 s84, s84, s83
  s_mul_i32 s31, s31, 393216
  s_mul_i32 s21, s29, 3072
  s_mul_i32 s30, s29, 12288
  s_add_u32 s30, s30, 110592
  s_add_u32 s20, s31, s21
  s_mul_i32 s32, s32, 98304
  s_mul_i32 s33, s29, 24576
  s_add_u32 s23, s31, s32
  s_add_u32 s23, s23, s33
  s_mov_b32 s22, 0x3dd53b95
  s_mov_b32 s28, 0x4b800000
  s_mov_b32 s34, 0x31756420
  s_and_b32 s35, s29, 1
  s_lshl_b32 s35, s35, 4
  v_lshlrev_b32 v246, 4, v1
  v_add_u32 v4, 0, v1
  v_mul_u32_u24 v251, 171, v4
  v_lshrrev_b32 v4, 13, v251
  v_lshl_add_u32 v4, v4, 2, s35
  v_bfe_u32 v4, s34, v4, 3
  v_lshlrev_b32 v4, 4, v4
  v_xor_b32 v242, v4, v246
  v_add_u32 v4, 64, v1
  v_mul_u32_u24 v252, 171, v4
  v_lshrrev_b32 v4, 13, v252
  v_lshl_add_u32 v4, v4, 2, s35
  v_bfe_u32 v4, s34, v4, 3
  v_lshlrev_b32 v4, 4, v4
  v_xor_b32 v243, v4, v246
  v_add_u32 v4, 128, v1
  v_mul_u32_u24 v253, 171, v4
  v_lshrrev_b32 v4, 13, v253
  v_lshl_add_u32 v4, v4, 2, s35
  v_bfe_u32 v4, s34, v4, 3
  v_lshlrev_b32 v4, 4, v4
  v_xor_b32 v244, v4, v246
  s_mov_b32 s78, 0x81ff81ff
  v_mov_b32 v32, 0x3e003e00
  v_add_u32 v33, 40503, v1
  v_mul_u32_u24 v16, 0x88381d, v33
  v_mul_u32_u24 v17, 0x58cc69, v33
  v_mul_u32_u24 v18, 0x98a857, v33
  v_mul_u32_u24 v19, 0x47cbeb, v33
  v_mul_u32_u24 v20, 0x663721, v33
  v_mul_u32_u24 v21, 0xf3e9fd, v33
  v_mul_u32_u24 v22, 0xf0e47b, v33
  v_mul_u32_u24 v23, 0x5d269f, v33
  v_mul_u32_u24 v24, 0x38b065, v33
  v_mul_u32_u24 v25, 0x8381d1, v33
  v_and_or_b32 v16, v16, s78, v32
  v_and_or_b32 v17, v17, s78, v32
  v_and_or_b32 v18, v18, s78, v32
  v_and_or_b32 v19, v19, s78, v32
  v_and_or_b32 v20, v20, s78, v32
  v_and_or_b32 v21, v21, s78, v32
  v_and_or_b32 v22, v22, s78, v32
  v_and_or_b32 v23, v23, s78, v32
  v_and_or_b32 v24, v24, s78, v32
  v_and_or_b32 v25, v25, s78, v32
  s_mul_i32 s33, s29, 12288
  s_add_u32 s33, s33, 36864
  s_waitcnt lgkmcnt(0)
  s_mov_b32 s8, s38
  s_and_b32 s9, s39, 0xffff
  s_mov_b32 s10, 0x3000000
  s_mov_b32 s11, 0x20000
  s_mov_b32 s4, s36
  s_and_b32 s5, s37, 0xffff
  s_mov_b32 s6, 0x3000000
  s_mov_b32 s7, 0x20000
  s_mov_b32 s12, s40
  s_and_b32 s13, s41, 0xffff
  s_mov_b32 s14, 0x3000000
  s_mov_b32 s15, 0x20000
  s_mov_b32 s16, s42
  s_and_b32 s17, s43, 0xffff
  s_mov_b32 s18, 0x3000000
  s_mov_b32 s19, 0x20000
  s_add_u32 m0, s21, 0
  s_nop 0
  buffer_load_dwordx4 v242, s[8:11], s20 offen nt lds
  buffer_load_dwordx4 v243, s[8:11], s20 offen offset:1024 nt lds
  buffer_load_dwordx4 v244, s[8:11], s20 offen offset:2048 nt lds
  s_cbranch_vccnz L_sk1
  s_add_u32 m0, s21, 98304
  s_nop 0
  buffer_load_dwordx4 v242, s[12:15], s20 offen nt lds
  buffer_load_dwordx4 v243, s[12:15], s20 offen offset:1024 nt lds
  buffer_load_dwordx4 v244, s[12:15], s20 offen offset:2048 nt lds
  s_add_u32 s20, s20, 12288
  s_add_u32 m0, s21, 12288
  s_nop 0
  buffer_load_dwordx4 v242, s[8:11], s20 offen nt lds
  buffer_load_dwordx4 v243, s[8:11], s20 offen offset:1024 nt lds
  buffer_load_dwordx4 v244, s[8:11], s20 offen offset:2048 nt lds
  s_add_u32 m0, s33, 0
  s_add_u32 s24, s23, 0
  buffer_load_dwordx4 v242, s[4:7], s24 offen nt lds
  buffer_load_dwordx4 v243, s[4:7], s24 offen offset:1024 nt lds
  buffer_load_dwordx4 v244, s[4:7], s24 offen offset:2048 nt lds
L_sk1:
  v_mul_u32_u24 v5, 384, v2
  v_lshl_add_u32 v245, v3, 4, v5
  v_lshrrev_b32 v4, 12, v251
  v_lshlrev_b32 v4, 4, v4
  v_xor_b32 v4, v4, v246
  s_add_u32 s32, s30, 0
  v_add_u32 v251, s32, v4
  v_lshrrev_b32 v4, 12, v252
  v_lshlrev_b32 v4, 4, v4
  v_xor_b32 v4, v4, v246
  s_add_u32 s32, s30, 1024
  v_add_u32 v252, s32, v4
  v_lshrrev_b32 v4, 12, v253
  v_lshlrev_b32 v4, 4, v4
  v_xor_b32 v4, v4, v246
  s_add_u32 s32, s30, 2048
  v_add_u32 v253, s32, v4
  v_and_b32 v4, 7, v2
  v_lshlrev_b32 v4, 4, v4
  v_lshlrev_b32 v6, 3, v3
  v_xor_b32 v4, v4, v6
  v_add3_u32 v247, v4, v5, s30
  v_lshrrev_b32 v4, 1, v2
  v_lshlrev_b32 v4, 2, v4
  v_bfe_u32 v4, s34, v4, 3
  v_xor_b32 v4, v4, v3
  v_lshl_add_u32 v236, v4, 4, v5
  v_xor_b32 v237, 64, v236
  v_bfe_u32 v4, v2, 1, 2
  v_lshl_add_u32 v4, v4, 2, s35
  v_bfe_u32 v4, s34, v4, 3
  v_xor_b32 v4, v4, v3
  v_lshl_add_u32 v4, v4, 4, v5
  v_add_u32 v248, s30, v4
  v_xor_b32 v249, 64, v248
  v_add_u32 v10, s33, v4
  v_xor_b32 v11, 64, v10
  v_lshrrev_b32 v4, 2, v2
  v_lshl_add_u32 v4, v3, 2, v4
  v_lshrrev_b32 v6, 1, v4
  v_lshlrev_b32 v6, 2, v6
  v_bfe_u32 v6, s34, v6, 3
  v_mul_u32_u24 v4, 384, v4
  v_bfe_u32 v5, v2, 1, 1
  v_xor_b32 v6, v6, v5
  v_lshl_add_u32 v4, v6, 4, v4
  v_and_b32 v5, 1, v2
  v_lshl_add_u32 v4, v5, 3, v4
  v_add_u32 v238, 61440, v4
  v_xor_b32 v239, 32, v238
  v_xor_b32 v240, 64, v238
  v_xor_b32 v241, 96, v238
  v_mov_b32 v232, 0x42c00000
  v_mov_b32 v233, 0x42c00000
  v_mov_b32 v234, 0x42c00000
  v_mov_b32 v235, 0x42c00000
  s_cbranch_vccz L_sk2
  s_cmp_gt_u32 s84, 1
  s_cbranch_scc0 L_nw0
L_wm1:
  v_mfma_f32_16x16x32_bf16 v[32:35], v[16:19], v[20:23], 0
  s_getreg_b32 s78, hwreg(HW_REG_IB_STS)
  v_mfma_f32_16x16x32_bf16 v[32:35], v[20:23], v[18:21], v[32:35]
  s_and_b32 s78, s78, 0xc0000f
  v_mfma_f32_16x16x32_bf16 v[32:35], v[18:21], v[22:25], v[32:35]
  s_cmp_gt_u32 s78, 0x0
  v_mfma_f32_16x16x32_bf16 v[32:35], v[22:25], v[16:19], v[32:35]
  s_cbranch_scc1 L_wm1
L_wm1x:
  s_waitcnt vmcnt(0)
L_nw0:
  s_add_u32 m0, s21, 98304
  s_nop 0
  buffer_load_dwordx4 v242, s[12:15], s20 offen nt lds
  buffer_load_dwordx4 v243, s[12:15], s20 offen offset:1024 nt lds
  buffer_load_dwordx4 v244, s[12:15], s20 offen offset:2048 nt lds
L_sk2:
  s_mov_b64 exec, 0
  s_cmp_eq_u32 s29, 0
  s_cbranch_scc1 L_pg1
  s_cmp_eq_u32 s29, 1
  s_cbranch_scc1 L_pg2
  s_cmp_eq_u32 s29, 2
  s_cbranch_scc1 L_pg3
  s_branch L_pg4
.p2align 12
L_main:
L_ret:
  s_mov_b64 exec, -1
  s_cbranch_vccz L_sk3
  s_cmp_gt_u32 s84, 2
  s_cbranch_scc0 L_nw1
L_wm2:
  v_mfma_f32_16x16x32_bf16 v[32:35], v[16:19], v[20:23], 0
  s_getreg_b32 s78, hwreg(HW_REG_IB_STS)
  v_mfma_f32_16x16x32_bf16 v[32:35], v[20:23], v[18:21], v[32:35]
  s_and_b32 s78, s78, 0xc0000f
  v_mfma_f32_16x16x32_bf16 v[32:35], v[18:21], v[22:25], v[32:35]
  s_cmp_gt_u32 s78, 0x0
  v_mfma_f32_16x16x32_bf16 v[32:35], v[22:25], v[16:19], v[32:35]
  s_cbranch_scc1 L_wm2
L_wm2x:
  s_waitcnt vmcnt(0)
L_nw1:
  s_add_u32 s20, s20, 12288
  s_add_u32 m0, s21, 12288
  s_nop 0
  buffer_load_dwordx4 v242, s[8:11], s20 offen nt lds
  s_cmp_gt_u32 s84, 3
  s_cbranch_scc0 L_nw2
L_wm3:
  v_mfma_f32_16x16x32_bf16 v[32:35], v[16:19], v[20:23], 0
  s_getreg_b32 s78, hwreg(HW_REG_IB_STS)
  v_mfma_f32_16x16x32_bf16 v[32:35], v[20:23], v[18:21], v[32:35]
  s_and_b32 s78, s78, 0xc0000f
  v_mfma_f32_16x16x32_bf16 v[32:35], v[18:21], v[22:25], v[32:35]
  s_cmp_gt_u32 s78, 0x0
  v_mfma_f32_16x16x32_bf16 v[32:35], v[22:25], v[16:19], v[32:35]
  s_cbranch_scc1 L_wm3
L_wm3x:
  s_waitcnt vmcnt(0)
L_nw2:
  buffer_load_dwordx4 v243, s[8:11], s20 offen offset:1024 nt lds
  s_cmp_gt_u32 s84, 4
  s_cbranch_scc0 L_nw3
L_wm4:
  v_mfma_f32_16x16x32_bf16 v[32:35], v[16:19], v[20:23], 0
  s_getreg_b32 s78, hwreg(HW_REG_IB_STS)
  v_mfma_f32_16x16x32_bf16 v[32:35], v[20:23], v[18:21], v[32:35]
  s_and_b32 s78, s78, 0xc0000f
  v_mfma_f32_16x16x32_bf16 v[32:35], v[18:21], v[22:25], v[32:35]
  s_cmp_gt_u32 s78, 0x0
  v_mfma_f32_16x16x32_bf16 v[32:35], v[22:25], v[16:19], v[32:35]
  s_cbranch_scc1 L_wm4
L_wm4x:
  s_waitcnt vmcnt(0)
L_nw3:
  buffer_load_dwordx4 v244, s[8:11], s20 offen offset:2048 nt lds
  s_cmp_gt_u32 s84, 5
  s_cbranch_scc0 L_nw4
L_wm5:
  v_mfma_f32_16x16x32_bf16 v[32:35], v[16:19], v[20:23], 0
  s_getreg_b32 s78, hwreg(HW_REG_IB_STS)
  v_mfma_f32_16x16x32_bf16 v[32:35], v[20:23], v[18:21], v[32:35]
  s_and_b32 s78, s78, 0xc0000f
  v_mfma_f32_16x16x32_bf16 v[32:35], v[18:21], v[22:25], v[32:35]
  s_cmp_gt_u32 s78, 0x0
  v_mfma_f32_16x16x32_bf16 v[32:35], v[22:25], v[16:19], v[32:35]
  s_cbranch_scc1 L_wm5
L_wm5x:
  s_waitcnt vmcnt(0)
L_nw4:
  s_add_u32 m0, s33, 0
  s_add_u32 s24, s23, 0
  buffer_load_dwordx4 v242, s[4:7], s24 offen nt lds
  buffer_load_dwordx4 v243, s[4:7], s24 offen offset:1024 nt lds
  buffer_load_dwordx4 v244, s[4:7], s24 offen offset:2048 nt lds
  s_cmp_gt_u32 s84, 6
  s_cbranch_scc0 L_nw5
L_wm6:
  v_mfma_f32_16x16x32_bf16 v[32:35], v[16:19], v[20:23], 0
  s_getreg_b32 s78, hwreg(HW_REG_IB_STS)
  v_mfma_f32_16x16x32_bf16 v[32:35], v[20:23], v[18:21], v[32:35]
  s_and_b32 s78, s78, 0xc0000f
  v_mfma_f32_16x16x32_bf16 v[32:35], v[18:21], v[22:25], v[32:35]
  s_cmp_gt_u32 s78, 0x0
  v_mfma_f32_16x16x32_bf16 v[32:35], v[22:25], v[16:19], v[32:35]
  s_cbranch_scc1 L_wm6
L_wm6x:
  s_waitcnt vmcnt(0)
L_nw5:
L_sk3:
  s_add_u32 m0, s33, 3072
  s_add_u32 s24, s23, 3072
  s_getreg_b32 s78, hwreg(HW_REG_IB_STS)
  s_and_b32 s78, s78, 0xc0000f
  s_cmp_gt_u32 s78, 0x9
  s_cbranch_scc0 L_wm7x
L_wm7:
  v_mfma_f32_16x16x32_bf16 v[32:35], v[16:19], v[20:23], 0
  s_getreg_b32 s78, hwreg(HW_REG_IB_STS)
  v_mfma_f32_16x16x32_bf16 v[32:35], v[20:23], v[18:21], v[32:35]
  s_and_b32 s78, s78, 0xc0000f
  v_mfma_f32_16x16x32_bf16 v[32:35], v[18:21], v[22:25], v[32:35]
  s_cmp_gt_u32 s78, 0x9
  v_mfma_f32_16x16x32_bf16 v[32:35], v[22:25], v[16:19], v[32:35]
  s_cbranch_scc1 L_wm7
L_wm7x:
  buffer_load_dwordx4 v242, s[4:7], s24 offen nt lds
  buffer_load_dwordx4 v243, s[4:7], s24 offen offset:1024 nt lds
  buffer_load_dwordx4 v244, s[4:7], s24 offen offset:2048 nt lds
  s_add_u32 m0, s33, 6144
  s_add_u32 s24, s23, 6144
  s_getreg_b32 s78, hwreg(HW_REG_IB_STS)
  s_and_b32 s78, s78, 0xc0000f
  s_cmp_gt_u32 s78, 0x9
  s_cbranch_scc0 L_wm8x
L_wm8:
  v_mfma_f32_16x16x32_bf16 v[32:35], v[16:19], v[20:23], 0
  s_getreg_b32 s78, hwreg(HW_REG_IB_STS)
  v_mfma_f32_16x16x32_bf16 v[32:35], v[20:23], v[18:21], v[32:35]
  s_and_b32 s78, s78, 0xc0000f
  v_mfma_f32_16x16x32_bf16 v[32:35], v[18:21], v[22:25], v[32:35]
  s_cmp_gt_u32 s78, 0x9
  v_mfma_f32_16x16x32_bf16 v[32:35], v[22:25], v[16:19], v[32:35]
  s_cbranch_scc1 L_wm8
L_wm8x:
  buffer_load_dwordx4 v242, s[4:7], s24 offen nt lds
  buffer_load_dwordx4 v243, s[4:7], s24 offen offset:1024 nt lds
  buffer_load_dwordx4 v244, s[4:7], s24 offen offset:2048 nt lds
  s_add_u32 m0, s33, 9216
  s_add_u32 s24, s23, 9216
  s_getreg_b32 s78, hwreg(HW_REG_IB_STS)
  s_and_b32 s78, s78, 0xc0000f
  s_cmp_gt_u32 s78, 0x9
  s_cbranch_scc0 L_wm9x
L_wm9:
  v_mfma_f32_16x16x32_bf16 v[32:35], v[16:19], v[20:23], 0
  s_getreg_b32 s78, hwreg(HW_REG_IB_STS)
  v_mfma_f32_16x16x32_bf16 v[32:35], v[20:23], v[18:21], v[32:35]
  s_and_b32 s78, s78, 0xc0000f
  v_mfma_f32_16x16x32_bf16 v[32:35], v[18:21], v[22:25], v[32:35]
  s_cmp_gt_u32 s78, 0x9
  v_mfma_f32_16x16x32_bf16 v[32:35], v[22:25], v[16:19], v[32:35]
  s_cbranch_scc1 L_wm9
L_wm9x:
  buffer_load_dwordx4 v242, s[4:7], s24 offen nt lds
  buffer_load_dwordx4 v243, s[4:7], s24 offen offset:1024 nt lds
  buffer_load_dwordx4 v244, s[4:7], s24 offen offset:2048 nt lds
  s_getreg_b32 s78, hwreg(HW_REG_IB_STS)
  s_and_b32 s78, s78, 0xc0000f
  s_cmp_gt_u32 s78, 0xc
  s_cbranch_scc0 L_wm10x
L_wm10:
  v_mfma_f32_16x16x32_bf16 v[32:35], v[16:19], v[20:23], 0
  s_getreg_b32 s78, hwreg(HW_REG_IB_STS)
  v_mfma_f32_16x16x32_bf16 v[32:35], v[20:23], v[18:21], v[32:35]
  s_and_b32 s78, s78, 0xc0000f
  v_mfma_f32_16x16x32_bf16 v[32:35], v[18:21], v[22:25], v[32:35]
  s_cmp_gt_u32 s78, 0xc
  v_mfma_f32_16x16x32_bf16 v[32:35], v[22:25], v[16:19], v[32:35]
  s_cbranch_scc1 L_wm10
L_wm10x:
  s_waitcnt vmcnt(12)
  s_barrier
  s_cbranch_vccnz L_sk4
  s_add_u32 m0, s21, 86016
  s_getreg_b32 s78, hwreg(HW_REG_IB_STS)
  s_and_b32 s78, s78, 0xc0000f
  s_cmp_gt_u32 s78, 0x9
  s_cbranch_scc0 L_wm11x
L_wm11:
  v_mfma_f32_16x16x32_bf16 v[32:35], v[16:19], v[20:23], 0
  s_getreg_b32 s78, hwreg(HW_REG_IB_STS)
  v_mfma_f32_16x16x32_bf16 v[32:35], v[20:23], v[18:21], v[32:35]
  s_and_b32 s78, s78, 0xc0000f
  v_mfma_f32_16x16x32_bf16 v[32:35], v[18:21], v[22:25], v[32:35]
  s_cmp_gt_u32 s78, 0x9
  v_mfma_f32_16x16x32_bf16 v[32:35], v[22:25], v[16:19], v[32:35]
  s_cbranch_scc1 L_wm11
L_wm11x:
  s_nop 0
  buffer_load_dwordx4 v242, s[12:15], s20 offen nt lds
  buffer_load_dwordx4 v243, s[12:15], s20 offen offset:1024 nt lds
  buffer_load_dwordx4 v244, s[12:15], s20 offen offset:2048 nt lds
L_sk4:
  ds_read_b128 a[96:99], v236 offset:0
  ds_read_b128 a[100:103], v237 offset:0
  ds_read_b128 a[104:107], v236 offset:128
  ds_read_b128 a[108:111], v237 offset:128
  ds_read_b128 a[112:115], v236 offset:256
  ds_read_b128 a[116:119], v237 offset:256
  ds_read_b128 a[140:143], v237 offset:6400
  ds_read_b128 a[136:139], v236 offset:6400
  ds_read_b128 a[132:135], v237 offset:6272
  ds_read_b128 a[128:131], v236 offset:6272
  ds_read_b128 a[124:127], v237 offset:6144
  ds_read_b128 a[120:123], v236 offset:6144
  ds_read_b128 v[144:147], v236 offset:12288
  ds_read_b128 v[148:151], v237 offset:12288
  ds_read_b128 v[152:155], v236 offset:12416
  ds_read_b128 v[156:159], v237 offset:12416
  ds_read_b128 v[160:163], v236 offset:12544
  ds_read_b128 v[164:167], v237 offset:12544
  ds_read_b128 a[240:243], v237 offset:18688
  ds_read_b128 v[184:187], v236 offset:18688
  ds_read_b128 v[180:183], v237 offset:18560
  ds_read_b128 v[176:179], v236 offset:18560
  ds_read_b128 v[172:175], v237 offset:18432
  ds_read_b128 v[168:171], v236 offset:18432
  ds_read_b64_tr_b16 a[144:145], v238 offset:36864
  ds_read_b64_tr_b16 a[146:147], v238 offset:43008
  ds_read_b64_tr_b16 a[148:149], v239 offset:36864
  ds_read_b64_tr_b16 a[150:151], v239 offset:43008
  ds_read_b64_tr_b16 a[152:153], v240 offset:36864
  ds_read_b64_tr_b16 a[154:155], v240 offset:43008
  ds_read_b64_tr_b16 a[156:157], v241 offset:36864
  ds_read_b64_tr_b16 a[158:159], v241 offset:43008
  ds_read_b64_tr_b16 a[160:161], v238 offset:36992
  ds_read_b64_tr_b16 a[162:163], v238 offset:43136
  ds_read_b64_tr_b16 a[164:165], v239 offset:36992
  ds_read_b64_tr_b16 a[166:167], v239 offset:43136
  ds_read_b64_tr_b16 a[168:169], v240 offset:36992
  ds_read_b64_tr_b16 a[170:171], v240 offset:43136
  ds_read_b64_tr_b16 a[172:173], v241 offset:36992
  ds_read_b64_tr_b16 a[174:175], v241 offset:43136
  ds_read_b64_tr_b16 a[176:177], v238 offset:37120
  ds_read_b64_tr_b16 a[178:179], v238 offset:43264
  ds_read_b64_tr_b16 a[180:181], v239 offset:37120
  ds_read_b64_tr_b16 a[182:183], v239 offset:43264
  ds_read_b64_tr_b16 a[184:185], v240 offset:37120
  ds_read_b64_tr_b16 a[186:187], v240 offset:43264
  ds_read_b64_tr_b16 a[188:189], v241 offset:37120
  ds_read_b64_tr_b16 a[190:191], v241 offset:43264
  s_cbranch_vccz L_sk5
  s_add_u32 m0, s21, 86016
  s_getreg_b32 s78, hwreg(HW_REG_IB_STS)
  s_and_b32 s78, s78, 0xc0000f
  s_cmp_gt_u32 s78, 0x9
  s_cbranch_scc0 L_wm12x
L_wm12:
  v_mfma_f32_16x16x32_bf16 v[32:35], v[16:19], v[20:23], 0
  s_getreg_b32 s78, hwreg(HW_REG_IB_STS)
  v_mfma_f32_16x16x32_bf16 v[32:35], v[20:23], v[18:21], v[32:35]
  s_and_b32 s78, s78, 0xc0000f
  v_mfma_f32_16x16x32_bf16 v[32:35], v[18:21], v[22:25], v[32:35]
  s_cmp_gt_u32 s78, 0x9
  v_mfma_f32_16x16x32_bf16 v[32:35], v[22:25], v[16:19], v[32:35]
  s_cbranch_scc1 L_wm12
L_wm12x:
  s_nop 0
  buffer_load_dwordx4 v242, s[12:15], s20 offen nt lds
  buffer_load_dwordx4 v243, s[12:15], s20 offen offset:1024 nt lds
  buffer_load_dwordx4 v244, s[12:15], s20 offen offset:2048 nt lds
L_sk5:
  s_add_u32 m0, s30, 0
  s_add_u32 s24, s23, 12288
  s_getreg_b32 s78, hwreg(HW_REG_IB_STS)
  s_and_b32 s78, s78, 0xc0000f
  s_cmp_gt_u32 s78, 0x9
  s_cbranch_scc0 L_wm13x
L_wm13:
  v_mfma_f32_16x16x32_bf16 v[32:35], v[16:19], v[20:23], 0
  s_getreg_b32 s78, hwreg(HW_REG_IB_STS)
  v_mfma_f32_16x16x32_bf16 v[32:35], v[20:23], v[18:21], v[32:35]
  s_and_b32 s78, s78, 0xc0000f
  v_mfma_f32_16x16x32_bf16 v[32:35], v[18:21], v[22:25], v[32:35]
  s_cmp_gt_u32 s78, 0x9
  v_mfma_f32_16x16x32_bf16 v[32:35], v[22:25], v[16:19], v[32:35]
  s_cbranch_scc1 L_wm13
L_wm13x:
  buffer_load_dwordx4 v242, s[4:7], s24 offen nt lds
  buffer_load_dwordx4 v243, s[4:7], s24 offen offset:1024 nt lds
  buffer_load_dwordx4 v244, s[4:7], s24 offen offset:2048 nt lds
  s_getreg_b32 s78, hwreg(HW_REG_IB_STS)
  s_and_b32 s78, s78, 0xc0000f
  s_cmp_gt_u32 s78, 0xc
  s_cbranch_scc0 L_wm14x
L_wm14:
  v_mfma_f32_16x16x32_bf16 v[32:35], v[16:19], v[20:23], 0
  s_getreg_b32 s78, hwreg(HW_REG_IB_STS)
  v_mfma_f32_16x16x32_bf16 v[32:35], v[20:23], v[18:21], v[32:35]
  s_and_b32 s78, s78, 0xc0000f
  v_mfma_f32_16x16x32_bf16 v[32:35], v[18:21], v[22:25], v[32:35]
  s_cmp_gt_u32 s78, 0xc
  v_mfma_f32_16x16x32_bf16 v[32:35], v[22:25], v[16:19], v[32:35]
  s_cbranch_scc1 L_wm14
L_wm14x:
  s_waitcnt vmcnt(12)
  ds_read_b128 a[0:3], v10 offset:0
  ds_read_b128 a[4:7], v11 offset:0
  ds_read_b128 a[8:11], v10 offset:128
  ds_read_b128 a[12:15], v11 offset:128
  ds_read_b128 a[16:19], v10 offset:256
  ds_read_b128 a[20:23], v11 offset:256
  s_waitcnt lgkmcnt(5)
  v_mfma_f32_16x16x32_bf16 v[192:195], a[96:99], a[0:3], v[232:235]
  s_waitcnt lgkmcnt(4)
  v_mfma_f32_16x16x32_bf16 v[192:195], a[100:103], a[4:7], v[192:195]
  s_waitcnt lgkmcnt(3)
  v_mfma_f32_16x16x32_bf16 v[192:195], a[104:107], a[8:11], v[192:195]
  s_waitcnt lgkmcnt(2)
  v_accvgpr_read_b32 v188, a144
  v_accvgpr_read_b32 v189, a145
  v_mfma_f32_16x16x32_bf16 v[192:195], a[108:111], a[12:15], v[192:195]
  s_waitcnt lgkmcnt(1)
  v_accvgpr_read_b32 v190, a146
  v_accvgpr_read_b32 v191, a147
  v_mfma_f32_16x16x32_bf16 v[192:195], a[112:115], a[16:19], v[192:195]
  s_waitcnt lgkmcnt(0)
  v_max3_f32 v188, |v188|, |v189|, |v190|
  v_accvgpr_read_b32 v189, a148
  v_mfma_f32_16x16x32_bf16 v[192:195], a[116:119], a[20:23], v[192:195]
  v_max3_f32 v188, v188, |v189|, |v191|
  v_ldexp_f32 v189, v188, 4
  v_mfma_f32_16x16x32_bf16 v[196:199], a[140:143], a[20:23], v[232:235]
  v_ldexp_f32 v190, v188, -9
  v_readfirstlane_b32 s3, v189
  v_mfma_f32_16x16x32_bf16 v[196:199], a[136:139], a[16:19], v[196:199]
  v_readfirstlane_b32 s85, v190
  v_mov_b32 v188, s3
  v_mfma_f32_16x16x32_bf16 v[196:199], a[132:135], a[12:15], v[196:199]
  v_mov_b32 v189, s3
  v_mov_b32 v190, s3
  v_mfma_f32_16x16x32_bf16 v[196:199], a[128:131], a[8:11], v[196:199]
  v_mov_b32 v191, s3
  v_mfma_f32_16x16x32_bf16 v[196:199], a[124:127], a[4:7], v[196:199]
  v_mfma_f32_16x16x32_bf16 v[196:199], a[120:123], a[0:3], v[196:199]
  v_mfma_f32_16x16x32_bf16 v[200:203], v[168:171], a[0:3], v[232:235]
  v_mfma_f32_16x16x32_bf16 v[200:203], v[172:175], a[4:7], v[200:203]
  v_mfma_f32_16x16x32_bf16 v[200:203], v[176:179], a[8:11], v[200:203]
  v_mfma_f32_16x16x32_bf16 v[200:203], v[180:183], a[12:15], v[200:203]
  v_max3_f32 v228, v192, v193, v194
  s_nop 2
  v_max3_f32 v224, v195, v196, v197
  v_mfma_f32_16x16x32_bf16 v[200:203], v[184:187], a[16:19], v[200:203]
  v_max3_f32 v228, v228, v198, v199
  v_max_f32 v228, v228, v224
  v_mfma_f32_16x16x32_bf16 v[200:203], a[240:243], a[20:23], v[200:203]
  v_mov_b32 v224, v228
  v_mfma_f32_16x16x32_bf16 v[204:207], v[164:167], a[20:23], v[232:235]
  s_nop 0
  v_permlane16_swap_b32 v228, v224
  v_mfma_f32_16x16x32_bf16 v[204:207], v[160:163], a[16:19], v[204:207]
  v_max_f32 v228, v228, v224
  v_mov_b32 v224, v228
  v_mfma_f32_16x16x32_bf16 v[204:207], v[156:159], a[12:15], v[204:207]
  s_nop 0
  v_permlane32_swap_b32 v228, v224
  v_mfma_f32_16x16x32_bf16 v[204:207], v[152:155], a[8:11], v[204:207]
  v_max_f32 v228, v228, v224
  v_mul_f32_e64 v228, v228, -s22
  v_mfma_f32_16x16x32_bf16 v[204:207], v[148:151], a[4:7], v[204:207]
  v_fma_f32 v192, v192, s22, v228
  v_fma_f32 v193, v193, s22, v228
  v_mfma_f32_16x16x32_bf16 v[204:207], v[144:147], a[0:3], v[204:207]
  s_add_u32 m0, s30, 3072
  s_add_u32 s24, s23, 15360
  buffer_load_dwordx4 v242, s[4:7], s24 offen nt lds
  buffer_load_dwordx4 v243, s[4:7], s24 offen offset:1024 nt lds
  buffer_load_dwordx4 v244, s[4:7], s24 offen offset:2048 nt lds
  v_fma_f32 v194, v194, s22, v228
  v_fma_f32 v195, v195, s22, v228
  v_exp_f32 v192, v192
  v_exp_f32 v193, v193
  v_exp_f32 v194, v194
  v_exp_f32 v195, v195
  v_fma_f32 v196, v196, s22, v228
  v_fma_f32 v197, v197, s22, v228
  v_fma_f32 v198, v198, s22, v228
  v_fma_f32 v199, v199, s22, v228
  v_exp_f32 v196, v196
  v_exp_f32 v197, v197
  v_exp_f32 v198, v198
  v_exp_f32 v199, v199
  v_mov_b32 v224, v192
  v_add_f32 v224, v224, v193
  v_add_f32 v224, v224, v194
  v_add_f32 v224, v224, v195
  v_cvt_pk_bf16_f32 v192, v192, v193
  v_cvt_pk_bf16_f32 v193, v194, v195
  v_fma_f32 v200, v200, s22, v228
  v_fma_f32 v201, v201, s22, v228
  v_fma_f32 v202, v202, s22, v228
  v_fma_f32 v203, v203, s22, v228
  v_exp_f32 v200, v200
  v_exp_f32 v201, v201
  v_exp_f32 v202, v202
  v_exp_f32 v203, v203
  v_add_f32 v224, v224, v196
  v_add_f32 v224, v224, v197
  v_add_f32 v224, v224, v198
  v_add_f32 v224, v224, v199
  s_add_u32 m0, s30, 6144
  s_add_u32 s24, s23, 18432
  buffer_load_dwordx4 v242, s[4:7], s24 offen nt lds
  buffer_load_dwordx4 v243, s[4:7], s24 offen offset:1024 nt lds
  buffer_load_dwordx4 v244, s[4:7], s24 offen offset:2048 nt lds
  s_getreg_b32 s78, hwreg(HW_REG_IB_STS)
  s_and_b32 s78, s78, 0xc0000f
  s_cmp_gt_u32 s78, 0xc
  s_cbranch_scc0 L_wm15x
L_wm15:
  v_mfma_f32_16x16x32_bf16 v[32:35], v[16:19], v[20:23], 0
  s_getreg_b32 s78, hwreg(HW_REG_IB_STS)
  v_mfma_f32_16x16x32_bf16 v[32:35], v[20:23], v[18:21], v[32:35]
  s_and_b32 s78, s78, 0xc0000f
  v_mfma_f32_16x16x32_bf16 v[32:35], v[18:21], v[22:25], v[32:35]
  s_cmp_gt_u32 s78, 0xc
  v_mfma_f32_16x16x32_bf16 v[32:35], v[22:25], v[16:19], v[32:35]
  s_cbranch_scc1 L_wm15
L_wm15x:
  s_waitcnt vmcnt(12)
  ds_read_b128 a[24:27], v10 offset:6144
  ds_read_b128 a[28:31], v11 offset:6144
  ds_read_b128 a[32:35], v10 offset:6272
  ds_read_b128 a[36:39], v11 offset:6272
  ds_read_b128 a[40:43], v10 offset:6400
  ds_read_b128 a[44:47], v11 offset:6400
  s_waitcnt lgkmcnt(5)
  v_mfma_f32_16x16x32_bf16 v[208:211], a[96:99], a[24:27], v[232:235]
  s_waitcnt lgkmcnt(4)
  v_cvt_pk_bf16_f32 v194, v196, v197
  v_cvt_pk_bf16_f32 v195, v198, v199
  v_mfma_f32_16x16x32_bf16 v[208:211], a[100:103], a[28:31], v[208:211]
  s_waitcnt lgkmcnt(3)
  v_fma_f32 v204, v204, s22, v228
  v_fma_f32 v205, v205, s22, v228
  v_mfma_f32_16x16x32_bf16 v[208:211], a[104:107], a[32:35], v[208:211]
  s_waitcnt lgkmcnt(2)
  v_fma_f32 v206, v206, s22, v228
  v_fma_f32 v207, v207, s22, v228
  v_mfma_f32_16x16x32_bf16 v[208:211], a[108:111], a[36:39], v[208:211]
  s_waitcnt lgkmcnt(1)
  v_exp_f32 v204, v204
  v_mfma_f32_16x16x32_bf16 v[208:211], a[112:115], a[40:43], v[208:211]
  s_waitcnt lgkmcnt(0)
  v_exp_f32 v205, v205
  v_mfma_f32_16x16x32_bf16 v[208:211], a[116:119], a[44:47], v[208:211]
  v_exp_f32 v206, v206
  v_mfma_f32_16x16x32_bf16 v[212:215], a[140:143], a[44:47], v[232:235]
  v_exp_f32 v207, v207
  v_mfma_f32_16x16x32_bf16 v[212:215], a[136:139], a[40:43], v[212:215]
  v_add_f32 v224, v224, v200
  v_add_f32 v224, v224, v201
  v_mfma_f32_16x16x32_bf16 v[212:215], a[132:135], a[36:39], v[212:215]
  v_add_f32 v224, v224, v202
  v_add_f32 v224, v224, v203
  v_mfma_f32_16x16x32_bf16 v[212:215], a[128:131], a[32:35], v[212:215]
  v_cvt_pk_bf16_f32 v203, v202, v203
  v_cvt_pk_bf16_f32 v202, v200, v201
  v_mfma_f32_16x16x32_bf16 v[212:215], a[124:127], a[28:31], v[212:215]
  v_add_f32 v224, v224, v204
  v_add_f32 v224, v224, v205
  v_mfma_f32_16x16x32_bf16 v[212:215], a[120:123], a[24:27], v[212:215]
  s_waitcnt vmcnt(9) lgkmcnt(0)
  v_add_f32 v224, v224, v206
  v_add_f32 v224, v224, v207
  v_mfma_f32_16x16x32_bf16 v[216:219], v[168:171], a[24:27], v[232:235]
  s_barrier
  v_cvt_pk_bf16_f32 v200, v204, v205
  v_cvt_pk_bf16_f32 v201, v206, v207
  v_mfma_f32_16x16x32_bf16 v[216:219], v[172:175], a[28:31], v[216:219]
  s_add_u32 m0, s30, 9216
  s_add_u32 s24, s23, 21504
  ds_read_b64_tr_b16 a[192:193], v238 offset:24576
  ds_read_b64_tr_b16 a[194:195], v238 offset:30720
  v_mfma_f32_16x16x32_bf16 v[216:219], v[176:179], a[32:35], v[216:219]
  buffer_load_dwordx4 v242, s[4:7], s24 offen nt lds
  v_mfma_f32_16x16x32_bf16 v[216:219], v[180:183], a[36:39], v[216:219]
  ds_read_b64_tr_b16 a[196:197], v239 offset:24576
  v_max3_f32 v229, v208, v209, v210
  v_mfma_f32_16x16x32_bf16 v[216:219], v[184:187], a[40:43], v[216:219]
  buffer_load_dwordx4 v243, s[4:7], s24 offen offset:1024 nt lds
  v_mfma_f32_16x16x32_bf16 v[216:219], a[240:243], a[44:47], v[216:219]
  ds_read_b64_tr_b16 a[198:199], v239 offset:30720
  ds_read_b64_tr_b16 a[200:201], v240 offset:24576
  v_mfma_f32_16x16x32_bf16 v[220:223], v[164:167], a[44:47], v[232:235]
  buffer_load_dwordx4 v244, s[4:7], s24 offen offset:2048 nt lds
  v_mfma_f32_16x16x32_bf16 v[220:223], v[160:163], a[40:43], v[220:223]
  ds_read_b64_tr_b16 a[202:203], v240 offset:30720
  v_max3_f32 v225, v211, v212, v213
  v_mfma_f32_16x16x32_bf16 v[220:223], v[156:159], a[36:39], v[220:223]
  ds_read_b64_tr_b16 a[204:205], v241 offset:24576
  ds_read_b64_tr_b16 a[206:207], v241 offset:30720
  v_mfma_f32_16x16x32_bf16 v[220:223], v[152:155], a[32:35], v[220:223]
  ds_read_b64_tr_b16 a[208:209], v238 offset:24704
  v_max3_f32 v229, v229, v214, v215
  v_mfma_f32_16x16x32_bf16 v[220:223], v[148:151], a[28:31], v[220:223]
  ds_read_b64_tr_b16 a[210:211], v238 offset:30848
  ds_read_b64_tr_b16 a[212:213], v239 offset:24704
  v_mfma_f32_16x16x32_bf16 v[220:223], v[144:147], a[24:27], v[220:223]
  ds_read_b64_tr_b16 a[214:215], v239 offset:30848
  v_max_f32 v229, v229, v225
  v_mfma_f32_16x16x32_bf16 v[0:3], a[144:147], v[192:195], v[188:191]
  s_add_u32 s20, s20, 12288
  ds_read_b64_tr_b16 a[216:217], v240 offset:24704
  ds_read_b64_tr_b16 a[218:219], v240 offset:30848
  v_mfma_f32_16x16x32_bf16 v[4:7], a[148:151], v[192:195], v[188:191]
  s_add_u32 m0, s21, 24576
  ds_read_b64_tr_b16 a[220:221], v241 offset:24704
  v_mov_b32 v225, v229
  v_mfma_f32_16x16x32_bf16 v[8:11], a[152:155], v[192:195], v[188:191]
  buffer_load_dwordx4 v242, s[8:11], s20 offen nt lds
  v_mfma_f32_16x16x32_bf16 v[12:15], a[156:159], v[192:195], v[188:191]
  ds_read_b64_tr_b16 a[222:223], v241 offset:30848
  ds_read_b64_tr_b16 a[224:225], v238 offset:24832
  v_mfma_f32_16x16x32_bf16 v[16:19], a[160:163], v[192:195], v[188:191]
  buffer_load_dwordx4 v243, s[8:11], s20 offen offset:1024 nt lds
  v_mfma_f32_16x16x32_bf16 v[20:23], a[164:167], v[192:195], v[188:191]
  ds_read_b64_tr_b16 a[226:227], v238 offset:30976
  v_mfma_f32_16x16x32_bf16 v[24:27], a[168:171], v[192:195], v[188:191]
  buffer_load_dwordx4 v244, s[8:11], s20 offen offset:2048 nt lds
  v_mfma_f32_16x16x32_bf16 v[28:31], a[172:175], v[192:195], v[188:191]
  ds_read_b64_tr_b16 a[228:229], v239 offset:24832
  ds_read_b64_tr_b16 a[230:231], v239 offset:30976
  v_mfma_f32_16x16x32_bf16 v[32:35], a[176:179], v[192:195], v[188:191]
  ds_read_b64_tr_b16 a[232:233], v240 offset:24832
  v_mfma_f32_16x16x32_bf16 v[36:39], a[180:183], v[192:195], v[188:191]
  ds_read_b64_tr_b16 a[234:235], v240 offset:30976
  ds_read_b64_tr_b16 a[236:237], v241 offset:24832
  v_mfma_f32_16x16x32_bf16 v[40:43], a[184:187], v[192:195], v[188:191]
  ds_read_b64_tr_b16 a[238:239], v241 offset:30976
  v_mfma_f32_16x16x32_bf16 v[44:47], a[188:191], v[192:195], v[188:191]
  s_waitcnt lgkmcnt(9)
  v_permlane16_swap_b32 v229, v225
  v_mfma_f32_16x16x32_bf16 v[0:3], a[192:195], v[200:203], v[0:3]
  v_max_f32 v229, v229, v225
  v_mov_b32 v225, v229
  v_mfma_f32_16x16x32_bf16 v[4:7], a[196:199], v[200:203], v[4:7]
  s_nop 0
  v_permlane32_swap_b32 v229, v225
  v_mfma_f32_16x16x32_bf16 v[8:11], a[200:203], v[200:203], v[8:11]
  v_max_f32 v229, v229, v225
  v_mul_f32_e64 v229, v229, -s22
  v_mfma_f32_16x16x32_bf16 v[12:15], a[204:207], v[200:203], v[12:15]
  v_fma_f32 v208, v208, s22, v229
  v_fma_f32 v209, v209, s22, v229
  v_fma_f32 v210, v210, s22, v229
  v_fma_f32 v211, v211, s22, v229
  v_exp_f32 v208, v208
  v_exp_f32 v209, v209
  v_exp_f32 v210, v210
  v_exp_f32 v211, v211
  v_fma_f32 v212, v212, s22, v229
  v_fma_f32 v213, v213, s22, v229
  v_fma_f32 v214, v214, s22, v229
  v_fma_f32 v215, v215, s22, v229
  v_exp_f32 v212, v212
  v_exp_f32 v213, v213
  v_exp_f32 v214, v214
  v_exp_f32 v215, v215
  v_mov_b32 v225, v208
  v_add_f32 v225, v225, v209
  v_add_f32 v225, v225, v210
  v_add_f32 v225, v225, v211
  v_cvt_pk_bf16_f32 v208, v208, v209
  v_cvt_pk_bf16_f32 v209, v210, v211
  v_fma_f32 v216, v216, s22, v229
  v_fma_f32 v217, v217, s22, v229
  v_fma_f32 v218, v218, s22, v229
  v_fma_f32 v219, v219, s22, v229
  v_mfma_f32_16x16x32_bf16 v[16:19], a[208:211], v[200:203], v[16:19]
  s_waitcnt vmcnt(9)
  ds_read_b128 a[48:51], v248 offset:0
  ds_read_b128 a[52:55], v249 offset:0
  v_mfma_f32_16x16x32_bf16 v[20:23], a[212:215], v[200:203], v[20:23]
  ds_read_b128 a[56:59], v248 offset:128
  ds_read_b128 a[60:63], v249 offset:128
  v_mfma_f32_16x16x32_bf16 v[24:27], a[216:219], v[200:203], v[24:27]
  s_waitcnt lgkmcnt(4)
  ds_read_b128 a[64:67], v248 offset:256
  ds_read_b128 a[68:71], v249 offset:256
  v_mfma_f32_16x16x32_bf16 v[28:31], a[220:223], v[200:203], v[28:31]
  v_exp_f32 v216, v216
  v_mfma_f32_16x16x32_bf16 v[32:35], a[224:227], v[200:203], v[32:35]
  v_exp_f32 v217, v217
  v_mfma_f32_16x16x32_bf16 v[36:39], a[228:231], v[200:203], v[36:39]
  v_exp_f32 v218, v218
  v_mfma_f32_16x16x32_bf16 v[40:43], a[232:235], v[200:203], v[40:43]
  v_exp_f32 v219, v219
  v_mfma_f32_16x16x32_bf16 v[44:47], a[236:239], v[200:203], v[44:47]
  s_waitcnt lgkmcnt(5)
  v_add_f32 v225, v225, v212
  v_add_f32 v225, v225, v213
  v_mfma_f32_16x16x32_bf16 v[192:195], a[96:99], a[48:51], v[232:235]
  s_waitcnt lgkmcnt(4)
  v_add_f32 v225, v225, v214
  v_add_f32 v225, v225, v215
  v_mfma_f32_16x16x32_bf16 v[192:195], a[100:103], a[52:55], v[192:195]
  s_waitcnt lgkmcnt(2)
  v_cvt_pk_bf16_f32 v210, v212, v213
  v_cvt_pk_bf16_f32 v211, v214, v215
  v_mfma_f32_16x16x32_bf16 v[192:195], a[104:107], a[56:59], v[192:195]
  v_fma_f32 v220, v220, s22, v229
  v_fma_f32 v221, v221, s22, v229
  v_mfma_f32_16x16x32_bf16 v[192:195], a[108:111], a[60:63], v[192:195]
  s_waitcnt lgkmcnt(0)
  v_fma_f32 v222, v222, s22, v229
  v_fma_f32 v223, v223, s22, v229
  v_mfma_f32_16x16x32_bf16 v[192:195], a[112:115], a[64:67], v[192:195]
  v_exp_f32 v220, v220
  v_mfma_f32_16x16x32_bf16 v[192:195], a[116:119], a[68:71], v[192:195]
  v_exp_f32 v221, v221
  v_mfma_f32_16x16x32_bf16 v[196:199], a[140:143], a[68:71], v[232:235]
  v_exp_f32 v222, v222
  v_mfma_f32_16x16x32_bf16 v[196:199], a[136:139], a[64:67], v[196:199]
  v_exp_f32 v223, v223
  v_mfma_f32_16x16x32_bf16 v[196:199], a[132:135], a[60:63], v[196:199]
  v_add_f32 v225, v225, v216
  v_add_f32 v225, v225, v217
  v_mfma_f32_16x16x32_bf16 v[196:199], a[128:131], a[56:59], v[196:199]
  v_add_f32 v225, v225, v218
  v_add_f32 v225, v225, v219
  v_mfma_f32_16x16x32_bf16 v[196:199], a[124:127], a[52:55], v[196:199]
  v_cvt_pk_bf16_f32 v219, v218, v219
  v_cvt_pk_bf16_f32 v218, v216, v217
  v_mfma_f32_16x16x32_bf16 v[196:199], a[120:123], a[48:51], v[196:199]
  v_add_f32 v225, v225, v220
  v_add_f32 v225, v225, v221
  v_mfma_f32_16x16x32_bf16 v[200:203], v[168:171], a[48:51], v[232:235]
  v_add_f32 v225, v225, v222
  v_add_f32 v225, v225, v223
  v_mfma_f32_16x16x32_bf16 v[200:203], v[172:175], a[52:55], v[200:203]
  s_add_u32 m0, s21, 73728
  v_cvt_pk_bf16_f32 v216, v220, v221
  v_cvt_pk_bf16_f32 v217, v222, v223
  v_mfma_f32_16x16x32_bf16 v[200:203], v[176:179], a[56:59], v[200:203]
  buffer_load_dwordx4 v242, s[12:15], s20 offen nt lds
  v_mfma_f32_16x16x32_bf16 v[200:203], v[180:183], a[60:63], v[200:203]
  v_max3_f32 v230, v192, v193, v194
  v_max3_f32 v226, v195, v196, v197
  v_mfma_f32_16x16x32_bf16 v[200:203], v[184:187], a[64:67], v[200:203]
  buffer_load_dwordx4 v243, s[12:15], s20 offen offset:1024 nt lds
  v_mfma_f32_16x16x32_bf16 v[200:203], a[240:243], a[68:71], v[200:203]
  v_max3_f32 v230, v230, v198, v199
  v_max_f32 v230, v230, v226
  v_mfma_f32_16x16x32_bf16 v[204:207], v[164:167], a[68:71], v[232:235]
  buffer_load_dwordx4 v244, s[12:15], s20 offen offset:2048 nt lds
  v_mfma_f32_16x16x32_bf16 v[204:207], v[160:163], a[64:67], v[204:207]
  v_mov_b32 v226, v230
  v_mfma_f32_16x16x32_bf16 v[204:207], v[156:159], a[60:63], v[204:207]
  s_nop 0
  v_permlane16_swap_b32 v230, v226
  v_mfma_f32_16x16x32_bf16 v[204:207], v[152:155], a[56:59], v[204:207]
  v_max_f32 v230, v230, v226
  v_mov_b32 v226, v230
  v_mfma_f32_16x16x32_bf16 v[204:207], v[148:151], a[52:55], v[204:207]
  s_nop 0
  v_permlane32_swap_b32 v230, v226
  v_mfma_f32_16x16x32_bf16 v[204:207], v[144:147], a[48:51], v[204:207]
  v_max_f32 v230, v230, v226
  v_mul_f32_e64 v230, v230, -s22
  v_mfma_f32_16x16x32_bf16 v[48:51], a[144:147], v[208:211], v[188:191]
  v_fma_f32 v192, v192, s22, v230
  v_fma_f32 v193, v193, s22, v230
  v_mfma_f32_16x16x32_bf16 v[52:55], a[148:151], v[208:211], v[188:191]
  v_fma_f32 v194, v194, s22, v230
  v_fma_f32 v195, v195, s22, v230
  v_mfma_f32_16x16x32_bf16 v[56:59], a[152:155], v[208:211], v[188:191]
  v_exp_f32 v192, v192
  v_mfma_f32_16x16x32_bf16 v[60:63], a[156:159], v[208:211], v[188:191]
  v_exp_f32 v193, v193
  v_mfma_f32_16x16x32_bf16 v[64:67], a[160:163], v[208:211], v[188:191]
  v_exp_f32 v194, v194
  v_mfma_f32_16x16x32_bf16 v[68:71], a[164:167], v[208:211], v[188:191]
L_pg1:
  s_cbranch_execz L_pg5
  v_exp_f32 v195, v195
  v_mfma_f32_16x16x32_bf16 v[72:75], a[168:171], v[208:211], v[188:191]
  v_fma_f32 v196, v196, s22, v230
  v_fma_f32 v197, v197, s22, v230
  v_mfma_f32_16x16x32_bf16 v[76:79], a[172:175], v[208:211], v[188:191]
  v_fma_f32 v198, v198, s22, v230
  v_fma_f32 v199, v199, s22, v230
  v_mfma_f32_16x16x32_bf16 v[80:83], a[176:179], v[208:211], v[188:191]
  v_exp_f32 v196, v196
  v_mfma_f32_16x16x32_bf16 v[84:87], a[180:183], v[208:211], v[188:191]
  v_exp_f32 v197, v197
  v_mfma_f32_16x16x32_bf16 v[88:91], a[184:187], v[208:211], v[188:191]
  v_exp_f32 v198, v198
  v_mfma_f32_16x16x32_bf16 v[92:95], a[188:191], v[208:211], v[188:191]
  v_exp_f32 v199, v199
  v_mfma_f32_16x16x32_bf16 v[48:51], a[192:195], v[216:219], v[48:51]
  v_mov_b32 v226, v192
  v_add_f32 v226, v226, v193
  v_mfma_f32_16x16x32_bf16 v[52:55], a[196:199], v[216:219], v[52:55]
  v_add_f32 v226, v226, v194
  v_add_f32 v226, v226, v195
  v_mfma_f32_16x16x32_bf16 v[56:59], a[200:203], v[216:219], v[56:59]
  v_cvt_pk_bf16_f32 v192, v192, v193
  v_cvt_pk_bf16_f32 v193, v194, v195
  v_mfma_f32_16x16x32_bf16 v[60:63], a[204:207], v[216:219], v[60:63]
  v_fma_f32 v200, v200, s22, v230
  v_fma_f32 v201, v201, s22, v230
  v_fma_f32 v202, v202, s22, v230
  v_fma_f32 v203, v203, s22, v230
  v_exp_f32 v200, v200
  v_exp_f32 v201, v201
  v_mfma_f32_16x16x32_bf16 v[64:67], a[208:211], v[216:219], v[64:67]
  s_waitcnt vmcnt(6)
  ds_read_b128 a[72:75], v248 offset:6144
  ds_read_b128 a[76:79], v249 offset:6144
  v_mfma_f32_16x16x32_bf16 v[68:71], a[212:215], v[216:219], v[68:71]
  ds_read_b128 a[80:83], v248 offset:6272
  ds_read_b128 a[84:87], v249 offset:6272
  v_mfma_f32_16x16x32_bf16 v[72:75], a[216:219], v[216:219], v[72:75]
  ds_read_b128 a[88:91], v248 offset:6400
  ds_read_b128 a[92:95], v249 offset:6400
  v_mfma_f32_16x16x32_bf16 v[76:79], a[220:223], v[216:219], v[76:79]
  v_exp_f32 v202, v202
  v_mfma_f32_16x16x32_bf16 v[80:83], a[224:227], v[216:219], v[80:83]
  v_exp_f32 v203, v203
  v_mfma_f32_16x16x32_bf16 v[84:87], a[228:231], v[216:219], v[84:87]
  v_add_f32 v226, v226, v196
  v_add_f32 v226, v226, v197
  v_mfma_f32_16x16x32_bf16 v[88:91], a[232:235], v[216:219], v[88:91]
  v_add_f32 v226, v226, v198
  v_add_f32 v226, v226, v199
  v_mfma_f32_16x16x32_bf16 v[92:95], a[236:239], v[216:219], v[92:95]
  s_waitcnt lgkmcnt(5)
  v_cvt_pk_bf16_f32 v194, v196, v197
  v_cvt_pk_bf16_f32 v195, v198, v199
  v_mfma_f32_16x16x32_bf16 v[208:211], a[96:99], a[72:75], v[232:235]
  s_waitcnt lgkmcnt(3)
  v_fma_f32 v204, v204, s22, v230
  v_fma_f32 v205, v205, s22, v230
  v_mfma_f32_16x16x32_bf16 v[208:211], a[100:103], a[76:79], v[208:211]
  v_fma_f32 v206, v206, s22, v230
  v_fma_f32 v207, v207, s22, v230
  v_mfma_f32_16x16x32_bf16 v[208:211], a[104:107], a[80:83], v[208:211]
  s_waitcnt lgkmcnt(0)
  v_exp_f32 v204, v204
  v_mfma_f32_16x16x32_bf16 v[208:211], a[108:111], a[84:87], v[208:211]
  v_exp_f32 v205, v205
  v_mfma_f32_16x16x32_bf16 v[208:211], a[112:115], a[88:91], v[208:211]
  s_add_u32 s20, s20, 12288
  v_exp_f32 v206, v206
  v_mfma_f32_16x16x32_bf16 v[208:211], a[116:119], a[92:95], v[208:211]
  s_add_u32 m0, s21, 36864
  v_exp_f32 v207, v207
  v_mfma_f32_16x16x32_bf16 v[212:215], a[140:143], a[92:95], v[232:235]
  buffer_load_dwordx4 v242, s[8:11], s20 offen nt lds
  v_mfma_f32_16x16x32_bf16 v[212:215], a[136:139], a[88:91], v[212:215]
  v_add_f32 v226, v226, v200
  v_add_f32 v226, v226, v201
  v_mfma_f32_16x16x32_bf16 v[212:215], a[132:135], a[84:87], v[212:215]
  buffer_load_dwordx4 v243, s[8:11], s20 offen offset:1024 nt lds
  v_mfma_f32_16x16x32_bf16 v[212:215], a[128:131], a[80:83], v[212:215]
  v_add_f32 v226, v226, v202
  v_add_f32 v226, v226, v203
  v_mfma_f32_16x16x32_bf16 v[212:215], a[124:127], a[76:79], v[212:215]
  buffer_load_dwordx4 v244, s[8:11], s20 offen offset:2048 nt lds
  v_mfma_f32_16x16x32_bf16 v[212:215], a[120:123], a[72:75], v[212:215]
  v_cvt_pk_bf16_f32 v203, v202, v203
  v_cvt_pk_bf16_f32 v202, v200, v201
  v_mfma_f32_16x16x32_bf16 v[216:219], v[168:171], a[72:75], v[232:235]
  v_add_f32 v226, v226, v204
  v_add_f32 v226, v226, v205
  v_mfma_f32_16x16x32_bf16 v[216:219], v[172:175], a[76:79], v[216:219]
  v_add_f32 v226, v226, v206
  v_add_f32 v226, v226, v207
  v_mfma_f32_16x16x32_bf16 v[216:219], v[176:179], a[80:83], v[216:219]
  v_cvt_pk_bf16_f32 v200, v204, v205
  v_cvt_pk_bf16_f32 v201, v206, v207
  v_mfma_f32_16x16x32_bf16 v[216:219], v[180:183], a[84:87], v[216:219]
  v_max3_f32 v231, v208, v209, v210
  v_max3_f32 v227, v211, v212, v213
  v_max3_f32 v231, v231, v214, v215
  v_mfma_f32_16x16x32_bf16 v[216:219], v[184:187], a[88:91], v[216:219]
  v_max_f32 v231, v231, v227
  v_mov_b32 v227, v231
  v_mfma_f32_16x16x32_bf16 v[216:219], a[240:243], a[92:95], v[216:219]
  s_nop 0
  v_permlane16_swap_b32 v231, v227
  v_max_f32 v231, v231, v227
  v_mfma_f32_16x16x32_bf16 v[220:223], v[164:167], a[92:95], v[232:235]
  v_mov_b32 v227, v231
  v_mfma_f32_16x16x32_bf16 v[220:223], v[160:163], a[88:91], v[220:223]
  s_nop 0
  v_permlane32_swap_b32 v231, v227
  v_max_f32 v231, v231, v227
  v_mfma_f32_16x16x32_bf16 v[220:223], v[156:159], a[84:87], v[220:223]
  v_mul_f32_e64 v231, v231, -s22
  v_fma_f32 v208, v208, s22, v231
  v_fma_f32 v209, v209, s22, v231
  v_mfma_f32_16x16x32_bf16 v[220:223], v[152:155], a[80:83], v[220:223]
  s_waitcnt vmcnt(6)
  v_fma_f32 v210, v210, s22, v231
  v_fma_f32 v211, v211, s22, v231
  v_mfma_f32_16x16x32_bf16 v[220:223], v[148:151], a[76:79], v[220:223]
  s_barrier
  v_exp_f32 v208, v208
  v_mfma_f32_16x16x32_bf16 v[220:223], v[144:147], a[72:75], v[220:223]
  v_exp_f32 v209, v209
  v_mfma_f32_16x16x32_bf16 v[96:99], a[144:147], v[192:195], v[188:191]
  ds_read_b128 a[96:99], v236 offset:24576
  v_exp_f32 v210, v210
  v_mfma_f32_16x16x32_bf16 v[100:103], a[148:151], v[192:195], v[188:191]
  v_exp_f32 v211, v211
  v_fma_f32 v212, v212, s22, v231
  v_mfma_f32_16x16x32_bf16 v[104:107], a[152:155], v[192:195], v[188:191]
  ds_read_b128 a[100:103], v237 offset:24576
  v_fma_f32 v213, v213, s22, v231
  v_fma_f32 v214, v214, s22, v231
  v_mfma_f32_16x16x32_bf16 v[108:111], a[156:159], v[192:195], v[188:191]
  v_fma_f32 v215, v215, s22, v231
  v_exp_f32 v212, v212
  v_mfma_f32_16x16x32_bf16 v[112:115], a[160:163], v[192:195], v[188:191]
  ds_read_b128 a[104:107], v236 offset:24704
  v_exp_f32 v213, v213
  v_mfma_f32_16x16x32_bf16 v[116:119], a[164:167], v[192:195], v[188:191]
  v_exp_f32 v214, v214
  v_mfma_f32_16x16x32_bf16 v[120:123], a[168:171], v[192:195], v[188:191]
  ds_read_b128 a[108:111], v237 offset:24704
  v_exp_f32 v215, v215
  v_mfma_f32_16x16x32_bf16 v[124:127], a[172:175], v[192:195], v[188:191]
  v_mov_b32 v227, v208
  v_add_f32 v227, v227, v209
  v_add_f32 v227, v227, v210
  v_mfma_f32_16x16x32_bf16 v[128:131], a[176:179], v[192:195], v[188:191]
  ds_read_b128 a[112:115], v236 offset:24832
  v_add_f32 v227, v227, v211
  v_fma_f32 v216, v216, s22, v231
  v_mfma_f32_16x16x32_bf16 v[132:135], a[180:183], v[192:195], v[188:191]
  v_fma_f32 v217, v217, s22, v231
  v_fma_f32 v218, v218, s22, v231
  v_fma_f32 v219, v219, s22, v231
  v_mfma_f32_16x16x32_bf16 v[136:139], a[184:187], v[192:195], v[188:191]
  ds_read_b128 a[116:119], v237 offset:24832
  v_exp_f32 v216, v216
  v_mfma_f32_16x16x32_bf16 v[140:143], a[188:191], v[192:195], v[188:191]
  v_exp_f32 v217, v217
  v_mfma_f32_16x16x32_bf16 v[96:99], a[192:195], v[200:203], v[96:99]
  ds_read_b128 a[140:143], v237 offset:30976
  v_exp_f32 v218, v218
  v_mfma_f32_16x16x32_bf16 v[100:103], a[196:199], v[200:203], v[100:103]
  v_exp_f32 v219, v219
  v_add_f32 v227, v227, v212
  v_mfma_f32_16x16x32_bf16 v[104:107], a[200:203], v[200:203], v[104:107]
  ds_read_b128 a[136:139], v236 offset:30976
  v_add_f32 v227, v227, v213
  v_add_f32 v227, v227, v214
  v_mfma_f32_16x16x32_bf16 v[108:111], a[204:207], v[200:203], v[108:111]
  v_add_f32 v227, v227, v215
  v_fma_f32 v220, v220, s22, v231
  v_fma_f32 v221, v221, s22, v231
  v_mfma_f32_16x16x32_bf16 v[112:115], a[208:211], v[200:203], v[112:115]
  ds_read_b128 a[132:135], v237 offset:30848
  v_fma_f32 v222, v222, s22, v231
  v_fma_f32 v223, v223, s22, v231
  v_mfma_f32_16x16x32_bf16 v[116:119], a[212:215], v[200:203], v[116:119]
  v_exp_f32 v220, v220
  v_mfma_f32_16x16x32_bf16 v[120:123], a[216:219], v[200:203], v[120:123]
  ds_read_b128 a[128:131], v236 offset:30848
  v_exp_f32 v221, v221
  v_mfma_f32_16x16x32_bf16 v[124:127], a[220:223], v[200:203], v[124:127]
  v_exp_f32 v222, v222
  v_mfma_f32_16x16x32_bf16 v[128:131], a[224:227], v[200:203], v[128:131]
  ds_read_b128 a[124:127], v237 offset:30720
  v_exp_f32 v223, v223
  v_mfma_f32_16x16x32_bf16 v[132:135], a[228:231], v[200:203], v[132:135]
  v_mfma_f32_16x16x32_bf16 v[136:139], a[232:235], v[200:203], v[136:139]
  ds_read_b128 a[120:123], v236 offset:30720
  v_mfma_f32_16x16x32_bf16 v[140:143], a[236:239], v[200:203], v[140:143]
  s_waitcnt lgkmcnt(4)
  v_mfma_f32_16x16x32_bf16 v[192:195], a[96:99], a[0:3], v[232:235]
  v_cvt_pk_bf16_f32 v208, v208, v209
  v_cvt_pk_bf16_f32 v209, v210, v211
  v_mfma_f32_16x16x32_bf16 v[192:195], a[100:103], a[4:7], v[192:195]
  v_cvt_pk_bf16_f32 v210, v212, v213
  v_cvt_pk_bf16_f32 v211, v214, v215
  v_mfma_f32_16x16x32_bf16 v[192:195], a[104:107], a[8:11], v[192:195]
  v_add_f32 v227, v227, v216
  v_add_f32 v227, v227, v217
  v_mfma_f32_16x16x32_bf16 v[192:195], a[108:111], a[12:15], v[192:195]
  s_waitcnt lgkmcnt(0)
  v_add_f32 v227, v227, v218
  v_add_f32 v227, v227, v219
  v_mfma_f32_16x16x32_bf16 v[192:195], a[112:115], a[16:19], v[192:195]
  s_barrier
  v_add_f32 v227, v227, v220
  v_add_f32 v227, v227, v221
  v_mfma_f32_16x16x32_bf16 v[192:195], a[116:119], a[20:23], v[192:195]
  s_add_u32 m0, s21, 61440
  v_add_f32 v227, v227, v222
  v_add_f32 v227, v227, v223
  v_mfma_f32_16x16x32_bf16 v[196:199], a[140:143], a[20:23], v[232:235]
  buffer_load_dwordx4 v242, s[12:15], s20 offen nt lds
  v_mfma_f32_16x16x32_bf16 v[196:199], a[136:139], a[16:19], v[196:199]
  v_cvt_pk_bf16_f32 v219, v218, v219
  v_cvt_pk_bf16_f32 v218, v216, v217
  v_mfma_f32_16x16x32_bf16 v[196:199], a[132:135], a[12:15], v[196:199]
  v_cvt_pk_bf16_f32 v216, v220, v221
  v_cvt_pk_bf16_f32 v217, v222, v223
  v_mfma_f32_16x16x32_bf16 v[196:199], a[128:131], a[8:11], v[196:199]
  v_fma_f32 v192, v192, s22, v228
  v_fma_f32 v193, v193, s22, v228
  v_mfma_f32_16x16x32_bf16 v[196:199], a[124:127], a[4:7], v[196:199]
  v_fma_f32 v194, v194, s22, v228
  v_fma_f32 v195, v195, s22, v228
  v_mfma_f32_16x16x32_bf16 v[196:199], a[120:123], a[0:3], v[196:199]
  buffer_load_dwordx4 v243, s[12:15], s20 offen offset:1024 nt lds
  v_mfma_f32_16x16x32_bf16 v[200:203], a[120:123], a[24:27], v[232:235]
  v_exp_f32 v192, v192
  v_mfma_f32_16x16x32_bf16 v[200:203], a[124:127], a[28:31], v[200:203]
  v_exp_f32 v193, v193
  v_mfma_f32_16x16x32_bf16 v[200:203], a[128:131], a[32:35], v[200:203]
  v_exp_f32 v194, v194
  v_mfma_f32_16x16x32_bf16 v[200:203], a[132:135], a[36:39], v[200:203]
  v_exp_f32 v195, v195
  v_mfma_f32_16x16x32_bf16 v[200:203], a[136:139], a[40:43], v[200:203]
  buffer_load_dwordx4 v244, s[12:15], s20 offen offset:2048 nt lds
  v_mfma_f32_16x16x32_bf16 v[200:203], a[140:143], a[44:47], v[200:203]
  v_fma_f32 v196, v196, s22, v228
  v_fma_f32 v197, v197, s22, v228
  v_mfma_f32_16x16x32_bf16 v[204:207], a[116:119], a[44:47], v[232:235]
  v_fma_f32 v198, v198, s22, v228
  v_fma_f32 v199, v199, s22, v228
  v_mfma_f32_16x16x32_bf16 v[204:207], a[112:115], a[40:43], v[204:207]
  s_add_u32 s20, s20, 12288
  v_exp_f32 v196, v196
  v_mfma_f32_16x16x32_bf16 v[204:207], a[108:111], a[36:39], v[204:207]
  s_add_u32 m0, s21, 0
  v_exp_f32 v197, v197
  v_mfma_f32_16x16x32_bf16 v[204:207], a[104:107], a[32:35], v[204:207]
  buffer_load_dwordx4 v242, s[8:11], s20 offen nt lds
  v_mfma_f32_16x16x32_bf16 v[204:207], a[100:103], a[28:31], v[204:207]
  v_exp_f32 v198, v198
  v_mfma_f32_16x16x32_bf16 v[204:207], a[96:99], a[24:27], v[204:207]
  v_exp_f32 v199, v199
  v_mfma_f32_16x16x32_bf16 v[144:147], a[144:147], v[208:211], v[188:191]
  v_fma_f32 v200, v200, s22, v229
  v_fma_f32 v201, v201, s22, v229
  v_mfma_f32_16x16x32_bf16 v[148:151], a[148:151], v[208:211], v[188:191]
  v_fma_f32 v202, v202, s22, v229
  v_fma_f32 v203, v203, s22, v229
  v_mfma_f32_16x16x32_bf16 v[152:155], a[152:155], v[208:211], v[188:191]
  buffer_load_dwordx4 v243, s[8:11], s20 offen offset:1024 nt lds
  v_mfma_f32_16x16x32_bf16 v[156:159], a[156:159], v[208:211], v[188:191]
  v_exp_f32 v200, v200
  v_mfma_f32_16x16x32_bf16 v[160:163], a[160:163], v[208:211], v[188:191]
  v_exp_f32 v201, v201
  v_mfma_f32_16x16x32_bf16 v[164:167], a[164:167], v[208:211], v[188:191]
  v_exp_f32 v202, v202
  v_mfma_f32_16x16x32_bf16 v[168:171], a[168:171], v[208:211], v[188:191]
  v_exp_f32 v203, v203
  v_mfma_f32_16x16x32_bf16 v[172:175], a[172:175], v[208:211], v[188:191]
  buffer_load_dwordx4 v244, s[8:11], s20 offen offset:2048 nt lds
  v_mfma_f32_16x16x32_bf16 v[176:179], a[176:179], v[208:211], v[188:191]
  v_fma_f32 v204, v204, s22, v229
  v_fma_f32 v205, v205, s22, v229
  v_mfma_f32_16x16x32_bf16 v[180:183], a[180:183], v[208:211], v[188:191]
  s_waitcnt vmcnt(9)
  v_fma_f32 v206, v206, s22, v229
  v_fma_f32 v207, v207, s22, v229
  v_mfma_f32_16x16x32_bf16 v[184:187], a[184:187], v[208:211], v[188:191]
  s_barrier
  v_exp_f32 v204, v204
  v_mfma_f32_16x16x32_bf16 v[188:191], a[188:191], v[208:211], v[188:191]
  v_exp_f32 v205, v205
  v_mfma_f32_16x16x32_bf16 v[144:147], a[192:195], v[216:219], v[144:147]
  ds_read_b64_tr_b16 a[144:145], v238 offset:12288
  v_add_f32 v224, v224, v192
  v_mfma_f32_16x16x32_bf16 v[148:151], a[196:199], v[216:219], v[148:151]
  ds_read_b64_tr_b16 a[146:147], v238 offset:18432
  v_add_f32 v224, v224, v193
  v_mfma_f32_16x16x32_bf16 v[152:155], a[200:203], v[216:219], v[152:155]
  v_exp_f32 v206, v206
  v_mfma_f32_16x16x32_bf16 v[156:159], a[204:207], v[216:219], v[156:159]
  ds_read_b64_tr_b16 a[148:149], v239 offset:12288
  v_add_f32 v224, v224, v194
  v_mfma_f32_16x16x32_bf16 v[160:163], a[208:211], v[216:219], v[160:163]
  ds_read_b64_tr_b16 a[150:151], v239 offset:18432
  v_add_f32 v224, v224, v195
  v_mfma_f32_16x16x32_bf16 v[164:167], a[212:215], v[216:219], v[164:167]
  v_exp_f32 v207, v207
  v_mfma_f32_16x16x32_bf16 v[168:171], a[216:219], v[216:219], v[168:171]
  ds_read_b64_tr_b16 a[152:153], v240 offset:12288
  v_cvt_pk_bf16_f32 v192, v192, v193
  v_mfma_f32_16x16x32_bf16 v[172:175], a[220:223], v[216:219], v[172:175]
  ds_read_b64_tr_b16 a[154:155], v240 offset:18432
  v_cvt_pk_bf16_f32 v193, v194, v195
  v_mfma_f32_16x16x32_bf16 v[176:179], a[224:227], v[216:219], v[176:179]
  v_add_f32 v224, v224, v196
  v_add_f32 v224, v224, v197
  v_mfma_f32_16x16x32_bf16 v[180:183], a[228:231], v[216:219], v[180:183]
  ds_read_b64_tr_b16 a[156:157], v241 offset:12288
  v_add_f32 v224, v224, v198
  v_mfma_f32_16x16x32_bf16 v[184:187], a[232:235], v[216:219], v[184:187]
  ds_read_b64_tr_b16 a[158:159], v241 offset:18432
  v_add_f32 v224, v224, v199
  v_mfma_f32_16x16x32_bf16 v[188:191], a[236:239], v[216:219], v[188:191]
  v_cvt_pk_bf16_f32 v194, v196, v197
  v_cvt_pk_bf16_f32 v195, v198, v199
  v_mfma_f32_16x16x32_bf16 v[208:211], a[96:99], a[48:51], v[232:235]
  ds_read_b64_tr_b16 a[160:161], v238 offset:12416
  v_add_f32 v225, v225, v200
  v_mfma_f32_16x16x32_bf16 v[208:211], a[100:103], a[52:55], v[208:211]
  ds_read_b64_tr_b16 a[162:163], v238 offset:18560
  v_add_f32 v225, v225, v201
  v_mfma_f32_16x16x32_bf16 v[208:211], a[104:107], a[56:59], v[208:211]
  v_add_f32 v225, v225, v202
  v_add_f32 v225, v225, v203
  v_mfma_f32_16x16x32_bf16 v[208:211], a[108:111], a[60:63], v[208:211]
  ds_read_b64_tr_b16 a[164:165], v239 offset:12416
  v_cvt_pk_bf16_f32 v203, v202, v203
  v_mfma_f32_16x16x32_bf16 v[208:211], a[112:115], a[64:67], v[208:211]
  ds_read_b64_tr_b16 a[166:167], v239 offset:18560
  v_cvt_pk_bf16_f32 v202, v200, v201
  v_mfma_f32_16x16x32_bf16 v[208:211], a[116:119], a[68:71], v[208:211]
  v_add_f32 v225, v225, v204
  v_add_f32 v225, v225, v205
  v_mfma_f32_16x16x32_bf16 v[212:215], a[140:143], a[68:71], v[232:235]
  ds_read_b64_tr_b16 a[168:169], v240 offset:12416
  v_add_f32 v225, v225, v206
  v_mfma_f32_16x16x32_bf16 v[212:215], a[136:139], a[64:67], v[212:215]
  ds_read_b64_tr_b16 a[170:171], v240 offset:18560
  v_add_f32 v225, v225, v207
  v_mfma_f32_16x16x32_bf16 v[212:215], a[132:135], a[60:63], v[212:215]
  v_cvt_pk_bf16_f32 v200, v204, v205
  v_cvt_pk_bf16_f32 v201, v206, v207
  v_mfma_f32_16x16x32_bf16 v[212:215], a[128:131], a[56:59], v[212:215]
  ds_read_b64_tr_b16 a[172:173], v241 offset:12416
  v_fma_f32 v208, v208, s22, v230
  v_mfma_f32_16x16x32_bf16 v[212:215], a[124:127], a[52:55], v[212:215]
  ds_read_b64_tr_b16 a[174:175], v241 offset:18560
  v_fma_f32 v209, v209, s22, v230
  v_mfma_f32_16x16x32_bf16 v[212:215], a[120:123], a[48:51], v[212:215]
  v_exp_f32 v208, v208
  v_mfma_f32_16x16x32_bf16 v[216:219], a[120:123], a[72:75], v[232:235]
  ds_read_b64_tr_b16 a[176:177], v238 offset:12544
  v_fma_f32 v210, v210, s22, v230
  v_mfma_f32_16x16x32_bf16 v[216:219], a[124:127], a[76:79], v[216:219]
  ds_read_b64_tr_b16 a[178:179], v238 offset:18688
  v_fma_f32 v211, v211, s22, v230
  v_mfma_f32_16x16x32_bf16 v[216:219], a[128:131], a[80:83], v[216:219]
  v_exp_f32 v209, v209
  v_mfma_f32_16x16x32_bf16 v[216:219], a[132:135], a[84:87], v[216:219]
  ds_read_b64_tr_b16 a[180:181], v239 offset:12544
  v_fma_f32 v212, v212, s22, v230
  v_mfma_f32_16x16x32_bf16 v[216:219], a[136:139], a[88:91], v[216:219]
  ds_read_b64_tr_b16 a[182:183], v239 offset:18688
  v_fma_f32 v213, v213, s22, v230
  v_mfma_f32_16x16x32_bf16 v[216:219], a[140:143], a[92:95], v[216:219]
  v_exp_f32 v210, v210
  v_mfma_f32_16x16x32_bf16 v[220:223], a[116:119], a[92:95], v[232:235]
  ds_read_b64_tr_b16 a[184:185], v240 offset:12544
  v_fma_f32 v214, v214, s22, v230
  v_mfma_f32_16x16x32_bf16 v[220:223], a[112:115], a[88:91], v[220:223]
  ds_read_b64_tr_b16 a[186:187], v240 offset:18688
  v_fma_f32 v215, v215, s22, v230
  v_mfma_f32_16x16x32_bf16 v[220:223], a[108:111], a[84:87], v[220:223]
  v_exp_f32 v211, v211
  v_mfma_f32_16x16x32_bf16 v[220:223], a[104:107], a[80:83], v[220:223]
  s_waitcnt vmcnt(6)
  ds_read_b64_tr_b16 a[188:189], v241 offset:12544
  v_fma_f32 v216, v216, s22, v231
  v_mfma_f32_16x16x32_bf16 v[220:223], a[100:103], a[76:79], v[220:223]
  s_barrier
  ds_read_b64_tr_b16 a[190:191], v241 offset:18688
  v_fma_f32 v217, v217, s22, v231
  v_mfma_f32_16x16x32_bf16 v[220:223], a[96:99], a[72:75], v[220:223]
  s_waitcnt lgkmcnt(4)
  v_exp_f32 v212, v212
  v_mfma_f32_16x16x32_bf16 v[0:3], a[144:147], v[192:195], v[0:3]
  ds_read_b128 a[96:99], v236 offset:36864
  v_fma_f32 v218, v218, s22, v231
  v_mfma_f32_16x16x32_bf16 v[48:51], a[144:147], v[200:203], v[48:51]
  v_exp_f32 v213, v213
  v_mfma_f32_16x16x32_bf16 v[52:55], a[148:151], v[200:203], v[52:55]
  ds_read_b128 a[100:103], v237 offset:36864
  v_fma_f32 v219, v219, s22, v231
  v_mfma_f32_16x16x32_bf16 v[4:7], a[148:151], v[192:195], v[4:7]
  v_exp_f32 v214, v214
  v_mfma_f32_16x16x32_bf16 v[8:11], a[152:155], v[192:195], v[8:11]
  ds_read_b128 a[104:107], v236 offset:36992
  v_fma_f32 v220, v220, s22, v231
  v_mfma_f32_16x16x32_bf16 v[56:59], a[152:155], v[200:203], v[56:59]
  v_exp_f32 v215, v215
  v_mfma_f32_16x16x32_bf16 v[60:63], a[156:159], v[200:203], v[60:63]
  ds_read_b128 a[108:111], v237 offset:36992
  v_fma_f32 v221, v221, s22, v231
  v_mfma_f32_16x16x32_bf16 v[12:15], a[156:159], v[192:195], v[12:15]
  v_exp_f32 v216, v216
  v_mfma_f32_16x16x32_bf16 v[16:19], a[160:163], v[192:195], v[16:19]
  ds_read_b128 a[112:115], v236 offset:37120
  v_fma_f32 v222, v222, s22, v231
  v_mfma_f32_16x16x32_bf16 v[64:67], a[160:163], v[200:203], v[64:67]
  v_exp_f32 v217, v217
  v_mfma_f32_16x16x32_bf16 v[68:71], a[164:167], v[200:203], v[68:71]
  ds_read_b128 a[116:119], v237 offset:37120
  v_fma_f32 v223, v223, s22, v231
  v_mfma_f32_16x16x32_bf16 v[20:23], a[164:167], v[192:195], v[20:23]
  v_exp_f32 v218, v218
  v_mfma_f32_16x16x32_bf16 v[24:27], a[168:171], v[192:195], v[24:27]
  ds_read_b128 a[140:143], v237 offset:43264
  v_add_f32 v226, v226, v208
  v_mfma_f32_16x16x32_bf16 v[72:75], a[168:171], v[200:203], v[72:75]
  v_exp_f32 v219, v219
  v_mfma_f32_16x16x32_bf16 v[76:79], a[172:175], v[200:203], v[76:79]
  ds_read_b128 a[136:139], v236 offset:43264
  v_add_f32 v226, v226, v209
  v_mfma_f32_16x16x32_bf16 v[28:31], a[172:175], v[192:195], v[28:31]
  v_exp_f32 v220, v220
  v_mfma_f32_16x16x32_bf16 v[32:35], a[176:179], v[192:195], v[32:35]
  ds_read_b128 a[132:135], v237 offset:43136
  v_add_f32 v226, v226, v210
  v_mfma_f32_16x16x32_bf16 v[80:83], a[176:179], v[200:203], v[80:83]
  v_exp_f32 v221, v221
  v_mfma_f32_16x16x32_bf16 v[84:87], a[180:183], v[200:203], v[84:87]
  ds_read_b128 a[128:131], v236 offset:43136
  v_add_f32 v226, v226, v211
  v_mfma_f32_16x16x32_bf16 v[36:39], a[180:183], v[192:195], v[36:39]
  s_waitcnt lgkmcnt(4)
  v_exp_f32 v222, v222
  v_mfma_f32_16x16x32_bf16 v[40:43], a[184:187], v[192:195], v[40:43]
  ds_read_b128 a[124:127], v237 offset:43008
  v_add_f32 v226, v226, v212
  v_mfma_f32_16x16x32_bf16 v[88:91], a[184:187], v[200:203], v[88:91]
  v_exp_f32 v223, v223
  v_mfma_f32_16x16x32_bf16 v[92:95], a[188:191], v[200:203], v[92:95]
  ds_read_b128 a[120:123], v236 offset:43008
  v_add_f32 v226, v226, v213
  v_mfma_f32_16x16x32_bf16 v[44:47], a[188:191], v[192:195], v[44:47]
  v_add_f32 v226, v226, v214
  v_add_f32 v226, v226, v215
  v_mfma_f32_16x16x32_bf16 v[192:195], a[96:99], a[0:3], v[232:235]
  v_cvt_pk_bf16_f32 v208, v208, v209
  v_cvt_pk_bf16_f32 v209, v210, v211
  v_mfma_f32_16x16x32_bf16 v[192:195], a[100:103], a[4:7], v[192:195]
  v_cvt_pk_bf16_f32 v210, v212, v213
  v_cvt_pk_bf16_f32 v211, v214, v215
  v_mfma_f32_16x16x32_bf16 v[192:195], a[104:107], a[8:11], v[192:195]
  v_add_f32 v227, v227, v216
  v_add_f32 v227, v227, v217
  v_mfma_f32_16x16x32_bf16 v[192:195], a[108:111], a[12:15], v[192:195]
  s_waitcnt lgkmcnt(0)
  v_add_f32 v227, v227, v218
  v_add_f32 v227, v227, v219
  v_mfma_f32_16x16x32_bf16 v[192:195], a[112:115], a[16:19], v[192:195]
  s_barrier
  v_add_f32 v227, v227, v220
  v_add_f32 v227, v227, v221
  v_mfma_f32_16x16x32_bf16 v[192:195], a[116:119], a[20:23], v[192:195]
  s_add_u32 m0, s21, 98304
  v_add_f32 v227, v227, v222
  v_add_f32 v227, v227, v223
  v_mfma_f32_16x16x32_bf16 v[196:199], a[140:143], a[20:23], v[232:235]
  buffer_load_dwordx4 v242, s[12:15], s20 offen nt lds
  v_mfma_f32_16x16x32_bf16 v[196:199], a[136:139], a[16:19], v[196:199]
  v_cvt_pk_bf16_f32 v219, v218, v219
  v_cvt_pk_bf16_f32 v218, v216, v217
  v_mfma_f32_16x16x32_bf16 v[196:199], a[132:135], a[12:15], v[196:199]
  v_cvt_pk_bf16_f32 v216, v220, v221
  v_cvt_pk_bf16_f32 v217, v222, v223
  v_mfma_f32_16x16x32_bf16 v[196:199], a[128:131], a[8:11], v[196:199]
  v_fma_f32 v192, v192, s22, v228
  v_fma_f32 v193, v193, s22, v228
  v_mfma_f32_16x16x32_bf16 v[196:199], a[124:127], a[4:7], v[196:199]
  v_fma_f32 v194, v194, s22, v228
  v_fma_f32 v195, v195, s22, v228
  v_mfma_f32_16x16x32_bf16 v[196:199], a[120:123], a[0:3], v[196:199]
  buffer_load_dwordx4 v243, s[12:15], s20 offen offset:1024 nt lds
  v_mfma_f32_16x16x32_bf16 v[200:203], a[120:123], a[24:27], v[232:235]
  v_exp_f32 v192, v192
  v_mfma_f32_16x16x32_bf16 v[200:203], a[124:127], a[28:31], v[200:203]
  v_exp_f32 v193, v193
  v_mfma_f32_16x16x32_bf16 v[200:203], a[128:131], a[32:35], v[200:203]
  v_exp_f32 v194, v194
  v_mfma_f32_16x16x32_bf16 v[200:203], a[132:135], a[36:39], v[200:203]
  v_exp_f32 v195, v195
  v_mfma_f32_16x16x32_bf16 v[200:203], a[136:139], a[40:43], v[200:203]
  buffer_load_dwordx4 v244, s[12:15], s20 offen offset:2048 nt lds
  v_mfma_f32_16x16x32_bf16 v[200:203], a[140:143], a[44:47], v[200:203]
  v_fma_f32 v196, v196, s22, v228
  v_fma_f32 v197, v197, s22, v228
  v_mfma_f32_16x16x32_bf16 v[204:207], a[116:119], a[44:47], v[232:235]
  v_fma_f32 v198, v198, s22, v228
  v_fma_f32 v199, v199, s22, v228
  v_mfma_f32_16x16x32_bf16 v[204:207], a[112:115], a[40:43], v[204:207]
  s_add_u32 s20, s20, 12288
  v_exp_f32 v196, v196
  v_mfma_f32_16x16x32_bf16 v[204:207], a[108:111], a[36:39], v[204:207]
  s_add_u32 m0, s21, 12288
  v_exp_f32 v197, v197
  v_mfma_f32_16x16x32_bf16 v[204:207], a[104:107], a[32:35], v[204:207]
  buffer_load_dwordx4 v242, s[8:11], s20 offen nt lds
  v_mfma_f32_16x16x32_bf16 v[204:207], a[100:103], a[28:31], v[204:207]
  v_exp_f32 v198, v198
  v_mfma_f32_16x16x32_bf16 v[204:207], a[96:99], a[24:27], v[204:207]
  v_exp_f32 v199, v199
  v_mfma_f32_16x16x32_bf16 v[96:99], a[144:147], v[208:211], v[96:99]
  v_fma_f32 v200, v200, s22, v229
  v_fma_f32 v201, v201, s22, v229
  v_mfma_f32_16x16x32_bf16 v[144:147], a[144:147], v[216:219], v[144:147]
  v_fma_f32 v202, v202, s22, v229
  v_fma_f32 v203, v203, s22, v229
  v_mfma_f32_16x16x32_bf16 v[148:151], a[148:151], v[216:219], v[148:151]
  buffer_load_dwordx4 v243, s[8:11], s20 offen offset:1024 nt lds
  v_mfma_f32_16x16x32_bf16 v[100:103], a[148:151], v[208:211], v[100:103]
  v_exp_f32 v200, v200
  v_mfma_f32_16x16x32_bf16 v[104:107], a[152:155], v[208:211], v[104:107]
  v_exp_f32 v201, v201
  v_mfma_f32_16x16x32_bf16 v[152:155], a[152:155], v[216:219], v[152:155]
  v_exp_f32 v202, v202
  v_mfma_f32_16x16x32_bf16 v[156:159], a[156:159], v[216:219], v[156:159]
  v_exp_f32 v203, v203
  v_mfma_f32_16x16x32_bf16 v[108:111], a[156:159], v[208:211], v[108:111]
  buffer_load_dwordx4 v244, s[8:11], s20 offen offset:2048 nt lds
  v_mfma_f32_16x16x32_bf16 v[112:115], a[160:163], v[208:211], v[112:115]
  v_fma_f32 v204, v204, s22, v229
  v_fma_f32 v205, v205, s22, v229
  v_mfma_f32_16x16x32_bf16 v[160:163], a[160:163], v[216:219], v[160:163]
  s_waitcnt vmcnt(9)
  v_fma_f32 v206, v206, s22, v229
  v_fma_f32 v207, v207, s22, v229
  v_mfma_f32_16x16x32_bf16 v[164:167], a[164:167], v[216:219], v[164:167]
  s_barrier
  v_exp_f32 v204, v204
  v_mfma_f32_16x16x32_bf16 v[116:119], a[164:167], v[208:211], v[116:119]
  v_exp_f32 v205, v205
  v_mfma_f32_16x16x32_bf16 v[120:123], a[168:171], v[208:211], v[120:123]
  ds_read_b64_tr_b16 a[144:145], v238 offset:0
  v_add_f32 v224, v224, v192
  v_mfma_f32_16x16x32_bf16 v[168:171], a[168:171], v[216:219], v[168:171]
  ds_read_b64_tr_b16 a[146:147], v238 offset:6144
  v_add_f32 v224, v224, v193
  v_mfma_f32_16x16x32_bf16 v[172:175], a[172:175], v[216:219], v[172:175]
  v_exp_f32 v206, v206
  v_mfma_f32_16x16x32_bf16 v[124:127], a[172:175], v[208:211], v[124:127]
  ds_read_b64_tr_b16 a[148:149], v239 offset:0
  v_add_f32 v224, v224, v194
  v_mfma_f32_16x16x32_bf16 v[128:131], a[176:179], v[208:211], v[128:131]
  ds_read_b64_tr_b16 a[150:151], v239 offset:6144
  v_add_f32 v224, v224, v195
  v_mfma_f32_16x16x32_bf16 v[176:179], a[176:179], v[216:219], v[176:179]
  v_exp_f32 v207, v207
  v_mfma_f32_16x16x32_bf16 v[180:183], a[180:183], v[216:219], v[180:183]
  s_add_u32 s24, s23, 208896
  ds_read_b64_tr_b16 a[152:153], v240 offset:0
  v_cvt_pk_bf16_f32 v192, v192, v193
  v_mfma_f32_16x16x32_bf16 v[132:135], a[180:183], v[208:211], v[132:135]
  s_add_u32 m0, s30, 0
  ds_read_b64_tr_b16 a[154:155], v240 offset:6144
  v_cvt_pk_bf16_f32 v193, v194, v195
  v_mfma_f32_16x16x32_bf16 v[136:139], a[184:187], v[208:211], v[136:139]
  buffer_load_dwordx4 v242, s[4:7], s24 offen nt lds
  v_add_f32 v224, v224, v196
  v_add_f32 v224, v224, v197
  v_mfma_f32_16x16x32_bf16 v[184:187], a[184:187], v[216:219], v[184:187]
  ds_read_b64_tr_b16 a[156:157], v241 offset:0
  v_add_f32 v224, v224, v198
  v_mfma_f32_16x16x32_bf16 v[188:191], a[188:191], v[216:219], v[188:191]
  ds_read_b64_tr_b16 a[158:159], v241 offset:6144
  v_add_f32 v224, v224, v199
  v_mfma_f32_16x16x32_bf16 v[140:143], a[188:191], v[208:211], v[140:143]
  v_cvt_pk_bf16_f32 v194, v196, v197
  v_cvt_pk_bf16_f32 v195, v198, v199
  v_mfma_f32_16x16x32_bf16 v[208:211], a[96:99], a[48:51], v[232:235]
  ds_read_b64_tr_b16 a[160:161], v238 offset:128
  v_add_f32 v225, v225, v200
  v_mfma_f32_16x16x32_bf16 v[208:211], a[100:103], a[52:55], v[208:211]
  ds_read_b64_tr_b16 a[162:163], v238 offset:6272
  v_add_f32 v225, v225, v201
  v_mfma_f32_16x16x32_bf16 v[208:211], a[104:107], a[56:59], v[208:211]
  v_add_f32 v225, v225, v202
  v_add_f32 v225, v225, v203
  v_mfma_f32_16x16x32_bf16 v[208:211], a[108:111], a[60:63], v[208:211]
  ds_read_b64_tr_b16 a[164:165], v239 offset:128
  v_cvt_pk_bf16_f32 v203, v202, v203
  v_mfma_f32_16x16x32_bf16 v[208:211], a[112:115], a[64:67], v[208:211]
L_pg2:
  s_cbranch_execz L_pg6
  ds_read_b64_tr_b16 a[166:167], v239 offset:6272
  v_cvt_pk_bf16_f32 v202, v200, v201
  v_mfma_f32_16x16x32_bf16 v[208:211], a[116:119], a[68:71], v[208:211]
  v_add_f32 v225, v225, v204
  v_add_f32 v225, v225, v205
  v_mfma_f32_16x16x32_bf16 v[212:215], a[140:143], a[68:71], v[232:235]
  ds_read_b64_tr_b16 a[168:169], v240 offset:128
  v_add_f32 v225, v225, v206
  v_mfma_f32_16x16x32_bf16 v[212:215], a[136:139], a[64:67], v[212:215]
  ds_read_b64_tr_b16 a[170:171], v240 offset:6272
  v_add_f32 v225, v225, v207
  v_mfma_f32_16x16x32_bf16 v[212:215], a[132:135], a[60:63], v[212:215]
  v_cvt_pk_bf16_f32 v200, v204, v205
  v_cvt_pk_bf16_f32 v201, v206, v207
  v_mfma_f32_16x16x32_bf16 v[212:215], a[128:131], a[56:59], v[212:215]
  ds_read_b64_tr_b16 a[172:173], v241 offset:128
  v_fma_f32 v208, v208, s22, v230
  v_mfma_f32_16x16x32_bf16 v[212:215], a[124:127], a[52:55], v[212:215]
  ds_read_b64_tr_b16 a[174:175], v241 offset:6272
  v_fma_f32 v209, v209, s22, v230
  v_mfma_f32_16x16x32_bf16 v[212:215], a[120:123], a[48:51], v[212:215]
  v_exp_f32 v208, v208
  v_mfma_f32_16x16x32_bf16 v[216:219], a[120:123], a[72:75], v[232:235]
  ds_read_b64_tr_b16 a[176:177], v238 offset:256
  v_fma_f32 v210, v210, s22, v230
  v_mfma_f32_16x16x32_bf16 v[216:219], a[124:127], a[76:79], v[216:219]
  ds_read_b64_tr_b16 a[178:179], v238 offset:6400
  v_fma_f32 v211, v211, s22, v230
  v_mfma_f32_16x16x32_bf16 v[216:219], a[128:131], a[80:83], v[216:219]
  buffer_load_dwordx4 v243, s[4:7], s24 offen offset:1024 nt lds
  v_exp_f32 v209, v209
  v_mfma_f32_16x16x32_bf16 v[216:219], a[132:135], a[84:87], v[216:219]
  ds_read_b64_tr_b16 a[180:181], v239 offset:256
  v_fma_f32 v212, v212, s22, v230
  v_mfma_f32_16x16x32_bf16 v[216:219], a[136:139], a[88:91], v[216:219]
  ds_read_b64_tr_b16 a[182:183], v239 offset:6400
  v_fma_f32 v213, v213, s22, v230
  v_mfma_f32_16x16x32_bf16 v[216:219], a[140:143], a[92:95], v[216:219]
  v_exp_f32 v210, v210
  v_mfma_f32_16x16x32_bf16 v[220:223], a[116:119], a[92:95], v[232:235]
  ds_read_b64_tr_b16 a[184:185], v240 offset:256
  v_fma_f32 v214, v214, s22, v230
  v_mfma_f32_16x16x32_bf16 v[220:223], a[112:115], a[88:91], v[220:223]
  ds_read_b64_tr_b16 a[186:187], v240 offset:6400
  v_fma_f32 v215, v215, s22, v230
  v_mfma_f32_16x16x32_bf16 v[220:223], a[108:111], a[84:87], v[220:223]
  v_exp_f32 v211, v211
  v_mfma_f32_16x16x32_bf16 v[220:223], a[104:107], a[80:83], v[220:223]
  s_waitcnt vmcnt(8)
  ds_read_b64_tr_b16 a[188:189], v241 offset:256
  v_fma_f32 v216, v216, s22, v231
  v_mfma_f32_16x16x32_bf16 v[220:223], a[100:103], a[76:79], v[220:223]
  s_barrier
  ds_read_b64_tr_b16 a[190:191], v241 offset:6400
  v_fma_f32 v217, v217, s22, v231
  v_mfma_f32_16x16x32_bf16 v[220:223], a[96:99], a[72:75], v[220:223]
  s_waitcnt lgkmcnt(4)
  v_exp_f32 v212, v212
  v_mfma_f32_16x16x32_bf16 v[0:3], a[144:147], v[192:195], v[0:3]
  ds_read_b128 a[96:99], v236 offset:0
  v_fma_f32 v218, v218, s22, v231
  v_mfma_f32_16x16x32_bf16 v[48:51], a[144:147], v[200:203], v[48:51]
  v_exp_f32 v213, v213
  v_mfma_f32_16x16x32_bf16 v[52:55], a[148:151], v[200:203], v[52:55]
  ds_read_b128 a[100:103], v237 offset:0
  v_fma_f32 v219, v219, s22, v231
  v_mfma_f32_16x16x32_bf16 v[4:7], a[148:151], v[192:195], v[4:7]
  v_exp_f32 v214, v214
  v_mfma_f32_16x16x32_bf16 v[8:11], a[152:155], v[192:195], v[8:11]
  ds_read_b128 a[104:107], v236 offset:128
  v_fma_f32 v220, v220, s22, v231
  v_mfma_f32_16x16x32_bf16 v[56:59], a[152:155], v[200:203], v[56:59]
  v_exp_f32 v215, v215
  v_mfma_f32_16x16x32_bf16 v[60:63], a[156:159], v[200:203], v[60:63]
  ds_read_b128 a[108:111], v237 offset:128
  v_fma_f32 v221, v221, s22, v231
  v_mfma_f32_16x16x32_bf16 v[12:15], a[156:159], v[192:195], v[12:15]
  v_exp_f32 v216, v216
  v_mfma_f32_16x16x32_bf16 v[16:19], a[160:163], v[192:195], v[16:19]
  ds_read_b128 a[112:115], v236 offset:256
  v_fma_f32 v222, v222, s22, v231
  v_mfma_f32_16x16x32_bf16 v[64:67], a[160:163], v[200:203], v[64:67]
  v_exp_f32 v217, v217
  v_mfma_f32_16x16x32_bf16 v[68:71], a[164:167], v[200:203], v[68:71]
  ds_read_b128 a[116:119], v237 offset:256
  v_fma_f32 v223, v223, s22, v231
  v_mfma_f32_16x16x32_bf16 v[20:23], a[164:167], v[192:195], v[20:23]
  v_exp_f32 v218, v218
  v_mfma_f32_16x16x32_bf16 v[24:27], a[168:171], v[192:195], v[24:27]
  ds_read_b128 a[140:143], v237 offset:6400
  v_add_f32 v226, v226, v208
  v_mfma_f32_16x16x32_bf16 v[72:75], a[168:171], v[200:203], v[72:75]
  v_exp_f32 v219, v219
  v_mfma_f32_16x16x32_bf16 v[76:79], a[172:175], v[200:203], v[76:79]
  ds_read_b128 a[136:139], v236 offset:6400
  v_add_f32 v226, v226, v209
  v_mfma_f32_16x16x32_bf16 v[28:31], a[172:175], v[192:195], v[28:31]
  v_exp_f32 v220, v220
  v_mfma_f32_16x16x32_bf16 v[32:35], a[176:179], v[192:195], v[32:35]
  ds_read_b128 a[132:135], v237 offset:6272
  v_add_f32 v226, v226, v210
  v_mfma_f32_16x16x32_bf16 v[80:83], a[176:179], v[200:203], v[80:83]
  v_exp_f32 v221, v221
  v_mfma_f32_16x16x32_bf16 v[84:87], a[180:183], v[200:203], v[84:87]
  ds_read_b128 a[128:131], v236 offset:6272
  v_add_f32 v226, v226, v211
  v_mfma_f32_16x16x32_bf16 v[36:39], a[180:183], v[192:195], v[36:39]
  s_waitcnt lgkmcnt(4)
  v_exp_f32 v222, v222
  v_mfma_f32_16x16x32_bf16 v[40:43], a[184:187], v[192:195], v[40:43]
  ds_read_b128 a[124:127], v237 offset:6144
  v_add_f32 v226, v226, v212
  v_mfma_f32_16x16x32_bf16 v[88:91], a[184:187], v[200:203], v[88:91]
  v_exp_f32 v223, v223
  v_mfma_f32_16x16x32_bf16 v[92:95], a[188:191], v[200:203], v[92:95]
  ds_read_b128 a[120:123], v236 offset:6144
  v_add_f32 v226, v226, v213
  v_mfma_f32_16x16x32_bf16 v[44:47], a[188:191], v[192:195], v[44:47]
  v_add_f32 v226, v226, v214
  v_add_f32 v226, v226, v215
  v_mfma_f32_16x16x32_bf16 v[192:195], a[96:99], a[0:3], v[232:235]
  v_cvt_pk_bf16_f32 v208, v208, v209
  v_cvt_pk_bf16_f32 v209, v210, v211
  v_mfma_f32_16x16x32_bf16 v[192:195], a[100:103], a[4:7], v[192:195]
  v_cvt_pk_bf16_f32 v210, v212, v213
  v_cvt_pk_bf16_f32 v211, v214, v215
  v_mfma_f32_16x16x32_bf16 v[192:195], a[104:107], a[8:11], v[192:195]
  v_add_f32 v227, v227, v216
  v_add_f32 v227, v227, v217
  v_mfma_f32_16x16x32_bf16 v[192:195], a[108:111], a[12:15], v[192:195]
  s_waitcnt lgkmcnt(0)
  v_add_f32 v227, v227, v218
  v_add_f32 v227, v227, v219
  v_mfma_f32_16x16x32_bf16 v[192:195], a[112:115], a[16:19], v[192:195]
  s_barrier
  v_add_f32 v227, v227, v220
  v_add_f32 v227, v227, v221
  v_mfma_f32_16x16x32_bf16 v[192:195], a[116:119], a[20:23], v[192:195]
  s_add_u32 m0, s21, 86016
  v_add_f32 v227, v227, v222
  v_add_f32 v227, v227, v223
  v_mfma_f32_16x16x32_bf16 v[196:199], a[140:143], a[20:23], v[232:235]
  buffer_load_dwordx4 v242, s[12:15], s20 offen nt lds
  v_mfma_f32_16x16x32_bf16 v[196:199], a[136:139], a[16:19], v[196:199]
  v_cvt_pk_bf16_f32 v219, v218, v219
  v_cvt_pk_bf16_f32 v218, v216, v217
  v_mfma_f32_16x16x32_bf16 v[196:199], a[132:135], a[12:15], v[196:199]
  v_cvt_pk_bf16_f32 v216, v220, v221
  v_cvt_pk_bf16_f32 v217, v222, v223
  v_mfma_f32_16x16x32_bf16 v[196:199], a[128:131], a[8:11], v[196:199]
  v_fma_f32 v192, v192, s22, v228
  v_fma_f32 v193, v193, s22, v228
  v_mfma_f32_16x16x32_bf16 v[196:199], a[124:127], a[4:7], v[196:199]
  v_fma_f32 v194, v194, s22, v228
  v_fma_f32 v195, v195, s22, v228
  v_mfma_f32_16x16x32_bf16 v[196:199], a[120:123], a[0:3], v[196:199]
  buffer_load_dwordx4 v243, s[12:15], s20 offen offset:1024 nt lds
  v_mfma_f32_16x16x32_bf16 v[200:203], a[120:123], a[24:27], v[232:235]
  v_exp_f32 v192, v192
  v_mfma_f32_16x16x32_bf16 v[200:203], a[124:127], a[28:31], v[200:203]
  v_exp_f32 v193, v193
  v_mfma_f32_16x16x32_bf16 v[200:203], a[128:131], a[32:35], v[200:203]
  v_exp_f32 v194, v194
  v_mfma_f32_16x16x32_bf16 v[200:203], a[132:135], a[36:39], v[200:203]
  v_exp_f32 v195, v195
  v_mfma_f32_16x16x32_bf16 v[200:203], a[136:139], a[40:43], v[200:203]
  buffer_load_dwordx4 v244, s[12:15], s20 offen offset:2048 nt lds
  v_mfma_f32_16x16x32_bf16 v[200:203], a[140:143], a[44:47], v[200:203]
  v_fma_f32 v196, v196, s22, v228
  v_fma_f32 v197, v197, s22, v228
  v_mfma_f32_16x16x32_bf16 v[204:207], a[116:119], a[44:47], v[232:235]
  v_fma_f32 v198, v198, s22, v228
  v_fma_f32 v199, v199, s22, v228
  v_mfma_f32_16x16x32_bf16 v[204:207], a[112:115], a[40:43], v[204:207]
  s_add_u32 s20, s20, 12288
  v_exp_f32 v196, v196
  v_mfma_f32_16x16x32_bf16 v[204:207], a[108:111], a[36:39], v[204:207]
  s_add_u32 m0, s21, 24576
  v_exp_f32 v197, v197
  v_mfma_f32_16x16x32_bf16 v[204:207], a[104:107], a[32:35], v[204:207]
  buffer_load_dwordx4 v242, s[8:11], s20 offen nt lds
  v_mfma_f32_16x16x32_bf16 v[204:207], a[100:103], a[28:31], v[204:207]
  v_exp_f32 v198, v198
  v_mfma_f32_16x16x32_bf16 v[204:207], a[96:99], a[24:27], v[204:207]
  v_exp_f32 v199, v199
  v_mfma_f32_16x16x32_bf16 v[96:99], a[144:147], v[208:211], v[96:99]
  v_fma_f32 v200, v200, s22, v229
  v_fma_f32 v201, v201, s22, v229
  v_mfma_f32_16x16x32_bf16 v[144:147], a[144:147], v[216:219], v[144:147]
  v_fma_f32 v202, v202, s22, v229
  v_fma_f32 v203, v203, s22, v229
  v_mfma_f32_16x16x32_bf16 v[148:151], a[148:151], v[216:219], v[148:151]
  buffer_load_dwordx4 v243, s[8:11], s20 offen offset:1024 nt lds
  v_mfma_f32_16x16x32_bf16 v[100:103], a[148:151], v[208:211], v[100:103]
  v_exp_f32 v200, v200
  v_mfma_f32_16x16x32_bf16 v[104:107], a[152:155], v[208:211], v[104:107]
  v_exp_f32 v201, v201
  v_mfma_f32_16x16x32_bf16 v[152:155], a[152:155], v[216:219], v[152:155]
  v_exp_f32 v202, v202
  v_mfma_f32_16x16x32_bf16 v[156:159], a[156:159], v[216:219], v[156:159]
  v_exp_f32 v203, v203
  v_mfma_f32_16x16x32_bf16 v[108:111], a[156:159], v[208:211], v[108:111]
  buffer_load_dwordx4 v244, s[8:11], s20 offen offset:2048 nt lds
  v_mfma_f32_16x16x32_bf16 v[112:115], a[160:163], v[208:211], v[112:115]
  v_fma_f32 v204, v204, s22, v229
  v_fma_f32 v205, v205, s22, v229
  v_mfma_f32_16x16x32_bf16 v[160:163], a[160:163], v[216:219], v[160:163]
  s_waitcnt vmcnt(11)
  v_fma_f32 v206, v206, s22, v229
  v_fma_f32 v207, v207, s22, v229
  v_mfma_f32_16x16x32_bf16 v[164:167], a[164:167], v[216:219], v[164:167]
  s_barrier
  v_exp_f32 v204, v204
  v_mfma_f32_16x16x32_bf16 v[116:119], a[164:167], v[208:211], v[116:119]
  v_exp_f32 v205, v205
  v_mfma_f32_16x16x32_bf16 v[120:123], a[168:171], v[208:211], v[120:123]
  ds_read_b64_tr_b16 a[144:145], v238 offset:36864
  v_add_f32 v224, v224, v192
  v_mfma_f32_16x16x32_bf16 v[168:171], a[168:171], v[216:219], v[168:171]
  ds_read_b64_tr_b16 a[146:147], v238 offset:43008
  v_add_f32 v224, v224, v193
  v_mfma_f32_16x16x32_bf16 v[172:175], a[172:175], v[216:219], v[172:175]
  v_exp_f32 v206, v206
  v_mfma_f32_16x16x32_bf16 v[124:127], a[172:175], v[208:211], v[124:127]
  ds_read_b64_tr_b16 a[148:149], v239 offset:36864
  v_add_f32 v224, v224, v194
  v_mfma_f32_16x16x32_bf16 v[128:131], a[176:179], v[208:211], v[128:131]
  ds_read_b64_tr_b16 a[150:151], v239 offset:43008
  v_add_f32 v224, v224, v195
  v_mfma_f32_16x16x32_bf16 v[176:179], a[176:179], v[216:219], v[176:179]
  v_exp_f32 v207, v207
  v_mfma_f32_16x16x32_bf16 v[180:183], a[180:183], v[216:219], v[180:183]
  ds_read_b64_tr_b16 a[152:153], v240 offset:36864
  v_cvt_pk_bf16_f32 v192, v192, v193
  v_mfma_f32_16x16x32_bf16 v[132:135], a[180:183], v[208:211], v[132:135]
  ds_read_b64_tr_b16 a[154:155], v240 offset:43008
  v_cvt_pk_bf16_f32 v193, v194, v195
  v_mfma_f32_16x16x32_bf16 v[136:139], a[184:187], v[208:211], v[136:139]
  v_add_f32 v224, v224, v196
  v_add_f32 v224, v224, v197
  v_mfma_f32_16x16x32_bf16 v[184:187], a[184:187], v[216:219], v[184:187]
  ds_read_b64_tr_b16 a[156:157], v241 offset:36864
  v_add_f32 v224, v224, v198
  v_mfma_f32_16x16x32_bf16 v[188:191], a[188:191], v[216:219], v[188:191]
  s_add_u32 m0, s21, 73728
  ds_read_b64_tr_b16 a[158:159], v241 offset:43008
  v_add_f32 v224, v224, v199
  v_mfma_f32_16x16x32_bf16 v[140:143], a[188:191], v[208:211], v[140:143]
  buffer_load_dwordx4 v242, s[12:15], s20 offen nt lds
  v_cvt_pk_bf16_f32 v194, v196, v197
  v_cvt_pk_bf16_f32 v195, v198, v199
  v_mfma_f32_16x16x32_bf16 v[208:211], a[96:99], a[48:51], v[232:235]
  ds_read_b64_tr_b16 a[160:161], v238 offset:36992
  v_add_f32 v225, v225, v200
  v_mfma_f32_16x16x32_bf16 v[208:211], a[100:103], a[52:55], v[208:211]
  ds_read_b64_tr_b16 a[162:163], v238 offset:43136
  v_add_f32 v225, v225, v201
  v_mfma_f32_16x16x32_bf16 v[208:211], a[104:107], a[56:59], v[208:211]
  buffer_load_dwordx4 v243, s[12:15], s20 offen offset:1024 nt lds
  v_add_f32 v225, v225, v202
  v_add_f32 v225, v225, v203
  v_mfma_f32_16x16x32_bf16 v[208:211], a[108:111], a[60:63], v[208:211]
  ds_read_b64_tr_b16 a[164:165], v239 offset:36992
  v_cvt_pk_bf16_f32 v203, v202, v203
  v_mfma_f32_16x16x32_bf16 v[208:211], a[112:115], a[64:67], v[208:211]
  ds_read_b64_tr_b16 a[166:167], v239 offset:43136
  v_cvt_pk_bf16_f32 v202, v200, v201
  v_mfma_f32_16x16x32_bf16 v[208:211], a[116:119], a[68:71], v[208:211]
  buffer_load_dwordx4 v244, s[12:15], s20 offen offset:2048 nt lds
  v_add_f32 v225, v225, v204
  v_add_f32 v225, v225, v205
  v_mfma_f32_16x16x32_bf16 v[212:215], a[140:143], a[68:71], v[232:235]
  ds_read_b64_tr_b16 a[168:169], v240 offset:36992
  v_add_f32 v225, v225, v206
  v_mfma_f32_16x16x32_bf16 v[212:215], a[136:139], a[64:67], v[212:215]
  ds_read_b64_tr_b16 a[170:171], v240 offset:43136
  v_add_f32 v225, v225, v207
  v_mfma_f32_16x16x32_bf16 v[212:215], a[132:135], a[60:63], v[212:215]
  v_cvt_pk_bf16_f32 v200, v204, v205
  v_cvt_pk_bf16_f32 v201, v206, v207
  v_mfma_f32_16x16x32_bf16 v[212:215], a[128:131], a[56:59], v[212:215]
  ds_read_b64_tr_b16 a[172:173], v241 offset:36992
  v_fma_f32 v208, v208, s22, v230
  v_mfma_f32_16x16x32_bf16 v[212:215], a[124:127], a[52:55], v[212:215]
  ds_read_b64_tr_b16 a[174:175], v241 offset:43136
  v_fma_f32 v209, v209, s22, v230
  v_mfma_f32_16x16x32_bf16 v[212:215], a[120:123], a[48:51], v[212:215]
  v_exp_f32 v208, v208
  v_mfma_f32_16x16x32_bf16 v[216:219], a[120:123], a[72:75], v[232:235]
  s_add_u32 s24, s23, 208896
  ds_read_b64_tr_b16 a[176:177], v238 offset:37120
  v_fma_f32 v210, v210, s22, v230
  v_mfma_f32_16x16x32_bf16 v[216:219], a[124:127], a[76:79], v[216:219]
  s_add_u32 m0, s30, 0
  ds_read_b64_tr_b16 a[178:179], v238 offset:43264
  v_fma_f32 v211, v211, s22, v230
  v_mfma_f32_16x16x32_bf16 v[216:219], a[128:131], a[80:83], v[216:219]
  buffer_load_dwordx4 v244, s[4:7], s24 offen offset:2048 nt lds
  v_exp_f32 v209, v209
  v_mfma_f32_16x16x32_bf16 v[216:219], a[132:135], a[84:87], v[216:219]
  ds_read_b64_tr_b16 a[180:181], v239 offset:37120
  v_fma_f32 v212, v212, s22, v230
  v_mfma_f32_16x16x32_bf16 v[216:219], a[136:139], a[88:91], v[216:219]
  ds_read_b64_tr_b16 a[182:183], v239 offset:43264
  v_fma_f32 v213, v213, s22, v230
  v_mfma_f32_16x16x32_bf16 v[216:219], a[140:143], a[92:95], v[216:219]
  v_exp_f32 v210, v210
  v_mfma_f32_16x16x32_bf16 v[220:223], a[116:119], a[92:95], v[232:235]
  s_add_u32 s24, s23, 211968
  ds_read_b64_tr_b16 a[184:185], v240 offset:37120
  v_fma_f32 v214, v214, s22, v230
  v_mfma_f32_16x16x32_bf16 v[220:223], a[112:115], a[88:91], v[220:223]
  s_add_u32 m0, s30, 3072
  ds_read_b64_tr_b16 a[186:187], v240 offset:43264
  v_fma_f32 v215, v215, s22, v230
  v_mfma_f32_16x16x32_bf16 v[220:223], a[108:111], a[84:87], v[220:223]
  buffer_load_dwordx4 v242, s[4:7], s24 offen nt lds
  v_exp_f32 v211, v211
  v_mfma_f32_16x16x32_bf16 v[220:223], a[104:107], a[80:83], v[220:223]
  s_waitcnt vmcnt(13)
  ds_read_b64_tr_b16 a[188:189], v241 offset:37120
  v_fma_f32 v216, v216, s22, v231
  v_mfma_f32_16x16x32_bf16 v[220:223], a[100:103], a[76:79], v[220:223]
  s_barrier
  ds_read_b64_tr_b16 a[190:191], v241 offset:43264
  v_fma_f32 v217, v217, s22, v231
  v_mfma_f32_16x16x32_bf16 v[220:223], a[96:99], a[72:75], v[220:223]
  s_waitcnt lgkmcnt(4)
  v_exp_f32 v212, v212
  v_mfma_f32_16x16x32_bf16 v[0:3], a[144:147], v[192:195], v[0:3]
  ds_read_b128 a[96:99], v236 offset:12288
  v_fma_f32 v218, v218, s22, v231
  v_mfma_f32_16x16x32_bf16 v[48:51], a[144:147], v[200:203], v[48:51]
  v_exp_f32 v213, v213
  v_mfma_f32_16x16x32_bf16 v[52:55], a[148:151], v[200:203], v[52:55]
  ds_read_b128 a[100:103], v237 offset:12288
  v_fma_f32 v219, v219, s22, v231
  v_mfma_f32_16x16x32_bf16 v[4:7], a[148:151], v[192:195], v[4:7]
  v_exp_f32 v214, v214
  v_mfma_f32_16x16x32_bf16 v[8:11], a[152:155], v[192:195], v[8:11]
  ds_read_b128 a[104:107], v236 offset:12416
  v_fma_f32 v220, v220, s22, v231
  v_mfma_f32_16x16x32_bf16 v[56:59], a[152:155], v[200:203], v[56:59]
  v_exp_f32 v215, v215
  v_mfma_f32_16x16x32_bf16 v[60:63], a[156:159], v[200:203], v[60:63]
  ds_read_b128 a[108:111], v237 offset:12416
  v_fma_f32 v221, v221, s22, v231
  v_mfma_f32_16x16x32_bf16 v[12:15], a[156:159], v[192:195], v[12:15]
  v_exp_f32 v216, v216
  v_mfma_f32_16x16x32_bf16 v[16:19], a[160:163], v[192:195], v[16:19]
  ds_read_b128 a[112:115], v236 offset:12544
  v_fma_f32 v222, v222, s22, v231
  v_mfma_f32_16x16x32_bf16 v[64:67], a[160:163], v[200:203], v[64:67]
  v_exp_f32 v217, v217
  v_mfma_f32_16x16x32_bf16 v[68:71], a[164:167], v[200:203], v[68:71]
  ds_read_b128 a[116:119], v237 offset:12544
  v_fma_f32 v223, v223, s22, v231
  v_mfma_f32_16x16x32_bf16 v[20:23], a[164:167], v[192:195], v[20:23]
  v_exp_f32 v218, v218
  v_mfma_f32_16x16x32_bf16 v[24:27], a[168:171], v[192:195], v[24:27]
  ds_read_b128 a[140:143], v237 offset:18688
  v_add_f32 v226, v226, v208
  v_mfma_f32_16x16x32_bf16 v[72:75], a[168:171], v[200:203], v[72:75]
  v_exp_f32 v219, v219
  v_mfma_f32_16x16x32_bf16 v[76:79], a[172:175], v[200:203], v[76:79]
  ds_read_b128 a[136:139], v236 offset:18688
  v_add_f32 v226, v226, v209
  v_mfma_f32_16x16x32_bf16 v[28:31], a[172:175], v[192:195], v[28:31]
  v_exp_f32 v220, v220
  v_mfma_f32_16x16x32_bf16 v[32:35], a[176:179], v[192:195], v[32:35]
  ds_read_b128 a[132:135], v237 offset:18560
  v_add_f32 v226, v226, v210
  v_mfma_f32_16x16x32_bf16 v[80:83], a[176:179], v[200:203], v[80:83]
  v_exp_f32 v221, v221
  v_mfma_f32_16x16x32_bf16 v[84:87], a[180:183], v[200:203], v[84:87]
  ds_read_b128 a[128:131], v236 offset:18560
  v_add_f32 v226, v226, v211
  v_mfma_f32_16x16x32_bf16 v[36:39], a[180:183], v[192:195], v[36:39]
  s_waitcnt lgkmcnt(4)
  v_exp_f32 v222, v222
  v_mfma_f32_16x16x32_bf16 v[40:43], a[184:187], v[192:195], v[40:43]
  ds_read_b128 a[124:127], v237 offset:18432
  v_add_f32 v226, v226, v212
  v_mfma_f32_16x16x32_bf16 v[88:91], a[184:187], v[200:203], v[88:91]
  v_exp_f32 v223, v223
  v_mfma_f32_16x16x32_bf16 v[92:95], a[188:191], v[200:203], v[92:95]
  ds_read_b128 a[120:123], v236 offset:18432
  v_add_f32 v226, v226, v213
  v_mfma_f32_16x16x32_bf16 v[44:47], a[188:191], v[192:195], v[44:47]
  v_add_f32 v226, v226, v214
  v_add_f32 v226, v226, v215
  v_mfma_f32_16x16x32_bf16 v[192:195], a[96:99], a[0:3], v[232:235]
  v_cvt_pk_bf16_f32 v208, v208, v209
  v_cvt_pk_bf16_f32 v209, v210, v211
  v_mfma_f32_16x16x32_bf16 v[192:195], a[100:103], a[4:7], v[192:195]
  v_cvt_pk_bf16_f32 v210, v212, v213
  v_cvt_pk_bf16_f32 v211, v214, v215
  v_mfma_f32_16x16x32_bf16 v[192:195], a[104:107], a[8:11], v[192:195]
  s_add_u32 s20, s20, 12288
  v_add_f32 v227, v227, v216
  v_add_f32 v227, v227, v217
  v_mfma_f32_16x16x32_bf16 v[192:195], a[108:111], a[12:15], v[192:195]
  s_waitcnt lgkmcnt(0)
  v_add_f32 v227, v227, v218
  v_add_f32 v227, v227, v219
  v_mfma_f32_16x16x32_bf16 v[192:195], a[112:115], a[16:19], v[192:195]
  s_barrier
  v_add_f32 v227, v227, v220
  v_add_f32 v227, v227, v221
  v_mfma_f32_16x16x32_bf16 v[192:195], a[116:119], a[20:23], v[192:195]
  s_add_u32 m0, s21, 36864
  v_add_f32 v227, v227, v222
  v_add_f32 v227, v227, v223
  v_mfma_f32_16x16x32_bf16 v[196:199], a[140:143], a[20:23], v[232:235]
  buffer_load_dwordx4 v242, s[8:11], s20 offen nt lds
  v_mfma_f32_16x16x32_bf16 v[196:199], a[136:139], a[16:19], v[196:199]
  v_cvt_pk_bf16_f32 v219, v218, v219
  v_cvt_pk_bf16_f32 v218, v216, v217
  v_mfma_f32_16x16x32_bf16 v[196:199], a[132:135], a[12:15], v[196:199]
  v_cvt_pk_bf16_f32 v216, v220, v221
  v_cvt_pk_bf16_f32 v217, v222, v223
  v_mfma_f32_16x16x32_bf16 v[196:199], a[128:131], a[8:11], v[196:199]
  v_fma_f32 v192, v192, s22, v228
  v_fma_f32 v193, v193, s22, v228
  v_mfma_f32_16x16x32_bf16 v[196:199], a[124:127], a[4:7], v[196:199]
  v_fma_f32 v194, v194, s22, v228
  v_fma_f32 v195, v195, s22, v228
  v_mfma_f32_16x16x32_bf16 v[196:199], a[120:123], a[0:3], v[196:199]
  buffer_load_dwordx4 v243, s[8:11], s20 offen offset:1024 nt lds
  v_mfma_f32_16x16x32_bf16 v[200:203], a[120:123], a[24:27], v[232:235]
  v_exp_f32 v192, v192
  v_mfma_f32_16x16x32_bf16 v[200:203], a[124:127], a[28:31], v[200:203]
  v_exp_f32 v193, v193
  v_mfma_f32_16x16x32_bf16 v[200:203], a[128:131], a[32:35], v[200:203]
  v_exp_f32 v194, v194
  v_mfma_f32_16x16x32_bf16 v[200:203], a[132:135], a[36:39], v[200:203]
  v_exp_f32 v195, v195
  v_mfma_f32_16x16x32_bf16 v[200:203], a[136:139], a[40:43], v[200:203]
  buffer_load_dwordx4 v244, s[8:11], s20 offen offset:2048 nt lds
  v_mfma_f32_16x16x32_bf16 v[200:203], a[140:143], a[44:47], v[200:203]
  v_fma_f32 v196, v196, s22, v228
  v_fma_f32 v197, v197, s22, v228
  v_mfma_f32_16x16x32_bf16 v[204:207], a[116:119], a[44:47], v[232:235]
  v_fma_f32 v198, v198, s22, v228
  v_fma_f32 v199, v199, s22, v228
  v_mfma_f32_16x16x32_bf16 v[204:207], a[112:115], a[40:43], v[204:207]
  v_exp_f32 v196, v196
  v_mfma_f32_16x16x32_bf16 v[204:207], a[108:111], a[36:39], v[204:207]
  s_add_u32 m0, s21, 61440
  v_exp_f32 v197, v197
  v_mfma_f32_16x16x32_bf16 v[204:207], a[104:107], a[32:35], v[204:207]
  buffer_load_dwordx4 v242, s[12:15], s20 offen nt lds
  v_mfma_f32_16x16x32_bf16 v[204:207], a[100:103], a[28:31], v[204:207]
  v_exp_f32 v198, v198
  v_mfma_f32_16x16x32_bf16 v[204:207], a[96:99], a[24:27], v[204:207]
  v_exp_f32 v199, v199
  v_mfma_f32_16x16x32_bf16 v[96:99], a[144:147], v[208:211], v[96:99]
  v_fma_f32 v200, v200, s22, v229
  v_fma_f32 v201, v201, s22, v229
  v_mfma_f32_16x16x32_bf16 v[144:147], a[144:147], v[216:219], v[144:147]
  v_fma_f32 v202, v202, s22, v229
  v_fma_f32 v203, v203, s22, v229
  v_mfma_f32_16x16x32_bf16 v[148:151], a[148:151], v[216:219], v[148:151]
  buffer_load_dwordx4 v243, s[12:15], s20 offen offset:1024 nt lds
  v_mfma_f32_16x16x32_bf16 v[100:103], a[148:151], v[208:211], v[100:103]
  v_exp_f32 v200, v200
  v_mfma_f32_16x16x32_bf16 v[104:107], a[152:155], v[208:211], v[104:107]
  v_exp_f32 v201, v201
  v_mfma_f32_16x16x32_bf16 v[152:155], a[152:155], v[216:219], v[152:155]
  v_exp_f32 v202, v202
  v_mfma_f32_16x16x32_bf16 v[156:159], a[156:159], v[216:219], v[156:159]
  v_exp_f32 v203, v203
  v_mfma_f32_16x16x32_bf16 v[108:111], a[156:159], v[208:211], v[108:111]
  buffer_load_dwordx4 v244, s[12:15], s20 offen offset:2048 nt lds
  v_mfma_f32_16x16x32_bf16 v[112:115], a[160:163], v[208:211], v[112:115]
  v_fma_f32 v204, v204, s22, v229
  v_fma_f32 v205, v205, s22, v229
  v_mfma_f32_16x16x32_bf16 v[160:163], a[160:163], v[216:219], v[160:163]
  s_waitcnt vmcnt(14)
  v_fma_f32 v206, v206, s22, v229
  v_fma_f32 v207, v207, s22, v229
  v_mfma_f32_16x16x32_bf16 v[164:167], a[164:167], v[216:219], v[164:167]
  s_barrier
  v_exp_f32 v204, v204
  v_mfma_f32_16x16x32_bf16 v[116:119], a[164:167], v[208:211], v[116:119]
  v_exp_f32 v205, v205
  v_mfma_f32_16x16x32_bf16 v[120:123], a[168:171], v[208:211], v[120:123]
  ds_read_b64_tr_b16 a[144:145], v238 offset:24576
  v_add_f32 v224, v224, v192
  v_mfma_f32_16x16x32_bf16 v[168:171], a[168:171], v[216:219], v[168:171]
  ds_read_b64_tr_b16 a[146:147], v238 offset:30720
  v_add_f32 v224, v224, v193
  v_mfma_f32_16x16x32_bf16 v[172:175], a[172:175], v[216:219], v[172:175]
  v_exp_f32 v206, v206
  v_mfma_f32_16x16x32_bf16 v[124:127], a[172:175], v[208:211], v[124:127]
  ds_read_b64_tr_b16 a[148:149], v239 offset:24576
  v_add_f32 v224, v224, v194
  v_mfma_f32_16x16x32_bf16 v[128:131], a[176:179], v[208:211], v[128:131]
  ds_read_b64_tr_b16 a[150:151], v239 offset:30720
  v_add_f32 v224, v224, v195
  v_mfma_f32_16x16x32_bf16 v[176:179], a[176:179], v[216:219], v[176:179]
  v_exp_f32 v207, v207
  v_mfma_f32_16x16x32_bf16 v[180:183], a[180:183], v[216:219], v[180:183]
  ds_read_b64_tr_b16 a[152:153], v240 offset:24576
  v_cvt_pk_bf16_f32 v192, v192, v193
  v_mfma_f32_16x16x32_bf16 v[132:135], a[180:183], v[208:211], v[132:135]
  ds_read_b64_tr_b16 a[154:155], v240 offset:30720
  v_cvt_pk_bf16_f32 v193, v194, v195
  v_mfma_f32_16x16x32_bf16 v[136:139], a[184:187], v[208:211], v[136:139]
  v_add_f32 v224, v224, v196
  v_add_f32 v224, v224, v197
  v_mfma_f32_16x16x32_bf16 v[184:187], a[184:187], v[216:219], v[184:187]
  s_add_u32 s20, s20, 12288
  ds_read_b64_tr_b16 a[156:157], v241 offset:24576
  v_add_f32 v224, v224, v198
  v_mfma_f32_16x16x32_bf16 v[188:191], a[188:191], v[216:219], v[188:191]
  s_add_u32 m0, s21, 0
  ds_read_b64_tr_b16 a[158:159], v241 offset:30720
  v_add_f32 v224, v224, v199
  v_mfma_f32_16x16x32_bf16 v[140:143], a[188:191], v[208:211], v[140:143]
  buffer_load_dwordx4 v242, s[8:11], s20 offen nt lds
  v_cvt_pk_bf16_f32 v194, v196, v197
  v_cvt_pk_bf16_f32 v195, v198, v199
  v_mfma_f32_16x16x32_bf16 v[208:211], a[96:99], a[48:51], v[232:235]
  ds_read_b64_tr_b16 a[160:161], v238 offset:24704
  v_add_f32 v225, v225, v200
  v_mfma_f32_16x16x32_bf16 v[208:211], a[100:103], a[52:55], v[208:211]
  ds_read_b64_tr_b16 a[162:163], v238 offset:30848
  v_add_f32 v225, v225, v201
  v_mfma_f32_16x16x32_bf16 v[208:211], a[104:107], a[56:59], v[208:211]
  buffer_load_dwordx4 v243, s[8:11], s20 offen offset:1024 nt lds
  v_add_f32 v225, v225, v202
  v_add_f32 v225, v225, v203
  v_mfma_f32_16x16x32_bf16 v[208:211], a[108:111], a[60:63], v[208:211]
  ds_read_b64_tr_b16 a[164:165], v239 offset:24704
  v_cvt_pk_bf16_f32 v203, v202, v203
  v_mfma_f32_16x16x32_bf16 v[208:211], a[112:115], a[64:67], v[208:211]
  ds_read_b64_tr_b16 a[166:167], v239 offset:30848
  v_cvt_pk_bf16_f32 v202, v200, v201
  v_mfma_f32_16x16x32_bf16 v[208:211], a[116:119], a[68:71], v[208:211]
  buffer_load_dwordx4 v244, s[8:11], s20 offen offset:2048 nt lds
  v_add_f32 v225, v225, v204
  v_add_f32 v225, v225, v205
  v_mfma_f32_16x16x32_bf16 v[212:215], a[140:143], a[68:71], v[232:235]
  ds_read_b64_tr_b16 a[168:169], v240 offset:24704
  v_add_f32 v225, v225, v206
  v_mfma_f32_16x16x32_bf16 v[212:215], a[136:139], a[64:67], v[212:215]
  ds_read_b64_tr_b16 a[170:171], v240 offset:30848
  v_add_f32 v225, v225, v207
  v_mfma_f32_16x16x32_bf16 v[212:215], a[132:135], a[60:63], v[212:215]
  v_cvt_pk_bf16_f32 v200, v204, v205
  v_cvt_pk_bf16_f32 v201, v206, v207
  v_mfma_f32_16x16x32_bf16 v[212:215], a[128:131], a[56:59], v[212:215]
  ds_read_b64_tr_b16 a[172:173], v241 offset:24704
  v_fma_f32 v208, v208, s22, v230
  v_mfma_f32_16x16x32_bf16 v[212:215], a[124:127], a[52:55], v[212:215]
  ds_read_b64_tr_b16 a[174:175], v241 offset:30848
  v_fma_f32 v209, v209, s22, v230
  v_mfma_f32_16x16x32_bf16 v[212:215], a[120:123], a[48:51], v[212:215]
  v_exp_f32 v208, v208
  v_mfma_f32_16x16x32_bf16 v[216:219], a[120:123], a[72:75], v[232:235]
  s_add_u32 s24, s23, 211968
  ds_read_b64_tr_b16 a[176:177], v238 offset:24832
  v_fma_f32 v210, v210, s22, v230
  v_mfma_f32_16x16x32_bf16 v[216:219], a[124:127], a[76:79], v[216:219]
  s_add_u32 m0, s30, 3072
  ds_read_b64_tr_b16 a[178:179], v238 offset:30976
  v_fma_f32 v211, v211, s22, v230
  v_mfma_f32_16x16x32_bf16 v[216:219], a[128:131], a[80:83], v[216:219]
  buffer_load_dwordx4 v243, s[4:7], s24 offen offset:1024 nt lds
  v_exp_f32 v209, v209
  v_mfma_f32_16x16x32_bf16 v[216:219], a[132:135], a[84:87], v[216:219]
  ds_read_b64_tr_b16 a[180:181], v239 offset:24832
  v_fma_f32 v212, v212, s22, v230
  v_mfma_f32_16x16x32_bf16 v[216:219], a[136:139], a[88:91], v[216:219]
  ds_read_b64_tr_b16 a[182:183], v239 offset:30976
  v_fma_f32 v213, v213, s22, v230
  v_mfma_f32_16x16x32_bf16 v[216:219], a[140:143], a[92:95], v[216:219]
  v_exp_f32 v210, v210
  v_mfma_f32_16x16x32_bf16 v[220:223], a[116:119], a[92:95], v[232:235]
  ds_read_b64_tr_b16 a[184:185], v240 offset:24832
  v_fma_f32 v214, v214, s22, v230
  v_mfma_f32_16x16x32_bf16 v[220:223], a[112:115], a[88:91], v[220:223]
  ds_read_b64_tr_b16 a[186:187], v240 offset:30976
  v_fma_f32 v215, v215, s22, v230
  v_mfma_f32_16x16x32_bf16 v[220:223], a[108:111], a[84:87], v[220:223]
  buffer_load_dwordx4 v244, s[4:7], s24 offen offset:2048 nt lds
  v_exp_f32 v211, v211
  v_mfma_f32_16x16x32_bf16 v[220:223], a[104:107], a[80:83], v[220:223]
  s_waitcnt vmcnt(16)
  ds_read_b64_tr_b16 a[188:189], v241 offset:24832
  v_fma_f32 v216, v216, s22, v231
  v_mfma_f32_16x16x32_bf16 v[220:223], a[100:103], a[76:79], v[220:223]
L_pg3:
  s_cbranch_execz L_pg7
  s_barrier
  ds_read_b64_tr_b16 a[190:191], v241 offset:30976
  v_fma_f32 v217, v217, s22, v231
  v_mfma_f32_16x16x32_bf16 v[220:223], a[96:99], a[72:75], v[220:223]
  s_waitcnt lgkmcnt(4)
  v_exp_f32 v212, v212
  v_mfma_f32_16x16x32_bf16 v[0:3], a[144:147], v[192:195], v[0:3]
  ds_read_b128 a[96:99], v236 offset:24576
  v_fma_f32 v218, v218, s22, v231
  v_mfma_f32_16x16x32_bf16 v[48:51], a[144:147], v[200:203], v[48:51]
  v_exp_f32 v213, v213
  v_mfma_f32_16x16x32_bf16 v[52:55], a[148:151], v[200:203], v[52:55]
  ds_read_b128 a[100:103], v237 offset:24576
  v_fma_f32 v219, v219, s22, v231
  v_mfma_f32_16x16x32_bf16 v[4:7], a[148:151], v[192:195], v[4:7]
  v_exp_f32 v214, v214
  v_mfma_f32_16x16x32_bf16 v[8:11], a[152:155], v[192:195], v[8:11]
  ds_read_b128 a[104:107], v236 offset:24704
  v_fma_f32 v220, v220, s22, v231
  v_mfma_f32_16x16x32_bf16 v[56:59], a[152:155], v[200:203], v[56:59]
  v_exp_f32 v215, v215
  v_mfma_f32_16x16x32_bf16 v[60:63], a[156:159], v[200:203], v[60:63]
  ds_read_b128 a[108:111], v237 offset:24704
  v_fma_f32 v221, v221, s22, v231
  v_mfma_f32_16x16x32_bf16 v[12:15], a[156:159], v[192:195], v[12:15]
  v_exp_f32 v216, v216
  v_mfma_f32_16x16x32_bf16 v[16:19], a[160:163], v[192:195], v[16:19]
  ds_read_b128 a[112:115], v236 offset:24832
  v_fma_f32 v222, v222, s22, v231
  v_mfma_f32_16x16x32_bf16 v[64:67], a[160:163], v[200:203], v[64:67]
  v_exp_f32 v217, v217
  v_mfma_f32_16x16x32_bf16 v[68:71], a[164:167], v[200:203], v[68:71]
  ds_read_b128 a[116:119], v237 offset:24832
  v_fma_f32 v223, v223, s22, v231
  v_mfma_f32_16x16x32_bf16 v[20:23], a[164:167], v[192:195], v[20:23]
  v_exp_f32 v218, v218
  v_mfma_f32_16x16x32_bf16 v[24:27], a[168:171], v[192:195], v[24:27]
  ds_read_b128 a[140:143], v237 offset:30976
  v_add_f32 v226, v226, v208
  v_mfma_f32_16x16x32_bf16 v[72:75], a[168:171], v[200:203], v[72:75]
  v_exp_f32 v219, v219
  v_mfma_f32_16x16x32_bf16 v[76:79], a[172:175], v[200:203], v[76:79]
  ds_read_b128 a[136:139], v236 offset:30976
  v_add_f32 v226, v226, v209
  v_mfma_f32_16x16x32_bf16 v[28:31], a[172:175], v[192:195], v[28:31]
  v_exp_f32 v220, v220
  v_mfma_f32_16x16x32_bf16 v[32:35], a[176:179], v[192:195], v[32:35]
  ds_read_b128 a[132:135], v237 offset:30848
  v_add_f32 v226, v226, v210
  v_mfma_f32_16x16x32_bf16 v[80:83], a[176:179], v[200:203], v[80:83]
  v_exp_f32 v221, v221
  v_mfma_f32_16x16x32_bf16 v[84:87], a[180:183], v[200:203], v[84:87]
  ds_read_b128 a[128:131], v236 offset:30848
  v_add_f32 v226, v226, v211
  v_mfma_f32_16x16x32_bf16 v[36:39], a[180:183], v[192:195], v[36:39]
  s_waitcnt lgkmcnt(4)
  v_exp_f32 v222, v222
  v_mfma_f32_16x16x32_bf16 v[40:43], a[184:187], v[192:195], v[40:43]
  ds_read_b128 a[124:127], v237 offset:30720
  v_add_f32 v226, v226, v212
  v_mfma_f32_16x16x32_bf16 v[88:91], a[184:187], v[200:203], v[88:91]
  v_exp_f32 v223, v223
  v_mfma_f32_16x16x32_bf16 v[92:95], a[188:191], v[200:203], v[92:95]
  ds_read_b128 a[120:123], v236 offset:30720
  v_add_f32 v226, v226, v213
  v_mfma_f32_16x16x32_bf16 v[44:47], a[188:191], v[192:195], v[44:47]
  v_add_f32 v226, v226, v214
  v_add_f32 v226, v226, v215
  v_mfma_f32_16x16x32_bf16 v[192:195], a[96:99], a[0:3], v[232:235]
  v_cvt_pk_bf16_f32 v208, v208, v209
  v_cvt_pk_bf16_f32 v209, v210, v211
  v_mfma_f32_16x16x32_bf16 v[192:195], a[100:103], a[4:7], v[192:195]
  v_cvt_pk_bf16_f32 v210, v212, v213
  v_cvt_pk_bf16_f32 v211, v214, v215
  v_mfma_f32_16x16x32_bf16 v[192:195], a[104:107], a[8:11], v[192:195]
  v_add_f32 v227, v227, v216
  v_add_f32 v227, v227, v217
  v_mfma_f32_16x16x32_bf16 v[192:195], a[108:111], a[12:15], v[192:195]
  s_waitcnt lgkmcnt(0)
  v_add_f32 v227, v227, v218
  v_add_f32 v227, v227, v219
  v_mfma_f32_16x16x32_bf16 v[192:195], a[112:115], a[16:19], v[192:195]
  s_barrier
  v_add_f32 v227, v227, v220
  v_add_f32 v227, v227, v221
  v_mfma_f32_16x16x32_bf16 v[192:195], a[116:119], a[20:23], v[192:195]
  s_add_u32 m0, s21, 98304
  v_add_f32 v227, v227, v222
  v_add_f32 v227, v227, v223
  v_mfma_f32_16x16x32_bf16 v[196:199], a[140:143], a[20:23], v[232:235]
  buffer_load_dwordx4 v242, s[12:15], s20 offen nt lds
  v_mfma_f32_16x16x32_bf16 v[196:199], a[136:139], a[16:19], v[196:199]
  v_cvt_pk_bf16_f32 v219, v218, v219
  v_cvt_pk_bf16_f32 v218, v216, v217
  v_mfma_f32_16x16x32_bf16 v[196:199], a[132:135], a[12:15], v[196:199]
  v_cvt_pk_bf16_f32 v216, v220, v221
  v_cvt_pk_bf16_f32 v217, v222, v223
  v_mfma_f32_16x16x32_bf16 v[196:199], a[128:131], a[8:11], v[196:199]
  v_fma_f32 v192, v192, s22, v228
  v_fma_f32 v193, v193, s22, v228
  v_mfma_f32_16x16x32_bf16 v[196:199], a[124:127], a[4:7], v[196:199]
  v_fma_f32 v194, v194, s22, v228
  v_fma_f32 v195, v195, s22, v228
  v_mfma_f32_16x16x32_bf16 v[196:199], a[120:123], a[0:3], v[196:199]
  buffer_load_dwordx4 v243, s[12:15], s20 offen offset:1024 nt lds
  v_mfma_f32_16x16x32_bf16 v[200:203], a[120:123], a[24:27], v[232:235]
  v_exp_f32 v192, v192
  v_mfma_f32_16x16x32_bf16 v[200:203], a[124:127], a[28:31], v[200:203]
  v_exp_f32 v193, v193
  v_mfma_f32_16x16x32_bf16 v[200:203], a[128:131], a[32:35], v[200:203]
  v_exp_f32 v194, v194
  v_mfma_f32_16x16x32_bf16 v[200:203], a[132:135], a[36:39], v[200:203]
  v_exp_f32 v195, v195
  v_mfma_f32_16x16x32_bf16 v[200:203], a[136:139], a[40:43], v[200:203]
  buffer_load_dwordx4 v244, s[12:15], s20 offen offset:2048 nt lds
  v_mfma_f32_16x16x32_bf16 v[200:203], a[140:143], a[44:47], v[200:203]
  v_fma_f32 v196, v196, s22, v228
  v_fma_f32 v197, v197, s22, v228
  v_mfma_f32_16x16x32_bf16 v[204:207], a[116:119], a[44:47], v[232:235]
  v_fma_f32 v198, v198, s22, v228
  v_fma_f32 v199, v199, s22, v228
  v_mfma_f32_16x16x32_bf16 v[204:207], a[112:115], a[40:43], v[204:207]
  s_add_u32 s20, s20, 12288
  v_exp_f32 v196, v196
  v_mfma_f32_16x16x32_bf16 v[204:207], a[108:111], a[36:39], v[204:207]
  s_add_u32 m0, s21, 12288
  v_exp_f32 v197, v197
  v_mfma_f32_16x16x32_bf16 v[204:207], a[104:107], a[32:35], v[204:207]
  buffer_load_dwordx4 v242, s[8:11], s20 offen nt lds
  v_mfma_f32_16x16x32_bf16 v[204:207], a[100:103], a[28:31], v[204:207]
  v_exp_f32 v198, v198
  v_mfma_f32_16x16x32_bf16 v[204:207], a[96:99], a[24:27], v[204:207]
  v_exp_f32 v199, v199
  v_mfma_f32_16x16x32_bf16 v[96:99], a[144:147], v[208:211], v[96:99]
  v_fma_f32 v200, v200, s22, v229
  v_fma_f32 v201, v201, s22, v229
  v_mfma_f32_16x16x32_bf16 v[144:147], a[144:147], v[216:219], v[144:147]
  v_fma_f32 v202, v202, s22, v229
  v_fma_f32 v203, v203, s22, v229
  v_mfma_f32_16x16x32_bf16 v[148:151], a[148:151], v[216:219], v[148:151]
  buffer_load_dwordx4 v243, s[8:11], s20 offen offset:1024 nt lds
  v_mfma_f32_16x16x32_bf16 v[100:103], a[148:151], v[208:211], v[100:103]
  v_exp_f32 v200, v200
  v_mfma_f32_16x16x32_bf16 v[104:107], a[152:155], v[208:211], v[104:107]
  v_exp_f32 v201, v201
  v_mfma_f32_16x16x32_bf16 v[152:155], a[152:155], v[216:219], v[152:155]
  v_exp_f32 v202, v202
  v_mfma_f32_16x16x32_bf16 v[156:159], a[156:159], v[216:219], v[156:159]
  v_exp_f32 v203, v203
  v_mfma_f32_16x16x32_bf16 v[108:111], a[156:159], v[208:211], v[108:111]
  buffer_load_dwordx4 v244, s[8:11], s20 offen offset:2048 nt lds
  v_mfma_f32_16x16x32_bf16 v[112:115], a[160:163], v[208:211], v[112:115]
  v_fma_f32 v204, v204, s22, v229
  v_fma_f32 v205, v205, s22, v229
  v_mfma_f32_16x16x32_bf16 v[160:163], a[160:163], v[216:219], v[160:163]
  s_waitcnt vmcnt(19)
  v_fma_f32 v206, v206, s22, v229
  v_fma_f32 v207, v207, s22, v229
  v_mfma_f32_16x16x32_bf16 v[164:167], a[164:167], v[216:219], v[164:167]
  s_barrier
  v_exp_f32 v204, v204
  v_mfma_f32_16x16x32_bf16 v[116:119], a[164:167], v[208:211], v[116:119]
  v_exp_f32 v205, v205
  v_mfma_f32_16x16x32_bf16 v[120:123], a[168:171], v[208:211], v[120:123]
  ds_read_b64_tr_b16 a[144:145], v238 offset:12288
  v_add_f32 v224, v224, v192
  v_mfma_f32_16x16x32_bf16 v[168:171], a[168:171], v[216:219], v[168:171]
  ds_read_b64_tr_b16 a[146:147], v238 offset:18432
  v_add_f32 v224, v224, v193
  v_mfma_f32_16x16x32_bf16 v[172:175], a[172:175], v[216:219], v[172:175]
  v_exp_f32 v206, v206
  v_mfma_f32_16x16x32_bf16 v[124:127], a[172:175], v[208:211], v[124:127]
  ds_read_b64_tr_b16 a[148:149], v239 offset:12288
  v_add_f32 v224, v224, v194
  v_mfma_f32_16x16x32_bf16 v[128:131], a[176:179], v[208:211], v[128:131]
  ds_read_b64_tr_b16 a[150:151], v239 offset:18432
  v_add_f32 v224, v224, v195
  v_mfma_f32_16x16x32_bf16 v[176:179], a[176:179], v[216:219], v[176:179]
  v_exp_f32 v207, v207
  v_mfma_f32_16x16x32_bf16 v[180:183], a[180:183], v[216:219], v[180:183]
  s_add_u32 s24, s23, 215040
  ds_read_b64_tr_b16 a[152:153], v240 offset:12288
  v_cvt_pk_bf16_f32 v192, v192, v193
  v_mfma_f32_16x16x32_bf16 v[132:135], a[180:183], v[208:211], v[132:135]
  s_add_u32 m0, s30, 6144
  ds_read_b64_tr_b16 a[154:155], v240 offset:18432
  v_cvt_pk_bf16_f32 v193, v194, v195
  v_mfma_f32_16x16x32_bf16 v[136:139], a[184:187], v[208:211], v[136:139]
  buffer_load_dwordx4 v242, s[4:7], s24 offen nt lds
  v_add_f32 v224, v224, v196
  v_add_f32 v224, v224, v197
  v_mfma_f32_16x16x32_bf16 v[184:187], a[184:187], v[216:219], v[184:187]
  ds_read_b64_tr_b16 a[156:157], v241 offset:12288
  v_add_f32 v224, v224, v198
  v_mfma_f32_16x16x32_bf16 v[188:191], a[188:191], v[216:219], v[188:191]
  ds_read_b64_tr_b16 a[158:159], v241 offset:18432
  v_add_f32 v224, v224, v199
  v_mfma_f32_16x16x32_bf16 v[140:143], a[188:191], v[208:211], v[140:143]
  v_cvt_pk_bf16_f32 v194, v196, v197
  v_cvt_pk_bf16_f32 v195, v198, v199
  v_mfma_f32_16x16x32_bf16 v[208:211], a[96:99], a[48:51], v[232:235]
  ds_read_b64_tr_b16 a[160:161], v238 offset:12416
  v_add_f32 v225, v225, v200
  v_mfma_f32_16x16x32_bf16 v[208:211], a[100:103], a[52:55], v[208:211]
  ds_read_b64_tr_b16 a[162:163], v238 offset:18560
  v_add_f32 v225, v225, v201
  v_mfma_f32_16x16x32_bf16 v[208:211], a[104:107], a[56:59], v[208:211]
  v_add_f32 v225, v225, v202
  v_add_f32 v225, v225, v203
  v_mfma_f32_16x16x32_bf16 v[208:211], a[108:111], a[60:63], v[208:211]
  ds_read_b64_tr_b16 a[164:165], v239 offset:12416
  v_cvt_pk_bf16_f32 v203, v202, v203
  v_mfma_f32_16x16x32_bf16 v[208:211], a[112:115], a[64:67], v[208:211]
  ds_read_b64_tr_b16 a[166:167], v239 offset:18560
  v_cvt_pk_bf16_f32 v202, v200, v201
  v_mfma_f32_16x16x32_bf16 v[208:211], a[116:119], a[68:71], v[208:211]
  v_add_f32 v225, v225, v204
  v_add_f32 v225, v225, v205
  v_mfma_f32_16x16x32_bf16 v[212:215], a[140:143], a[68:71], v[232:235]
  ds_read_b64_tr_b16 a[168:169], v240 offset:12416
  v_add_f32 v225, v225, v206
  v_mfma_f32_16x16x32_bf16 v[212:215], a[136:139], a[64:67], v[212:215]
  ds_read_b64_tr_b16 a[170:171], v240 offset:18560
  v_add_f32 v225, v225, v207
  v_mfma_f32_16x16x32_bf16 v[212:215], a[132:135], a[60:63], v[212:215]
  v_cvt_pk_bf16_f32 v200, v204, v205
  v_cvt_pk_bf16_f32 v201, v206, v207
  v_mfma_f32_16x16x32_bf16 v[212:215], a[128:131], a[56:59], v[212:215]
  ds_read_b64_tr_b16 a[172:173], v241 offset:12416
  v_fma_f32 v208, v208, s22, v230
  v_mfma_f32_16x16x32_bf16 v[212:215], a[124:127], a[52:55], v[212:215]
  ds_read_b64_tr_b16 a[174:175], v241 offset:18560
  v_fma_f32 v209, v209, s22, v230
  v_mfma_f32_16x16x32_bf16 v[212:215], a[120:123], a[48:51], v[212:215]
  v_exp_f32 v208, v208
  v_mfma_f32_16x16x32_bf16 v[216:219], a[120:123], a[72:75], v[232:235]
  ds_read_b64_tr_b16 a[176:177], v238 offset:12544
  v_fma_f32 v210, v210, s22, v230
  v_mfma_f32_16x16x32_bf16 v[216:219], a[124:127], a[76:79], v[216:219]
  ds_read_b64_tr_b16 a[178:179], v238 offset:18688
  v_fma_f32 v211, v211, s22, v230
  v_mfma_f32_16x16x32_bf16 v[216:219], a[128:131], a[80:83], v[216:219]
  buffer_load_dwordx4 v243, s[4:7], s24 offen offset:1024 nt lds
  v_exp_f32 v209, v209
  v_mfma_f32_16x16x32_bf16 v[216:219], a[132:135], a[84:87], v[216:219]
  ds_read_b64_tr_b16 a[180:181], v239 offset:12544
  v_fma_f32 v212, v212, s22, v230
  v_mfma_f32_16x16x32_bf16 v[216:219], a[136:139], a[88:91], v[216:219]
  ds_read_b64_tr_b16 a[182:183], v239 offset:18688
  v_fma_f32 v213, v213, s22, v230
  v_mfma_f32_16x16x32_bf16 v[216:219], a[140:143], a[92:95], v[216:219]
  v_exp_f32 v210, v210
  v_mfma_f32_16x16x32_bf16 v[220:223], a[116:119], a[92:95], v[232:235]
  ds_read_b64_tr_b16 a[184:185], v240 offset:12544
  v_fma_f32 v214, v214, s22, v230
  v_mfma_f32_16x16x32_bf16 v[220:223], a[112:115], a[88:91], v[220:223]
  ds_read_b64_tr_b16 a[186:187], v240 offset:18688
  v_fma_f32 v215, v215, s22, v230
  v_mfma_f32_16x16x32_bf16 v[220:223], a[108:111], a[84:87], v[220:223]
  v_exp_f32 v211, v211
  v_mfma_f32_16x16x32_bf16 v[220:223], a[104:107], a[80:83], v[220:223]
  s_waitcnt vmcnt(16)
  ds_read_b64_tr_b16 a[188:189], v241 offset:12544
  v_fma_f32 v216, v216, s22, v231
  v_mfma_f32_16x16x32_bf16 v[220:223], a[100:103], a[76:79], v[220:223]
  s_barrier
  ds_read_b64_tr_b16 a[190:191], v241 offset:18688
  v_fma_f32 v217, v217, s22, v231
  v_mfma_f32_16x16x32_bf16 v[220:223], a[96:99], a[72:75], v[220:223]
  s_waitcnt lgkmcnt(4)
  v_exp_f32 v212, v212
  v_mfma_f32_16x16x32_bf16 v[0:3], a[144:147], v[192:195], v[0:3]
  ds_read_b128 a[96:99], v236 offset:36864
  v_fma_f32 v218, v218, s22, v231
  v_mfma_f32_16x16x32_bf16 v[48:51], a[144:147], v[200:203], v[48:51]
  v_exp_f32 v213, v213
  v_mfma_f32_16x16x32_bf16 v[52:55], a[148:151], v[200:203], v[52:55]
  ds_read_b128 a[100:103], v237 offset:36864
  v_fma_f32 v219, v219, s22, v231
  v_mfma_f32_16x16x32_bf16 v[4:7], a[148:151], v[192:195], v[4:7]
  v_exp_f32 v214, v214
  v_mfma_f32_16x16x32_bf16 v[8:11], a[152:155], v[192:195], v[8:11]
  ds_read_b128 a[104:107], v236 offset:36992
  v_fma_f32 v220, v220, s22, v231
  v_mfma_f32_16x16x32_bf16 v[56:59], a[152:155], v[200:203], v[56:59]
  v_exp_f32 v215, v215
  v_mfma_f32_16x16x32_bf16 v[60:63], a[156:159], v[200:203], v[60:63]
  ds_read_b128 a[108:111], v237 offset:36992
  v_fma_f32 v221, v221, s22, v231
  v_mfma_f32_16x16x32_bf16 v[12:15], a[156:159], v[192:195], v[12:15]
  v_exp_f32 v216, v216
  v_mfma_f32_16x16x32_bf16 v[16:19], a[160:163], v[192:195], v[16:19]
  ds_read_b128 a[112:115], v236 offset:37120
  v_fma_f32 v222, v222, s22, v231
  v_mfma_f32_16x16x32_bf16 v[64:67], a[160:163], v[200:203], v[64:67]
  v_exp_f32 v217, v217
  v_mfma_f32_16x16x32_bf16 v[68:71], a[164:167], v[200:203], v[68:71]
  ds_read_b128 a[116:119], v237 offset:37120
  v_fma_f32 v223, v223, s22, v231
  v_mfma_f32_16x16x32_bf16 v[20:23], a[164:167], v[192:195], v[20:23]
  v_exp_f32 v218, v218
  v_mfma_f32_16x16x32_bf16 v[24:27], a[168:171], v[192:195], v[24:27]
  ds_read_b128 a[140:143], v237 offset:43264
  v_add_f32 v226, v226, v208
  v_mfma_f32_16x16x32_bf16 v[72:75], a[168:171], v[200:203], v[72:75]
  v_exp_f32 v219, v219
  v_mfma_f32_16x16x32_bf16 v[76:79], a[172:175], v[200:203], v[76:79]
  ds_read_b128 a[136:139], v236 offset:43264
  v_add_f32 v226, v226, v209
  v_mfma_f32_16x16x32_bf16 v[28:31], a[172:175], v[192:195], v[28:31]
  v_exp_f32 v220, v220
  v_mfma_f32_16x16x32_bf16 v[32:35], a[176:179], v[192:195], v[32:35]
  ds_read_b128 a[132:135], v237 offset:43136
  v_add_f32 v226, v226, v210
  v_mfma_f32_16x16x32_bf16 v[80:83], a[176:179], v[200:203], v[80:83]
  v_exp_f32 v221, v221
  v_mfma_f32_16x16x32_bf16 v[84:87], a[180:183], v[200:203], v[84:87]
  ds_read_b128 a[128:131], v236 offset:43136
  v_add_f32 v226, v226, v211
  v_mfma_f32_16x16x32_bf16 v[36:39], a[180:183], v[192:195], v[36:39]
  s_waitcnt lgkmcnt(4)
  v_exp_f32 v222, v222
  v_mfma_f32_16x16x32_bf16 v[40:43], a[184:187], v[192:195], v[40:43]
  ds_read_b128 a[124:127], v237 offset:43008
  v_add_f32 v226, v226, v212
  v_mfma_f32_16x16x32_bf16 v[88:91], a[184:187], v[200:203], v[88:91]
  v_exp_f32 v223, v223
  v_mfma_f32_16x16x32_bf16 v[92:95], a[188:191], v[200:203], v[92:95]
  ds_read_b128 a[120:123], v236 offset:43008
  v_add_f32 v226, v226, v213
  v_mfma_f32_16x16x32_bf16 v[44:47], a[188:191], v[192:195], v[44:47]
  v_add_f32 v226, v226, v214
  v_add_f32 v226, v226, v215
  v_mfma_f32_16x16x32_bf16 v[192:195], a[96:99], a[0:3], v[232:235]
  v_cvt_pk_bf16_f32 v208, v208, v209
  v_cvt_pk_bf16_f32 v209, v210, v211
  v_mfma_f32_16x16x32_bf16 v[192:195], a[100:103], a[4:7], v[192:195]
  v_cvt_pk_bf16_f32 v210, v212, v213
  v_cvt_pk_bf16_f32 v211, v214, v215
  v_mfma_f32_16x16x32_bf16 v[192:195], a[104:107], a[8:11], v[192:195]
  v_add_f32 v227, v227, v216
  v_add_f32 v227, v227, v217
  v_mfma_f32_16x16x32_bf16 v[192:195], a[108:111], a[12:15], v[192:195]
  s_waitcnt vmcnt(10) lgkmcnt(0)
  v_add_f32 v227, v227, v218
  v_add_f32 v227, v227, v219
  v_mfma_f32_16x16x32_bf16 v[192:195], a[112:115], a[16:19], v[192:195]
  s_barrier
  v_add_f32 v227, v227, v220
  v_add_f32 v227, v227, v221
  v_mfma_f32_16x16x32_bf16 v[192:195], a[116:119], a[20:23], v[192:195]
  s_add_u32 m0, s21, 86016
  v_add_f32 v227, v227, v222
  v_add_f32 v227, v227, v223
  v_mfma_f32_16x16x32_bf16 v[196:199], a[140:143], a[20:23], v[232:235]
  buffer_load_dwordx4 v242, s[12:15], s20 offen nt lds
  v_mfma_f32_16x16x32_bf16 v[196:199], a[136:139], a[16:19], v[196:199]
  v_cvt_pk_bf16_f32 v219, v218, v219
  v_cvt_pk_bf16_f32 v218, v216, v217
  v_mfma_f32_16x16x32_bf16 v[196:199], a[132:135], a[12:15], v[196:199]
  v_cvt_pk_bf16_f32 v216, v220, v221
  v_cvt_pk_bf16_f32 v217, v222, v223
  v_mfma_f32_16x16x32_bf16 v[196:199], a[128:131], a[8:11], v[196:199]
  v_fma_f32 v192, v192, s22, v228
  v_fma_f32 v193, v193, s22, v228
  v_mfma_f32_16x16x32_bf16 v[196:199], a[124:127], a[4:7], v[196:199]
  v_fma_f32 v194, v194, s22, v228
  v_fma_f32 v195, v195, s22, v228
  v_mfma_f32_16x16x32_bf16 v[196:199], a[120:123], a[0:3], v[196:199]
  buffer_load_dwordx4 v243, s[12:15], s20 offen offset:1024 nt lds
  v_mfma_f32_16x16x32_bf16 v[200:203], a[120:123], a[24:27], v[232:235]
  v_exp_f32 v192, v192
  v_mfma_f32_16x16x32_bf16 v[200:203], a[124:127], a[28:31], v[200:203]
  v_exp_f32 v193, v193
  v_mfma_f32_16x16x32_bf16 v[200:203], a[128:131], a[32:35], v[200:203]
  v_exp_f32 v194, v194
  v_mfma_f32_16x16x32_bf16 v[200:203], a[132:135], a[36:39], v[200:203]
  v_exp_f32 v195, v195
  v_mfma_f32_16x16x32_bf16 v[200:203], a[136:139], a[40:43], v[200:203]
  buffer_load_dwordx4 v244, s[12:15], s20 offen offset:2048 nt lds
  v_mfma_f32_16x16x32_bf16 v[200:203], a[140:143], a[44:47], v[200:203]
  v_fma_f32 v196, v196, s22, v228
  v_fma_f32 v197, v197, s22, v228
  v_mfma_f32_16x16x32_bf16 v[204:207], a[116:119], a[44:47], v[232:235]
  v_fma_f32 v198, v198, s22, v228
  v_fma_f32 v199, v199, s22, v228
  v_mfma_f32_16x16x32_bf16 v[204:207], a[112:115], a[40:43], v[204:207]
  s_add_u32 s20, s20, 12288
  v_exp_f32 v196, v196
  v_mfma_f32_16x16x32_bf16 v[204:207], a[108:111], a[36:39], v[204:207]
  s_add_u32 m0, s21, 24576
  v_exp_f32 v197, v197
  v_mfma_f32_16x16x32_bf16 v[204:207], a[104:107], a[32:35], v[204:207]
  buffer_load_dwordx4 v242, s[8:11], s20 offen nt lds
  v_mfma_f32_16x16x32_bf16 v[204:207], a[100:103], a[28:31], v[204:207]
  v_exp_f32 v198, v198
  v_mfma_f32_16x16x32_bf16 v[204:207], a[96:99], a[24:27], v[204:207]
  v_exp_f32 v199, v199
  v_mfma_f32_16x16x32_bf16 v[96:99], a[144:147], v[208:211], v[96:99]
  v_fma_f32 v200, v200, s22, v229
  v_fma_f32 v201, v201, s22, v229
  v_mfma_f32_16x16x32_bf16 v[144:147], a[144:147], v[216:219], v[144:147]
  v_fma_f32 v202, v202, s22, v229
  v_fma_f32 v203, v203, s22, v229
  v_mfma_f32_16x16x32_bf16 v[148:151], a[148:151], v[216:219], v[148:151]
  buffer_load_dwordx4 v243, s[8:11], s20 offen offset:1024 nt lds
  v_mfma_f32_16x16x32_bf16 v[100:103], a[148:151], v[208:211], v[100:103]
  v_exp_f32 v200, v200
  v_mfma_f32_16x16x32_bf16 v[104:107], a[152:155], v[208:211], v[104:107]
  v_exp_f32 v201, v201
  v_mfma_f32_16x16x32_bf16 v[152:155], a[152:155], v[216:219], v[152:155]
  v_exp_f32 v202, v202
  v_mfma_f32_16x16x32_bf16 v[156:159], a[156:159], v[216:219], v[156:159]
  v_exp_f32 v203, v203
  v_mfma_f32_16x16x32_bf16 v[108:111], a[156:159], v[208:211], v[108:111]
  buffer_load_dwordx4 v244, s[8:11], s20 offen offset:2048 nt lds
  v_mfma_f32_16x16x32_bf16 v[112:115], a[160:163], v[208:211], v[112:115]
  v_fma_f32 v204, v204, s22, v229
  v_fma_f32 v205, v205, s22, v229
  v_mfma_f32_16x16x32_bf16 v[160:163], a[160:163], v[216:219], v[160:163]
  v_fma_f32 v206, v206, s22, v229
  v_fma_f32 v207, v207, s22, v229
  v_mfma_f32_16x16x32_bf16 v[164:167], a[164:167], v[216:219], v[164:167]
  v_exp_f32 v204, v204
  v_mfma_f32_16x16x32_bf16 v[116:119], a[164:167], v[208:211], v[116:119]
  v_exp_f32 v205, v205
  v_mfma_f32_16x16x32_bf16 v[120:123], a[168:171], v[208:211], v[120:123]
  ds_read_b64_tr_b16 a[144:145], v238 offset:0
  v_add_f32 v224, v224, v192
  v_mfma_f32_16x16x32_bf16 v[168:171], a[168:171], v[216:219], v[168:171]
  ds_read_b64_tr_b16 a[146:147], v238 offset:6144
  v_add_f32 v224, v224, v193
  v_mfma_f32_16x16x32_bf16 v[172:175], a[172:175], v[216:219], v[172:175]
  v_exp_f32 v206, v206
  v_mfma_f32_16x16x32_bf16 v[124:127], a[172:175], v[208:211], v[124:127]
  ds_read_b64_tr_b16 a[148:149], v239 offset:0
  v_add_f32 v224, v224, v194
  v_mfma_f32_16x16x32_bf16 v[128:131], a[176:179], v[208:211], v[128:131]
  ds_read_b64_tr_b16 a[150:151], v239 offset:6144
  v_add_f32 v224, v224, v195
  v_mfma_f32_16x16x32_bf16 v[176:179], a[176:179], v[216:219], v[176:179]
  v_exp_f32 v207, v207
  v_mfma_f32_16x16x32_bf16 v[180:183], a[180:183], v[216:219], v[180:183]
  s_add_u32 s24, s23, 215040
  ds_read_b64_tr_b16 a[152:153], v240 offset:0
  v_cvt_pk_bf16_f32 v192, v192, v193
  v_mfma_f32_16x16x32_bf16 v[132:135], a[180:183], v[208:211], v[132:135]
  s_add_u32 m0, s30, 6144
  ds_read_b64_tr_b16 a[154:155], v240 offset:6144
  v_cvt_pk_bf16_f32 v193, v194, v195
  v_mfma_f32_16x16x32_bf16 v[136:139], a[184:187], v[208:211], v[136:139]
  buffer_load_dwordx4 v244, s[4:7], s24 offen offset:2048 nt lds
  v_add_f32 v224, v224, v196
  v_add_f32 v224, v224, v197
  v_mfma_f32_16x16x32_bf16 v[184:187], a[184:187], v[216:219], v[184:187]
  ds_read_b64_tr_b16 a[156:157], v241 offset:0
  v_add_f32 v224, v224, v198
  v_mfma_f32_16x16x32_bf16 v[188:191], a[188:191], v[216:219], v[188:191]
  ds_read_b64_tr_b16 a[158:159], v241 offset:6144
  v_add_f32 v224, v224, v199
  v_mfma_f32_16x16x32_bf16 v[140:143], a[188:191], v[208:211], v[140:143]
  v_cvt_pk_bf16_f32 v194, v196, v197
  v_cvt_pk_bf16_f32 v195, v198, v199
  v_mfma_f32_16x16x32_bf16 v[208:211], a[96:99], a[48:51], v[232:235]
  s_add_u32 s24, s23, 218112
  ds_read_b64_tr_b16 a[160:161], v238 offset:128
  v_add_f32 v225, v225, v200
  v_mfma_f32_16x16x32_bf16 v[208:211], a[100:103], a[52:55], v[208:211]
  s_add_u32 m0, s30, 9216
  ds_read_b64_tr_b16 a[162:163], v238 offset:6272
  v_add_f32 v225, v225, v201
  v_mfma_f32_16x16x32_bf16 v[208:211], a[104:107], a[56:59], v[208:211]
  buffer_load_dwordx4 v242, s[4:7], s24 offen nt lds
  v_add_f32 v225, v225, v202
  v_add_f32 v225, v225, v203
  v_mfma_f32_16x16x32_bf16 v[208:211], a[108:111], a[60:63], v[208:211]
  ds_read_b64_tr_b16 a[164:165], v239 offset:128
  v_cvt_pk_bf16_f32 v203, v202, v203
  v_mfma_f32_16x16x32_bf16 v[208:211], a[112:115], a[64:67], v[208:211]
  ds_read_b64_tr_b16 a[166:167], v239 offset:6272
  v_cvt_pk_bf16_f32 v202, v200, v201
  v_mfma_f32_16x16x32_bf16 v[208:211], a[116:119], a[68:71], v[208:211]
  v_add_f32 v225, v225, v204
  v_add_f32 v225, v225, v205
  v_mfma_f32_16x16x32_bf16 v[212:215], a[140:143], a[68:71], v[232:235]
  s_add_u32 s25, s23, 196608
  ds_read_b64_tr_b16 a[168:169], v240 offset:128
  v_add_f32 v225, v225, v206
  v_mfma_f32_16x16x32_bf16 v[212:215], a[136:139], a[64:67], v[212:215]
  ds_read_b64_tr_b16 a[170:171], v240 offset:6272
  v_add_f32 v225, v225, v207
  v_mfma_f32_16x16x32_bf16 v[212:215], a[132:135], a[60:63], v[212:215]
  buffer_load_dwordx4 a[192:195], v245, s[4:7], s25 offen nt
  v_cvt_pk_bf16_f32 v200, v204, v205
  v_cvt_pk_bf16_f32 v201, v206, v207
  v_mfma_f32_16x16x32_bf16 v[212:215], a[128:131], a[56:59], v[212:215]
  ds_read_b64_tr_b16 a[172:173], v241 offset:128
  v_fma_f32 v208, v208, s22, v230
  v_mfma_f32_16x16x32_bf16 v[212:215], a[124:127], a[52:55], v[212:215]
  ds_read_b64_tr_b16 a[174:175], v241 offset:6272
  v_fma_f32 v209, v209, s22, v230
  v_mfma_f32_16x16x32_bf16 v[212:215], a[120:123], a[48:51], v[212:215]
  v_exp_f32 v208, v208
  v_mfma_f32_16x16x32_bf16 v[216:219], a[120:123], a[72:75], v[232:235]
  ds_read_b64_tr_b16 a[176:177], v238 offset:256
  v_fma_f32 v210, v210, s22, v230
  v_mfma_f32_16x16x32_bf16 v[216:219], a[124:127], a[76:79], v[216:219]
  ds_read_b64_tr_b16 a[178:179], v238 offset:6400
  v_fma_f32 v211, v211, s22, v230
  v_mfma_f32_16x16x32_bf16 v[216:219], a[128:131], a[80:83], v[216:219]
  buffer_load_dwordx4 a[196:199], v245, s[4:7], s25 offen offset:64 nt
  v_exp_f32 v209, v209
  v_mfma_f32_16x16x32_bf16 v[216:219], a[132:135], a[84:87], v[216:219]
  ds_read_b64_tr_b16 a[180:181], v239 offset:256
  v_fma_f32 v212, v212, s22, v230
  v_mfma_f32_16x16x32_bf16 v[216:219], a[136:139], a[88:91], v[216:219]
  ds_read_b64_tr_b16 a[182:183], v239 offset:6400
  v_fma_f32 v213, v213, s22, v230
  v_mfma_f32_16x16x32_bf16 v[216:219], a[140:143], a[92:95], v[216:219]
  v_exp_f32 v210, v210
  v_mfma_f32_16x16x32_bf16 v[220:223], a[116:119], a[92:95], v[232:235]
  ds_read_b64_tr_b16 a[184:185], v240 offset:256
  v_fma_f32 v214, v214, s22, v230
  v_mfma_f32_16x16x32_bf16 v[220:223], a[112:115], a[88:91], v[220:223]
  ds_read_b64_tr_b16 a[186:187], v240 offset:6400
  v_fma_f32 v215, v215, s22, v230
  v_mfma_f32_16x16x32_bf16 v[220:223], a[108:111], a[84:87], v[220:223]
  v_exp_f32 v211, v211
  v_mfma_f32_16x16x32_bf16 v[220:223], a[104:107], a[80:83], v[220:223]
  ds_read_b64_tr_b16 a[188:189], v241 offset:256
  v_fma_f32 v216, v216, s22, v231
  v_mfma_f32_16x16x32_bf16 v[220:223], a[100:103], a[76:79], v[220:223]
  ds_read_b64_tr_b16 a[190:191], v241 offset:6400
  v_fma_f32 v217, v217, s22, v231
  v_mfma_f32_16x16x32_bf16 v[220:223], a[96:99], a[72:75], v[220:223]
  s_waitcnt lgkmcnt(5)
  v_exp_f32 v212, v212
  v_mfma_f32_16x16x32_bf16 v[0:3], a[144:147], v[192:195], v[0:3]
  ds_read_b128 a[96:99], v236 offset:0
  v_fma_f32 v218, v218, s22, v231
  v_mfma_f32_16x16x32_bf16 v[48:51], a[144:147], v[200:203], v[48:51]
  v_exp_f32 v213, v213
  v_mfma_f32_16x16x32_bf16 v[52:55], a[148:151], v[200:203], v[52:55]
  ds_read_b128 a[100:103], v237 offset:0
  v_fma_f32 v219, v219, s22, v231
  v_mfma_f32_16x16x32_bf16 v[4:7], a[148:151], v[192:195], v[4:7]
  v_exp_f32 v214, v214
  v_mfma_f32_16x16x32_bf16 v[8:11], a[152:155], v[192:195], v[8:11]
  ds_read_b128 a[104:107], v236 offset:128
  v_fma_f32 v220, v220, s22, v231
  v_mfma_f32_16x16x32_bf16 v[56:59], a[152:155], v[200:203], v[56:59]
  v_exp_f32 v215, v215
  v_mfma_f32_16x16x32_bf16 v[60:63], a[156:159], v[200:203], v[60:63]
  ds_read_b128 a[108:111], v237 offset:128
  v_fma_f32 v221, v221, s22, v231
  v_mfma_f32_16x16x32_bf16 v[12:15], a[156:159], v[192:195], v[12:15]
  v_exp_f32 v216, v216
  v_mfma_f32_16x16x32_bf16 v[16:19], a[160:163], v[192:195], v[16:19]
  ds_read_b128 a[112:115], v236 offset:256
  v_fma_f32 v222, v222, s22, v231
  v_mfma_f32_16x16x32_bf16 v[64:67], a[160:163], v[200:203], v[64:67]
  v_exp_f32 v217, v217
  v_mfma_f32_16x16x32_bf16 v[68:71], a[164:167], v[200:203], v[68:71]
  ds_read_b128 a[116:119], v237 offset:256
  v_fma_f32 v223, v223, s22, v231
  v_mfma_f32_16x16x32_bf16 v[20:23], a[164:167], v[192:195], v[20:23]
  v_exp_f32 v218, v218
  v_mfma_f32_16x16x32_bf16 v[24:27], a[168:171], v[192:195], v[24:27]
  ds_read_b128 a[140:143], v237 offset:6400
  v_add_f32 v226, v226, v208
  v_mfma_f32_16x16x32_bf16 v[72:75], a[168:171], v[200:203], v[72:75]
  v_exp_f32 v219, v219
  v_mfma_f32_16x16x32_bf16 v[76:79], a[172:175], v[200:203], v[76:79]
  ds_read_b128 a[136:139], v236 offset:6400
  v_add_f32 v226, v226, v209
  v_mfma_f32_16x16x32_bf16 v[28:31], a[172:175], v[192:195], v[28:31]
  v_exp_f32 v220, v220
  v_mfma_f32_16x16x32_bf16 v[32:35], a[176:179], v[192:195], v[32:35]
  ds_read_b128 a[132:135], v237 offset:6272
  v_add_f32 v226, v226, v210
  v_mfma_f32_16x16x32_bf16 v[80:83], a[176:179], v[200:203], v[80:83]
  s_waitcnt lgkmcnt(4)
  v_exp_f32 v221, v221
  v_mfma_f32_16x16x32_bf16 v[84:87], a[180:183], v[200:203], v[84:87]
L_pg4:
  s_cbranch_execz L_pg8
  ds_read_b128 a[128:131], v236 offset:6272
  v_add_f32 v226, v226, v211
  v_mfma_f32_16x16x32_bf16 v[36:39], a[180:183], v[192:195], v[36:39]
  v_exp_f32 v222, v222
  v_mfma_f32_16x16x32_bf16 v[40:43], a[184:187], v[192:195], v[40:43]
  ds_read_b128 a[124:127], v237 offset:6144
  v_add_f32 v226, v226, v212
  v_mfma_f32_16x16x32_bf16 v[88:91], a[184:187], v[200:203], v[88:91]
  v_exp_f32 v223, v223
  v_mfma_f32_16x16x32_bf16 v[92:95], a[188:191], v[200:203], v[92:95]
  ds_read_b128 a[120:123], v236 offset:6144
  v_add_f32 v226, v226, v213
  v_mfma_f32_16x16x32_bf16 v[44:47], a[188:191], v[192:195], v[44:47]
  v_add_f32 v226, v226, v214
  v_add_f32 v226, v226, v215
  v_mfma_f32_16x16x32_bf16 v[192:195], a[96:99], a[0:3], v[232:235]
  v_cvt_pk_bf16_f32 v208, v208, v209
  v_cvt_pk_bf16_f32 v209, v210, v211
  v_mfma_f32_16x16x32_bf16 v[192:195], a[100:103], a[4:7], v[192:195]
  v_cvt_pk_bf16_f32 v210, v212, v213
  v_cvt_pk_bf16_f32 v211, v214, v215
  v_mfma_f32_16x16x32_bf16 v[192:195], a[104:107], a[8:11], v[192:195]
  v_add_f32 v227, v227, v216
  v_add_f32 v227, v227, v217
  v_mfma_f32_16x16x32_bf16 v[192:195], a[108:111], a[12:15], v[192:195]
  s_waitcnt vmcnt(12) lgkmcnt(0)
  v_add_f32 v227, v227, v218
  v_add_f32 v227, v227, v219
  v_mfma_f32_16x16x32_bf16 v[192:195], a[112:115], a[16:19], v[192:195]
  s_barrier
  v_add_f32 v227, v227, v220
  v_add_f32 v227, v227, v221
  v_mfma_f32_16x16x32_bf16 v[192:195], a[116:119], a[20:23], v[192:195]
  s_add_u32 m0, s21, 73728
  v_add_f32 v227, v227, v222
  v_add_f32 v227, v227, v223
  v_mfma_f32_16x16x32_bf16 v[196:199], a[140:143], a[20:23], v[232:235]
  buffer_load_dwordx4 v242, s[12:15], s20 offen nt lds
  v_mfma_f32_16x16x32_bf16 v[196:199], a[136:139], a[16:19], v[196:199]
  v_cvt_pk_bf16_f32 v219, v218, v219
  v_cvt_pk_bf16_f32 v218, v216, v217
  v_mfma_f32_16x16x32_bf16 v[196:199], a[132:135], a[12:15], v[196:199]
  v_cvt_pk_bf16_f32 v216, v220, v221
  v_cvt_pk_bf16_f32 v217, v222, v223
  v_mfma_f32_16x16x32_bf16 v[196:199], a[128:131], a[8:11], v[196:199]
  v_fma_f32 v192, v192, s22, v228
  v_fma_f32 v193, v193, s22, v228
  v_mfma_f32_16x16x32_bf16 v[196:199], a[124:127], a[4:7], v[196:199]
  v_fma_f32 v194, v194, s22, v228
  v_fma_f32 v195, v195, s22, v228
  v_mfma_f32_16x16x32_bf16 v[196:199], a[120:123], a[0:3], v[196:199]
  buffer_load_dwordx4 v243, s[12:15], s20 offen offset:1024 nt lds
  v_mfma_f32_16x16x32_bf16 v[200:203], a[120:123], a[24:27], v[232:235]
  v_exp_f32 v192, v192
  v_mfma_f32_16x16x32_bf16 v[200:203], a[124:127], a[28:31], v[200:203]
  v_exp_f32 v193, v193
  v_mfma_f32_16x16x32_bf16 v[200:203], a[128:131], a[32:35], v[200:203]
  v_exp_f32 v194, v194
  v_mfma_f32_16x16x32_bf16 v[200:203], a[132:135], a[36:39], v[200:203]
  v_exp_f32 v195, v195
  v_mfma_f32_16x16x32_bf16 v[200:203], a[136:139], a[40:43], v[200:203]
  buffer_load_dwordx4 v244, s[12:15], s20 offen offset:2048 nt lds
  v_mfma_f32_16x16x32_bf16 v[200:203], a[140:143], a[44:47], v[200:203]
  v_fma_f32 v196, v196, s22, v228
  v_fma_f32 v197, v197, s22, v228
  v_mfma_f32_16x16x32_bf16 v[204:207], a[116:119], a[44:47], v[232:235]
  v_fma_f32 v198, v198, s22, v228
  v_fma_f32 v199, v199, s22, v228
  v_mfma_f32_16x16x32_bf16 v[204:207], a[112:115], a[40:43], v[204:207]
  s_add_u32 s20, s20, 12288
  v_exp_f32 v196, v196
  v_mfma_f32_16x16x32_bf16 v[204:207], a[108:111], a[36:39], v[204:207]
  s_add_u32 m0, s21, 36864
  v_exp_f32 v197, v197
  v_mfma_f32_16x16x32_bf16 v[204:207], a[104:107], a[32:35], v[204:207]
  buffer_load_dwordx4 v242, s[8:11], s20 offen nt lds
  v_mfma_f32_16x16x32_bf16 v[204:207], a[100:103], a[28:31], v[204:207]
  v_exp_f32 v198, v198
  v_mfma_f32_16x16x32_bf16 v[204:207], a[96:99], a[24:27], v[204:207]
  v_exp_f32 v199, v199
  v_mfma_f32_16x16x32_bf16 v[96:99], a[144:147], v[208:211], v[96:99]
  v_fma_f32 v200, v200, s22, v229
  v_fma_f32 v201, v201, s22, v229
  v_mfma_f32_16x16x32_bf16 v[144:147], a[144:147], v[216:219], v[144:147]
  v_fma_f32 v202, v202, s22, v229
  v_fma_f32 v203, v203, s22, v229
  v_mfma_f32_16x16x32_bf16 v[148:151], a[148:151], v[216:219], v[148:151]
  buffer_load_dwordx4 v243, s[8:11], s20 offen offset:1024 nt lds
  v_mfma_f32_16x16x32_bf16 v[100:103], a[148:151], v[208:211], v[100:103]
  v_exp_f32 v200, v200
  v_mfma_f32_16x16x32_bf16 v[104:107], a[152:155], v[208:211], v[104:107]
  v_exp_f32 v201, v201
  v_mfma_f32_16x16x32_bf16 v[152:155], a[152:155], v[216:219], v[152:155]
  v_exp_f32 v202, v202
  v_mfma_f32_16x16x32_bf16 v[156:159], a[156:159], v[216:219], v[156:159]
  v_exp_f32 v203, v203
  v_mfma_f32_16x16x32_bf16 v[108:111], a[156:159], v[208:211], v[108:111]
  buffer_load_dwordx4 v244, s[8:11], s20 offen offset:2048 nt lds
  v_mfma_f32_16x16x32_bf16 v[112:115], a[160:163], v[208:211], v[112:115]
  v_fma_f32 v204, v204, s22, v229
  v_fma_f32 v205, v205, s22, v229
  v_mfma_f32_16x16x32_bf16 v[160:163], a[160:163], v[216:219], v[160:163]
  v_fma_f32 v206, v206, s22, v229
  v_fma_f32 v207, v207, s22, v229
  v_mfma_f32_16x16x32_bf16 v[164:167], a[164:167], v[216:219], v[164:167]
  v_exp_f32 v204, v204
  v_mfma_f32_16x16x32_bf16 v[116:119], a[164:167], v[208:211], v[116:119]
  v_exp_f32 v205, v205
  v_mfma_f32_16x16x32_bf16 v[120:123], a[168:171], v[208:211], v[120:123]
  ds_read_b64_tr_b16 a[144:145], v238 offset:36864
  v_add_f32 v224, v224, v192
  v_mfma_f32_16x16x32_bf16 v[168:171], a[168:171], v[216:219], v[168:171]
  ds_read_b64_tr_b16 a[146:147], v238 offset:43008
  v_add_f32 v224, v224, v193
  v_mfma_f32_16x16x32_bf16 v[172:175], a[172:175], v[216:219], v[172:175]
  v_exp_f32 v206, v206
  v_mfma_f32_16x16x32_bf16 v[124:127], a[172:175], v[208:211], v[124:127]
  ds_read_b64_tr_b16 a[148:149], v239 offset:36864
  v_add_f32 v224, v224, v194
  v_mfma_f32_16x16x32_bf16 v[128:131], a[176:179], v[208:211], v[128:131]
  ds_read_b64_tr_b16 a[150:151], v239 offset:43008
  v_add_f32 v224, v224, v195
  v_mfma_f32_16x16x32_bf16 v[176:179], a[176:179], v[216:219], v[176:179]
  v_exp_f32 v207, v207
  v_mfma_f32_16x16x32_bf16 v[180:183], a[180:183], v[216:219], v[180:183]
  s_add_u32 s24, s23, 218112
  ds_read_b64_tr_b16 a[152:153], v240 offset:36864
  v_cvt_pk_bf16_f32 v192, v192, v193
  v_mfma_f32_16x16x32_bf16 v[132:135], a[180:183], v[208:211], v[132:135]
  s_add_u32 m0, s30, 9216
  ds_read_b64_tr_b16 a[154:155], v240 offset:43008
  v_cvt_pk_bf16_f32 v193, v194, v195
  v_mfma_f32_16x16x32_bf16 v[136:139], a[184:187], v[208:211], v[136:139]
  buffer_load_dwordx4 v243, s[4:7], s24 offen offset:1024 nt lds
  v_add_f32 v224, v224, v196
  v_add_f32 v224, v224, v197
  v_mfma_f32_16x16x32_bf16 v[184:187], a[184:187], v[216:219], v[184:187]
  ds_read_b64_tr_b16 a[156:157], v241 offset:36864
  v_add_f32 v224, v224, v198
  v_mfma_f32_16x16x32_bf16 v[188:191], a[188:191], v[216:219], v[188:191]
  ds_read_b64_tr_b16 a[158:159], v241 offset:43008
  v_add_f32 v224, v224, v199
  v_mfma_f32_16x16x32_bf16 v[140:143], a[188:191], v[208:211], v[140:143]
  v_cvt_pk_bf16_f32 v194, v196, v197
  v_cvt_pk_bf16_f32 v195, v198, v199
  v_mfma_f32_16x16x32_bf16 v[208:211], a[96:99], a[48:51], v[232:235]
  ds_read_b64_tr_b16 a[160:161], v238 offset:36992
  v_add_f32 v225, v225, v200
  v_mfma_f32_16x16x32_bf16 v[208:211], a[100:103], a[52:55], v[208:211]
  ds_read_b64_tr_b16 a[162:163], v238 offset:43136
  v_add_f32 v225, v225, v201
  v_mfma_f32_16x16x32_bf16 v[208:211], a[104:107], a[56:59], v[208:211]
  buffer_load_dwordx4 v244, s[4:7], s24 offen offset:2048 nt lds
  v_add_f32 v225, v225, v202
  v_add_f32 v225, v225, v203
  v_mfma_f32_16x16x32_bf16 v[208:211], a[108:111], a[60:63], v[208:211]
  ds_read_b64_tr_b16 a[164:165], v239 offset:36992
  v_cvt_pk_bf16_f32 v203, v202, v203
  v_mfma_f32_16x16x32_bf16 v[208:211], a[112:115], a[64:67], v[208:211]
  ds_read_b64_tr_b16 a[166:167], v239 offset:43136
  v_cvt_pk_bf16_f32 v202, v200, v201
  v_mfma_f32_16x16x32_bf16 v[208:211], a[116:119], a[68:71], v[208:211]
  v_add_f32 v225, v225, v204
  v_add_f32 v225, v225, v205
  v_mfma_f32_16x16x32_bf16 v[212:215], a[140:143], a[68:71], v[232:235]
  s_add_u32 s25, s23, 196608
  ds_read_b64_tr_b16 a[168:169], v240 offset:36992
  v_add_f32 v225, v225, v206
  v_mfma_f32_16x16x32_bf16 v[212:215], a[136:139], a[64:67], v[212:215]
  ds_read_b64_tr_b16 a[170:171], v240 offset:43136
  v_add_f32 v225, v225, v207
  v_mfma_f32_16x16x32_bf16 v[212:215], a[132:135], a[60:63], v[212:215]
  buffer_load_dwordx4 a[200:203], v245, s[4:7], s25 offen offset:128 nt
  v_cvt_pk_bf16_f32 v200, v204, v205
  v_cvt_pk_bf16_f32 v201, v206, v207
  v_mfma_f32_16x16x32_bf16 v[212:215], a[128:131], a[56:59], v[212:215]
  ds_read_b64_tr_b16 a[172:173], v241 offset:36992
  v_fma_f32 v208, v208, s22, v230
  v_mfma_f32_16x16x32_bf16 v[212:215], a[124:127], a[52:55], v[212:215]
  ds_read_b64_tr_b16 a[174:175], v241 offset:43136
  v_fma_f32 v209, v209, s22, v230
  v_mfma_f32_16x16x32_bf16 v[212:215], a[120:123], a[48:51], v[212:215]
  v_exp_f32 v208, v208
  v_mfma_f32_16x16x32_bf16 v[216:219], a[120:123], a[72:75], v[232:235]
  ds_read_b64_tr_b16 a[176:177], v238 offset:37120
  v_fma_f32 v210, v210, s22, v230
  v_mfma_f32_16x16x32_bf16 v[216:219], a[124:127], a[76:79], v[216:219]
  ds_read_b64_tr_b16 a[178:179], v238 offset:43264
  v_fma_f32 v211, v211, s22, v230
  v_mfma_f32_16x16x32_bf16 v[216:219], a[128:131], a[80:83], v[216:219]
  buffer_load_dwordx4 a[204:207], v245, s[4:7], s25 offen offset:192 nt
  v_exp_f32 v209, v209
  v_mfma_f32_16x16x32_bf16 v[216:219], a[132:135], a[84:87], v[216:219]
  ds_read_b64_tr_b16 a[180:181], v239 offset:37120
  v_fma_f32 v212, v212, s22, v230
  v_mfma_f32_16x16x32_bf16 v[216:219], a[136:139], a[88:91], v[216:219]
  ds_read_b64_tr_b16 a[182:183], v239 offset:43264
  v_fma_f32 v213, v213, s22, v230
  v_mfma_f32_16x16x32_bf16 v[216:219], a[140:143], a[92:95], v[216:219]
  v_exp_f32 v210, v210
  v_mfma_f32_16x16x32_bf16 v[220:223], a[116:119], a[92:95], v[232:235]
  ds_read_b64_tr_b16 a[184:185], v240 offset:37120
  v_fma_f32 v214, v214, s22, v230
  v_mfma_f32_16x16x32_bf16 v[220:223], a[112:115], a[88:91], v[220:223]
  ds_read_b64_tr_b16 a[186:187], v240 offset:43264
  v_fma_f32 v215, v215, s22, v230
  v_mfma_f32_16x16x32_bf16 v[220:223], a[108:111], a[84:87], v[220:223]
  v_exp_f32 v211, v211
  v_mfma_f32_16x16x32_bf16 v[220:223], a[104:107], a[80:83], v[220:223]
  ds_read_b64_tr_b16 a[188:189], v241 offset:37120
  v_fma_f32 v216, v216, s22, v231
  v_mfma_f32_16x16x32_bf16 v[220:223], a[100:103], a[76:79], v[220:223]
  ds_read_b64_tr_b16 a[190:191], v241 offset:43264
  v_fma_f32 v217, v217, s22, v231
  v_mfma_f32_16x16x32_bf16 v[220:223], a[96:99], a[72:75], v[220:223]
  s_waitcnt lgkmcnt(5)
  v_exp_f32 v212, v212
  v_mfma_f32_16x16x32_bf16 v[0:3], a[144:147], v[192:195], v[0:3]
  ds_read_b128 a[96:99], v236 offset:12288
  v_fma_f32 v218, v218, s22, v231
  v_mfma_f32_16x16x32_bf16 v[48:51], a[144:147], v[200:203], v[48:51]
  v_exp_f32 v213, v213
  v_mfma_f32_16x16x32_bf16 v[52:55], a[148:151], v[200:203], v[52:55]
  ds_read_b128 a[100:103], v237 offset:12288
  v_fma_f32 v219, v219, s22, v231
  v_mfma_f32_16x16x32_bf16 v[4:7], a[148:151], v[192:195], v[4:7]
  v_exp_f32 v214, v214
  v_mfma_f32_16x16x32_bf16 v[8:11], a[152:155], v[192:195], v[8:11]
  ds_read_b128 a[104:107], v236 offset:12416
  v_fma_f32 v220, v220, s22, v231
  v_mfma_f32_16x16x32_bf16 v[56:59], a[152:155], v[200:203], v[56:59]
  v_exp_f32 v215, v215
  v_mfma_f32_16x16x32_bf16 v[60:63], a[156:159], v[200:203], v[60:63]
  ds_read_b128 a[108:111], v237 offset:12416
  v_fma_f32 v221, v221, s22, v231
  v_mfma_f32_16x16x32_bf16 v[12:15], a[156:159], v[192:195], v[12:15]
  v_exp_f32 v216, v216
  v_mfma_f32_16x16x32_bf16 v[16:19], a[160:163], v[192:195], v[16:19]
  ds_read_b128 a[112:115], v236 offset:12544
  v_fma_f32 v222, v222, s22, v231
  v_mfma_f32_16x16x32_bf16 v[64:67], a[160:163], v[200:203], v[64:67]
  v_exp_f32 v217, v217
  v_mfma_f32_16x16x32_bf16 v[68:71], a[164:167], v[200:203], v[68:71]
  ds_read_b128 a[116:119], v237 offset:12544
  v_fma_f32 v223, v223, s22, v231
  v_mfma_f32_16x16x32_bf16 v[20:23], a[164:167], v[192:195], v[20:23]
  v_exp_f32 v218, v218
  v_mfma_f32_16x16x32_bf16 v[24:27], a[168:171], v[192:195], v[24:27]
  ds_read_b128 a[140:143], v237 offset:18688
  v_add_f32 v226, v226, v208
  v_mfma_f32_16x16x32_bf16 v[72:75], a[168:171], v[200:203], v[72:75]
  v_exp_f32 v219, v219
  v_mfma_f32_16x16x32_bf16 v[76:79], a[172:175], v[200:203], v[76:79]
  ds_read_b128 a[136:139], v236 offset:18688
  v_add_f32 v226, v226, v209
  v_mfma_f32_16x16x32_bf16 v[28:31], a[172:175], v[192:195], v[28:31]
  v_exp_f32 v220, v220
  v_mfma_f32_16x16x32_bf16 v[32:35], a[176:179], v[192:195], v[32:35]
  ds_read_b128 a[132:135], v237 offset:18560
  v_add_f32 v226, v226, v210
  v_mfma_f32_16x16x32_bf16 v[80:83], a[176:179], v[200:203], v[80:83]
  s_waitcnt lgkmcnt(4)
  v_exp_f32 v221, v221
  v_mfma_f32_16x16x32_bf16 v[84:87], a[180:183], v[200:203], v[84:87]
  ds_read_b128 a[128:131], v236 offset:18560
  v_add_f32 v226, v226, v211
  v_mfma_f32_16x16x32_bf16 v[36:39], a[180:183], v[192:195], v[36:39]
  v_exp_f32 v222, v222
  v_mfma_f32_16x16x32_bf16 v[40:43], a[184:187], v[192:195], v[40:43]
  ds_read_b128 a[124:127], v237 offset:18432
  v_add_f32 v226, v226, v212
  v_mfma_f32_16x16x32_bf16 v[88:91], a[184:187], v[200:203], v[88:91]
  v_exp_f32 v223, v223
  v_mfma_f32_16x16x32_bf16 v[92:95], a[188:191], v[200:203], v[92:95]
  ds_read_b128 a[120:123], v236 offset:18432
  v_add_f32 v226, v226, v213
  v_mfma_f32_16x16x32_bf16 v[44:47], a[188:191], v[192:195], v[44:47]
  v_add_f32 v226, v226, v214
  v_add_f32 v226, v226, v215
  v_mfma_f32_16x16x32_bf16 v[192:195], a[96:99], a[0:3], v[232:235]
  v_cvt_pk_bf16_f32 v208, v208, v209
  v_cvt_pk_bf16_f32 v209, v210, v211
  v_mfma_f32_16x16x32_bf16 v[192:195], a[100:103], a[4:7], v[192:195]
  v_cvt_pk_bf16_f32 v210, v212, v213
  v_cvt_pk_bf16_f32 v211, v214, v215
  v_mfma_f32_16x16x32_bf16 v[192:195], a[104:107], a[8:11], v[192:195]
  v_add_f32 v227, v227, v216
  v_add_f32 v227, v227, v217
  v_mfma_f32_16x16x32_bf16 v[192:195], a[108:111], a[12:15], v[192:195]
  s_waitcnt vmcnt(14) lgkmcnt(0)
  v_add_f32 v227, v227, v218
  v_add_f32 v227, v227, v219
  v_mfma_f32_16x16x32_bf16 v[192:195], a[112:115], a[16:19], v[192:195]
  s_barrier
  v_add_f32 v227, v227, v220
  v_add_f32 v227, v227, v221
  v_mfma_f32_16x16x32_bf16 v[192:195], a[116:119], a[20:23], v[192:195]
  s_add_u32 m0, s21, 61440
  v_add_f32 v227, v227, v222
  v_add_f32 v227, v227, v223
  v_mfma_f32_16x16x32_bf16 v[196:199], a[140:143], a[20:23], v[232:235]
  buffer_load_dwordx4 v242, s[12:15], s20 offen nt lds
  v_mfma_f32_16x16x32_bf16 v[196:199], a[136:139], a[16:19], v[196:199]
  v_cvt_pk_bf16_f32 v219, v218, v219
  v_cvt_pk_bf16_f32 v218, v216, v217
  v_mfma_f32_16x16x32_bf16 v[196:199], a[132:135], a[12:15], v[196:199]
  v_cvt_pk_bf16_f32 v216, v220, v221
  v_cvt_pk_bf16_f32 v217, v222, v223
  v_mfma_f32_16x16x32_bf16 v[196:199], a[128:131], a[8:11], v[196:199]
  v_fma_f32 v192, v192, s22, v228
  v_fma_f32 v193, v193, s22, v228
  v_mfma_f32_16x16x32_bf16 v[196:199], a[124:127], a[4:7], v[196:199]
  v_fma_f32 v194, v194, s22, v228
  v_fma_f32 v195, v195, s22, v228
  v_mfma_f32_16x16x32_bf16 v[196:199], a[120:123], a[0:3], v[196:199]
  buffer_load_dwordx4 v243, s[12:15], s20 offen offset:1024 nt lds
  v_mfma_f32_16x16x32_bf16 v[200:203], a[120:123], a[24:27], v[232:235]
  v_exp_f32 v192, v192
  v_mfma_f32_16x16x32_bf16 v[200:203], a[124:127], a[28:31], v[200:203]
  v_exp_f32 v193, v193
  v_mfma_f32_16x16x32_bf16 v[200:203], a[128:131], a[32:35], v[200:203]
  v_exp_f32 v194, v194
  v_mfma_f32_16x16x32_bf16 v[200:203], a[132:135], a[36:39], v[200:203]
  v_exp_f32 v195, v195
  v_mfma_f32_16x16x32_bf16 v[200:203], a[136:139], a[40:43], v[200:203]
  buffer_load_dwordx4 v244, s[12:15], s20 offen offset:2048 nt lds
  v_mfma_f32_16x16x32_bf16 v[200:203], a[140:143], a[44:47], v[200:203]
  v_fma_f32 v196, v196, s22, v228
  v_fma_f32 v197, v197, s22, v228
  v_mfma_f32_16x16x32_bf16 v[204:207], a[116:119], a[44:47], v[232:235]
  v_fma_f32 v198, v198, s22, v228
  v_fma_f32 v199, v199, s22, v228
  v_mfma_f32_16x16x32_bf16 v[204:207], a[112:115], a[40:43], v[204:207]
  s_add_u32 s20, s20, 12288
  v_exp_f32 v196, v196
  v_mfma_f32_16x16x32_bf16 v[204:207], a[108:111], a[36:39], v[204:207]
  s_add_u32 m0, s21, 0
  v_exp_f32 v197, v197
  v_mfma_f32_16x16x32_bf16 v[204:207], a[104:107], a[32:35], v[204:207]
  buffer_load_dwordx4 v242, s[8:11], s20 offen nt lds
  v_mfma_f32_16x16x32_bf16 v[204:207], a[100:103], a[28:31], v[204:207]
  v_exp_f32 v198, v198
  v_mfma_f32_16x16x32_bf16 v[204:207], a[96:99], a[24:27], v[204:207]
  v_exp_f32 v199, v199
  v_mfma_f32_16x16x32_bf16 v[96:99], a[144:147], v[208:211], v[96:99]
  v_fma_f32 v200, v200, s22, v229
  v_fma_f32 v201, v201, s22, v229
  v_mfma_f32_16x16x32_bf16 v[144:147], a[144:147], v[216:219], v[144:147]
  v_fma_f32 v202, v202, s22, v229
  v_fma_f32 v203, v203, s22, v229
  v_mfma_f32_16x16x32_bf16 v[148:151], a[148:151], v[216:219], v[148:151]
  buffer_load_dwordx4 v243, s[8:11], s20 offen offset:1024 nt lds
  v_mfma_f32_16x16x32_bf16 v[100:103], a[148:151], v[208:211], v[100:103]
  v_exp_f32 v200, v200
  v_mfma_f32_16x16x32_bf16 v[104:107], a[152:155], v[208:211], v[104:107]
  v_exp_f32 v201, v201
  v_mfma_f32_16x16x32_bf16 v[152:155], a[152:155], v[216:219], v[152:155]
  v_exp_f32 v202, v202
  v_mfma_f32_16x16x32_bf16 v[156:159], a[156:159], v[216:219], v[156:159]
  v_exp_f32 v203, v203
  v_mfma_f32_16x16x32_bf16 v[108:111], a[156:159], v[208:211], v[108:111]
  buffer_load_dwordx4 v244, s[8:11], s20 offen offset:2048 nt lds
  v_mfma_f32_16x16x32_bf16 v[112:115], a[160:163], v[208:211], v[112:115]
  v_fma_f32 v204, v204, s22, v229
  v_fma_f32 v205, v205, s22, v229
  v_mfma_f32_16x16x32_bf16 v[160:163], a[160:163], v[216:219], v[160:163]
  v_fma_f32 v206, v206, s22, v229
  v_fma_f32 v207, v207, s22, v229
  v_mfma_f32_16x16x32_bf16 v[164:167], a[164:167], v[216:219], v[164:167]
  v_exp_f32 v204, v204
  v_mfma_f32_16x16x32_bf16 v[116:119], a[164:167], v[208:211], v[116:119]
  v_exp_f32 v205, v205
  v_mfma_f32_16x16x32_bf16 v[120:123], a[168:171], v[208:211], v[120:123]
  ds_read_b64_tr_b16 a[144:145], v238 offset:24576
  v_add_f32 v224, v224, v192
  v_mfma_f32_16x16x32_bf16 v[168:171], a[168:171], v[216:219], v[168:171]
  ds_read_b64_tr_b16 a[146:147], v238 offset:30720
  v_add_f32 v224, v224, v193
  v_mfma_f32_16x16x32_bf16 v[172:175], a[172:175], v[216:219], v[172:175]
  v_exp_f32 v206, v206
  v_mfma_f32_16x16x32_bf16 v[124:127], a[172:175], v[208:211], v[124:127]
  ds_read_b64_tr_b16 a[148:149], v239 offset:24576
  v_add_f32 v224, v224, v194
  v_mfma_f32_16x16x32_bf16 v[128:131], a[176:179], v[208:211], v[128:131]
  ds_read_b64_tr_b16 a[150:151], v239 offset:30720
  v_add_f32 v224, v224, v195
  v_mfma_f32_16x16x32_bf16 v[176:179], a[176:179], v[216:219], v[176:179]
  v_exp_f32 v207, v207
  v_mfma_f32_16x16x32_bf16 v[180:183], a[180:183], v[216:219], v[180:183]
  s_add_u32 s25, s23, 196608
  ds_read_b64_tr_b16 a[152:153], v240 offset:24576
  v_cvt_pk_bf16_f32 v192, v192, v193
  v_mfma_f32_16x16x32_bf16 v[132:135], a[180:183], v[208:211], v[132:135]
  ds_read_b64_tr_b16 a[154:155], v240 offset:30720
  v_cvt_pk_bf16_f32 v193, v194, v195
  v_mfma_f32_16x16x32_bf16 v[136:139], a[184:187], v[208:211], v[136:139]
  buffer_load_dwordx4 a[208:211], v245, s[4:7], s25 offen offset:256 nt
  v_add_f32 v224, v224, v196
  v_add_f32 v224, v224, v197
  v_mfma_f32_16x16x32_bf16 v[184:187], a[184:187], v[216:219], v[184:187]
  ds_read_b64_tr_b16 a[156:157], v241 offset:24576
  v_add_f32 v224, v224, v198
  v_mfma_f32_16x16x32_bf16 v[188:191], a[188:191], v[216:219], v[188:191]
  ds_read_b64_tr_b16 a[158:159], v241 offset:30720
  v_add_f32 v224, v224, v199
  v_mfma_f32_16x16x32_bf16 v[140:143], a[188:191], v[208:211], v[140:143]
  v_cvt_pk_bf16_f32 v194, v196, v197
  v_cvt_pk_bf16_f32 v195, v198, v199
  v_mfma_f32_16x16x32_bf16 v[208:211], a[96:99], a[48:51], v[232:235]
  ds_read_b64_tr_b16 a[160:161], v238 offset:24704
  v_add_f32 v225, v225, v200
  v_mfma_f32_16x16x32_bf16 v[208:211], a[100:103], a[52:55], v[208:211]
  ds_read_b64_tr_b16 a[162:163], v238 offset:30848
  v_add_f32 v225, v225, v201
  v_mfma_f32_16x16x32_bf16 v[208:211], a[104:107], a[56:59], v[208:211]
  v_add_f32 v225, v225, v202
  v_add_f32 v225, v225, v203
  v_mfma_f32_16x16x32_bf16 v[208:211], a[108:111], a[60:63], v[208:211]
  ds_read_b64_tr_b16 a[164:165], v239 offset:24704
  v_cvt_pk_bf16_f32 v203, v202, v203
  v_mfma_f32_16x16x32_bf16 v[208:211], a[112:115], a[64:67], v[208:211]
  ds_read_b64_tr_b16 a[166:167], v239 offset:30848
  v_cvt_pk_bf16_f32 v202, v200, v201
  v_mfma_f32_16x16x32_bf16 v[208:211], a[116:119], a[68:71], v[208:211]
  v_add_f32 v225, v225, v204
  v_add_f32 v225, v225, v205
  v_mfma_f32_16x16x32_bf16 v[212:215], a[140:143], a[68:71], v[232:235]
  ds_read_b64_tr_b16 a[168:169], v240 offset:24704
  v_add_f32 v225, v225, v206
  v_mfma_f32_16x16x32_bf16 v[212:215], a[136:139], a[64:67], v[212:215]
  ds_read_b64_tr_b16 a[170:171], v240 offset:30848
  v_add_f32 v225, v225, v207
  v_mfma_f32_16x16x32_bf16 v[212:215], a[132:135], a[60:63], v[212:215]
  v_cvt_pk_bf16_f32 v200, v204, v205
  v_cvt_pk_bf16_f32 v201, v206, v207
  v_mfma_f32_16x16x32_bf16 v[212:215], a[128:131], a[56:59], v[212:215]
  ds_read_b64_tr_b16 a[172:173], v241 offset:24704
  v_fma_f32 v208, v208, s22, v230
  v_mfma_f32_16x16x32_bf16 v[212:215], a[124:127], a[52:55], v[212:215]
  ds_read_b64_tr_b16 a[174:175], v241 offset:30848
  v_fma_f32 v209, v209, s22, v230
  v_mfma_f32_16x16x32_bf16 v[212:215], a[120:123], a[48:51], v[212:215]
  v_exp_f32 v208, v208
  v_mfma_f32_16x16x32_bf16 v[216:219], a[120:123], a[72:75], v[232:235]
  ds_read_b64_tr_b16 a[176:177], v238 offset:24832
  v_fma_f32 v210, v210, s22, v230
  v_mfma_f32_16x16x32_bf16 v[216:219], a[124:127], a[76:79], v[216:219]
  ds_read_b64_tr_b16 a[178:179], v238 offset:30976
  v_fma_f32 v211, v211, s22, v230
  v_mfma_f32_16x16x32_bf16 v[216:219], a[128:131], a[80:83], v[216:219]
  buffer_load_dwordx4 a[212:215], v245, s[4:7], s25 offen offset:320 nt
  v_exp_f32 v209, v209
  v_mfma_f32_16x16x32_bf16 v[216:219], a[132:135], a[84:87], v[216:219]
  ds_read_b64_tr_b16 a[180:181], v239 offset:24832
  v_fma_f32 v212, v212, s22, v230
  v_mfma_f32_16x16x32_bf16 v[216:219], a[136:139], a[88:91], v[216:219]
  ds_read_b64_tr_b16 a[182:183], v239 offset:30976
  v_fma_f32 v213, v213, s22, v230
  v_mfma_f32_16x16x32_bf16 v[216:219], a[140:143], a[92:95], v[216:219]
  v_exp_f32 v210, v210
  v_mfma_f32_16x16x32_bf16 v[220:223], a[116:119], a[92:95], v[232:235]
  ds_read_b64_tr_b16 a[184:185], v240 offset:24832
  v_fma_f32 v214, v214, s22, v230
  v_mfma_f32_16x16x32_bf16 v[220:223], a[112:115], a[88:91], v[220:223]
  ds_read_b64_tr_b16 a[186:187], v240 offset:30976
  v_fma_f32 v215, v215, s22, v230
  v_mfma_f32_16x16x32_bf16 v[220:223], a[108:111], a[84:87], v[220:223]
  v_exp_f32 v211, v211
  v_mfma_f32_16x16x32_bf16 v[220:223], a[104:107], a[80:83], v[220:223]
  ds_read_b64_tr_b16 a[188:189], v241 offset:24832
  v_fma_f32 v216, v216, s22, v231
  v_mfma_f32_16x16x32_bf16 v[220:223], a[100:103], a[76:79], v[220:223]
  ds_read_b64_tr_b16 a[190:191], v241 offset:30976
  v_fma_f32 v217, v217, s22, v231
  v_mfma_f32_16x16x32_bf16 v[220:223], a[96:99], a[72:75], v[220:223]
  s_waitcnt lgkmcnt(5)
  v_exp_f32 v212, v212
  v_mfma_f32_16x16x32_bf16 v[0:3], a[144:147], v[192:195], v[0:3]
  ds_read_b128 a[96:99], v236 offset:24576
  v_fma_f32 v218, v218, s22, v231
  v_mfma_f32_16x16x32_bf16 v[48:51], a[144:147], v[200:203], v[48:51]
  v_exp_f32 v213, v213
  v_mfma_f32_16x16x32_bf16 v[52:55], a[148:151], v[200:203], v[52:55]
  ds_read_b128 a[100:103], v237 offset:24576
  v_fma_f32 v219, v219, s22, v231
  v_mfma_f32_16x16x32_bf16 v[4:7], a[148:151], v[192:195], v[4:7]
  v_exp_f32 v214, v214
  v_mfma_f32_16x16x32_bf16 v[8:11], a[152:155], v[192:195], v[8:11]
  ds_read_b128 a[104:107], v236 offset:24704
  v_fma_f32 v220, v220, s22, v231
  v_mfma_f32_16x16x32_bf16 v[56:59], a[152:155], v[200:203], v[56:59]
  v_exp_f32 v215, v215
  v_mfma_f32_16x16x32_bf16 v[60:63], a[156:159], v[200:203], v[60:63]
  ds_read_b128 a[108:111], v237 offset:24704
  v_fma_f32 v221, v221, s22, v231
  v_mfma_f32_16x16x32_bf16 v[12:15], a[156:159], v[192:195], v[12:15]
  v_exp_f32 v216, v216
  v_mfma_f32_16x16x32_bf16 v[16:19], a[160:163], v[192:195], v[16:19]
  ds_read_b128 a[112:115], v236 offset:24832
  v_fma_f32 v222, v222, s22, v231
  v_mfma_f32_16x16x32_bf16 v[64:67], a[160:163], v[200:203], v[64:67]
  v_exp_f32 v217, v217
  v_mfma_f32_16x16x32_bf16 v[68:71], a[164:167], v[200:203], v[68:71]
  ds_read_b128 a[116:119], v237 offset:24832
  v_fma_f32 v223, v223, s22, v231
  v_mfma_f32_16x16x32_bf16 v[20:23], a[164:167], v[192:195], v[20:23]
  v_exp_f32 v218, v218
  v_mfma_f32_16x16x32_bf16 v[24:27], a[168:171], v[192:195], v[24:27]
  ds_read_b128 a[140:143], v237 offset:30976
  v_add_f32 v226, v226, v208
  v_mfma_f32_16x16x32_bf16 v[72:75], a[168:171], v[200:203], v[72:75]
  v_exp_f32 v219, v219
  v_mfma_f32_16x16x32_bf16 v[76:79], a[172:175], v[200:203], v[76:79]
  ds_read_b128 a[136:139], v236 offset:30976
  v_add_f32 v226, v226, v209
  v_mfma_f32_16x16x32_bf16 v[28:31], a[172:175], v[192:195], v[28:31]
  v_exp_f32 v220, v220
  v_mfma_f32_16x16x32_bf16 v[32:35], a[176:179], v[192:195], v[32:35]
  ds_read_b128 a[132:135], v237 offset:30848
  v_add_f32 v226, v226, v210
  v_mfma_f32_16x16x32_bf16 v[80:83], a[176:179], v[200:203], v[80:83]
  s_waitcnt lgkmcnt(4)
  v_exp_f32 v221, v221
  v_mfma_f32_16x16x32_bf16 v[84:87], a[180:183], v[200:203], v[84:87]
  ds_read_b128 a[128:131], v236 offset:30848
  v_add_f32 v226, v226, v211
  v_mfma_f32_16x16x32_bf16 v[36:39], a[180:183], v[192:195], v[36:39]
  v_exp_f32 v222, v222
  v_mfma_f32_16x16x32_bf16 v[40:43], a[184:187], v[192:195], v[40:43]
  ds_read_b128 a[124:127], v237 offset:30720
  v_add_f32 v226, v226, v212
  v_mfma_f32_16x16x32_bf16 v[88:91], a[184:187], v[200:203], v[88:91]
  v_exp_f32 v223, v223
  v_mfma_f32_16x16x32_bf16 v[92:95], a[188:191], v[200:203], v[92:95]
  ds_read_b128 a[120:123], v236 offset:30720
  v_add_f32 v226, v226, v213
  v_mfma_f32_16x16x32_bf16 v[44:47], a[188:191], v[192:195], v[44:47]
  v_add_f32 v226, v226, v214
  v_add_f32 v226, v226, v215
  v_mfma_f32_16x16x32_bf16 v[192:195], a[96:99], a[0:3], v[232:235]
  v_cvt_pk_bf16_f32 v208, v208, v209
  v_cvt_pk_bf16_f32 v209, v210, v211
  v_mfma_f32_16x16x32_bf16 v[192:195], a[100:103], a[4:7], v[192:195]
  v_cvt_pk_bf16_f32 v210, v212, v213
  v_cvt_pk_bf16_f32 v211, v214, v215
  v_mfma_f32_16x16x32_bf16 v[192:195], a[104:107], a[8:11], v[192:195]
  v_add_f32 v227, v227, v216
  v_add_f32 v227, v227, v217
  v_mfma_f32_16x16x32_bf16 v[192:195], a[108:111], a[12:15], v[192:195]
  s_waitcnt vmcnt(12) lgkmcnt(0)
  v_add_f32 v227, v227, v218
  v_add_f32 v227, v227, v219
  v_mfma_f32_16x16x32_bf16 v[192:195], a[112:115], a[16:19], v[192:195]
  s_barrier
  v_add_f32 v227, v227, v220
  v_add_f32 v227, v227, v221
  v_mfma_f32_16x16x32_bf16 v[192:195], a[116:119], a[20:23], v[192:195]
  s_add_u32 m0, s21, 98304
  v_add_f32 v227, v227, v222
  v_add_f32 v227, v227, v223
  v_mfma_f32_16x16x32_bf16 v[196:199], a[140:143], a[20:23], v[232:235]
  buffer_load_dwordx4 v242, s[12:15], s20 offen nt lds
  v_mfma_f32_16x16x32_bf16 v[196:199], a[136:139], a[16:19], v[196:199]
  v_cvt_pk_bf16_f32 v219, v218, v219
  v_cvt_pk_bf16_f32 v218, v216, v217
  v_mfma_f32_16x16x32_bf16 v[196:199], a[132:135], a[12:15], v[196:199]
  v_cvt_pk_bf16_f32 v216, v220, v221
  v_cvt_pk_bf16_f32 v217, v222, v223
  v_mfma_f32_16x16x32_bf16 v[196:199], a[128:131], a[8:11], v[196:199]
  v_fma_f32 v192, v192, s22, v228
  v_fma_f32 v193, v193, s22, v228
  v_mfma_f32_16x16x32_bf16 v[196:199], a[124:127], a[4:7], v[196:199]
  v_fma_f32 v194, v194, s22, v228
  v_fma_f32 v195, v195, s22, v228
  v_mfma_f32_16x16x32_bf16 v[196:199], a[120:123], a[0:3], v[196:199]
  buffer_load_dwordx4 v243, s[12:15], s20 offen offset:1024 nt lds
  v_mfma_f32_16x16x32_bf16 v[200:203], a[120:123], a[24:27], v[232:235]
  v_exp_f32 v192, v192
  v_mfma_f32_16x16x32_bf16 v[200:203], a[124:127], a[28:31], v[200:203]
  v_exp_f32 v193, v193
  v_mfma_f32_16x16x32_bf16 v[200:203], a[128:131], a[32:35], v[200:203]
  v_exp_f32 v194, v194
  v_mfma_f32_16x16x32_bf16 v[200:203], a[132:135], a[36:39], v[200:203]
  v_exp_f32 v195, v195
  v_mfma_f32_16x16x32_bf16 v[200:203], a[136:139], a[40:43], v[200:203]
  buffer_load_dwordx4 v244, s[12:15], s20 offen offset:2048 nt lds
  v_mfma_f32_16x16x32_bf16 v[200:203], a[140:143], a[44:47], v[200:203]
  v_fma_f32 v196, v196, s22, v228
  v_fma_f32 v197, v197, s22, v228
  v_mfma_f32_16x16x32_bf16 v[204:207], a[116:119], a[44:47], v[232:235]
  v_fma_f32 v198, v198, s22, v228
  v_fma_f32 v199, v199, s22, v228
  v_mfma_f32_16x16x32_bf16 v[204:207], a[112:115], a[40:43], v[204:207]
  s_add_u32 s20, s20, 12288
  v_exp_f32 v196, v196
  v_mfma_f32_16x16x32_bf16 v[204:207], a[108:111], a[36:39], v[204:207]
  s_add_u32 m0, s21, 12288
L_pg5:
  s_cbranch_execz L_pg9
  v_exp_f32 v197, v197
  v_mfma_f32_16x16x32_bf16 v[204:207], a[104:107], a[32:35], v[204:207]
  buffer_load_dwordx4 v242, s[8:11], s20 offen nt lds
  v_mfma_f32_16x16x32_bf16 v[204:207], a[100:103], a[28:31], v[204:207]
  v_exp_f32 v198, v198
  v_mfma_f32_16x16x32_bf16 v[204:207], a[96:99], a[24:27], v[204:207]
  v_exp_f32 v199, v199
  v_mfma_f32_16x16x32_bf16 v[96:99], a[144:147], v[208:211], v[96:99]
  v_fma_f32 v200, v200, s22, v229
  v_fma_f32 v201, v201, s22, v229
  v_mfma_f32_16x16x32_bf16 v[144:147], a[144:147], v[216:219], v[144:147]
  v_fma_f32 v202, v202, s22, v229
  v_fma_f32 v203, v203, s22, v229
  v_mfma_f32_16x16x32_bf16 v[148:151], a[148:151], v[216:219], v[148:151]
  buffer_load_dwordx4 v243, s[8:11], s20 offen offset:1024 nt lds
  v_mfma_f32_16x16x32_bf16 v[100:103], a[148:151], v[208:211], v[100:103]
  v_exp_f32 v200, v200
  v_mfma_f32_16x16x32_bf16 v[104:107], a[152:155], v[208:211], v[104:107]
  v_exp_f32 v201, v201
  v_mfma_f32_16x16x32_bf16 v[152:155], a[152:155], v[216:219], v[152:155]
  v_exp_f32 v202, v202
  v_mfma_f32_16x16x32_bf16 v[156:159], a[156:159], v[216:219], v[156:159]
  v_exp_f32 v203, v203
  v_mfma_f32_16x16x32_bf16 v[108:111], a[156:159], v[208:211], v[108:111]
  buffer_load_dwordx4 v244, s[8:11], s20 offen offset:2048 nt lds
  v_mfma_f32_16x16x32_bf16 v[112:115], a[160:163], v[208:211], v[112:115]
  v_fma_f32 v204, v204, s22, v229
  v_fma_f32 v205, v205, s22, v229
  v_mfma_f32_16x16x32_bf16 v[160:163], a[160:163], v[216:219], v[160:163]
  v_fma_f32 v206, v206, s22, v229
  v_fma_f32 v207, v207, s22, v229
  v_mfma_f32_16x16x32_bf16 v[164:167], a[164:167], v[216:219], v[164:167]
  v_exp_f32 v204, v204
  v_mfma_f32_16x16x32_bf16 v[116:119], a[164:167], v[208:211], v[116:119]
  v_exp_f32 v205, v205
  v_mfma_f32_16x16x32_bf16 v[120:123], a[168:171], v[208:211], v[120:123]
  ds_read_b64_tr_b16 a[144:145], v238 offset:12288
  v_add_f32 v224, v224, v192
  v_mfma_f32_16x16x32_bf16 v[168:171], a[168:171], v[216:219], v[168:171]
  ds_read_b64_tr_b16 a[146:147], v238 offset:18432
  v_add_f32 v224, v224, v193
  v_mfma_f32_16x16x32_bf16 v[172:175], a[172:175], v[216:219], v[172:175]
  v_exp_f32 v206, v206
  v_mfma_f32_16x16x32_bf16 v[124:127], a[172:175], v[208:211], v[124:127]
  ds_read_b64_tr_b16 a[148:149], v239 offset:12288
  v_add_f32 v224, v224, v194
  v_mfma_f32_16x16x32_bf16 v[128:131], a[176:179], v[208:211], v[128:131]
  ds_read_b64_tr_b16 a[150:151], v239 offset:18432
  v_add_f32 v224, v224, v195
  v_mfma_f32_16x16x32_bf16 v[176:179], a[176:179], v[216:219], v[176:179]
  v_exp_f32 v207, v207
  v_mfma_f32_16x16x32_bf16 v[180:183], a[180:183], v[216:219], v[180:183]
  s_add_u32 s25, s23, 202752
  ds_read_b64_tr_b16 a[152:153], v240 offset:12288
  v_cvt_pk_bf16_f32 v192, v192, v193
  v_mfma_f32_16x16x32_bf16 v[132:135], a[180:183], v[208:211], v[132:135]
  ds_read_b64_tr_b16 a[154:155], v240 offset:18432
  v_cvt_pk_bf16_f32 v193, v194, v195
  v_mfma_f32_16x16x32_bf16 v[136:139], a[184:187], v[208:211], v[136:139]
  buffer_load_dwordx4 a[216:219], v245, s[4:7], s25 offen nt
  v_add_f32 v224, v224, v196
  v_add_f32 v224, v224, v197
  v_mfma_f32_16x16x32_bf16 v[184:187], a[184:187], v[216:219], v[184:187]
  ds_read_b64_tr_b16 a[156:157], v241 offset:12288
  v_add_f32 v224, v224, v198
  v_mfma_f32_16x16x32_bf16 v[188:191], a[188:191], v[216:219], v[188:191]
  ds_read_b64_tr_b16 a[158:159], v241 offset:18432
  v_add_f32 v224, v224, v199
  v_mfma_f32_16x16x32_bf16 v[140:143], a[188:191], v[208:211], v[140:143]
  v_cvt_pk_bf16_f32 v194, v196, v197
  v_cvt_pk_bf16_f32 v195, v198, v199
  v_mfma_f32_16x16x32_bf16 v[208:211], a[96:99], a[48:51], v[232:235]
  ds_read_b64_tr_b16 a[160:161], v238 offset:12416
  v_add_f32 v225, v225, v200
  v_mfma_f32_16x16x32_bf16 v[208:211], a[100:103], a[52:55], v[208:211]
  ds_read_b64_tr_b16 a[162:163], v238 offset:18560
  v_add_f32 v225, v225, v201
  v_mfma_f32_16x16x32_bf16 v[208:211], a[104:107], a[56:59], v[208:211]
  v_add_f32 v225, v225, v202
  v_add_f32 v225, v225, v203
  v_mfma_f32_16x16x32_bf16 v[208:211], a[108:111], a[60:63], v[208:211]
  ds_read_b64_tr_b16 a[164:165], v239 offset:12416
  v_cvt_pk_bf16_f32 v203, v202, v203
  v_mfma_f32_16x16x32_bf16 v[208:211], a[112:115], a[64:67], v[208:211]
  ds_read_b64_tr_b16 a[166:167], v239 offset:18560
  v_cvt_pk_bf16_f32 v202, v200, v201
  v_mfma_f32_16x16x32_bf16 v[208:211], a[116:119], a[68:71], v[208:211]
  v_add_f32 v225, v225, v204
  v_add_f32 v225, v225, v205
  v_mfma_f32_16x16x32_bf16 v[212:215], a[140:143], a[68:71], v[232:235]
  ds_read_b64_tr_b16 a[168:169], v240 offset:12416
  v_add_f32 v225, v225, v206
  v_mfma_f32_16x16x32_bf16 v[212:215], a[136:139], a[64:67], v[212:215]
  ds_read_b64_tr_b16 a[170:171], v240 offset:18560
  v_add_f32 v225, v225, v207
  v_mfma_f32_16x16x32_bf16 v[212:215], a[132:135], a[60:63], v[212:215]
  v_cvt_pk_bf16_f32 v200, v204, v205
  v_cvt_pk_bf16_f32 v201, v206, v207
  v_mfma_f32_16x16x32_bf16 v[212:215], a[128:131], a[56:59], v[212:215]
  ds_read_b64_tr_b16 a[172:173], v241 offset:12416
  v_fma_f32 v208, v208, s22, v230
  v_mfma_f32_16x16x32_bf16 v[212:215], a[124:127], a[52:55], v[212:215]
  ds_read_b64_tr_b16 a[174:175], v241 offset:18560
  v_fma_f32 v209, v209, s22, v230
  v_mfma_f32_16x16x32_bf16 v[212:215], a[120:123], a[48:51], v[212:215]
  v_exp_f32 v208, v208
  v_mfma_f32_16x16x32_bf16 v[216:219], a[120:123], a[72:75], v[232:235]
  ds_read_b64_tr_b16 a[176:177], v238 offset:12544
  v_fma_f32 v210, v210, s22, v230
  v_mfma_f32_16x16x32_bf16 v[216:219], a[124:127], a[76:79], v[216:219]
  ds_read_b64_tr_b16 a[178:179], v238 offset:18688
  v_fma_f32 v211, v211, s22, v230
  v_mfma_f32_16x16x32_bf16 v[216:219], a[128:131], a[80:83], v[216:219]
  buffer_load_dwordx4 a[220:223], v245, s[4:7], s25 offen offset:64 nt
  v_exp_f32 v209, v209
  v_mfma_f32_16x16x32_bf16 v[216:219], a[132:135], a[84:87], v[216:219]
  ds_read_b64_tr_b16 a[180:181], v239 offset:12544
  v_fma_f32 v212, v212, s22, v230
  v_mfma_f32_16x16x32_bf16 v[216:219], a[136:139], a[88:91], v[216:219]
  ds_read_b64_tr_b16 a[182:183], v239 offset:18688
  v_fma_f32 v213, v213, s22, v230
  v_mfma_f32_16x16x32_bf16 v[216:219], a[140:143], a[92:95], v[216:219]
  v_exp_f32 v210, v210
  v_mfma_f32_16x16x32_bf16 v[220:223], a[116:119], a[92:95], v[232:235]
  ds_read_b64_tr_b16 a[184:185], v240 offset:12544
  v_fma_f32 v214, v214, s22, v230
  v_mfma_f32_16x16x32_bf16 v[220:223], a[112:115], a[88:91], v[220:223]
  ds_read_b64_tr_b16 a[186:187], v240 offset:18688
  v_fma_f32 v215, v215, s22, v230
  v_mfma_f32_16x16x32_bf16 v[220:223], a[108:111], a[84:87], v[220:223]
  v_exp_f32 v211, v211
  v_mfma_f32_16x16x32_bf16 v[220:223], a[104:107], a[80:83], v[220:223]
  ds_read_b64_tr_b16 a[188:189], v241 offset:12544
  v_fma_f32 v216, v216, s22, v231
  v_mfma_f32_16x16x32_bf16 v[220:223], a[100:103], a[76:79], v[220:223]
  ds_read_b64_tr_b16 a[190:191], v241 offset:18688
  v_fma_f32 v217, v217, s22, v231
  v_mfma_f32_16x16x32_bf16 v[220:223], a[96:99], a[72:75], v[220:223]
  s_waitcnt lgkmcnt(5)
  v_exp_f32 v212, v212
  v_mfma_f32_16x16x32_bf16 v[0:3], a[144:147], v[192:195], v[0:3]
  ds_read_b128 a[96:99], v236 offset:36864
  v_fma_f32 v218, v218, s22, v231
  v_mfma_f32_16x16x32_bf16 v[48:51], a[144:147], v[200:203], v[48:51]
  v_exp_f32 v213, v213
  v_mfma_f32_16x16x32_bf16 v[52:55], a[148:151], v[200:203], v[52:55]
  ds_read_b128 a[100:103], v237 offset:36864
  v_fma_f32 v219, v219, s22, v231
  v_mfma_f32_16x16x32_bf16 v[4:7], a[148:151], v[192:195], v[4:7]
  v_exp_f32 v214, v214
  v_mfma_f32_16x16x32_bf16 v[8:11], a[152:155], v[192:195], v[8:11]
  ds_read_b128 a[104:107], v236 offset:36992
  v_fma_f32 v220, v220, s22, v231
  v_mfma_f32_16x16x32_bf16 v[56:59], a[152:155], v[200:203], v[56:59]
  v_exp_f32 v215, v215
  v_mfma_f32_16x16x32_bf16 v[60:63], a[156:159], v[200:203], v[60:63]
  ds_read_b128 a[108:111], v237 offset:36992
  v_fma_f32 v221, v221, s22, v231
  v_mfma_f32_16x16x32_bf16 v[12:15], a[156:159], v[192:195], v[12:15]
  v_exp_f32 v216, v216
  v_mfma_f32_16x16x32_bf16 v[16:19], a[160:163], v[192:195], v[16:19]
  ds_read_b128 a[112:115], v236 offset:37120
  v_fma_f32 v222, v222, s22, v231
  v_mfma_f32_16x16x32_bf16 v[64:67], a[160:163], v[200:203], v[64:67]
  v_exp_f32 v217, v217
  v_mfma_f32_16x16x32_bf16 v[68:71], a[164:167], v[200:203], v[68:71]
  ds_read_b128 a[116:119], v237 offset:37120
  v_fma_f32 v223, v223, s22, v231
  v_mfma_f32_16x16x32_bf16 v[20:23], a[164:167], v[192:195], v[20:23]
  v_exp_f32 v218, v218
  v_mfma_f32_16x16x32_bf16 v[24:27], a[168:171], v[192:195], v[24:27]
  ds_read_b128 a[140:143], v237 offset:43264
  v_add_f32 v226, v226, v208
  v_mfma_f32_16x16x32_bf16 v[72:75], a[168:171], v[200:203], v[72:75]
  v_exp_f32 v219, v219
  v_mfma_f32_16x16x32_bf16 v[76:79], a[172:175], v[200:203], v[76:79]
  ds_read_b128 a[136:139], v236 offset:43264
  v_add_f32 v226, v226, v209
  v_mfma_f32_16x16x32_bf16 v[28:31], a[172:175], v[192:195], v[28:31]
  v_exp_f32 v220, v220
  v_mfma_f32_16x16x32_bf16 v[32:35], a[176:179], v[192:195], v[32:35]
  ds_read_b128 a[132:135], v237 offset:43136
  v_add_f32 v226, v226, v210
  v_mfma_f32_16x16x32_bf16 v[80:83], a[176:179], v[200:203], v[80:83]
  s_waitcnt lgkmcnt(4)
  v_exp_f32 v221, v221
  v_mfma_f32_16x16x32_bf16 v[84:87], a[180:183], v[200:203], v[84:87]
  ds_read_b128 a[128:131], v236 offset:43136
  v_add_f32 v226, v226, v211
  v_mfma_f32_16x16x32_bf16 v[36:39], a[180:183], v[192:195], v[36:39]
  v_exp_f32 v222, v222
  v_mfma_f32_16x16x32_bf16 v[40:43], a[184:187], v[192:195], v[40:43]
  ds_read_b128 a[124:127], v237 offset:43008
  v_add_f32 v226, v226, v212
  v_mfma_f32_16x16x32_bf16 v[88:91], a[184:187], v[200:203], v[88:91]
  v_exp_f32 v223, v223
  v_mfma_f32_16x16x32_bf16 v[92:95], a[188:191], v[200:203], v[92:95]
  ds_read_b128 a[120:123], v236 offset:43008
  v_add_f32 v226, v226, v213
  v_mfma_f32_16x16x32_bf16 v[44:47], a[188:191], v[192:195], v[44:47]
  v_add_f32 v226, v226, v214
  v_add_f32 v226, v226, v215
  v_mfma_f32_16x16x32_bf16 v[192:195], a[96:99], a[0:3], v[232:235]
  v_cvt_pk_bf16_f32 v208, v208, v209
  v_cvt_pk_bf16_f32 v209, v210, v211
  v_mfma_f32_16x16x32_bf16 v[192:195], a[100:103], a[4:7], v[192:195]
  v_cvt_pk_bf16_f32 v210, v212, v213
  v_cvt_pk_bf16_f32 v211, v214, v215
  v_mfma_f32_16x16x32_bf16 v[192:195], a[104:107], a[8:11], v[192:195]
  v_add_f32 v227, v227, v216
  v_add_f32 v227, v227, v217
  v_mfma_f32_16x16x32_bf16 v[192:195], a[108:111], a[12:15], v[192:195]
  s_waitcnt vmcnt(10) lgkmcnt(0)
  v_add_f32 v227, v227, v218
  v_add_f32 v227, v227, v219
  v_mfma_f32_16x16x32_bf16 v[192:195], a[112:115], a[16:19], v[192:195]
  s_barrier
  v_add_f32 v227, v227, v220
  v_add_f32 v227, v227, v221
  v_mfma_f32_16x16x32_bf16 v[192:195], a[116:119], a[20:23], v[192:195]
  s_add_u32 m0, s21, 86016
  v_add_f32 v227, v227, v222
  v_add_f32 v227, v227, v223
  v_mfma_f32_16x16x32_bf16 v[196:199], a[140:143], a[20:23], v[232:235]
  buffer_load_dwordx4 v242, s[12:15], s20 offen nt lds
  v_mfma_f32_16x16x32_bf16 v[196:199], a[136:139], a[16:19], v[196:199]
  v_cvt_pk_bf16_f32 v219, v218, v219
  v_cvt_pk_bf16_f32 v218, v216, v217
  v_mfma_f32_16x16x32_bf16 v[196:199], a[132:135], a[12:15], v[196:199]
  v_cvt_pk_bf16_f32 v216, v220, v221
  v_cvt_pk_bf16_f32 v217, v222, v223
  v_mfma_f32_16x16x32_bf16 v[196:199], a[128:131], a[8:11], v[196:199]
  v_fma_f32 v192, v192, s22, v228
  v_fma_f32 v193, v193, s22, v228
  v_mfma_f32_16x16x32_bf16 v[196:199], a[124:127], a[4:7], v[196:199]
  v_fma_f32 v194, v194, s22, v228
  v_fma_f32 v195, v195, s22, v228
  v_mfma_f32_16x16x32_bf16 v[196:199], a[120:123], a[0:3], v[196:199]
  buffer_load_dwordx4 v243, s[12:15], s20 offen offset:1024 nt lds
  v_mfma_f32_16x16x32_bf16 v[200:203], a[120:123], a[24:27], v[232:235]
  v_exp_f32 v192, v192
  v_mfma_f32_16x16x32_bf16 v[200:203], a[124:127], a[28:31], v[200:203]
  v_exp_f32 v193, v193
  v_mfma_f32_16x16x32_bf16 v[200:203], a[128:131], a[32:35], v[200:203]
  v_exp_f32 v194, v194
  v_mfma_f32_16x16x32_bf16 v[200:203], a[132:135], a[36:39], v[200:203]
  v_exp_f32 v195, v195
  v_mfma_f32_16x16x32_bf16 v[200:203], a[136:139], a[40:43], v[200:203]
  buffer_load_dwordx4 v244, s[12:15], s20 offen offset:2048 nt lds
  v_mfma_f32_16x16x32_bf16 v[200:203], a[140:143], a[44:47], v[200:203]
  v_fma_f32 v196, v196, s22, v228
  v_fma_f32 v197, v197, s22, v228
  v_mfma_f32_16x16x32_bf16 v[204:207], a[116:119], a[44:47], v[232:235]
  v_fma_f32 v198, v198, s22, v228
  v_fma_f32 v199, v199, s22, v228
  v_mfma_f32_16x16x32_bf16 v[204:207], a[112:115], a[40:43], v[204:207]
  s_add_u32 s20, s20, 12288
  v_exp_f32 v196, v196
  v_mfma_f32_16x16x32_bf16 v[204:207], a[108:111], a[36:39], v[204:207]
  s_add_u32 m0, s21, 24576
  v_exp_f32 v197, v197
  v_mfma_f32_16x16x32_bf16 v[204:207], a[104:107], a[32:35], v[204:207]
  buffer_load_dwordx4 v242, s[8:11], s20 offen nt lds
  v_mfma_f32_16x16x32_bf16 v[204:207], a[100:103], a[28:31], v[204:207]
  v_exp_f32 v198, v198
  v_mfma_f32_16x16x32_bf16 v[204:207], a[96:99], a[24:27], v[204:207]
  v_exp_f32 v199, v199
  v_mfma_f32_16x16x32_bf16 v[96:99], a[144:147], v[208:211], v[96:99]
  v_fma_f32 v200, v200, s22, v229
  v_fma_f32 v201, v201, s22, v229
  v_mfma_f32_16x16x32_bf16 v[144:147], a[144:147], v[216:219], v[144:147]
  v_fma_f32 v202, v202, s22, v229
  v_fma_f32 v203, v203, s22, v229
  v_mfma_f32_16x16x32_bf16 v[148:151], a[148:151], v[216:219], v[148:151]
  buffer_load_dwordx4 v243, s[8:11], s20 offen offset:1024 nt lds
  v_mfma_f32_16x16x32_bf16 v[100:103], a[148:151], v[208:211], v[100:103]
  v_exp_f32 v200, v200
  v_mfma_f32_16x16x32_bf16 v[104:107], a[152:155], v[208:211], v[104:107]
  v_exp_f32 v201, v201
  v_mfma_f32_16x16x32_bf16 v[152:155], a[152:155], v[216:219], v[152:155]
  v_exp_f32 v202, v202
  v_mfma_f32_16x16x32_bf16 v[156:159], a[156:159], v[216:219], v[156:159]
  v_exp_f32 v203, v203
  v_mfma_f32_16x16x32_bf16 v[108:111], a[156:159], v[208:211], v[108:111]
  buffer_load_dwordx4 v244, s[8:11], s20 offen offset:2048 nt lds
  v_mfma_f32_16x16x32_bf16 v[112:115], a[160:163], v[208:211], v[112:115]
  v_fma_f32 v204, v204, s22, v229
  v_fma_f32 v205, v205, s22, v229
  v_mfma_f32_16x16x32_bf16 v[160:163], a[160:163], v[216:219], v[160:163]
  v_fma_f32 v206, v206, s22, v229
  v_fma_f32 v207, v207, s22, v229
  v_mfma_f32_16x16x32_bf16 v[164:167], a[164:167], v[216:219], v[164:167]
  v_exp_f32 v204, v204
  v_mfma_f32_16x16x32_bf16 v[116:119], a[164:167], v[208:211], v[116:119]
  v_exp_f32 v205, v205
  v_mfma_f32_16x16x32_bf16 v[120:123], a[168:171], v[208:211], v[120:123]
  ds_read_b64_tr_b16 a[144:145], v238 offset:0
  v_add_f32 v224, v224, v192
  v_mfma_f32_16x16x32_bf16 v[168:171], a[168:171], v[216:219], v[168:171]
  ds_read_b64_tr_b16 a[146:147], v238 offset:6144
  v_add_f32 v224, v224, v193
  v_mfma_f32_16x16x32_bf16 v[172:175], a[172:175], v[216:219], v[172:175]
  v_exp_f32 v206, v206
  v_mfma_f32_16x16x32_bf16 v[124:127], a[172:175], v[208:211], v[124:127]
  ds_read_b64_tr_b16 a[148:149], v239 offset:0
  v_add_f32 v224, v224, v194
  v_mfma_f32_16x16x32_bf16 v[128:131], a[176:179], v[208:211], v[128:131]
  ds_read_b64_tr_b16 a[150:151], v239 offset:6144
  v_add_f32 v224, v224, v195
  v_mfma_f32_16x16x32_bf16 v[176:179], a[176:179], v[216:219], v[176:179]
  v_exp_f32 v207, v207
  v_mfma_f32_16x16x32_bf16 v[180:183], a[180:183], v[216:219], v[180:183]
  s_add_u32 s25, s23, 202752
  ds_read_b64_tr_b16 a[152:153], v240 offset:0
  v_cvt_pk_bf16_f32 v192, v192, v193
  v_mfma_f32_16x16x32_bf16 v[132:135], a[180:183], v[208:211], v[132:135]
  ds_read_b64_tr_b16 a[154:155], v240 offset:6144
  v_cvt_pk_bf16_f32 v193, v194, v195
  v_mfma_f32_16x16x32_bf16 v[136:139], a[184:187], v[208:211], v[136:139]
  buffer_load_dwordx4 a[224:227], v245, s[4:7], s25 offen offset:128 nt
  v_add_f32 v224, v224, v196
  v_add_f32 v224, v224, v197
  v_mfma_f32_16x16x32_bf16 v[184:187], a[184:187], v[216:219], v[184:187]
  ds_read_b64_tr_b16 a[156:157], v241 offset:0
  v_add_f32 v224, v224, v198
  v_mfma_f32_16x16x32_bf16 v[188:191], a[188:191], v[216:219], v[188:191]
  ds_read_b64_tr_b16 a[158:159], v241 offset:6144
  v_add_f32 v224, v224, v199
  v_mfma_f32_16x16x32_bf16 v[140:143], a[188:191], v[208:211], v[140:143]
  v_cvt_pk_bf16_f32 v194, v196, v197
  v_cvt_pk_bf16_f32 v195, v198, v199
  v_mfma_f32_16x16x32_bf16 v[208:211], a[96:99], a[48:51], v[232:235]
  ds_read_b64_tr_b16 a[160:161], v238 offset:128
  v_add_f32 v225, v225, v200
  v_mfma_f32_16x16x32_bf16 v[208:211], a[100:103], a[52:55], v[208:211]
  ds_read_b64_tr_b16 a[162:163], v238 offset:6272
  v_add_f32 v225, v225, v201
  v_mfma_f32_16x16x32_bf16 v[208:211], a[104:107], a[56:59], v[208:211]
  v_add_f32 v225, v225, v202
  v_add_f32 v225, v225, v203
  v_mfma_f32_16x16x32_bf16 v[208:211], a[108:111], a[60:63], v[208:211]
  ds_read_b64_tr_b16 a[164:165], v239 offset:128
  v_cvt_pk_bf16_f32 v203, v202, v203
  v_mfma_f32_16x16x32_bf16 v[208:211], a[112:115], a[64:67], v[208:211]
  ds_read_b64_tr_b16 a[166:167], v239 offset:6272
  v_cvt_pk_bf16_f32 v202, v200, v201
  v_mfma_f32_16x16x32_bf16 v[208:211], a[116:119], a[68:71], v[208:211]
  v_add_f32 v225, v225, v204
  v_add_f32 v225, v225, v205
  v_mfma_f32_16x16x32_bf16 v[212:215], a[140:143], a[68:71], v[232:235]
  ds_read_b64_tr_b16 a[168:169], v240 offset:128
  v_add_f32 v225, v225, v206
  v_mfma_f32_16x16x32_bf16 v[212:215], a[136:139], a[64:67], v[212:215]
  ds_read_b64_tr_b16 a[170:171], v240 offset:6272
  v_add_f32 v225, v225, v207
  v_mfma_f32_16x16x32_bf16 v[212:215], a[132:135], a[60:63], v[212:215]
  v_cvt_pk_bf16_f32 v200, v204, v205
  v_cvt_pk_bf16_f32 v201, v206, v207
  v_mfma_f32_16x16x32_bf16 v[212:215], a[128:131], a[56:59], v[212:215]
  ds_read_b64_tr_b16 a[172:173], v241 offset:128
  v_fma_f32 v208, v208, s22, v230
  v_mfma_f32_16x16x32_bf16 v[212:215], a[124:127], a[52:55], v[212:215]
  ds_read_b64_tr_b16 a[174:175], v241 offset:6272
  v_fma_f32 v209, v209, s22, v230
  v_mfma_f32_16x16x32_bf16 v[212:215], a[120:123], a[48:51], v[212:215]
  v_exp_f32 v208, v208
  v_mfma_f32_16x16x32_bf16 v[216:219], a[120:123], a[72:75], v[232:235]
  ds_read_b64_tr_b16 a[176:177], v238 offset:256
  v_fma_f32 v210, v210, s22, v230
  v_mfma_f32_16x16x32_bf16 v[216:219], a[124:127], a[76:79], v[216:219]
  ds_read_b64_tr_b16 a[178:179], v238 offset:6400
  v_fma_f32 v211, v211, s22, v230
  v_mfma_f32_16x16x32_bf16 v[216:219], a[128:131], a[80:83], v[216:219]
  buffer_load_dwordx4 a[228:231], v245, s[4:7], s25 offen offset:192 nt
  v_exp_f32 v209, v209
  v_mfma_f32_16x16x32_bf16 v[216:219], a[132:135], a[84:87], v[216:219]
  ds_read_b64_tr_b16 a[180:181], v239 offset:256
  v_fma_f32 v212, v212, s22, v230
  v_mfma_f32_16x16x32_bf16 v[216:219], a[136:139], a[88:91], v[216:219]
  ds_read_b64_tr_b16 a[182:183], v239 offset:6400
  v_fma_f32 v213, v213, s22, v230
  v_mfma_f32_16x16x32_bf16 v[216:219], a[140:143], a[92:95], v[216:219]
  v_exp_f32 v210, v210
  v_mfma_f32_16x16x32_bf16 v[220:223], a[116:119], a[92:95], v[232:235]
  ds_read_b64_tr_b16 a[184:185], v240 offset:256
  v_fma_f32 v214, v214, s22, v230
  v_mfma_f32_16x16x32_bf16 v[220:223], a[112:115], a[88:91], v[220:223]
  ds_read_b64_tr_b16 a[186:187], v240 offset:6400
  v_fma_f32 v215, v215, s22, v230
  v_mfma_f32_16x16x32_bf16 v[220:223], a[108:111], a[84:87], v[220:223]
  v_exp_f32 v211, v211
  v_mfma_f32_16x16x32_bf16 v[220:223], a[104:107], a[80:83], v[220:223]
  ds_read_b64_tr_b16 a[188:189], v241 offset:256
  v_fma_f32 v216, v216, s22, v231
  v_mfma_f32_16x16x32_bf16 v[220:223], a[100:103], a[76:79], v[220:223]
  ds_read_b64_tr_b16 a[190:191], v241 offset:6400
  v_fma_f32 v217, v217, s22, v231
  v_mfma_f32_16x16x32_bf16 v[220:223], a[96:99], a[72:75], v[220:223]
  s_waitcnt lgkmcnt(5)
  v_exp_f32 v212, v212
  v_mfma_f32_16x16x32_bf16 v[0:3], a[144:147], v[192:195], v[0:3]
  ds_read_b128 a[96:99], v236 offset:0
  v_fma_f32 v218, v218, s22, v231
  v_mfma_f32_16x16x32_bf16 v[48:51], a[144:147], v[200:203], v[48:51]
  v_exp_f32 v213, v213
  v_mfma_f32_16x16x32_bf16 v[52:55], a[148:151], v[200:203], v[52:55]
  ds_read_b128 a[100:103], v237 offset:0
  v_fma_f32 v219, v219, s22, v231
  v_mfma_f32_16x16x32_bf16 v[4:7], a[148:151], v[192:195], v[4:7]
  v_exp_f32 v214, v214
  v_mfma_f32_16x16x32_bf16 v[8:11], a[152:155], v[192:195], v[8:11]
  ds_read_b128 a[104:107], v236 offset:128
  v_fma_f32 v220, v220, s22, v231
  v_mfma_f32_16x16x32_bf16 v[56:59], a[152:155], v[200:203], v[56:59]
  v_exp_f32 v215, v215
  v_mfma_f32_16x16x32_bf16 v[60:63], a[156:159], v[200:203], v[60:63]
  ds_read_b128 a[108:111], v237 offset:128
  v_fma_f32 v221, v221, s22, v231
  v_mfma_f32_16x16x32_bf16 v[12:15], a[156:159], v[192:195], v[12:15]
  v_exp_f32 v216, v216
  v_mfma_f32_16x16x32_bf16 v[16:19], a[160:163], v[192:195], v[16:19]
  ds_read_b128 a[112:115], v236 offset:256
  v_fma_f32 v222, v222, s22, v231
  v_mfma_f32_16x16x32_bf16 v[64:67], a[160:163], v[200:203], v[64:67]
  v_exp_f32 v217, v217
  v_mfma_f32_16x16x32_bf16 v[68:71], a[164:167], v[200:203], v[68:71]
  ds_read_b128 a[116:119], v237 offset:256
  v_fma_f32 v223, v223, s22, v231
  v_mfma_f32_16x16x32_bf16 v[20:23], a[164:167], v[192:195], v[20:23]
  v_exp_f32 v218, v218
  v_mfma_f32_16x16x32_bf16 v[24:27], a[168:171], v[192:195], v[24:27]
  ds_read_b128 a[140:143], v237 offset:6400
  v_add_f32 v226, v226, v208
  v_mfma_f32_16x16x32_bf16 v[72:75], a[168:171], v[200:203], v[72:75]
  v_exp_f32 v219, v219
  v_mfma_f32_16x16x32_bf16 v[76:79], a[172:175], v[200:203], v[76:79]
  ds_read_b128 a[136:139], v236 offset:6400
  v_add_f32 v226, v226, v209
  v_mfma_f32_16x16x32_bf16 v[28:31], a[172:175], v[192:195], v[28:31]
  v_exp_f32 v220, v220
  v_mfma_f32_16x16x32_bf16 v[32:35], a[176:179], v[192:195], v[32:35]
  ds_read_b128 a[132:135], v237 offset:6272
  v_add_f32 v226, v226, v210
  v_mfma_f32_16x16x32_bf16 v[80:83], a[176:179], v[200:203], v[80:83]
  s_waitcnt lgkmcnt(4)
  v_exp_f32 v221, v221
  v_mfma_f32_16x16x32_bf16 v[84:87], a[180:183], v[200:203], v[84:87]
  ds_read_b128 a[128:131], v236 offset:6272
  v_add_f32 v226, v226, v211
  v_mfma_f32_16x16x32_bf16 v[36:39], a[180:183], v[192:195], v[36:39]
  v_exp_f32 v222, v222
  v_mfma_f32_16x16x32_bf16 v[40:43], a[184:187], v[192:195], v[40:43]
  ds_read_b128 a[124:127], v237 offset:6144
  v_add_f32 v226, v226, v212
  v_mfma_f32_16x16x32_bf16 v[88:91], a[184:187], v[200:203], v[88:91]
  v_exp_f32 v223, v223
  v_mfma_f32_16x16x32_bf16 v[92:95], a[188:191], v[200:203], v[92:95]
  ds_read_b128 a[120:123], v236 offset:6144
  v_add_f32 v226, v226, v213
  v_mfma_f32_16x16x32_bf16 v[44:47], a[188:191], v[192:195], v[44:47]
  v_add_f32 v226, v226, v214
  v_add_f32 v226, v226, v215
  v_mfma_f32_16x16x32_bf16 v[192:195], a[96:99], a[0:3], v[232:235]
  v_cvt_pk_bf16_f32 v208, v208, v209
  v_cvt_pk_bf16_f32 v209, v210, v211
  v_mfma_f32_16x16x32_bf16 v[192:195], a[100:103], a[4:7], v[192:195]
  v_cvt_pk_bf16_f32 v210, v212, v213
  v_cvt_pk_bf16_f32 v211, v214, v215
  v_mfma_f32_16x16x32_bf16 v[192:195], a[104:107], a[8:11], v[192:195]
  v_add_f32 v227, v227, v216
  v_add_f32 v227, v227, v217
  v_mfma_f32_16x16x32_bf16 v[192:195], a[108:111], a[12:15], v[192:195]
  s_waitcnt vmcnt(10) lgkmcnt(0)
  v_add_f32 v227, v227, v218
  v_add_f32 v227, v227, v219
  v_mfma_f32_16x16x32_bf16 v[192:195], a[112:115], a[16:19], v[192:195]
  s_barrier
  v_add_f32 v227, v227, v220
  v_add_f32 v227, v227, v221
  v_mfma_f32_16x16x32_bf16 v[192:195], a[116:119], a[20:23], v[192:195]
  s_add_u32 m0, s21, 73728
  v_add_f32 v227, v227, v222
  v_add_f32 v227, v227, v223
  v_mfma_f32_16x16x32_bf16 v[196:199], a[140:143], a[20:23], v[232:235]
  buffer_load_dwordx4 v242, s[12:15], s20 offen nt lds
  v_mfma_f32_16x16x32_bf16 v[196:199], a[136:139], a[16:19], v[196:199]
  v_cvt_pk_bf16_f32 v219, v218, v219
  v_cvt_pk_bf16_f32 v218, v216, v217
  v_mfma_f32_16x16x32_bf16 v[196:199], a[132:135], a[12:15], v[196:199]
  v_cvt_pk_bf16_f32 v216, v220, v221
  v_cvt_pk_bf16_f32 v217, v222, v223
  v_mfma_f32_16x16x32_bf16 v[196:199], a[128:131], a[8:11], v[196:199]
  v_fma_f32 v192, v192, s22, v228
  v_fma_f32 v193, v193, s22, v228
  v_mfma_f32_16x16x32_bf16 v[196:199], a[124:127], a[4:7], v[196:199]
  v_fma_f32 v194, v194, s22, v228
  v_fma_f32 v195, v195, s22, v228
  v_mfma_f32_16x16x32_bf16 v[196:199], a[120:123], a[0:3], v[196:199]
  buffer_load_dwordx4 v243, s[12:15], s20 offen offset:1024 nt lds
  v_mfma_f32_16x16x32_bf16 v[200:203], a[120:123], a[24:27], v[232:235]
  v_exp_f32 v192, v192
  v_mfma_f32_16x16x32_bf16 v[200:203], a[124:127], a[28:31], v[200:203]
  v_exp_f32 v193, v193
  v_mfma_f32_16x16x32_bf16 v[200:203], a[128:131], a[32:35], v[200:203]
  v_exp_f32 v194, v194
  v_mfma_f32_16x16x32_bf16 v[200:203], a[132:135], a[36:39], v[200:203]
  v_exp_f32 v195, v195
  v_mfma_f32_16x16x32_bf16 v[200:203], a[136:139], a[40:43], v[200:203]
  buffer_load_dwordx4 v244, s[12:15], s20 offen offset:2048 nt lds
  v_mfma_f32_16x16x32_bf16 v[200:203], a[140:143], a[44:47], v[200:203]
  v_fma_f32 v196, v196, s22, v228
  v_fma_f32 v197, v197, s22, v228
  v_mfma_f32_16x16x32_bf16 v[204:207], a[116:119], a[44:47], v[232:235]
  v_fma_f32 v198, v198, s22, v228
  v_fma_f32 v199, v199, s22, v228
  v_mfma_f32_16x16x32_bf16 v[204:207], a[112:115], a[40:43], v[204:207]
  s_add_u32 s20, s20, 12288
  v_exp_f32 v196, v196
  v_mfma_f32_16x16x32_bf16 v[204:207], a[108:111], a[36:39], v[204:207]
  s_add_u32 m0, s21, 36864
  v_exp_f32 v197, v197
  v_mfma_f32_16x16x32_bf16 v[204:207], a[104:107], a[32:35], v[204:207]
  buffer_load_dwordx4 v242, s[8:11], s20 offen nt lds
  v_mfma_f32_16x16x32_bf16 v[204:207], a[100:103], a[28:31], v[204:207]
  v_exp_f32 v198, v198
  v_mfma_f32_16x16x32_bf16 v[204:207], a[96:99], a[24:27], v[204:207]
  v_exp_f32 v199, v199
  v_mfma_f32_16x16x32_bf16 v[96:99], a[144:147], v[208:211], v[96:99]
  v_fma_f32 v200, v200, s22, v229
  v_fma_f32 v201, v201, s22, v229
  v_mfma_f32_16x16x32_bf16 v[144:147], a[144:147], v[216:219], v[144:147]
  v_fma_f32 v202, v202, s22, v229
  v_fma_f32 v203, v203, s22, v229
  v_mfma_f32_16x16x32_bf16 v[148:151], a[148:151], v[216:219], v[148:151]
  buffer_load_dwordx4 v243, s[8:11], s20 offen offset:1024 nt lds
  v_mfma_f32_16x16x32_bf16 v[100:103], a[148:151], v[208:211], v[100:103]
  v_exp_f32 v200, v200
  v_mfma_f32_16x16x32_bf16 v[104:107], a[152:155], v[208:211], v[104:107]
  v_exp_f32 v201, v201
  v_mfma_f32_16x16x32_bf16 v[152:155], a[152:155], v[216:219], v[152:155]
  v_exp_f32 v202, v202
  v_mfma_f32_16x16x32_bf16 v[156:159], a[156:159], v[216:219], v[156:159]
  v_exp_f32 v203, v203
  v_mfma_f32_16x16x32_bf16 v[108:111], a[156:159], v[208:211], v[108:111]
  buffer_load_dwordx4 v244, s[8:11], s20 offen offset:2048 nt lds
  v_mfma_f32_16x16x32_bf16 v[112:115], a[160:163], v[208:211], v[112:115]
  v_fma_f32 v204, v204, s22, v229
  v_fma_f32 v205, v205, s22, v229
  v_mfma_f32_16x16x32_bf16 v[160:163], a[160:163], v[216:219], v[160:163]
  v_fma_f32 v206, v206, s22, v229
  v_fma_f32 v207, v207, s22, v229
  v_mfma_f32_16x16x32_bf16 v[164:167], a[164:167], v[216:219], v[164:167]
  v_exp_f32 v204, v204
  v_mfma_f32_16x16x32_bf16 v[116:119], a[164:167], v[208:211], v[116:119]
  v_exp_f32 v205, v205
  v_mfma_f32_16x16x32_bf16 v[120:123], a[168:171], v[208:211], v[120:123]
  ds_read_b64_tr_b16 a[144:145], v238 offset:36864
  v_add_f32 v224, v224, v192
  v_mfma_f32_16x16x32_bf16 v[168:171], a[168:171], v[216:219], v[168:171]
  ds_read_b64_tr_b16 a[146:147], v238 offset:43008
  v_add_f32 v224, v224, v193
  v_mfma_f32_16x16x32_bf16 v[172:175], a[172:175], v[216:219], v[172:175]
  v_exp_f32 v206, v206
  v_mfma_f32_16x16x32_bf16 v[124:127], a[172:175], v[208:211], v[124:127]
  ds_read_b64_tr_b16 a[148:149], v239 offset:36864
  v_add_f32 v224, v224, v194
  v_mfma_f32_16x16x32_bf16 v[128:131], a[176:179], v[208:211], v[128:131]
  ds_read_b64_tr_b16 a[150:151], v239 offset:43008
  v_add_f32 v224, v224, v195
  v_mfma_f32_16x16x32_bf16 v[176:179], a[176:179], v[216:219], v[176:179]
  v_exp_f32 v207, v207
  v_mfma_f32_16x16x32_bf16 v[180:183], a[180:183], v[216:219], v[180:183]
  s_add_u32 s25, s23, 202752
  ds_read_b64_tr_b16 a[152:153], v240 offset:36864
  v_cvt_pk_bf16_f32 v192, v192, v193
  v_mfma_f32_16x16x32_bf16 v[132:135], a[180:183], v[208:211], v[132:135]
  ds_read_b64_tr_b16 a[154:155], v240 offset:43008
  v_cvt_pk_bf16_f32 v193, v194, v195
  v_mfma_f32_16x16x32_bf16 v[136:139], a[184:187], v[208:211], v[136:139]
  buffer_load_dwordx4 a[232:235], v245, s[4:7], s25 offen offset:256 nt
  v_add_f32 v224, v224, v196
  v_add_f32 v224, v224, v197
  v_mfma_f32_16x16x32_bf16 v[184:187], a[184:187], v[216:219], v[184:187]
L_pg6:
  s_cbranch_execz L_pg10
  ds_read_b64_tr_b16 a[156:157], v241 offset:36864
  v_add_f32 v224, v224, v198
  v_mfma_f32_16x16x32_bf16 v[188:191], a[188:191], v[216:219], v[188:191]
  ds_read_b64_tr_b16 a[158:159], v241 offset:43008
  v_add_f32 v224, v224, v199
  v_mfma_f32_16x16x32_bf16 v[140:143], a[188:191], v[208:211], v[140:143]
  v_cvt_pk_bf16_f32 v194, v196, v197
  v_cvt_pk_bf16_f32 v195, v198, v199
  v_mfma_f32_16x16x32_bf16 v[208:211], a[96:99], a[48:51], v[232:235]
  ds_read_b64_tr_b16 a[160:161], v238 offset:36992
  v_add_f32 v225, v225, v200
  v_mfma_f32_16x16x32_bf16 v[208:211], a[100:103], a[52:55], v[208:211]
  ds_read_b64_tr_b16 a[162:163], v238 offset:43136
  v_add_f32 v225, v225, v201
  v_mfma_f32_16x16x32_bf16 v[208:211], a[104:107], a[56:59], v[208:211]
  v_add_f32 v225, v225, v202
  v_add_f32 v225, v225, v203
  v_mfma_f32_16x16x32_bf16 v[208:211], a[108:111], a[60:63], v[208:211]
  ds_read_b64_tr_b16 a[164:165], v239 offset:36992
  v_cvt_pk_bf16_f32 v203, v202, v203
  v_mfma_f32_16x16x32_bf16 v[208:211], a[112:115], a[64:67], v[208:211]
  ds_read_b64_tr_b16 a[166:167], v239 offset:43136
  v_cvt_pk_bf16_f32 v202, v200, v201
  v_mfma_f32_16x16x32_bf16 v[208:211], a[116:119], a[68:71], v[208:211]
  v_add_f32 v225, v225, v204
  v_add_f32 v225, v225, v205
  v_mfma_f32_16x16x32_bf16 v[212:215], a[140:143], a[68:71], v[232:235]
  ds_read_b64_tr_b16 a[168:169], v240 offset:36992
  v_add_f32 v225, v225, v206
  v_mfma_f32_16x16x32_bf16 v[212:215], a[136:139], a[64:67], v[212:215]
  ds_read_b64_tr_b16 a[170:171], v240 offset:43136
  v_add_f32 v225, v225, v207
  v_mfma_f32_16x16x32_bf16 v[212:215], a[132:135], a[60:63], v[212:215]
  v_cvt_pk_bf16_f32 v200, v204, v205
  v_cvt_pk_bf16_f32 v201, v206, v207
  v_mfma_f32_16x16x32_bf16 v[212:215], a[128:131], a[56:59], v[212:215]
  ds_read_b64_tr_b16 a[172:173], v241 offset:36992
  v_fma_f32 v208, v208, s22, v230
  v_mfma_f32_16x16x32_bf16 v[212:215], a[124:127], a[52:55], v[212:215]
  ds_read_b64_tr_b16 a[174:175], v241 offset:43136
  v_fma_f32 v209, v209, s22, v230
  v_mfma_f32_16x16x32_bf16 v[212:215], a[120:123], a[48:51], v[212:215]
  v_exp_f32 v208, v208
  v_mfma_f32_16x16x32_bf16 v[216:219], a[120:123], a[72:75], v[232:235]
  ds_read_b64_tr_b16 a[176:177], v238 offset:37120
  v_fma_f32 v210, v210, s22, v230
  v_mfma_f32_16x16x32_bf16 v[216:219], a[124:127], a[76:79], v[216:219]
  ds_read_b64_tr_b16 a[178:179], v238 offset:43264
  v_fma_f32 v211, v211, s22, v230
  v_mfma_f32_16x16x32_bf16 v[216:219], a[128:131], a[80:83], v[216:219]
  buffer_load_dwordx4 a[236:239], v245, s[4:7], s25 offen offset:320 nt
  v_exp_f32 v209, v209
  v_mfma_f32_16x16x32_bf16 v[216:219], a[132:135], a[84:87], v[216:219]
  ds_read_b64_tr_b16 a[180:181], v239 offset:37120
  v_fma_f32 v212, v212, s22, v230
  v_mfma_f32_16x16x32_bf16 v[216:219], a[136:139], a[88:91], v[216:219]
  ds_read_b64_tr_b16 a[182:183], v239 offset:43264
  v_fma_f32 v213, v213, s22, v230
  v_mfma_f32_16x16x32_bf16 v[216:219], a[140:143], a[92:95], v[216:219]
  v_exp_f32 v210, v210
  v_mfma_f32_16x16x32_bf16 v[220:223], a[116:119], a[92:95], v[232:235]
  ds_read_b64_tr_b16 a[184:185], v240 offset:37120
  v_fma_f32 v214, v214, s22, v230
  v_mfma_f32_16x16x32_bf16 v[220:223], a[112:115], a[88:91], v[220:223]
  ds_read_b64_tr_b16 a[186:187], v240 offset:43264
  v_fma_f32 v215, v215, s22, v230
  v_mfma_f32_16x16x32_bf16 v[220:223], a[108:111], a[84:87], v[220:223]
  v_exp_f32 v211, v211
  v_mfma_f32_16x16x32_bf16 v[220:223], a[104:107], a[80:83], v[220:223]
  ds_read_b64_tr_b16 a[188:189], v241 offset:37120
  v_fma_f32 v216, v216, s22, v231
  v_mfma_f32_16x16x32_bf16 v[220:223], a[100:103], a[76:79], v[220:223]
  ds_read_b64_tr_b16 a[190:191], v241 offset:43264
  v_fma_f32 v217, v217, s22, v231
  v_mfma_f32_16x16x32_bf16 v[220:223], a[96:99], a[72:75], v[220:223]
  s_waitcnt lgkmcnt(5)
  v_exp_f32 v212, v212
  v_mfma_f32_16x16x32_bf16 v[0:3], a[144:147], v[192:195], v[0:3]
  ds_read_b128 a[96:99], v236 offset:12288
  v_fma_f32 v218, v218, s22, v231
  v_mfma_f32_16x16x32_bf16 v[48:51], a[144:147], v[200:203], v[48:51]
  v_exp_f32 v213, v213
  v_mfma_f32_16x16x32_bf16 v[52:55], a[148:151], v[200:203], v[52:55]
  ds_read_b128 a[100:103], v237 offset:12288
  v_fma_f32 v219, v219, s22, v231
  v_mfma_f32_16x16x32_bf16 v[4:7], a[148:151], v[192:195], v[4:7]
  v_exp_f32 v214, v214
  v_mfma_f32_16x16x32_bf16 v[8:11], a[152:155], v[192:195], v[8:11]
  ds_read_b128 a[104:107], v236 offset:12416
  v_fma_f32 v220, v220, s22, v231
  v_mfma_f32_16x16x32_bf16 v[56:59], a[152:155], v[200:203], v[56:59]
  v_exp_f32 v215, v215
  v_mfma_f32_16x16x32_bf16 v[60:63], a[156:159], v[200:203], v[60:63]
  ds_read_b128 a[108:111], v237 offset:12416
  v_fma_f32 v221, v221, s22, v231
  v_mfma_f32_16x16x32_bf16 v[12:15], a[156:159], v[192:195], v[12:15]
  v_exp_f32 v216, v216
  v_mfma_f32_16x16x32_bf16 v[16:19], a[160:163], v[192:195], v[16:19]
  ds_read_b128 a[112:115], v236 offset:12544
  v_fma_f32 v222, v222, s22, v231
  v_mfma_f32_16x16x32_bf16 v[64:67], a[160:163], v[200:203], v[64:67]
  v_exp_f32 v217, v217
  v_mfma_f32_16x16x32_bf16 v[68:71], a[164:167], v[200:203], v[68:71]
  ds_read_b128 a[116:119], v237 offset:12544
  v_fma_f32 v223, v223, s22, v231
  v_mfma_f32_16x16x32_bf16 v[20:23], a[164:167], v[192:195], v[20:23]
  v_exp_f32 v218, v218
  v_mfma_f32_16x16x32_bf16 v[24:27], a[168:171], v[192:195], v[24:27]
  ds_read_b128 a[140:143], v237 offset:18688
  v_add_f32 v226, v226, v208
  v_mfma_f32_16x16x32_bf16 v[72:75], a[168:171], v[200:203], v[72:75]
  v_exp_f32 v219, v219
  v_mfma_f32_16x16x32_bf16 v[76:79], a[172:175], v[200:203], v[76:79]
  ds_read_b128 a[136:139], v236 offset:18688
  v_add_f32 v226, v226, v209
  v_mfma_f32_16x16x32_bf16 v[28:31], a[172:175], v[192:195], v[28:31]
  v_exp_f32 v220, v220
  v_mfma_f32_16x16x32_bf16 v[32:35], a[176:179], v[192:195], v[32:35]
  ds_read_b128 a[132:135], v237 offset:18560
  v_add_f32 v226, v226, v210
  v_mfma_f32_16x16x32_bf16 v[80:83], a[176:179], v[200:203], v[80:83]
  s_waitcnt lgkmcnt(4)
  v_exp_f32 v221, v221
  v_mfma_f32_16x16x32_bf16 v[84:87], a[180:183], v[200:203], v[84:87]
  ds_read_b128 a[128:131], v236 offset:18560
  v_add_f32 v226, v226, v211
  v_mfma_f32_16x16x32_bf16 v[36:39], a[180:183], v[192:195], v[36:39]
  v_exp_f32 v222, v222
  v_mfma_f32_16x16x32_bf16 v[40:43], a[184:187], v[192:195], v[40:43]
  ds_read_b128 a[124:127], v237 offset:18432
  v_add_f32 v226, v226, v212
  v_mfma_f32_16x16x32_bf16 v[88:91], a[184:187], v[200:203], v[88:91]
  v_exp_f32 v223, v223
  v_mfma_f32_16x16x32_bf16 v[92:95], a[188:191], v[200:203], v[92:95]
  ds_read_b128 a[120:123], v236 offset:18432
  v_add_f32 v226, v226, v213
  v_mfma_f32_16x16x32_bf16 v[44:47], a[188:191], v[192:195], v[44:47]
  v_add_f32 v226, v226, v214
  v_add_f32 v226, v226, v215
  v_mfma_f32_16x16x32_bf16 v[192:195], a[96:99], a[0:3], v[232:235]
  v_cvt_pk_bf16_f32 v208, v208, v209
  v_cvt_pk_bf16_f32 v209, v210, v211
  v_mfma_f32_16x16x32_bf16 v[192:195], a[100:103], a[4:7], v[192:195]
  v_cvt_pk_bf16_f32 v210, v212, v213
  v_cvt_pk_bf16_f32 v211, v214, v215
  v_mfma_f32_16x16x32_bf16 v[192:195], a[104:107], a[8:11], v[192:195]
  v_add_f32 v227, v227, v216
  v_add_f32 v227, v227, v217
  v_mfma_f32_16x16x32_bf16 v[192:195], a[108:111], a[12:15], v[192:195]
  s_waitcnt vmcnt(10) lgkmcnt(0)
  v_add_f32 v227, v227, v218
  v_add_f32 v227, v227, v219
  v_mfma_f32_16x16x32_bf16 v[192:195], a[112:115], a[16:19], v[192:195]
  s_barrier
  v_add_f32 v227, v227, v220
  v_add_f32 v227, v227, v221
  v_mfma_f32_16x16x32_bf16 v[192:195], a[116:119], a[20:23], v[192:195]
  s_add_u32 m0, s21, 61440
  v_add_f32 v227, v227, v222
  v_add_f32 v227, v227, v223
  v_mfma_f32_16x16x32_bf16 v[196:199], a[140:143], a[20:23], v[232:235]
  buffer_load_dwordx4 v242, s[12:15], s20 offen nt lds
  v_mfma_f32_16x16x32_bf16 v[196:199], a[136:139], a[16:19], v[196:199]
  v_cvt_pk_bf16_f32 v219, v218, v219
  v_cvt_pk_bf16_f32 v218, v216, v217
  v_mfma_f32_16x16x32_bf16 v[196:199], a[132:135], a[12:15], v[196:199]
  v_cvt_pk_bf16_f32 v216, v220, v221
  v_cvt_pk_bf16_f32 v217, v222, v223
  v_mfma_f32_16x16x32_bf16 v[196:199], a[128:131], a[8:11], v[196:199]
  v_fma_f32 v192, v192, s22, v228
  v_fma_f32 v193, v193, s22, v228
  v_mfma_f32_16x16x32_bf16 v[196:199], a[124:127], a[4:7], v[196:199]
  v_fma_f32 v194, v194, s22, v228
  v_fma_f32 v195, v195, s22, v228
  v_mfma_f32_16x16x32_bf16 v[196:199], a[120:123], a[0:3], v[196:199]
  buffer_load_dwordx4 v243, s[12:15], s20 offen offset:1024 nt lds
  v_mfma_f32_16x16x32_bf16 v[200:203], a[120:123], a[24:27], v[232:235]
  v_exp_f32 v192, v192
  v_mfma_f32_16x16x32_bf16 v[200:203], a[124:127], a[28:31], v[200:203]
  v_exp_f32 v193, v193
  v_mfma_f32_16x16x32_bf16 v[200:203], a[128:131], a[32:35], v[200:203]
  v_exp_f32 v194, v194
  v_mfma_f32_16x16x32_bf16 v[200:203], a[132:135], a[36:39], v[200:203]
  v_exp_f32 v195, v195
  v_mfma_f32_16x16x32_bf16 v[200:203], a[136:139], a[40:43], v[200:203]
  buffer_load_dwordx4 v244, s[12:15], s20 offen offset:2048 nt lds
  v_mfma_f32_16x16x32_bf16 v[200:203], a[140:143], a[44:47], v[200:203]
  v_fma_f32 v196, v196, s22, v228
  v_fma_f32 v197, v197, s22, v228
  v_mfma_f32_16x16x32_bf16 v[204:207], a[116:119], a[44:47], v[232:235]
  v_fma_f32 v198, v198, s22, v228
  v_fma_f32 v199, v199, s22, v228
  v_mfma_f32_16x16x32_bf16 v[204:207], a[112:115], a[40:43], v[204:207]
  s_add_u32 s20, s20, 12288
  v_exp_f32 v196, v196
  v_mfma_f32_16x16x32_bf16 v[204:207], a[108:111], a[36:39], v[204:207]
  s_add_u32 m0, s21, 0
  v_exp_f32 v197, v197
  v_mfma_f32_16x16x32_bf16 v[204:207], a[104:107], a[32:35], v[204:207]
  buffer_load_dwordx4 v242, s[8:11], s20 offen nt lds
  v_mfma_f32_16x16x32_bf16 v[204:207], a[100:103], a[28:31], v[204:207]
  v_exp_f32 v198, v198
  v_mfma_f32_16x16x32_bf16 v[204:207], a[96:99], a[24:27], v[204:207]
  v_exp_f32 v199, v199
  v_mfma_f32_16x16x32_bf16 v[96:99], a[144:147], v[208:211], v[96:99]
  v_fma_f32 v200, v200, s22, v229
  v_fma_f32 v201, v201, s22, v229
  v_mfma_f32_16x16x32_bf16 v[144:147], a[144:147], v[216:219], v[144:147]
  v_fma_f32 v202, v202, s22, v229
  v_fma_f32 v203, v203, s22, v229
  v_mfma_f32_16x16x32_bf16 v[148:151], a[148:151], v[216:219], v[148:151]
  buffer_load_dwordx4 v243, s[8:11], s20 offen offset:1024 nt lds
  v_mfma_f32_16x16x32_bf16 v[100:103], a[148:151], v[208:211], v[100:103]
  v_exp_f32 v200, v200
  v_mfma_f32_16x16x32_bf16 v[104:107], a[152:155], v[208:211], v[104:107]
  v_exp_f32 v201, v201
  v_mfma_f32_16x16x32_bf16 v[152:155], a[152:155], v[216:219], v[152:155]
  v_exp_f32 v202, v202
  v_mfma_f32_16x16x32_bf16 v[156:159], a[156:159], v[216:219], v[156:159]
  v_exp_f32 v203, v203
  v_mfma_f32_16x16x32_bf16 v[108:111], a[156:159], v[208:211], v[108:111]
  buffer_load_dwordx4 v244, s[8:11], s20 offen offset:2048 nt lds
  v_mfma_f32_16x16x32_bf16 v[112:115], a[160:163], v[208:211], v[112:115]
  v_fma_f32 v204, v204, s22, v229
  v_fma_f32 v205, v205, s22, v229
  v_mfma_f32_16x16x32_bf16 v[160:163], a[160:163], v[216:219], v[160:163]
  v_fma_f32 v206, v206, s22, v229
  v_fma_f32 v207, v207, s22, v229
  v_mfma_f32_16x16x32_bf16 v[164:167], a[164:167], v[216:219], v[164:167]
  v_exp_f32 v204, v204
  v_mfma_f32_16x16x32_bf16 v[116:119], a[164:167], v[208:211], v[116:119]
  v_exp_f32 v205, v205
  v_mfma_f32_16x16x32_bf16 v[120:123], a[168:171], v[208:211], v[120:123]
  ds_read_b64_tr_b16 a[144:145], v238 offset:24576
  v_add_f32 v224, v224, v192
  v_mfma_f32_16x16x32_bf16 v[168:171], a[168:171], v[216:219], v[168:171]
  ds_read_b64_tr_b16 a[146:147], v238 offset:30720
  v_add_f32 v224, v224, v193
  v_mfma_f32_16x16x32_bf16 v[172:175], a[172:175], v[216:219], v[172:175]
  v_exp_f32 v206, v206
  v_mfma_f32_16x16x32_bf16 v[124:127], a[172:175], v[208:211], v[124:127]
  ds_read_b64_tr_b16 a[148:149], v239 offset:24576
  v_add_f32 v224, v224, v194
  v_mfma_f32_16x16x32_bf16 v[128:131], a[176:179], v[208:211], v[128:131]
  ds_read_b64_tr_b16 a[150:151], v239 offset:30720
  v_add_f32 v224, v224, v195
  v_mfma_f32_16x16x32_bf16 v[176:179], a[176:179], v[216:219], v[176:179]
  v_exp_f32 v207, v207
  v_mfma_f32_16x16x32_bf16 v[180:183], a[180:183], v[216:219], v[180:183]
  ds_read_b64_tr_b16 a[152:153], v240 offset:24576
  v_cvt_pk_bf16_f32 v192, v192, v193
  v_mfma_f32_16x16x32_bf16 v[132:135], a[180:183], v[208:211], v[132:135]
  ds_read_b64_tr_b16 a[154:155], v240 offset:30720
  v_cvt_pk_bf16_f32 v193, v194, v195
  v_mfma_f32_16x16x32_bf16 v[136:139], a[184:187], v[208:211], v[136:139]
  v_add_f32 v224, v224, v196
  v_add_f32 v224, v224, v197
  v_mfma_f32_16x16x32_bf16 v[184:187], a[184:187], v[216:219], v[184:187]
  ds_read_b64_tr_b16 a[156:157], v241 offset:24576
  v_add_f32 v224, v224, v198
  v_mfma_f32_16x16x32_bf16 v[188:191], a[188:191], v[216:219], v[188:191]
  s_add_u32 m0, s21, 98304
  ds_read_b64_tr_b16 a[158:159], v241 offset:30720
  v_add_f32 v224, v224, v199
  v_mfma_f32_16x16x32_bf16 v[140:143], a[188:191], v[208:211], v[140:143]
  buffer_load_dwordx4 v242, s[12:15], s20 offen nt lds
  v_cvt_pk_bf16_f32 v194, v196, v197
  v_cvt_pk_bf16_f32 v195, v198, v199
  v_mfma_f32_16x16x32_bf16 v[208:211], a[96:99], a[48:51], v[232:235]
  ds_read_b64_tr_b16 a[160:161], v238 offset:24704
  v_add_f32 v225, v225, v200
  v_mfma_f32_16x16x32_bf16 v[208:211], a[100:103], a[52:55], v[208:211]
  ds_read_b64_tr_b16 a[162:163], v238 offset:30848
  v_add_f32 v225, v225, v201
  v_mfma_f32_16x16x32_bf16 v[208:211], a[104:107], a[56:59], v[208:211]
  buffer_load_dwordx4 v243, s[12:15], s20 offen offset:1024 nt lds
  v_add_f32 v225, v225, v202
  v_add_f32 v225, v225, v203
  v_mfma_f32_16x16x32_bf16 v[208:211], a[108:111], a[60:63], v[208:211]
  ds_read_b64_tr_b16 a[164:165], v239 offset:24704
  v_cvt_pk_bf16_f32 v203, v202, v203
  v_mfma_f32_16x16x32_bf16 v[208:211], a[112:115], a[64:67], v[208:211]
  ds_read_b64_tr_b16 a[166:167], v239 offset:30848
  v_cvt_pk_bf16_f32 v202, v200, v201
  v_mfma_f32_16x16x32_bf16 v[208:211], a[116:119], a[68:71], v[208:211]
  buffer_load_dwordx4 v244, s[12:15], s20 offen offset:2048 nt lds
  v_add_f32 v225, v225, v204
  v_add_f32 v225, v225, v205
  v_mfma_f32_16x16x32_bf16 v[212:215], a[140:143], a[68:71], v[232:235]
  ds_read_b64_tr_b16 a[168:169], v240 offset:24704
  v_add_f32 v225, v225, v206
  v_mfma_f32_16x16x32_bf16 v[212:215], a[136:139], a[64:67], v[212:215]
  ds_read_b64_tr_b16 a[170:171], v240 offset:30848
  v_add_f32 v225, v225, v207
  v_mfma_f32_16x16x32_bf16 v[212:215], a[132:135], a[60:63], v[212:215]
  v_cvt_pk_bf16_f32 v200, v204, v205
  v_cvt_pk_bf16_f32 v201, v206, v207
  v_mfma_f32_16x16x32_bf16 v[212:215], a[128:131], a[56:59], v[212:215]
  ds_read_b64_tr_b16 a[172:173], v241 offset:24704
  v_fma_f32 v208, v208, s22, v230
  v_mfma_f32_16x16x32_bf16 v[212:215], a[124:127], a[52:55], v[212:215]
  ds_read_b64_tr_b16 a[174:175], v241 offset:30848
  v_fma_f32 v209, v209, s22, v230
  v_mfma_f32_16x16x32_bf16 v[212:215], a[120:123], a[48:51], v[212:215]
  v_exp_f32 v208, v208
  v_mfma_f32_16x16x32_bf16 v[216:219], a[120:123], a[72:75], v[232:235]
  ds_read_b64_tr_b16 a[176:177], v238 offset:24832
  v_fma_f32 v210, v210, s22, v230
  v_mfma_f32_16x16x32_bf16 v[216:219], a[124:127], a[76:79], v[216:219]
  ds_read_b64_tr_b16 a[178:179], v238 offset:30976
  v_fma_f32 v211, v211, s22, v230
  v_mfma_f32_16x16x32_bf16 v[216:219], a[128:131], a[80:83], v[216:219]
  v_exp_f32 v209, v209
  v_mfma_f32_16x16x32_bf16 v[216:219], a[132:135], a[84:87], v[216:219]
  ds_read_b64_tr_b16 a[180:181], v239 offset:24832
  v_fma_f32 v212, v212, s22, v230
  v_mfma_f32_16x16x32_bf16 v[216:219], a[136:139], a[88:91], v[216:219]
  ds_read_b64_tr_b16 a[182:183], v239 offset:30976
  v_fma_f32 v213, v213, s22, v230
  v_mfma_f32_16x16x32_bf16 v[216:219], a[140:143], a[92:95], v[216:219]
  v_exp_f32 v210, v210
  v_mfma_f32_16x16x32_bf16 v[220:223], a[116:119], a[92:95], v[232:235]
  ds_read_b64_tr_b16 a[184:185], v240 offset:24832
  v_fma_f32 v214, v214, s22, v230
  v_mfma_f32_16x16x32_bf16 v[220:223], a[112:115], a[88:91], v[220:223]
  ds_read_b64_tr_b16 a[186:187], v240 offset:30976
  v_fma_f32 v215, v215, s22, v230
  v_mfma_f32_16x16x32_bf16 v[220:223], a[108:111], a[84:87], v[220:223]
  v_exp_f32 v211, v211
  v_mfma_f32_16x16x32_bf16 v[220:223], a[104:107], a[80:83], v[220:223]
  ds_read_b64_tr_b16 a[188:189], v241 offset:24832
  v_fma_f32 v216, v216, s22, v231
  v_mfma_f32_16x16x32_bf16 v[220:223], a[100:103], a[76:79], v[220:223]
  ds_read_b64_tr_b16 a[190:191], v241 offset:30976
  v_fma_f32 v217, v217, s22, v231
  v_mfma_f32_16x16x32_bf16 v[220:223], a[96:99], a[72:75], v[220:223]
  s_waitcnt lgkmcnt(5)
  v_exp_f32 v212, v212
  v_mfma_f32_16x16x32_bf16 v[0:3], a[144:147], v[192:195], v[0:3]
  ds_read_b128 a[96:99], v236 offset:24576
  v_fma_f32 v218, v218, s22, v231
  v_mfma_f32_16x16x32_bf16 v[48:51], a[144:147], v[200:203], v[48:51]
  v_exp_f32 v213, v213
  v_mfma_f32_16x16x32_bf16 v[52:55], a[148:151], v[200:203], v[52:55]
  ds_read_b128 a[100:103], v237 offset:24576
  v_fma_f32 v219, v219, s22, v231
  v_mfma_f32_16x16x32_bf16 v[4:7], a[148:151], v[192:195], v[4:7]
  v_exp_f32 v214, v214
  v_mfma_f32_16x16x32_bf16 v[8:11], a[152:155], v[192:195], v[8:11]
  ds_read_b128 a[104:107], v236 offset:24704
  v_fma_f32 v220, v220, s22, v231
  v_mfma_f32_16x16x32_bf16 v[56:59], a[152:155], v[200:203], v[56:59]
  v_exp_f32 v215, v215
  v_mfma_f32_16x16x32_bf16 v[60:63], a[156:159], v[200:203], v[60:63]
  ds_read_b128 a[108:111], v237 offset:24704
  v_fma_f32 v221, v221, s22, v231
  v_mfma_f32_16x16x32_bf16 v[12:15], a[156:159], v[192:195], v[12:15]
  v_exp_f32 v216, v216
  v_mfma_f32_16x16x32_bf16 v[16:19], a[160:163], v[192:195], v[16:19]
  ds_read_b128 a[112:115], v236 offset:24832
  v_fma_f32 v222, v222, s22, v231
  v_mfma_f32_16x16x32_bf16 v[64:67], a[160:163], v[200:203], v[64:67]
  v_exp_f32 v217, v217
  v_mfma_f32_16x16x32_bf16 v[68:71], a[164:167], v[200:203], v[68:71]
  ds_read_b128 a[116:119], v237 offset:24832
  v_fma_f32 v223, v223, s22, v231
  v_mfma_f32_16x16x32_bf16 v[20:23], a[164:167], v[192:195], v[20:23]
  v_exp_f32 v218, v218
  v_mfma_f32_16x16x32_bf16 v[24:27], a[168:171], v[192:195], v[24:27]
  ds_read_b128 a[140:143], v237 offset:30976
  v_add_f32 v226, v226, v208
  v_mfma_f32_16x16x32_bf16 v[72:75], a[168:171], v[200:203], v[72:75]
  v_exp_f32 v219, v219
  v_mfma_f32_16x16x32_bf16 v[76:79], a[172:175], v[200:203], v[76:79]
  ds_read_b128 a[136:139], v236 offset:30976
  v_add_f32 v226, v226, v209
  v_mfma_f32_16x16x32_bf16 v[28:31], a[172:175], v[192:195], v[28:31]
  v_exp_f32 v220, v220
  v_mfma_f32_16x16x32_bf16 v[32:35], a[176:179], v[192:195], v[32:35]
  ds_read_b128 a[132:135], v237 offset:30848
  v_add_f32 v226, v226, v210
  v_mfma_f32_16x16x32_bf16 v[80:83], a[176:179], v[200:203], v[80:83]
  s_waitcnt lgkmcnt(4)
  v_exp_f32 v221, v221
  v_mfma_f32_16x16x32_bf16 v[84:87], a[180:183], v[200:203], v[84:87]
  ds_read_b128 a[128:131], v236 offset:30848
  v_add_f32 v226, v226, v211
  v_mfma_f32_16x16x32_bf16 v[36:39], a[180:183], v[192:195], v[36:39]
  v_exp_f32 v222, v222
  v_mfma_f32_16x16x32_bf16 v[40:43], a[184:187], v[192:195], v[40:43]
  ds_read_b128 a[124:127], v237 offset:30720
  v_add_f32 v226, v226, v212
  v_mfma_f32_16x16x32_bf16 v[88:91], a[184:187], v[200:203], v[88:91]
  v_exp_f32 v223, v223
  v_mfma_f32_16x16x32_bf16 v[92:95], a[188:191], v[200:203], v[92:95]
  ds_read_b128 a[120:123], v236 offset:30720
  v_add_f32 v226, v226, v213
  v_mfma_f32_16x16x32_bf16 v[44:47], a[188:191], v[192:195], v[44:47]
  v_add_f32 v226, v226, v214
  v_add_f32 v226, v226, v215
  v_mfma_f32_16x16x32_bf16 v[192:195], a[96:99], a[0:3], v[232:235]
  v_cvt_pk_bf16_f32 v208, v208, v209
  v_cvt_pk_bf16_f32 v209, v210, v211
  v_mfma_f32_16x16x32_bf16 v[192:195], a[100:103], a[4:7], v[192:195]
  v_cvt_pk_bf16_f32 v210, v212, v213
  v_cvt_pk_bf16_f32 v211, v214, v215
  v_mfma_f32_16x16x32_bf16 v[192:195], a[104:107], a[8:11], v[192:195]
  s_add_u32 s20, s20, 12288
  v_add_f32 v227, v227, v216
  v_add_f32 v227, v227, v217
  v_mfma_f32_16x16x32_bf16 v[192:195], a[108:111], a[12:15], v[192:195]
  s_waitcnt vmcnt(11) lgkmcnt(0)
  v_add_f32 v227, v227, v218
  v_add_f32 v227, v227, v219
  v_mfma_f32_16x16x32_bf16 v[192:195], a[112:115], a[16:19], v[192:195]
  s_barrier
  v_add_f32 v227, v227, v220
  v_add_f32 v227, v227, v221
  v_mfma_f32_16x16x32_bf16 v[192:195], a[116:119], a[20:23], v[192:195]
  s_add_u32 m0, s21, 12288
  v_add_f32 v227, v227, v222
  v_add_f32 v227, v227, v223
  v_mfma_f32_16x16x32_bf16 v[196:199], a[140:143], a[20:23], v[232:235]
  buffer_load_dwordx4 v242, s[8:11], s20 offen nt lds
  v_mfma_f32_16x16x32_bf16 v[196:199], a[136:139], a[16:19], v[196:199]
  v_cvt_pk_bf16_f32 v219, v218, v219
  v_cvt_pk_bf16_f32 v218, v216, v217
  v_mfma_f32_16x16x32_bf16 v[196:199], a[132:135], a[12:15], v[196:199]
  v_cvt_pk_bf16_f32 v216, v220, v221
  v_cvt_pk_bf16_f32 v217, v222, v223
  v_mfma_f32_16x16x32_bf16 v[196:199], a[128:131], a[8:11], v[196:199]
  v_fma_f32 v192, v192, s22, v228
  v_fma_f32 v193, v193, s22, v228
  v_mfma_f32_16x16x32_bf16 v[196:199], a[124:127], a[4:7], v[196:199]
  v_fma_f32 v194, v194, s22, v228
  v_fma_f32 v195, v195, s22, v228
  v_mfma_f32_16x16x32_bf16 v[196:199], a[120:123], a[0:3], v[196:199]
  buffer_load_dwordx4 v243, s[8:11], s20 offen offset:1024 nt lds
  v_mfma_f32_16x16x32_bf16 v[200:203], a[120:123], a[24:27], v[232:235]
  v_exp_f32 v192, v192
  v_mfma_f32_16x16x32_bf16 v[200:203], a[124:127], a[28:31], v[200:203]
  v_exp_f32 v193, v193
  v_mfma_f32_16x16x32_bf16 v[200:203], a[128:131], a[32:35], v[200:203]
  v_exp_f32 v194, v194
  v_mfma_f32_16x16x32_bf16 v[200:203], a[132:135], a[36:39], v[200:203]
  v_exp_f32 v195, v195
  v_mfma_f32_16x16x32_bf16 v[200:203], a[136:139], a[40:43], v[200:203]
  buffer_load_dwordx4 v244, s[8:11], s20 offen offset:2048 nt lds
  v_mfma_f32_16x16x32_bf16 v[200:203], a[140:143], a[44:47], v[200:203]
  v_fma_f32 v196, v196, s22, v228
  v_fma_f32 v197, v197, s22, v228
  v_mfma_f32_16x16x32_bf16 v[204:207], a[116:119], a[44:47], v[232:235]
  v_fma_f32 v198, v198, s22, v228
  v_fma_f32 v199, v199, s22, v228
  v_mfma_f32_16x16x32_bf16 v[204:207], a[112:115], a[40:43], v[204:207]
  v_exp_f32 v196, v196
  v_mfma_f32_16x16x32_bf16 v[204:207], a[108:111], a[36:39], v[204:207]
  s_add_u32 m0, s21, 86016
  v_exp_f32 v197, v197
  v_mfma_f32_16x16x32_bf16 v[204:207], a[104:107], a[32:35], v[204:207]
  buffer_load_dwordx4 v242, s[12:15], s20 offen nt lds
  v_mfma_f32_16x16x32_bf16 v[204:207], a[100:103], a[28:31], v[204:207]
  v_exp_f32 v198, v198
  v_mfma_f32_16x16x32_bf16 v[204:207], a[96:99], a[24:27], v[204:207]
  v_exp_f32 v199, v199
  v_mfma_f32_16x16x32_bf16 v[96:99], a[144:147], v[208:211], v[96:99]
  v_fma_f32 v200, v200, s22, v229
  v_fma_f32 v201, v201, s22, v229
  v_mfma_f32_16x16x32_bf16 v[144:147], a[144:147], v[216:219], v[144:147]
  v_fma_f32 v202, v202, s22, v229
  v_fma_f32 v203, v203, s22, v229
  v_mfma_f32_16x16x32_bf16 v[148:151], a[148:151], v[216:219], v[148:151]
  buffer_load_dwordx4 v243, s[12:15], s20 offen offset:1024 nt lds
  v_mfma_f32_16x16x32_bf16 v[100:103], a[148:151], v[208:211], v[100:103]
  v_exp_f32 v200, v200
  v_mfma_f32_16x16x32_bf16 v[104:107], a[152:155], v[208:211], v[104:107]
  v_exp_f32 v201, v201
  v_mfma_f32_16x16x32_bf16 v[152:155], a[152:155], v[216:219], v[152:155]
  v_exp_f32 v202, v202
  v_mfma_f32_16x16x32_bf16 v[156:159], a[156:159], v[216:219], v[156:159]
  v_exp_f32 v203, v203
  v_mfma_f32_16x16x32_bf16 v[108:111], a[156:159], v[208:211], v[108:111]
  buffer_load_dwordx4 v244, s[12:15], s20 offen offset:2048 nt lds
  v_mfma_f32_16x16x32_bf16 v[112:115], a[160:163], v[208:211], v[112:115]
  v_fma_f32 v204, v204, s22, v229
  v_fma_f32 v205, v205, s22, v229
  v_mfma_f32_16x16x32_bf16 v[160:163], a[160:163], v[216:219], v[160:163]
  v_fma_f32 v206, v206, s22, v229
  v_fma_f32 v207, v207, s22, v229
  v_mfma_f32_16x16x32_bf16 v[164:167], a[164:167], v[216:219], v[164:167]
  v_exp_f32 v204, v204
  v_mfma_f32_16x16x32_bf16 v[116:119], a[164:167], v[208:211], v[116:119]
  v_exp_f32 v205, v205
  v_mfma_f32_16x16x32_bf16 v[120:123], a[168:171], v[208:211], v[120:123]
  ds_read_b64_tr_b16 a[144:145], v238 offset:12288
  v_add_f32 v224, v224, v192
  v_mfma_f32_16x16x32_bf16 v[168:171], a[168:171], v[216:219], v[168:171]
  ds_read_b64_tr_b16 a[146:147], v238 offset:18432
  v_add_f32 v224, v224, v193
  v_mfma_f32_16x16x32_bf16 v[172:175], a[172:175], v[216:219], v[172:175]
  v_exp_f32 v206, v206
  v_mfma_f32_16x16x32_bf16 v[124:127], a[172:175], v[208:211], v[124:127]
  ds_read_b64_tr_b16 a[148:149], v239 offset:12288
  v_add_f32 v224, v224, v194
  v_mfma_f32_16x16x32_bf16 v[128:131], a[176:179], v[208:211], v[128:131]
  ds_read_b64_tr_b16 a[150:151], v239 offset:18432
  v_add_f32 v224, v224, v195
  v_mfma_f32_16x16x32_bf16 v[176:179], a[176:179], v[216:219], v[176:179]
  v_exp_f32 v207, v207
  v_mfma_f32_16x16x32_bf16 v[180:183], a[180:183], v[216:219], v[180:183]
  ds_read_b64_tr_b16 a[152:153], v240 offset:12288
  v_cvt_pk_bf16_f32 v192, v192, v193
  v_mfma_f32_16x16x32_bf16 v[132:135], a[180:183], v[208:211], v[132:135]
  ds_read_b64_tr_b16 a[154:155], v240 offset:18432
  v_cvt_pk_bf16_f32 v193, v194, v195
  v_mfma_f32_16x16x32_bf16 v[136:139], a[184:187], v[208:211], v[136:139]
  v_add_f32 v224, v224, v196
  v_add_f32 v224, v224, v197
  v_mfma_f32_16x16x32_bf16 v[184:187], a[184:187], v[216:219], v[184:187]
  s_add_u32 s20, s20, 12288
  ds_read_b64_tr_b16 a[156:157], v241 offset:12288
  v_add_f32 v224, v224, v198
  v_mfma_f32_16x16x32_bf16 v[188:191], a[188:191], v[216:219], v[188:191]
  s_add_u32 m0, s21, 24576
  ds_read_b64_tr_b16 a[158:159], v241 offset:18432
  v_add_f32 v224, v224, v199
  v_mfma_f32_16x16x32_bf16 v[140:143], a[188:191], v[208:211], v[140:143]
  buffer_load_dwordx4 v242, s[8:11], s20 offen nt lds
  v_cvt_pk_bf16_f32 v194, v196, v197
  v_cvt_pk_bf16_f32 v195, v198, v199
  v_mfma_f32_16x16x32_bf16 v[208:211], a[96:99], a[48:51], v[232:235]
  ds_read_b64_tr_b16 a[160:161], v238 offset:12416
  v_add_f32 v225, v225, v200
  v_mfma_f32_16x16x32_bf16 v[208:211], a[100:103], a[52:55], v[208:211]
  ds_read_b64_tr_b16 a[162:163], v238 offset:18560
  v_add_f32 v225, v225, v201
  v_mfma_f32_16x16x32_bf16 v[208:211], a[104:107], a[56:59], v[208:211]
  buffer_load_dwordx4 v243, s[8:11], s20 offen offset:1024 nt lds
  v_add_f32 v225, v225, v202
  v_add_f32 v225, v225, v203
  v_mfma_f32_16x16x32_bf16 v[208:211], a[108:111], a[60:63], v[208:211]
  ds_read_b64_tr_b16 a[164:165], v239 offset:12416
  v_cvt_pk_bf16_f32 v203, v202, v203
  v_mfma_f32_16x16x32_bf16 v[208:211], a[112:115], a[64:67], v[208:211]
  ds_read_b64_tr_b16 a[166:167], v239 offset:18560
  v_cvt_pk_bf16_f32 v202, v200, v201
  v_mfma_f32_16x16x32_bf16 v[208:211], a[116:119], a[68:71], v[208:211]
  buffer_load_dwordx4 v244, s[8:11], s20 offen offset:2048 nt lds
  v_add_f32 v225, v225, v204
  v_add_f32 v225, v225, v205
  v_mfma_f32_16x16x32_bf16 v[212:215], a[140:143], a[68:71], v[232:235]
  ds_read_b64_tr_b16 a[168:169], v240 offset:12416
  v_add_f32 v225, v225, v206
  v_mfma_f32_16x16x32_bf16 v[212:215], a[136:139], a[64:67], v[212:215]
  ds_read_b64_tr_b16 a[170:171], v240 offset:18560
  v_add_f32 v225, v225, v207
  v_mfma_f32_16x16x32_bf16 v[212:215], a[132:135], a[60:63], v[212:215]
  v_cvt_pk_bf16_f32 v200, v204, v205
  v_cvt_pk_bf16_f32 v201, v206, v207
  v_mfma_f32_16x16x32_bf16 v[212:215], a[128:131], a[56:59], v[212:215]
  ds_read_b64_tr_b16 a[172:173], v241 offset:12416
  v_fma_f32 v208, v208, s22, v230
  v_mfma_f32_16x16x32_bf16 v[212:215], a[124:127], a[52:55], v[212:215]
  ds_read_b64_tr_b16 a[174:175], v241 offset:18560
  v_fma_f32 v209, v209, s22, v230
  v_mfma_f32_16x16x32_bf16 v[212:215], a[120:123], a[48:51], v[212:215]
  v_exp_f32 v208, v208
  v_mfma_f32_16x16x32_bf16 v[216:219], a[120:123], a[72:75], v[232:235]
  ds_read_b64_tr_b16 a[176:177], v238 offset:12544
  v_fma_f32 v210, v210, s22, v230
  v_mfma_f32_16x16x32_bf16 v[216:219], a[124:127], a[76:79], v[216:219]
  ds_read_b64_tr_b16 a[178:179], v238 offset:18688
  v_fma_f32 v211, v211, s22, v230
  v_mfma_f32_16x16x32_bf16 v[216:219], a[128:131], a[80:83], v[216:219]
  v_exp_f32 v209, v209
  v_mfma_f32_16x16x32_bf16 v[216:219], a[132:135], a[84:87], v[216:219]
  ds_read_b64_tr_b16 a[180:181], v239 offset:12544
  v_fma_f32 v212, v212, s22, v230
  v_mfma_f32_16x16x32_bf16 v[216:219], a[136:139], a[88:91], v[216:219]
  ds_read_b64_tr_b16 a[182:183], v239 offset:18688
  v_fma_f32 v213, v213, s22, v230
  v_mfma_f32_16x16x32_bf16 v[216:219], a[140:143], a[92:95], v[216:219]
  v_exp_f32 v210, v210
  v_mfma_f32_16x16x32_bf16 v[220:223], a[116:119], a[92:95], v[232:235]
  ds_read_b64_tr_b16 a[184:185], v240 offset:12544
  v_fma_f32 v214, v214, s22, v230
  v_mfma_f32_16x16x32_bf16 v[220:223], a[112:115], a[88:91], v[220:223]
L_pg7:
  s_cbranch_execz L_pg11
  ds_read_b64_tr_b16 a[186:187], v240 offset:18688
  v_fma_f32 v215, v215, s22, v230
  v_mfma_f32_16x16x32_bf16 v[220:223], a[108:111], a[84:87], v[220:223]
  v_exp_f32 v211, v211
  v_mfma_f32_16x16x32_bf16 v[220:223], a[104:107], a[80:83], v[220:223]
  ds_read_b64_tr_b16 a[188:189], v241 offset:12544
  v_fma_f32 v216, v216, s22, v231
  v_mfma_f32_16x16x32_bf16 v[220:223], a[100:103], a[76:79], v[220:223]
  ds_read_b64_tr_b16 a[190:191], v241 offset:18688
  v_fma_f32 v217, v217, s22, v231
  v_mfma_f32_16x16x32_bf16 v[220:223], a[96:99], a[72:75], v[220:223]
  s_waitcnt lgkmcnt(5)
  v_exp_f32 v212, v212
  v_mfma_f32_16x16x32_bf16 v[0:3], a[144:147], v[192:195], v[0:3]
  ds_read_b128 a[96:99], v236 offset:36864
  v_fma_f32 v218, v218, s22, v231
  v_mfma_f32_16x16x32_bf16 v[48:51], a[144:147], v[200:203], v[48:51]
  v_exp_f32 v213, v213
  v_mfma_f32_16x16x32_bf16 v[52:55], a[148:151], v[200:203], v[52:55]
  ds_read_b128 a[100:103], v237 offset:36864
  v_fma_f32 v219, v219, s22, v231
  v_mfma_f32_16x16x32_bf16 v[4:7], a[148:151], v[192:195], v[4:7]
  v_exp_f32 v214, v214
  v_mfma_f32_16x16x32_bf16 v[8:11], a[152:155], v[192:195], v[8:11]
  ds_read_b128 a[104:107], v236 offset:36992
  v_fma_f32 v220, v220, s22, v231
  v_mfma_f32_16x16x32_bf16 v[56:59], a[152:155], v[200:203], v[56:59]
  v_exp_f32 v215, v215
  v_mfma_f32_16x16x32_bf16 v[60:63], a[156:159], v[200:203], v[60:63]
  ds_read_b128 a[108:111], v237 offset:36992
  v_fma_f32 v221, v221, s22, v231
  v_mfma_f32_16x16x32_bf16 v[12:15], a[156:159], v[192:195], v[12:15]
  v_exp_f32 v216, v216
  v_mfma_f32_16x16x32_bf16 v[16:19], a[160:163], v[192:195], v[16:19]
  ds_read_b128 a[112:115], v236 offset:37120
  v_fma_f32 v222, v222, s22, v231
  v_mfma_f32_16x16x32_bf16 v[64:67], a[160:163], v[200:203], v[64:67]
  v_exp_f32 v217, v217
  v_mfma_f32_16x16x32_bf16 v[68:71], a[164:167], v[200:203], v[68:71]
  ds_read_b128 a[116:119], v237 offset:37120
  v_fma_f32 v223, v223, s22, v231
  v_mfma_f32_16x16x32_bf16 v[20:23], a[164:167], v[192:195], v[20:23]
  v_exp_f32 v218, v218
  v_mfma_f32_16x16x32_bf16 v[24:27], a[168:171], v[192:195], v[24:27]
  ds_read_b128 a[140:143], v237 offset:43264
  v_add_f32 v226, v226, v208
  v_mfma_f32_16x16x32_bf16 v[72:75], a[168:171], v[200:203], v[72:75]
  v_exp_f32 v219, v219
  v_mfma_f32_16x16x32_bf16 v[76:79], a[172:175], v[200:203], v[76:79]
  ds_read_b128 a[136:139], v236 offset:43264
  v_add_f32 v226, v226, v209
  v_mfma_f32_16x16x32_bf16 v[28:31], a[172:175], v[192:195], v[28:31]
  v_exp_f32 v220, v220
  v_mfma_f32_16x16x32_bf16 v[32:35], a[176:179], v[192:195], v[32:35]
  ds_read_b128 a[132:135], v237 offset:43136
  v_add_f32 v226, v226, v210
  v_mfma_f32_16x16x32_bf16 v[80:83], a[176:179], v[200:203], v[80:83]
  s_waitcnt lgkmcnt(4)
  v_exp_f32 v221, v221
  v_mfma_f32_16x16x32_bf16 v[84:87], a[180:183], v[200:203], v[84:87]
  ds_read_b128 a[128:131], v236 offset:43136
  v_add_f32 v226, v226, v211
  v_mfma_f32_16x16x32_bf16 v[36:39], a[180:183], v[192:195], v[36:39]
  v_exp_f32 v222, v222
  v_mfma_f32_16x16x32_bf16 v[40:43], a[184:187], v[192:195], v[40:43]
  ds_read_b128 a[124:127], v237 offset:43008
  v_add_f32 v226, v226, v212
  v_mfma_f32_16x16x32_bf16 v[88:91], a[184:187], v[200:203], v[88:91]
  v_exp_f32 v223, v223
  v_mfma_f32_16x16x32_bf16 v[92:95], a[188:191], v[200:203], v[92:95]
  ds_read_b128 a[120:123], v236 offset:43008
  v_add_f32 v226, v226, v213
  v_mfma_f32_16x16x32_bf16 v[44:47], a[188:191], v[192:195], v[44:47]
  v_add_f32 v226, v226, v214
  v_add_f32 v226, v226, v215
  v_mfma_f32_16x16x32_bf16 v[192:195], a[96:99], a[0:3], v[232:235]
  v_cvt_pk_bf16_f32 v208, v208, v209
  v_cvt_pk_bf16_f32 v209, v210, v211
  v_mfma_f32_16x16x32_bf16 v[192:195], a[100:103], a[4:7], v[192:195]
  v_cvt_pk_bf16_f32 v210, v212, v213
  v_cvt_pk_bf16_f32 v211, v214, v215
  v_mfma_f32_16x16x32_bf16 v[192:195], a[104:107], a[8:11], v[192:195]
  v_add_f32 v227, v227, v216
  v_add_f32 v227, v227, v217
  v_mfma_f32_16x16x32_bf16 v[192:195], a[108:111], a[12:15], v[192:195]
  s_waitcnt vmcnt(12) lgkmcnt(0)
  v_add_f32 v227, v227, v218
  v_add_f32 v227, v227, v219
  v_mfma_f32_16x16x32_bf16 v[192:195], a[112:115], a[16:19], v[192:195]
  s_barrier
  v_add_f32 v227, v227, v220
  v_add_f32 v227, v227, v221
  v_mfma_f32_16x16x32_bf16 v[192:195], a[116:119], a[20:23], v[192:195]
  s_add_u32 m0, s21, 73728
  v_add_f32 v227, v227, v222
  v_add_f32 v227, v227, v223
  v_mfma_f32_16x16x32_bf16 v[196:199], a[140:143], a[20:23], v[232:235]
  buffer_load_dwordx4 v242, s[12:15], s20 offen nt lds
  v_mfma_f32_16x16x32_bf16 v[196:199], a[136:139], a[16:19], v[196:199]
  v_cvt_pk_bf16_f32 v219, v218, v219
  v_cvt_pk_bf16_f32 v218, v216, v217
  v_mfma_f32_16x16x32_bf16 v[196:199], a[132:135], a[12:15], v[196:199]
  v_cvt_pk_bf16_f32 v216, v220, v221
  v_cvt_pk_bf16_f32 v217, v222, v223
  v_mfma_f32_16x16x32_bf16 v[196:199], a[128:131], a[8:11], v[196:199]
  v_fma_f32 v192, v192, s22, v228
  v_fma_f32 v193, v193, s22, v228
  v_mfma_f32_16x16x32_bf16 v[196:199], a[124:127], a[4:7], v[196:199]
  v_fma_f32 v194, v194, s22, v228
  v_fma_f32 v195, v195, s22, v228
  v_mfma_f32_16x16x32_bf16 v[196:199], a[120:123], a[0:3], v[196:199]
  buffer_load_dwordx4 v243, s[12:15], s20 offen offset:1024 nt lds
  v_mfma_f32_16x16x32_bf16 v[200:203], a[120:123], a[24:27], v[232:235]
  v_exp_f32 v192, v192
  v_mfma_f32_16x16x32_bf16 v[200:203], a[124:127], a[28:31], v[200:203]
  v_exp_f32 v193, v193
  v_mfma_f32_16x16x32_bf16 v[200:203], a[128:131], a[32:35], v[200:203]
  v_exp_f32 v194, v194
  v_mfma_f32_16x16x32_bf16 v[200:203], a[132:135], a[36:39], v[200:203]
  v_exp_f32 v195, v195
  v_mfma_f32_16x16x32_bf16 v[200:203], a[136:139], a[40:43], v[200:203]
  buffer_load_dwordx4 v244, s[12:15], s20 offen offset:2048 nt lds
  v_mfma_f32_16x16x32_bf16 v[200:203], a[140:143], a[44:47], v[200:203]
  v_fma_f32 v196, v196, s22, v228
  v_fma_f32 v197, v197, s22, v228
  v_mfma_f32_16x16x32_bf16 v[204:207], a[116:119], a[44:47], v[232:235]
  v_fma_f32 v198, v198, s22, v228
  v_fma_f32 v199, v199, s22, v228
  v_mfma_f32_16x16x32_bf16 v[204:207], a[112:115], a[40:43], v[204:207]
  s_add_u32 s20, s20, 12288
  v_exp_f32 v196, v196
  v_mfma_f32_16x16x32_bf16 v[204:207], a[108:111], a[36:39], v[204:207]
  s_add_u32 m0, s21, 36864
  v_exp_f32 v197, v197
  v_mfma_f32_16x16x32_bf16 v[204:207], a[104:107], a[32:35], v[204:207]
  buffer_load_dwordx4 v242, s[8:11], s20 offen nt lds
  v_mfma_f32_16x16x32_bf16 v[204:207], a[100:103], a[28:31], v[204:207]
  v_exp_f32 v198, v198
  v_mfma_f32_16x16x32_bf16 v[204:207], a[96:99], a[24:27], v[204:207]
  v_exp_f32 v199, v199
  v_mfma_f32_16x16x32_bf16 v[96:99], a[144:147], v[208:211], v[96:99]
  v_fma_f32 v200, v200, s22, v229
  v_fma_f32 v201, v201, s22, v229
  v_mfma_f32_16x16x32_bf16 v[144:147], a[144:147], v[216:219], v[144:147]
  v_fma_f32 v202, v202, s22, v229
  v_fma_f32 v203, v203, s22, v229
  v_mfma_f32_16x16x32_bf16 v[148:151], a[148:151], v[216:219], v[148:151]
  buffer_load_dwordx4 v243, s[8:11], s20 offen offset:1024 nt lds
  v_mfma_f32_16x16x32_bf16 v[100:103], a[148:151], v[208:211], v[100:103]
  v_exp_f32 v200, v200
  v_mfma_f32_16x16x32_bf16 v[104:107], a[152:155], v[208:211], v[104:107]
  v_exp_f32 v201, v201
  v_mfma_f32_16x16x32_bf16 v[152:155], a[152:155], v[216:219], v[152:155]
  v_exp_f32 v202, v202
  v_mfma_f32_16x16x32_bf16 v[156:159], a[156:159], v[216:219], v[156:159]
  v_exp_f32 v203, v203
  v_mfma_f32_16x16x32_bf16 v[108:111], a[156:159], v[208:211], v[108:111]
  buffer_load_dwordx4 v244, s[8:11], s20 offen offset:2048 nt lds
  v_mfma_f32_16x16x32_bf16 v[112:115], a[160:163], v[208:211], v[112:115]
  v_fma_f32 v204, v204, s22, v229
  v_fma_f32 v205, v205, s22, v229
  v_mfma_f32_16x16x32_bf16 v[160:163], a[160:163], v[216:219], v[160:163]
  v_fma_f32 v206, v206, s22, v229
  v_fma_f32 v207, v207, s22, v229
  v_mfma_f32_16x16x32_bf16 v[164:167], a[164:167], v[216:219], v[164:167]
  v_exp_f32 v204, v204
  v_mfma_f32_16x16x32_bf16 v[116:119], a[164:167], v[208:211], v[116:119]
  v_exp_f32 v205, v205
  v_mfma_f32_16x16x32_bf16 v[120:123], a[168:171], v[208:211], v[120:123]
  ds_read_b64_tr_b16 a[144:145], v238 offset:0
  v_add_f32 v224, v224, v192
  v_mfma_f32_16x16x32_bf16 v[168:171], a[168:171], v[216:219], v[168:171]
  ds_read_b64_tr_b16 a[146:147], v238 offset:6144
  v_add_f32 v224, v224, v193
  v_mfma_f32_16x16x32_bf16 v[172:175], a[172:175], v[216:219], v[172:175]
  v_exp_f32 v206, v206
  v_mfma_f32_16x16x32_bf16 v[124:127], a[172:175], v[208:211], v[124:127]
  ds_read_b64_tr_b16 a[148:149], v239 offset:0
  v_add_f32 v224, v224, v194
  v_mfma_f32_16x16x32_bf16 v[128:131], a[176:179], v[208:211], v[128:131]
  ds_read_b64_tr_b16 a[150:151], v239 offset:6144
  v_add_f32 v224, v224, v195
  v_mfma_f32_16x16x32_bf16 v[176:179], a[176:179], v[216:219], v[176:179]
  v_exp_f32 v207, v207
  v_mfma_f32_16x16x32_bf16 v[180:183], a[180:183], v[216:219], v[180:183]
  ds_read_b64_tr_b16 a[152:153], v240 offset:0
  v_cvt_pk_bf16_f32 v192, v192, v193
  v_mfma_f32_16x16x32_bf16 v[132:135], a[180:183], v[208:211], v[132:135]
  ds_read_b64_tr_b16 a[154:155], v240 offset:6144
  v_cvt_pk_bf16_f32 v193, v194, v195
  v_mfma_f32_16x16x32_bf16 v[136:139], a[184:187], v[208:211], v[136:139]
  v_add_f32 v224, v224, v196
  v_add_f32 v224, v224, v197
  v_mfma_f32_16x16x32_bf16 v[184:187], a[184:187], v[216:219], v[184:187]
  ds_read_b64_tr_b16 a[156:157], v241 offset:0
  v_add_f32 v224, v224, v198
  v_mfma_f32_16x16x32_bf16 v[188:191], a[188:191], v[216:219], v[188:191]
  ds_read_b64_tr_b16 a[158:159], v241 offset:6144
  v_add_f32 v224, v224, v199
  v_mfma_f32_16x16x32_bf16 v[140:143], a[188:191], v[208:211], v[140:143]
  v_cvt_pk_bf16_f32 v194, v196, v197
  v_cvt_pk_bf16_f32 v195, v198, v199
  v_mfma_f32_16x16x32_bf16 v[208:211], a[96:99], a[48:51], v[232:235]
  ds_read_b64_tr_b16 a[160:161], v238 offset:128
  v_add_f32 v225, v225, v200
  v_mfma_f32_16x16x32_bf16 v[208:211], a[100:103], a[52:55], v[208:211]
  ds_read_b64_tr_b16 a[162:163], v238 offset:6272
  v_add_f32 v225, v225, v201
  v_mfma_f32_16x16x32_bf16 v[208:211], a[104:107], a[56:59], v[208:211]
  v_add_f32 v225, v225, v202
  v_add_f32 v225, v225, v203
  v_mfma_f32_16x16x32_bf16 v[208:211], a[108:111], a[60:63], v[208:211]
  ds_read_b64_tr_b16 a[164:165], v239 offset:128
  v_cvt_pk_bf16_f32 v203, v202, v203
  v_mfma_f32_16x16x32_bf16 v[208:211], a[112:115], a[64:67], v[208:211]
  ds_read_b64_tr_b16 a[166:167], v239 offset:6272
  v_cvt_pk_bf16_f32 v202, v200, v201
  v_mfma_f32_16x16x32_bf16 v[208:211], a[116:119], a[68:71], v[208:211]
  v_add_f32 v225, v225, v204
  v_add_f32 v225, v225, v205
  v_mfma_f32_16x16x32_bf16 v[212:215], a[140:143], a[68:71], v[232:235]
  ds_read_b64_tr_b16 a[168:169], v240 offset:128
  v_add_f32 v225, v225, v206
  v_mfma_f32_16x16x32_bf16 v[212:215], a[136:139], a[64:67], v[212:215]
  ds_read_b64_tr_b16 a[170:171], v240 offset:6272
  v_add_f32 v225, v225, v207
  v_mfma_f32_16x16x32_bf16 v[212:215], a[132:135], a[60:63], v[212:215]
  v_cvt_pk_bf16_f32 v200, v204, v205
  v_cvt_pk_bf16_f32 v201, v206, v207
  v_mfma_f32_16x16x32_bf16 v[212:215], a[128:131], a[56:59], v[212:215]
  ds_read_b64_tr_b16 a[172:173], v241 offset:128
  v_fma_f32 v208, v208, s22, v230
  v_mfma_f32_16x16x32_bf16 v[212:215], a[124:127], a[52:55], v[212:215]
  ds_read_b64_tr_b16 a[174:175], v241 offset:6272
  v_fma_f32 v209, v209, s22, v230
  v_mfma_f32_16x16x32_bf16 v[212:215], a[120:123], a[48:51], v[212:215]
  v_exp_f32 v208, v208
  v_mfma_f32_16x16x32_bf16 v[216:219], a[120:123], a[72:75], v[232:235]
  ds_read_b64_tr_b16 a[176:177], v238 offset:256
  v_fma_f32 v210, v210, s22, v230
  v_mfma_f32_16x16x32_bf16 v[216:219], a[124:127], a[76:79], v[216:219]
  ds_read_b64_tr_b16 a[178:179], v238 offset:6400
  v_fma_f32 v211, v211, s22, v230
  v_mfma_f32_16x16x32_bf16 v[216:219], a[128:131], a[80:83], v[216:219]
  v_exp_f32 v209, v209
  v_mfma_f32_16x16x32_bf16 v[216:219], a[132:135], a[84:87], v[216:219]
  ds_read_b64_tr_b16 a[180:181], v239 offset:256
  v_fma_f32 v212, v212, s22, v230
  v_mfma_f32_16x16x32_bf16 v[216:219], a[136:139], a[88:91], v[216:219]
  ds_read_b64_tr_b16 a[182:183], v239 offset:6400
  v_fma_f32 v213, v213, s22, v230
  v_mfma_f32_16x16x32_bf16 v[216:219], a[140:143], a[92:95], v[216:219]
  v_exp_f32 v210, v210
  v_mfma_f32_16x16x32_bf16 v[220:223], a[116:119], a[92:95], v[232:235]
  ds_read_b64_tr_b16 a[184:185], v240 offset:256
  v_fma_f32 v214, v214, s22, v230
  v_mfma_f32_16x16x32_bf16 v[220:223], a[112:115], a[88:91], v[220:223]
  ds_read_b64_tr_b16 a[186:187], v240 offset:6400
  v_fma_f32 v215, v215, s22, v230
  v_mfma_f32_16x16x32_bf16 v[220:223], a[108:111], a[84:87], v[220:223]
  v_exp_f32 v211, v211
  v_mfma_f32_16x16x32_bf16 v[220:223], a[104:107], a[80:83], v[220:223]
  ds_read_b64_tr_b16 a[188:189], v241 offset:256
  v_fma_f32 v216, v216, s22, v231
  v_mfma_f32_16x16x32_bf16 v[220:223], a[100:103], a[76:79], v[220:223]
  ds_read_b64_tr_b16 a[190:191], v241 offset:6400
  v_fma_f32 v217, v217, s22, v231
  v_mfma_f32_16x16x32_bf16 v[220:223], a[96:99], a[72:75], v[220:223]
  s_waitcnt lgkmcnt(5)
  v_exp_f32 v212, v212
  v_mfma_f32_16x16x32_bf16 v[0:3], a[144:147], v[192:195], v[0:3]
  ds_read_b128 a[96:99], v236 offset:0
  v_fma_f32 v218, v218, s22, v231
  v_mfma_f32_16x16x32_bf16 v[48:51], a[144:147], v[200:203], v[48:51]
  v_exp_f32 v213, v213
  v_mfma_f32_16x16x32_bf16 v[52:55], a[148:151], v[200:203], v[52:55]
  ds_read_b128 a[100:103], v237 offset:0
  v_fma_f32 v219, v219, s22, v231
  v_mfma_f32_16x16x32_bf16 v[4:7], a[148:151], v[192:195], v[4:7]
  v_exp_f32 v214, v214
  v_mfma_f32_16x16x32_bf16 v[8:11], a[152:155], v[192:195], v[8:11]
  ds_read_b128 a[104:107], v236 offset:128
  v_fma_f32 v220, v220, s22, v231
  v_mfma_f32_16x16x32_bf16 v[56:59], a[152:155], v[200:203], v[56:59]
  v_exp_f32 v215, v215
  v_mfma_f32_16x16x32_bf16 v[60:63], a[156:159], v[200:203], v[60:63]
  ds_read_b128 a[108:111], v237 offset:128
  v_fma_f32 v221, v221, s22, v231
  v_mfma_f32_16x16x32_bf16 v[12:15], a[156:159], v[192:195], v[12:15]
  v_exp_f32 v216, v216
  v_mfma_f32_16x16x32_bf16 v[16:19], a[160:163], v[192:195], v[16:19]
  ds_read_b128 a[112:115], v236 offset:256
  v_fma_f32 v222, v222, s22, v231
  v_mfma_f32_16x16x32_bf16 v[64:67], a[160:163], v[200:203], v[64:67]
  v_exp_f32 v217, v217
  v_mfma_f32_16x16x32_bf16 v[68:71], a[164:167], v[200:203], v[68:71]
  ds_read_b128 a[116:119], v237 offset:256
  v_fma_f32 v223, v223, s22, v231
  v_mfma_f32_16x16x32_bf16 v[20:23], a[164:167], v[192:195], v[20:23]
  v_exp_f32 v218, v218
  v_mfma_f32_16x16x32_bf16 v[24:27], a[168:171], v[192:195], v[24:27]
  ds_read_b128 a[140:143], v237 offset:6400
  v_add_f32 v226, v226, v208
  v_mfma_f32_16x16x32_bf16 v[72:75], a[168:171], v[200:203], v[72:75]
  v_exp_f32 v219, v219
  v_mfma_f32_16x16x32_bf16 v[76:79], a[172:175], v[200:203], v[76:79]
  ds_read_b128 a[136:139], v236 offset:6400
  v_add_f32 v226, v226, v209
  v_mfma_f32_16x16x32_bf16 v[28:31], a[172:175], v[192:195], v[28:31]
  v_exp_f32 v220, v220
  v_mfma_f32_16x16x32_bf16 v[32:35], a[176:179], v[192:195], v[32:35]
  ds_read_b128 a[132:135], v237 offset:6272
  v_add_f32 v226, v226, v210
  v_mfma_f32_16x16x32_bf16 v[80:83], a[176:179], v[200:203], v[80:83]
  s_waitcnt lgkmcnt(4)
  v_exp_f32 v221, v221
  v_mfma_f32_16x16x32_bf16 v[84:87], a[180:183], v[200:203], v[84:87]
  ds_read_b128 a[128:131], v236 offset:6272
  v_add_f32 v226, v226, v211
  v_mfma_f32_16x16x32_bf16 v[36:39], a[180:183], v[192:195], v[36:39]
  v_exp_f32 v222, v222
  v_mfma_f32_16x16x32_bf16 v[40:43], a[184:187], v[192:195], v[40:43]
  ds_read_b128 a[124:127], v237 offset:6144
  v_add_f32 v226, v226, v212
  v_mfma_f32_16x16x32_bf16 v[88:91], a[184:187], v[200:203], v[88:91]
  v_exp_f32 v223, v223
  v_mfma_f32_16x16x32_bf16 v[92:95], a[188:191], v[200:203], v[92:95]
  ds_read_b128 a[120:123], v236 offset:6144
  v_add_f32 v226, v226, v213
  v_mfma_f32_16x16x32_bf16 v[44:47], a[188:191], v[192:195], v[44:47]
  v_add_f32 v226, v226, v214
  v_add_f32 v226, v226, v215
  v_mfma_f32_16x16x32_bf16 v[192:195], a[96:99], a[192:195], v[232:235]
  ds_read_b128 a[48:51], v248 offset:0
  v_xor_b32 v250, 96, v247
  v_permlane16_swap_b32 v224, v225
  v_mfma_f32_16x16x32_bf16 v[192:195], a[100:103], a[196:199], v[192:195]
  ds_read_b128 a[52:55], v249 offset:0
  v_add_f32 v224, v224, v225
  v_mov_b32 v225, v224
  v_mfma_f32_16x16x32_bf16 v[192:195], a[104:107], a[200:203], v[192:195]
  ds_read_b128 a[56:59], v248 offset:128
  v_cvt_pk_bf16_f32 v208, v208, v209
  v_cvt_pk_bf16_f32 v209, v210, v211
  v_mfma_f32_16x16x32_bf16 v[192:195], a[108:111], a[204:207], v[192:195]
  s_waitcnt vmcnt(12) lgkmcnt(3)
  ds_read_b128 a[60:63], v249 offset:128
  v_permlane32_swap_b32 v224, v225
  v_mfma_f32_16x16x32_bf16 v[192:195], a[112:115], a[208:211], v[192:195]
  s_barrier
  ds_read_b128 a[64:67], v248 offset:256
  v_add_f32 v225, v224, v225
  v_cvt_pk_bf16_f32 v210, v212, v213
  v_mfma_f32_16x16x32_bf16 v[192:195], a[116:119], a[212:215], v[192:195]
  ds_read_b128 a[68:71], v249 offset:256
  v_cvt_pk_bf16_f32 v211, v214, v215
  v_rcp_f32 v212, v225
  v_mfma_f32_16x16x32_bf16 v[196:199], a[140:143], a[212:215], v[232:235]
  ds_read_b128 a[72:75], v248 offset:6144
  v_cmp_ngt_f32_e64 s[44:45], s28, v225
  v_mov_b32 v213, v212
  v_mfma_f32_16x16x32_bf16 v[196:199], a[136:139], a[208:211], v[196:199]
  ds_read_b128 a[76:79], v249 offset:6144
  v_permlane16_swap_b32 v212, v213
  v_mfma_f32_16x16x32_bf16 v[196:199], a[132:135], a[204:207], v[196:199]
  ds_read_b128 a[80:83], v248 offset:6272
  v_mul_f32_e64 v214, -v212, s3
  v_mul_f32_e64 v215, -v213, s3
  v_mfma_f32_16x16x32_bf16 v[196:199], a[128:131], a[200:203], v[196:199]
  ds_read_b128 a[84:87], v249 offset:6272
  v_add_f32 v227, v227, v216
  v_add_f32 v227, v227, v217
  v_mfma_f32_16x16x32_bf16 v[196:199], a[124:127], a[196:199], v[196:199]
  ds_read_b128 a[88:91], v248 offset:6400
  v_add_f32 v227, v227, v218
  v_add_f32 v227, v227, v219
  v_mfma_f32_16x16x32_bf16 v[196:199], a[120:123], a[192:195], v[196:199]
  ds_read_b128 a[92:95], v249 offset:6400
  v_add_f32 v227, v227, v220
  v_add_f32 v227, v227, v221
  v_mfma_f32_16x16x32_bf16 v[200:203], a[120:123], a[216:219], v[232:235]
  v_add_f32 v227, v227, v222
  v_add_f32 v227, v227, v223
  v_mfma_f32_16x16x32_bf16 v[200:203], a[124:127], a[220:223], v[200:203]
  v_cvt_pk_bf16_f32 v219, v218, v219
  v_cvt_pk_bf16_f32 v218, v216, v217
  v_cvt_pk_bf16_f32 v216, v220, v221
  v_cvt_pk_bf16_f32 v217, v222, v223
  v_pk_fma_f32 v[0:1], v[0:1], v[212:213], v[214:215] op_sel:[0,0,0] op_sel_hi:[1,0,0]
  v_pk_fma_f32 v[2:3], v[2:3], v[212:213], v[214:215] op_sel:[0,0,0] op_sel_hi:[1,0,0]
  v_permlane16_swap_b32 v226, v227
  v_mfma_f32_16x16x32_bf16 v[200:203], a[128:131], a[224:227], v[200:203]
  v_xor_b32 v248, 32, v247
  v_xor_b32 v249, 64, v247
  v_add_f32 v226, v226, v227
  v_mov_b32 v227, v226
  v_cvt_pk_bf16_f32 v0, v0, v1
  v_pk_fma_f32 v[4:5], v[4:5], v[212:213], v[214:215] op_sel:[0,0,0] op_sel_hi:[1,0,0]
  v_pk_fma_f32 v[6:7], v[6:7], v[212:213], v[214:215] op_sel:[0,0,0] op_sel_hi:[1,0,0]
  v_cvt_pk_bf16_f32 v1, v2, v3
  v_mfma_f32_16x16x32_bf16 v[200:203], a[132:135], a[228:231], v[200:203]
  ds_write_b64 v247, v[0:1] offset:0
  v_permlane32_swap_b32 v226, v227
  v_cvt_pk_bf16_f32 v4, v4, v5
  v_cvt_pk_bf16_f32 v5, v6, v7
  v_pk_fma_f32 v[8:9], v[8:9], v[212:213], v[214:215] op_sel:[0,0,0] op_sel_hi:[1,0,0]
  v_pk_fma_f32 v[10:11], v[10:11], v[212:213], v[214:215] op_sel:[0,0,0] op_sel_hi:[1,0,0]
  v_max3_f32 v3, |v2|, |v3|, |v6|
  v_mfma_f32_16x16x32_bf16 v[200:203], a[136:139], a[232:235], v[200:203]
  ds_write_b64 v248, v[4:5] offset:0
  v_add_f32 v227, v226, v227
  v_rcp_f32 v226, v227
  v_cvt_pk_bf16_f32 v8, v8, v9
  v_cvt_pk_bf16_f32 v9, v10, v11
  v_pk_fma_f32 v[12:13], v[12:13], v[212:213], v[214:215] op_sel:[0,0,0] op_sel_hi:[1,0,0]
  v_pk_fma_f32 v[14:15], v[14:15], v[212:213], v[214:215] op_sel:[0,0,0] op_sel_hi:[1,0,0]
  v_cmp_nle_f32_e64 s[36:37], s85, v3
  v_mfma_f32_16x16x32_bf16 v[200:203], a[140:143], a[236:239], v[200:203]
  ds_write_b64 v249, v[8:9] offset:0
  v_cmp_ngt_f32_e64 s[48:49], s28, v227
  v_mov_b32 v227, v226
  v_cvt_pk_bf16_f32 v12, v12, v13
  v_pk_fma_f32 v[16:17], v[16:17], v[212:213], v[214:215] op_sel:[0,0,0] op_sel_hi:[1,0,0]
  v_pk_fma_f32 v[18:19], v[18:19], v[212:213], v[214:215] op_sel:[0,0,0] op_sel_hi:[1,0,0]
  v_cvt_pk_bf16_f32 v13, v14, v15
  v_mfma_f32_16x16x32_bf16 v[204:207], a[116:119], a[236:239], v[232:235]
  ds_write_b64 v250, v[12:13] offset:0
  v_permlane16_swap_b32 v226, v227
  v_cvt_pk_bf16_f32 v16, v16, v17
  v_pk_fma_f32 v[20:21], v[20:21], v[212:213], v[214:215] op_sel:[0,0,0] op_sel_hi:[1,0,0]
  v_pk_fma_f32 v[22:23], v[22:23], v[212:213], v[214:215] op_sel:[0,0,0] op_sel_hi:[1,0,0]
  v_cvt_pk_bf16_f32 v17, v18, v19
  v_mfma_f32_16x16x32_bf16 v[204:207], a[112:115], a[232:235], v[204:207]
  ds_write_b64 v247, v[16:17] offset:128
  v_mul_f32_e64 v230, -v226, s3
  v_mul_f32_e64 v231, -v227, s3
  v_cvt_pk_bf16_f32 v20, v20, v21
  v_pk_fma_f32 v[24:25], v[24:25], v[212:213], v[214:215] op_sel:[0,0,0] op_sel_hi:[1,0,0]
  v_pk_fma_f32 v[26:27], v[26:27], v[212:213], v[214:215] op_sel:[0,0,0] op_sel_hi:[1,0,0]
  v_cvt_pk_bf16_f32 v21, v22, v23
  v_mfma_f32_16x16x32_bf16 v[204:207], a[108:111], a[228:231], v[204:207]
  ds_write_b64 v248, v[20:21] offset:128
  v_max3_f32 v228, v192, v193, v194
  v_max3_f32 v224, v195, v196, v197
  v_cvt_pk_bf16_f32 v24, v24, v25
  v_pk_fma_f32 v[28:29], v[28:29], v[212:213], v[214:215] op_sel:[0,0,0] op_sel_hi:[1,0,0]
  v_pk_fma_f32 v[30:31], v[30:31], v[212:213], v[214:215] op_sel:[0,0,0] op_sel_hi:[1,0,0]
  v_cvt_pk_bf16_f32 v25, v26, v27
  v_mfma_f32_16x16x32_bf16 v[204:207], a[104:107], a[224:227], v[204:207]
  ds_write_b64 v249, v[24:25] offset:128
  v_max3_f32 v228, v228, v198, v199
  v_max_f32 v228, v228, v224
  v_cvt_pk_bf16_f32 v28, v28, v29
  v_pk_fma_f32 v[32:33], v[32:33], v[212:213], v[214:215] op_sel:[0,0,0] op_sel_hi:[1,0,0]
  v_pk_fma_f32 v[34:35], v[34:35], v[212:213], v[214:215] op_sel:[0,0,0] op_sel_hi:[1,0,0]
  v_cvt_pk_bf16_f32 v29, v30, v31
  v_mfma_f32_16x16x32_bf16 v[204:207], a[100:103], a[220:223], v[204:207]
  s_add_u32 s88, s23, 0
  ds_write_b64 v250, v[28:29] offset:128
  v_cvt_pk_bf16_f32 v32, v32, v33
  v_pk_fma_f32 v[36:37], v[36:37], v[212:213], v[214:215] op_sel:[0,0,0] op_sel_hi:[1,0,0]
  v_pk_fma_f32 v[38:39], v[38:39], v[212:213], v[214:215] op_sel:[0,0,0] op_sel_hi:[1,0,0]
  v_cvt_pk_bf16_f32 v33, v34, v35
  v_mfma_f32_16x16x32_bf16 v[204:207], a[96:99], a[216:219], v[204:207]
  s_add_u32 s89, s23, 3072
  ds_write_b64 v247, v[32:33] offset:256
  v_cvt_pk_bf16_f32 v36, v36, v37
  v_pk_fma_f32 v[40:41], v[40:41], v[212:213], v[214:215] op_sel:[0,0,0] op_sel_hi:[1,0,0]
  v_pk_fma_f32 v[42:43], v[42:43], v[212:213], v[214:215] op_sel:[0,0,0] op_sel_hi:[1,0,0]
  v_cvt_pk_bf16_f32 v37, v38, v39
  v_mfma_f32_16x16x32_bf16 v[96:99], a[144:147], v[208:211], v[96:99]
  s_add_u32 s90, s23, 6144
  ds_write_b64 v248, v[36:37] offset:256
  v_cvt_pk_bf16_f32 v40, v40, v41
  v_pk_fma_f32 v[44:45], v[44:45], v[212:213], v[214:215] op_sel:[0,0,0] op_sel_hi:[1,0,0]
  v_pk_fma_f32 v[46:47], v[46:47], v[212:213], v[214:215] op_sel:[0,0,0] op_sel_hi:[1,0,0]
  v_cvt_pk_bf16_f32 v41, v42, v43
  v_mfma_f32_16x16x32_bf16 v[144:147], a[144:147], v[216:219], v[144:147]
  s_add_u32 s91, s23, 9216
  ds_write_b64 v249, v[40:41] offset:256
  v_cvt_pk_bf16_f32 v44, v44, v45
  v_pk_fma_f32 v[48:49], v[48:49], v[212:213], v[214:215] op_sel:[0,1,1] op_sel_hi:[1,1,1]
  v_pk_fma_f32 v[50:51], v[50:51], v[212:213], v[214:215] op_sel:[0,1,1] op_sel_hi:[1,1,1]
  v_cvt_pk_bf16_f32 v45, v46, v47
  v_mfma_f32_16x16x32_bf16 v[148:151], a[148:151], v[216:219], v[148:151]
  s_add_u32 s92, s23, 12288
  ds_write_b64 v250, v[44:45] offset:256
  v_max3_f32 v229, v200, v201, v202
  v_max3_f32 v225, v203, v204, v205
  v_cvt_pk_bf16_f32 v48, v48, v49
  v_pk_fma_f32 v[52:53], v[52:53], v[212:213], v[214:215] op_sel:[0,1,1] op_sel_hi:[1,1,1]
  v_pk_fma_f32 v[54:55], v[54:55], v[212:213], v[214:215] op_sel:[0,1,1] op_sel_hi:[1,1,1]
  v_cvt_pk_bf16_f32 v49, v50, v51
  v_mfma_f32_16x16x32_bf16 v[100:103], a[148:151], v[208:211], v[100:103]
  s_add_u32 s93, s23, 15360
  ds_read_b128 a[0:3], v251 offset:0
  ds_write_b64 v247, v[48:49] offset:6144
  v_max3_f32 v229, v229, v206, v207
  v_max_f32 v229, v229, v225
  v_cvt_pk_bf16_f32 v52, v52, v53
  v_cvt_pk_bf16_f32 v53, v54, v55
  v_pk_fma_f32 v[56:57], v[56:57], v[212:213], v[214:215] op_sel:[0,1,1] op_sel_hi:[1,1,1]
  v_pk_fma_f32 v[58:59], v[58:59], v[212:213], v[214:215] op_sel:[0,1,1] op_sel_hi:[1,1,1]
  v_max3_f32 v51, |v50|, |v51|, |v54|
  v_mfma_f32_16x16x32_bf16 v[104:107], a[152:155], v[208:211], v[104:107]
  s_add_u32 s94, s23, 18432
  ds_write_b64 v248, v[52:53] offset:6144
  v_permlane16_swap_b32 v228, v229
  v_cvt_pk_bf16_f32 v56, v56, v57
  v_cvt_pk_bf16_f32 v57, v58, v59
  v_pk_fma_f32 v[60:61], v[60:61], v[212:213], v[214:215] op_sel:[0,1,1] op_sel_hi:[1,1,1]
  v_pk_fma_f32 v[62:63], v[62:63], v[212:213], v[214:215] op_sel:[0,1,1] op_sel_hi:[1,1,1]
  v_cmp_nle_f32_e64 s[38:39], s85, v51
  v_mfma_f32_16x16x32_bf16 v[152:155], a[152:155], v[216:219], v[152:155]
  s_add_u32 s95, s23, 21504
  ds_read_b128 a[4:7], v252 offset:0
  ds_write_b64 v249, v[56:57] offset:6144
  v_max_f32 v228, v228, v229
  v_mov_b32 v229, v228
  v_cvt_pk_bf16_f32 v60, v60, v61
  v_pk_fma_f32 v[64:65], v[64:65], v[212:213], v[214:215] op_sel:[0,1,1] op_sel_hi:[1,1,1]
  v_pk_fma_f32 v[66:67], v[66:67], v[212:213], v[214:215] op_sel:[0,1,1] op_sel_hi:[1,1,1]
  v_cvt_pk_bf16_f32 v61, v62, v63
  v_mfma_f32_16x16x32_bf16 v[156:159], a[156:159], v[216:219], v[156:159]
  s_waitcnt lgkmcnt(3)
  buffer_store_dwordx4 a[0:3], v246, s[16:19], s88 offen sc0 sc1 nt
  ds_write_b64 v250, v[60:61] offset:6144
  v_permlane32_swap_b32 v228, v229
  v_cvt_pk_bf16_f32 v64, v64, v65
  v_pk_fma_f32 v[68:69], v[68:69], v[212:213], v[214:215] op_sel:[0,1,1] op_sel_hi:[1,1,1]
  v_pk_fma_f32 v[70:71], v[70:71], v[212:213], v[214:215] op_sel:[0,1,1] op_sel_hi:[1,1,1]
  v_cvt_pk_bf16_f32 v65, v66, v67
  v_mfma_f32_16x16x32_bf16 v[108:111], a[156:159], v[208:211], v[108:111]
  ds_read_b128 a[8:11], v253 offset:0
  ds_write_b64 v247, v[64:65] offset:6272
  v_max_f32 v228, v228, v229
  v_mul_f32_e64 v228, v228, -s22
  v_cvt_pk_bf16_f32 v68, v68, v69
  v_pk_fma_f32 v[72:73], v[72:73], v[212:213], v[214:215] op_sel:[0,1,1] op_sel_hi:[1,1,1]
  v_pk_fma_f32 v[74:75], v[74:75], v[212:213], v[214:215] op_sel:[0,1,1] op_sel_hi:[1,1,1]
  v_cvt_pk_bf16_f32 v69, v70, v71
  v_mfma_f32_16x16x32_bf16 v[112:115], a[160:163], v[208:211], v[112:115]
  ds_write_b64 v248, v[68:69] offset:6272
  v_mov_b32 v229, v228
  v_cvt_pk_bf16_f32 v72, v72, v73
  v_pk_fma_f32 v[76:77], v[76:77], v[212:213], v[214:215] op_sel:[0,1,1] op_sel_hi:[1,1,1]
  v_pk_fma_f32 v[78:79], v[78:79], v[212:213], v[214:215] op_sel:[0,1,1] op_sel_hi:[1,1,1]
  v_cvt_pk_bf16_f32 v73, v74, v75
  v_mfma_f32_16x16x32_bf16 v[160:163], a[160:163], v[216:219], v[160:163]
  ds_read_b128 a[12:15], v251 offset:3072
  ds_write_b64 v249, v[72:73] offset:6272
  v_permlane16_swap_b32 v228, v229
  v_cvt_pk_bf16_f32 v76, v76, v77
  v_pk_fma_f32 v[80:81], v[80:81], v[212:213], v[214:215] op_sel:[0,1,1] op_sel_hi:[1,1,1]
  v_pk_fma_f32 v[82:83], v[82:83], v[212:213], v[214:215] op_sel:[0,1,1] op_sel_hi:[1,1,1]
  v_cvt_pk_bf16_f32 v77, v78, v79
  v_mfma_f32_16x16x32_bf16 v[164:167], a[164:167], v[216:219], v[164:167]
  s_waitcnt lgkmcnt(3)
  buffer_store_dwordx4 a[4:7], v246, s[16:19], s88 offen offset:1024 sc0 sc1 nt
  ds_write_b64 v250, v[76:77] offset:6272
  v_fma_f32 v192, v192, s22, v228
  v_fma_f32 v193, v193, s22, v228
  v_cvt_pk_bf16_f32 v80, v80, v81
  v_pk_fma_f32 v[84:85], v[84:85], v[212:213], v[214:215] op_sel:[0,1,1] op_sel_hi:[1,1,1]
  v_pk_fma_f32 v[86:87], v[86:87], v[212:213], v[214:215] op_sel:[0,1,1] op_sel_hi:[1,1,1]
  v_cvt_pk_bf16_f32 v81, v82, v83
  v_mfma_f32_16x16x32_bf16 v[116:119], a[164:167], v[208:211], v[116:119]
  ds_read_b128 a[16:19], v252 offset:3072
  ds_write_b64 v247, v[80:81] offset:6400
  v_fma_f32 v194, v194, s22, v228
  v_fma_f32 v195, v195, s22, v228
  v_cvt_pk_bf16_f32 v84, v84, v85
  v_pk_fma_f32 v[88:89], v[88:89], v[212:213], v[214:215] op_sel:[0,1,1] op_sel_hi:[1,1,1]
  v_pk_fma_f32 v[90:91], v[90:91], v[212:213], v[214:215] op_sel:[0,1,1] op_sel_hi:[1,1,1]
  v_cvt_pk_bf16_f32 v85, v86, v87
  v_mfma_f32_16x16x32_bf16 v[120:123], a[168:171], v[208:211], v[120:123]
L_pg8:
  s_cbranch_execz L_pg12
  ds_read_b64_tr_b16 a[144:145], v238 offset:36864
  ds_write_b64 v248, v[84:85] offset:6400
  v_exp_f32 v192, v192
  v_cvt_pk_bf16_f32 v88, v88, v89
  v_pk_fma_f32 v[92:93], v[92:93], v[212:213], v[214:215] op_sel:[0,1,1] op_sel_hi:[1,1,1]
  v_pk_fma_f32 v[94:95], v[94:95], v[212:213], v[214:215] op_sel:[0,1,1] op_sel_hi:[1,1,1]
  v_cvt_pk_bf16_f32 v89, v90, v91
  v_mfma_f32_16x16x32_bf16 v[168:171], a[168:171], v[216:219], v[168:171]
  ds_read_b64_tr_b16 a[146:147], v238 offset:43008
  ds_read_b128 a[20:23], v253 offset:3072
  ds_write_b64 v249, v[88:89] offset:6400
  v_exp_f32 v193, v193
  v_cvt_pk_bf16_f32 v92, v92, v93
  v_pk_fma_f32 v[96:97], v[96:97], v[226:227], v[230:231] op_sel:[0,0,0] op_sel_hi:[1,0,0]
  v_pk_fma_f32 v[98:99], v[98:99], v[226:227], v[230:231] op_sel:[0,0,0] op_sel_hi:[1,0,0]
  v_cvt_pk_bf16_f32 v93, v94, v95
  v_mfma_f32_16x16x32_bf16 v[172:175], a[172:175], v[216:219], v[172:175]
  buffer_store_dwordx4 a[8:11], v246, s[16:19], s88 offen offset:2048 sc0 sc1 nt
  ds_write_b64 v250, v[92:93] offset:6400
  v_exp_f32 v194, v194
  v_cvt_pk_bf16_f32 v96, v96, v97
  v_pk_fma_f32 v[100:101], v[100:101], v[226:227], v[230:231] op_sel:[0,0,0] op_sel_hi:[1,0,0]
  v_pk_fma_f32 v[102:103], v[102:103], v[226:227], v[230:231] op_sel:[0,0,0] op_sel_hi:[1,0,0]
  v_cvt_pk_bf16_f32 v97, v98, v99
  v_mfma_f32_16x16x32_bf16 v[124:127], a[172:175], v[208:211], v[124:127]
  ds_read_b64_tr_b16 a[148:149], v239 offset:36864
  ds_read_b128 a[24:27], v251 offset:6144
  ds_write_b64 v247, v[96:97] offset:0
  v_exp_f32 v195, v195
  v_cvt_pk_bf16_f32 v100, v100, v101
  v_cvt_pk_bf16_f32 v101, v102, v103
  v_pk_fma_f32 v[104:105], v[104:105], v[226:227], v[230:231] op_sel:[0,0,0] op_sel_hi:[1,0,0]
  v_pk_fma_f32 v[106:107], v[106:107], v[226:227], v[230:231] op_sel:[0,0,0] op_sel_hi:[1,0,0]
  v_max3_f32 v99, |v98|, |v99|, |v102|
  v_mfma_f32_16x16x32_bf16 v[128:131], a[176:179], v[208:211], v[128:131]
  ds_read_b64_tr_b16 a[150:151], v239 offset:43008
  ds_write_b64 v248, v[100:101] offset:0
  v_fma_f32 v196, v196, s22, v228
  v_fma_f32 v197, v197, s22, v228
  v_cvt_pk_bf16_f32 v104, v104, v105
  v_cvt_pk_bf16_f32 v105, v106, v107
  v_pk_fma_f32 v[108:109], v[108:109], v[226:227], v[230:231] op_sel:[0,0,0] op_sel_hi:[1,0,0]
  v_pk_fma_f32 v[110:111], v[110:111], v[226:227], v[230:231] op_sel:[0,0,0] op_sel_hi:[1,0,0]
  v_cmp_nle_f32_e64 s[40:41], s85, v99
  v_mfma_f32_16x16x32_bf16 v[176:179], a[176:179], v[216:219], v[176:179]
  s_waitcnt lgkmcnt(4)
  buffer_store_dwordx4 a[12:15], v246, s[16:19], s89 offen sc0 sc1 nt
  ds_read_b128 a[28:31], v252 offset:6144
  ds_write_b64 v249, v[104:105] offset:0
  v_fma_f32 v198, v198, s22, v228
  v_fma_f32 v199, v199, s22, v228
  v_cvt_pk_bf16_f32 v108, v108, v109
  v_pk_fma_f32 v[112:113], v[112:113], v[226:227], v[230:231] op_sel:[0,0,0] op_sel_hi:[1,0,0]
  v_pk_fma_f32 v[114:115], v[114:115], v[226:227], v[230:231] op_sel:[0,0,0] op_sel_hi:[1,0,0]
  v_cvt_pk_bf16_f32 v109, v110, v111
  v_mfma_f32_16x16x32_bf16 v[180:183], a[180:183], v[216:219], v[180:183]
  ds_read_b64_tr_b16 a[152:153], v240 offset:36864
  ds_write_b64 v250, v[108:109] offset:0
  v_exp_f32 v196, v196
  v_cvt_pk_bf16_f32 v112, v112, v113
  v_pk_fma_f32 v[116:117], v[116:117], v[226:227], v[230:231] op_sel:[0,0,0] op_sel_hi:[1,0,0]
  v_pk_fma_f32 v[118:119], v[118:119], v[226:227], v[230:231] op_sel:[0,0,0] op_sel_hi:[1,0,0]
  v_cvt_pk_bf16_f32 v113, v114, v115
  v_mfma_f32_16x16x32_bf16 v[132:135], a[180:183], v[208:211], v[132:135]
  ds_read_b64_tr_b16 a[154:155], v240 offset:43008
  ds_read_b128 a[32:35], v253 offset:6144
  ds_write_b64 v247, v[112:113] offset:128
  v_exp_f32 v197, v197
  v_cvt_pk_bf16_f32 v116, v116, v117
  v_pk_fma_f32 v[120:121], v[120:121], v[226:227], v[230:231] op_sel:[0,0,0] op_sel_hi:[1,0,0]
  v_pk_fma_f32 v[122:123], v[122:123], v[226:227], v[230:231] op_sel:[0,0,0] op_sel_hi:[1,0,0]
  v_cvt_pk_bf16_f32 v117, v118, v119
  v_mfma_f32_16x16x32_bf16 v[136:139], a[184:187], v[208:211], v[136:139]
  buffer_store_dwordx4 a[16:19], v246, s[16:19], s89 offen offset:1024 sc0 sc1 nt
  ds_write_b64 v248, v[116:117] offset:128
  v_exp_f32 v198, v198
  v_cvt_pk_bf16_f32 v120, v120, v121
  v_pk_fma_f32 v[124:125], v[124:125], v[226:227], v[230:231] op_sel:[0,0,0] op_sel_hi:[1,0,0]
  v_pk_fma_f32 v[126:127], v[126:127], v[226:227], v[230:231] op_sel:[0,0,0] op_sel_hi:[1,0,0]
  v_cvt_pk_bf16_f32 v121, v122, v123
  v_mfma_f32_16x16x32_bf16 v[184:187], a[184:187], v[216:219], v[184:187]
  ds_read_b64_tr_b16 a[156:157], v241 offset:36864
  ds_read_b128 a[36:39], v251 offset:9216
  ds_write_b64 v249, v[120:121] offset:128
  v_exp_f32 v199, v199
  v_cvt_pk_bf16_f32 v124, v124, v125
  v_pk_fma_f32 v[128:129], v[128:129], v[226:227], v[230:231] op_sel:[0,0,0] op_sel_hi:[1,0,0]
  v_pk_fma_f32 v[130:131], v[130:131], v[226:227], v[230:231] op_sel:[0,0,0] op_sel_hi:[1,0,0]
  v_cvt_pk_bf16_f32 v125, v126, v127
  v_mfma_f32_16x16x32_bf16 v[188:191], a[188:191], v[216:219], v[188:191]
  ds_read_b64_tr_b16 a[158:159], v241 offset:43008
  ds_write_b64 v250, v[124:125] offset:128
  v_mov_b32 v224, v192
  v_add_f32 v224, v224, v193
  v_cvt_pk_bf16_f32 v128, v128, v129
  v_pk_fma_f32 v[132:133], v[132:133], v[226:227], v[230:231] op_sel:[0,0,0] op_sel_hi:[1,0,0]
  v_pk_fma_f32 v[134:135], v[134:135], v[226:227], v[230:231] op_sel:[0,0,0] op_sel_hi:[1,0,0]
  v_cvt_pk_bf16_f32 v129, v130, v131
  v_mfma_f32_16x16x32_bf16 v[140:143], a[188:191], v[208:211], v[140:143]
  buffer_store_dwordx4 a[20:23], v246, s[16:19], s89 offen offset:2048 sc0 sc1 nt
  ds_read_b128 a[40:43], v252 offset:9216
  ds_write_b64 v247, v[128:129] offset:256
  v_add_f32 v224, v224, v194
  v_add_f32 v224, v224, v195
  v_cvt_pk_bf16_f32 v132, v132, v133
  v_pk_fma_f32 v[136:137], v[136:137], v[226:227], v[230:231] op_sel:[0,0,0] op_sel_hi:[1,0,0]
  v_pk_fma_f32 v[138:139], v[138:139], v[226:227], v[230:231] op_sel:[0,0,0] op_sel_hi:[1,0,0]
  v_cvt_pk_bf16_f32 v133, v134, v135
  v_mfma_f32_16x16x32_bf16 v[208:211], a[96:99], a[48:51], v[232:235]
  ds_read_b64_tr_b16 a[160:161], v238 offset:36992
  ds_write_b64 v248, v[132:133] offset:256
  v_cvt_pk_bf16_f32 v192, v192, v193
  v_cvt_pk_bf16_f32 v193, v194, v195
  v_cvt_pk_bf16_f32 v136, v136, v137
  v_pk_fma_f32 v[140:141], v[140:141], v[226:227], v[230:231] op_sel:[0,0,0] op_sel_hi:[1,0,0]
  v_pk_fma_f32 v[142:143], v[142:143], v[226:227], v[230:231] op_sel:[0,0,0] op_sel_hi:[1,0,0]
  v_cvt_pk_bf16_f32 v137, v138, v139
  v_mfma_f32_16x16x32_bf16 v[208:211], a[100:103], a[52:55], v[208:211]
  ds_read_b64_tr_b16 a[162:163], v238 offset:43136
  ds_read_b128 a[44:47], v253 offset:9216
  ds_write_b64 v249, v[136:137] offset:256
  v_fma_f32 v200, v200, s22, v229
  v_fma_f32 v201, v201, s22, v229
  v_cvt_pk_bf16_f32 v140, v140, v141
  v_pk_fma_f32 v[144:145], v[144:145], v[226:227], v[230:231] op_sel:[0,1,1] op_sel_hi:[1,1,1]
  v_pk_fma_f32 v[146:147], v[146:147], v[226:227], v[230:231] op_sel:[0,1,1] op_sel_hi:[1,1,1]
  v_cvt_pk_bf16_f32 v141, v142, v143
  v_mfma_f32_16x16x32_bf16 v[208:211], a[104:107], a[56:59], v[208:211]
  s_waitcnt lgkmcnt(5)
  buffer_store_dwordx4 a[24:27], v246, s[16:19], s90 offen sc0 sc1 nt
  ds_write_b64 v250, v[140:141] offset:256
  v_fma_f32 v202, v202, s22, v229
  v_fma_f32 v203, v203, s22, v229
  v_cvt_pk_bf16_f32 v144, v144, v145
  v_pk_fma_f32 v[148:149], v[148:149], v[226:227], v[230:231] op_sel:[0,1,1] op_sel_hi:[1,1,1]
  v_pk_fma_f32 v[150:151], v[150:151], v[226:227], v[230:231] op_sel:[0,1,1] op_sel_hi:[1,1,1]
  v_cvt_pk_bf16_f32 v145, v146, v147
  v_mfma_f32_16x16x32_bf16 v[208:211], a[108:111], a[60:63], v[208:211]
  ds_read_b64_tr_b16 a[164:165], v239 offset:36992
  ds_write_b64 v247, v[144:145] offset:6144
  v_exp_f32 v200, v200
  v_cvt_pk_bf16_f32 v148, v148, v149
  v_cvt_pk_bf16_f32 v149, v150, v151
  v_pk_fma_f32 v[152:153], v[152:153], v[226:227], v[230:231] op_sel:[0,1,1] op_sel_hi:[1,1,1]
  v_pk_fma_f32 v[154:155], v[154:155], v[226:227], v[230:231] op_sel:[0,1,1] op_sel_hi:[1,1,1]
  v_max3_f32 v147, |v146|, |v147|, |v150|
  v_mfma_f32_16x16x32_bf16 v[208:211], a[112:115], a[64:67], v[208:211]
  s_add_u32 m0, s21, 61440
  ds_read_b64_tr_b16 a[166:167], v239 offset:43136
  ds_write_b64 v248, v[148:149] offset:6144
  v_mov_b32 v140, s3
  v_mov_b32 v141, s3
  v_cvt_pk_bf16_f32 v152, v152, v153
  v_cvt_pk_bf16_f32 v153, v154, v155
  v_pk_fma_f32 v[156:157], v[156:157], v[226:227], v[230:231] op_sel:[0,1,1] op_sel_hi:[1,1,1]
  v_pk_fma_f32 v[158:159], v[158:159], v[226:227], v[230:231] op_sel:[0,1,1] op_sel_hi:[1,1,1]
  v_cmp_nle_f32_e64 s[42:43], s85, v147
  v_mfma_f32_16x16x32_bf16 v[208:211], a[116:119], a[68:71], v[208:211]
  buffer_load_dwordx4 v242, s[12:15], s20 offen nt lds
  ds_write_b64 v249, v[152:153] offset:6144
  v_mov_b32 v142, s3
  v_mov_b32 v143, s3
  v_cvt_pk_bf16_f32 v156, v156, v157
  v_pk_fma_f32 v[160:161], v[160:161], v[226:227], v[230:231] op_sel:[0,1,1] op_sel_hi:[1,1,1]
  v_pk_fma_f32 v[162:163], v[162:163], v[226:227], v[230:231] op_sel:[0,1,1] op_sel_hi:[1,1,1]
  v_cvt_pk_bf16_f32 v157, v158, v159
  v_mfma_f32_16x16x32_bf16 v[212:215], a[140:143], a[68:71], v[232:235]
  ds_read_b64_tr_b16 a[168:169], v240 offset:36992
  ds_write_b64 v250, v[156:157] offset:6144
  v_exp_f32 v201, v201
  v_cvt_pk_bf16_f32 v160, v160, v161
  v_pk_fma_f32 v[164:165], v[164:165], v[226:227], v[230:231] op_sel:[0,1,1] op_sel_hi:[1,1,1]
  v_pk_fma_f32 v[166:167], v[166:167], v[226:227], v[230:231] op_sel:[0,1,1] op_sel_hi:[1,1,1]
  v_cvt_pk_bf16_f32 v161, v162, v163
  v_mfma_f32_16x16x32_bf16 v[212:215], a[136:139], a[64:67], v[212:215]
  ds_read_b64_tr_b16 a[170:171], v240 offset:43136
  ds_write_b64 v247, v[160:161] offset:6272
  v_exp_f32 v202, v202
  v_cvt_pk_bf16_f32 v164, v164, v165
  v_pk_fma_f32 v[168:169], v[168:169], v[226:227], v[230:231] op_sel:[0,1,1] op_sel_hi:[1,1,1]
  v_pk_fma_f32 v[170:171], v[170:171], v[226:227], v[230:231] op_sel:[0,1,1] op_sel_hi:[1,1,1]
  v_cvt_pk_bf16_f32 v165, v166, v167
  v_mfma_f32_16x16x32_bf16 v[212:215], a[132:135], a[60:63], v[212:215]
  buffer_load_dwordx4 v243, s[12:15], s20 offen offset:1024 nt lds
  ds_write_b64 v248, v[164:165] offset:6272
  v_exp_f32 v203, v203
  v_cvt_pk_bf16_f32 v168, v168, v169
  v_pk_fma_f32 v[172:173], v[172:173], v[226:227], v[230:231] op_sel:[0,1,1] op_sel_hi:[1,1,1]
  v_pk_fma_f32 v[174:175], v[174:175], v[226:227], v[230:231] op_sel:[0,1,1] op_sel_hi:[1,1,1]
  v_cvt_pk_bf16_f32 v169, v170, v171
  v_mfma_f32_16x16x32_bf16 v[212:215], a[128:131], a[56:59], v[212:215]
  ds_read_b64_tr_b16 a[172:173], v241 offset:36992
  ds_write_b64 v249, v[168:169] offset:6272
  v_add_f32 v224, v224, v196
  v_add_f32 v224, v224, v197
  v_cvt_pk_bf16_f32 v172, v172, v173
  v_pk_fma_f32 v[176:177], v[176:177], v[226:227], v[230:231] op_sel:[0,1,1] op_sel_hi:[1,1,1]
  v_pk_fma_f32 v[178:179], v[178:179], v[226:227], v[230:231] op_sel:[0,1,1] op_sel_hi:[1,1,1]
  v_cvt_pk_bf16_f32 v173, v174, v175
  v_mfma_f32_16x16x32_bf16 v[212:215], a[124:127], a[52:55], v[212:215]
  ds_read_b64_tr_b16 a[174:175], v241 offset:43136
  ds_write_b64 v250, v[172:173] offset:6272
  v_add_f32 v224, v224, v198
  v_add_f32 v224, v224, v199
  v_cvt_pk_bf16_f32 v176, v176, v177
  v_pk_fma_f32 v[180:181], v[180:181], v[226:227], v[230:231] op_sel:[0,1,1] op_sel_hi:[1,1,1]
  v_pk_fma_f32 v[182:183], v[182:183], v[226:227], v[230:231] op_sel:[0,1,1] op_sel_hi:[1,1,1]
  v_cvt_pk_bf16_f32 v177, v178, v179
  v_mfma_f32_16x16x32_bf16 v[212:215], a[120:123], a[48:51], v[212:215]
  buffer_load_dwordx4 v244, s[12:15], s20 offen offset:2048 nt lds
  ds_write_b64 v247, v[176:177] offset:6400
  v_cvt_pk_bf16_f32 v194, v196, v197
  v_cvt_pk_bf16_f32 v195, v198, v199
  v_cvt_pk_bf16_f32 v180, v180, v181
  v_pk_fma_f32 v[184:185], v[184:185], v[226:227], v[230:231] op_sel:[0,1,1] op_sel_hi:[1,1,1]
  v_pk_fma_f32 v[186:187], v[186:187], v[226:227], v[230:231] op_sel:[0,1,1] op_sel_hi:[1,1,1]
  v_cvt_pk_bf16_f32 v181, v182, v183
  v_mfma_f32_16x16x32_bf16 v[216:219], a[120:123], a[72:75], v[232:235]
  s_add_u32 s20, s20, 12288
  ds_read_b64_tr_b16 a[176:177], v238 offset:37120
  ds_write_b64 v248, v[180:181] offset:6400
  v_fma_f32 v204, v204, s22, v229
  v_fma_f32 v205, v205, s22, v229
  v_cvt_pk_bf16_f32 v184, v184, v185
  v_pk_fma_f32 v[188:189], v[188:189], v[226:227], v[230:231] op_sel:[0,1,1] op_sel_hi:[1,1,1]
  v_pk_fma_f32 v[190:191], v[190:191], v[226:227], v[230:231] op_sel:[0,1,1] op_sel_hi:[1,1,1]
  v_cvt_pk_bf16_f32 v185, v186, v187
  v_mfma_f32_16x16x32_bf16 v[216:219], a[124:127], a[76:79], v[216:219]
  s_add_u32 m0, s21, 0
  ds_read_b64_tr_b16 a[178:179], v238 offset:43264
  ds_write_b64 v249, v[184:185] offset:6400
  v_fma_f32 v206, v206, s22, v229
  v_fma_f32 v207, v207, s22, v229
  v_cvt_pk_bf16_f32 v188, v188, v189
  v_cvt_pk_bf16_f32 v189, v190, v191
  v_mfma_f32_16x16x32_bf16 v[216:219], a[128:131], a[80:83], v[216:219]
  buffer_load_dwordx4 v242, s[8:11], s20 offen nt lds
  ds_write_b64 v250, v[188:189] offset:6400
  v_exp_f32 v204, v204
  v_mfma_f32_16x16x32_bf16 v[216:219], a[132:135], a[84:87], v[216:219]
  ds_read_b64_tr_b16 a[180:181], v239 offset:37120
  v_exp_f32 v205, v205
  v_mfma_f32_16x16x32_bf16 v[216:219], a[136:139], a[88:91], v[216:219]
  ds_read_b64_tr_b16 a[182:183], v239 offset:43264
  v_exp_f32 v206, v206
  v_mfma_f32_16x16x32_bf16 v[216:219], a[140:143], a[92:95], v[216:219]
  buffer_load_dwordx4 v243, s[8:11], s20 offen offset:1024 nt lds
  v_exp_f32 v207, v207
  v_mfma_f32_16x16x32_bf16 v[220:223], a[116:119], a[92:95], v[232:235]
  ds_read_b64_tr_b16 a[184:185], v240 offset:37120
  v_mov_b32 v225, v200
  v_add_f32 v225, v225, v201
  v_add_f32 v225, v225, v202
  v_mfma_f32_16x16x32_bf16 v[220:223], a[112:115], a[88:91], v[220:223]
  ds_read_b64_tr_b16 a[186:187], v240 offset:43264
  v_add_f32 v225, v225, v203
  v_cvt_pk_bf16_f32 v203, v202, v203
  v_cvt_pk_bf16_f32 v202, v200, v201
  v_mfma_f32_16x16x32_bf16 v[220:223], a[108:111], a[84:87], v[220:223]
  buffer_load_dwordx4 v244, s[8:11], s20 offen offset:2048 nt lds
  v_add_f32 v225, v225, v204
  v_add_f32 v225, v225, v205
  v_add_f32 v225, v225, v206
  v_mfma_f32_16x16x32_bf16 v[220:223], a[104:107], a[80:83], v[220:223]
  ds_read_b64_tr_b16 a[188:189], v241 offset:37120
  v_add_f32 v225, v225, v207
  v_cvt_pk_bf16_f32 v200, v204, v205
  v_cvt_pk_bf16_f32 v201, v206, v207
  v_mfma_f32_16x16x32_bf16 v[220:223], a[100:103], a[76:79], v[220:223]
  ds_read_b64_tr_b16 a[190:191], v241 offset:43264
  v_mfma_f32_16x16x32_bf16 v[220:223], a[96:99], a[72:75], v[220:223]
  v_mfma_f32_16x16x32_bf16 v[0:3], a[144:147], v[192:195], v[140:143]
  ds_read_b128 a[96:99], v236 offset:12288
  v_max3_f32 v230, v208, v209, v210
  v_max3_f32 v226, v211, v212, v213
  v_max3_f32 v230, v230, v214, v215
  v_mfma_f32_16x16x32_bf16 v[48:51], a[144:147], v[200:203], v[140:143]
  v_max_f32 v230, v230, v226
  v_mfma_f32_16x16x32_bf16 v[52:55], a[148:151], v[200:203], v[140:143]
  ds_read_b128 a[100:103], v237 offset:12288
  v_max3_f32 v231, v216, v217, v218
  v_max3_f32 v227, v219, v220, v221
  v_max3_f32 v231, v231, v222, v223
  v_max_f32 v231, v231, v227
  v_mfma_f32_16x16x32_bf16 v[4:7], a[148:151], v[192:195], v[140:143]
  s_nop 0
  v_permlane16_swap_b32 v230, v231
  v_max_f32 v230, v230, v231
  v_mov_b32 v231, v230
  v_mfma_f32_16x16x32_bf16 v[8:11], a[152:155], v[192:195], v[140:143]
  ds_read_b128 a[104:107], v236 offset:12416
  v_permlane32_swap_b32 v230, v231
  v_max_f32 v230, v230, v231
  v_mul_f32_e64 v230, v230, -s22
  v_mfma_f32_16x16x32_bf16 v[56:59], a[152:155], v[200:203], v[140:143]
  v_mov_b32 v231, v230
  v_mfma_f32_16x16x32_bf16 v[60:63], a[156:159], v[200:203], v[140:143]
  ds_read_b128 a[108:111], v237 offset:12416
  v_permlane16_swap_b32 v230, v231
  v_fma_f32 v208, v208, s22, v230
  v_fma_f32 v209, v209, s22, v230
  v_mfma_f32_16x16x32_bf16 v[12:15], a[156:159], v[192:195], v[140:143]
  s_waitcnt lgkmcnt(2)
  v_fma_f32 v210, v210, s22, v230
  v_fma_f32 v211, v211, s22, v230
  v_exp_f32 v208, v208
  v_mfma_f32_16x16x32_bf16 v[16:19], a[160:163], v[192:195], v[140:143]
  ds_read_b128 a[112:115], v236 offset:12544
  v_exp_f32 v209, v209
  v_exp_f32 v210, v210
  v_mfma_f32_16x16x32_bf16 v[64:67], a[160:163], v[200:203], v[140:143]
  v_exp_f32 v211, v211
  v_fma_f32 v212, v212, s22, v230
  v_fma_f32 v213, v213, s22, v230
  v_mfma_f32_16x16x32_bf16 v[68:71], a[164:167], v[200:203], v[140:143]
  ds_read_b128 a[116:119], v237 offset:12544
  v_fma_f32 v214, v214, s22, v230
  v_fma_f32 v215, v215, s22, v230
  v_exp_f32 v212, v212
  v_mfma_f32_16x16x32_bf16 v[20:23], a[164:167], v[192:195], v[140:143]
  v_exp_f32 v213, v213
  v_exp_f32 v214, v214
  v_mfma_f32_16x16x32_bf16 v[24:27], a[168:171], v[192:195], v[140:143]
  ds_read_b128 a[140:143], v237 offset:18688
  v_exp_f32 v215, v215
  v_mov_b32 v226, v208
  v_mfma_f32_16x16x32_bf16 v[72:75], a[168:171], v[200:203], v[140:143]
  v_add_f32 v226, v226, v209
  v_add_f32 v226, v226, v210
  v_add_f32 v226, v226, v211
  v_mfma_f32_16x16x32_bf16 v[76:79], a[172:175], v[200:203], v[140:143]
  ds_read_b128 a[136:139], v236 offset:18688
  v_fma_f32 v216, v216, s22, v231
  v_fma_f32 v217, v217, s22, v231
  v_fma_f32 v218, v218, s22, v231
  v_fma_f32 v219, v219, s22, v231
  v_mfma_f32_16x16x32_bf16 v[28:31], a[172:175], v[192:195], v[140:143]
  v_exp_f32 v216, v216
  v_exp_f32 v217, v217
  v_mfma_f32_16x16x32_bf16 v[32:35], a[176:179], v[192:195], v[140:143]
  ds_read_b128 a[132:135], v237 offset:18560
  v_exp_f32 v218, v218
  v_exp_f32 v219, v219
  v_mfma_f32_16x16x32_bf16 v[80:83], a[176:179], v[200:203], v[140:143]
  v_add_f32 v226, v226, v212
  v_add_f32 v226, v226, v213
  v_add_f32 v226, v226, v214
  v_mfma_f32_16x16x32_bf16 v[84:87], a[180:183], v[200:203], v[140:143]
  buffer_store_dwordx4 a[28:31], v246, s[16:19], s90 offen offset:1024 sc0 sc1 nt
  ds_read_b128 a[128:131], v236 offset:18560
  v_add_f32 v226, v226, v215
  v_fma_f32 v220, v220, s22, v231
  v_fma_f32 v221, v221, s22, v231
  v_mfma_f32_16x16x32_bf16 v[36:39], a[180:183], v[192:195], v[140:143]
  v_fma_f32 v222, v222, s22, v231
  v_fma_f32 v223, v223, s22, v231
  v_exp_f32 v220, v220
  v_mfma_f32_16x16x32_bf16 v[40:43], a[184:187], v[192:195], v[140:143]
  ds_read_b128 a[124:127], v237 offset:18432
  v_exp_f32 v221, v221
  v_exp_f32 v222, v222
  v_mfma_f32_16x16x32_bf16 v[88:91], a[184:187], v[200:203], v[140:143]
  v_exp_f32 v223, v223
  v_mfma_f32_16x16x32_bf16 v[92:95], a[188:191], v[200:203], v[140:143]
  ds_read_b128 a[120:123], v236 offset:18432
  v_mfma_f32_16x16x32_bf16 v[44:47], a[188:191], v[192:195], v[140:143]
  v_mfma_f32_16x16x32_bf16 v[192:195], a[96:99], a[192:195], v[232:235]
  v_cvt_pk_bf16_f32 v208, v208, v209
  v_cvt_pk_bf16_f32 v209, v210, v211
  v_mfma_f32_16x16x32_bf16 v[192:195], a[100:103], a[196:199], v[192:195]
  s_waitcnt lgkmcnt(2)
  v_cvt_pk_bf16_f32 v210, v212, v213
  v_cvt_pk_bf16_f32 v211, v214, v215
  v_mfma_f32_16x16x32_bf16 v[192:195], a[104:107], a[200:203], v[192:195]
  v_mov_b32 v227, v216
  v_add_f32 v227, v227, v217
  v_mfma_f32_16x16x32_bf16 v[192:195], a[108:111], a[204:207], v[192:195]
  s_waitcnt vmcnt(20) lgkmcnt(0)
  v_add_f32 v227, v227, v218
  v_add_f32 v227, v227, v219
  v_mfma_f32_16x16x32_bf16 v[192:195], a[112:115], a[208:211], v[192:195]
  s_barrier
  v_add_f32 v227, v227, v220
  v_add_f32 v227, v227, v221
  v_mfma_f32_16x16x32_bf16 v[192:195], a[116:119], a[212:215], v[192:195]
  s_add_u32 m0, s21, 98304
  v_add_f32 v227, v227, v222
  v_add_f32 v227, v227, v223
  v_mfma_f32_16x16x32_bf16 v[196:199], a[140:143], a[212:215], v[232:235]
  buffer_load_dwordx4 v242, s[12:15], s20 offen nt lds
  v_mfma_f32_16x16x32_bf16 v[196:199], a[136:139], a[208:211], v[196:199]
  v_cvt_pk_bf16_f32 v219, v218, v219
  v_cvt_pk_bf16_f32 v218, v216, v217
  v_mfma_f32_16x16x32_bf16 v[196:199], a[132:135], a[204:207], v[196:199]
  v_cvt_pk_bf16_f32 v216, v220, v221
  v_cvt_pk_bf16_f32 v217, v222, v223
  v_mfma_f32_16x16x32_bf16 v[196:199], a[128:131], a[200:203], v[196:199]
  v_fma_f32 v192, v192, s22, v228
  v_fma_f32 v193, v193, s22, v228
  v_mfma_f32_16x16x32_bf16 v[196:199], a[124:127], a[196:199], v[196:199]
  v_fma_f32 v194, v194, s22, v228
  v_fma_f32 v195, v195, s22, v228
  v_mfma_f32_16x16x32_bf16 v[196:199], a[120:123], a[192:195], v[196:199]
  buffer_load_dwordx4 v243, s[12:15], s20 offen offset:1024 nt lds
  v_mfma_f32_16x16x32_bf16 v[200:203], a[120:123], a[216:219], v[232:235]
  v_exp_f32 v192, v192
  v_mfma_f32_16x16x32_bf16 v[200:203], a[124:127], a[220:223], v[200:203]
  v_exp_f32 v193, v193
  v_mfma_f32_16x16x32_bf16 v[200:203], a[128:131], a[224:227], v[200:203]
  v_exp_f32 v194, v194
  v_mfma_f32_16x16x32_bf16 v[200:203], a[132:135], a[228:231], v[200:203]
  v_exp_f32 v195, v195
  v_mfma_f32_16x16x32_bf16 v[200:203], a[136:139], a[232:235], v[200:203]
  buffer_load_dwordx4 v244, s[12:15], s20 offen offset:2048 nt lds
  v_mfma_f32_16x16x32_bf16 v[200:203], a[140:143], a[236:239], v[200:203]
  v_fma_f32 v196, v196, s22, v228
  v_fma_f32 v197, v197, s22, v228
  v_mfma_f32_16x16x32_bf16 v[204:207], a[116:119], a[236:239], v[232:235]
  v_fma_f32 v198, v198, s22, v228
  v_fma_f32 v199, v199, s22, v228
  v_mfma_f32_16x16x32_bf16 v[204:207], a[112:115], a[232:235], v[204:207]
  s_add_u32 s20, s20, 12288
  v_exp_f32 v196, v196
  v_mfma_f32_16x16x32_bf16 v[204:207], a[108:111], a[228:231], v[204:207]
  s_add_u32 m0, s21, 12288
  v_exp_f32 v197, v197
  v_mfma_f32_16x16x32_bf16 v[204:207], a[104:107], a[224:227], v[204:207]
  buffer_load_dwordx4 v242, s[8:11], s20 offen nt lds
  v_mfma_f32_16x16x32_bf16 v[204:207], a[100:103], a[220:223], v[204:207]
  v_exp_f32 v198, v198
  v_mfma_f32_16x16x32_bf16 v[204:207], a[96:99], a[216:219], v[204:207]
  v_exp_f32 v199, v199
  v_mfma_f32_16x16x32_bf16 v[96:99], a[144:147], v[208:211], v[140:143]
  v_fma_f32 v200, v200, s22, v229
  v_fma_f32 v201, v201, s22, v229
  v_mfma_f32_16x16x32_bf16 v[144:147], a[144:147], v[216:219], v[140:143]
  v_fma_f32 v202, v202, s22, v229
  v_fma_f32 v203, v203, s22, v229
  v_mfma_f32_16x16x32_bf16 v[148:151], a[148:151], v[216:219], v[140:143]
  buffer_load_dwordx4 v243, s[8:11], s20 offen offset:1024 nt lds
  v_mfma_f32_16x16x32_bf16 v[100:103], a[148:151], v[208:211], v[140:143]
  v_exp_f32 v200, v200
  v_mfma_f32_16x16x32_bf16 v[104:107], a[152:155], v[208:211], v[140:143]
  v_exp_f32 v201, v201
  v_mfma_f32_16x16x32_bf16 v[152:155], a[152:155], v[216:219], v[140:143]
  v_exp_f32 v202, v202
  v_mfma_f32_16x16x32_bf16 v[156:159], a[156:159], v[216:219], v[140:143]
  v_exp_f32 v203, v203
  v_mfma_f32_16x16x32_bf16 v[108:111], a[156:159], v[208:211], v[140:143]
  buffer_load_dwordx4 v244, s[8:11], s20 offen offset:2048 nt lds
  v_mfma_f32_16x16x32_bf16 v[112:115], a[160:163], v[208:211], v[140:143]
  v_fma_f32 v204, v204, s22, v229
  v_fma_f32 v205, v205, s22, v229
  v_mfma_f32_16x16x32_bf16 v[160:163], a[160:163], v[216:219], v[140:143]
  v_fma_f32 v206, v206, s22, v229
  v_fma_f32 v207, v207, s22, v229
  v_mfma_f32_16x16x32_bf16 v[164:167], a[164:167], v[216:219], v[140:143]
  v_exp_f32 v204, v204
  v_mfma_f32_16x16x32_bf16 v[116:119], a[164:167], v[208:211], v[140:143]
  v_exp_f32 v205, v205
  v_mfma_f32_16x16x32_bf16 v[120:123], a[168:171], v[208:211], v[140:143]
  ds_read_b64_tr_b16 a[144:145], v238 offset:24576
  v_add_f32 v224, v224, v192
  v_mfma_f32_16x16x32_bf16 v[168:171], a[168:171], v[216:219], v[140:143]
  ds_read_b64_tr_b16 a[146:147], v238 offset:30720
  v_add_f32 v224, v224, v193
  v_mfma_f32_16x16x32_bf16 v[172:175], a[172:175], v[216:219], v[140:143]
  v_exp_f32 v206, v206
  v_mfma_f32_16x16x32_bf16 v[124:127], a[172:175], v[208:211], v[140:143]
  ds_read_b64_tr_b16 a[148:149], v239 offset:24576
  v_add_f32 v224, v224, v194
  v_mfma_f32_16x16x32_bf16 v[128:131], a[176:179], v[208:211], v[140:143]
  ds_read_b64_tr_b16 a[150:151], v239 offset:30720
  v_add_f32 v224, v224, v195
  v_mfma_f32_16x16x32_bf16 v[176:179], a[176:179], v[216:219], v[140:143]
  v_exp_f32 v207, v207
  v_mfma_f32_16x16x32_bf16 v[180:183], a[180:183], v[216:219], v[140:143]
  ds_read_b64_tr_b16 a[152:153], v240 offset:24576
  v_cvt_pk_bf16_f32 v192, v192, v193
  v_mfma_f32_16x16x32_bf16 v[132:135], a[180:183], v[208:211], v[140:143]
  ds_read_b64_tr_b16 a[154:155], v240 offset:30720
  v_cvt_pk_bf16_f32 v193, v194, v195
  v_mfma_f32_16x16x32_bf16 v[136:139], a[184:187], v[208:211], v[140:143]
  buffer_store_dwordx4 a[32:35], v246, s[16:19], s90 offen offset:2048 sc0 sc1 nt
  v_add_f32 v224, v224, v196
  v_add_f32 v224, v224, v197
  v_mfma_f32_16x16x32_bf16 v[184:187], a[184:187], v[216:219], v[140:143]
  ds_read_b64_tr_b16 a[156:157], v241 offset:24576
  v_add_f32 v224, v224, v198
  v_mfma_f32_16x16x32_bf16 v[188:191], a[188:191], v[216:219], v[140:143]
  ds_read_b64_tr_b16 a[158:159], v241 offset:30720
  v_add_f32 v224, v224, v199
  v_mfma_f32_16x16x32_bf16 v[140:143], a[188:191], v[208:211], v[140:143]
  v_cvt_pk_bf16_f32 v194, v196, v197
  v_cvt_pk_bf16_f32 v195, v198, v199
  v_mfma_f32_16x16x32_bf16 v[208:211], a[96:99], a[48:51], v[232:235]
  ds_read_b64_tr_b16 a[160:161], v238 offset:24704
  v_add_f32 v225, v225, v200
  v_mfma_f32_16x16x32_bf16 v[208:211], a[100:103], a[52:55], v[208:211]
  ds_read_b64_tr_b16 a[162:163], v238 offset:30848
  v_add_f32 v225, v225, v201
  v_mfma_f32_16x16x32_bf16 v[208:211], a[104:107], a[56:59], v[208:211]
  v_add_f32 v225, v225, v202
  v_add_f32 v225, v225, v203
  v_mfma_f32_16x16x32_bf16 v[208:211], a[108:111], a[60:63], v[208:211]
  ds_read_b64_tr_b16 a[164:165], v239 offset:24704
  v_cvt_pk_bf16_f32 v203, v202, v203
  v_mfma_f32_16x16x32_bf16 v[208:211], a[112:115], a[64:67], v[208:211]
  ds_read_b64_tr_b16 a[166:167], v239 offset:30848
  v_cvt_pk_bf16_f32 v202, v200, v201
  v_mfma_f32_16x16x32_bf16 v[208:211], a[116:119], a[68:71], v[208:211]
  v_add_f32 v225, v225, v204
  v_add_f32 v225, v225, v205
  v_mfma_f32_16x16x32_bf16 v[212:215], a[140:143], a[68:71], v[232:235]
  ds_read_b64_tr_b16 a[168:169], v240 offset:24704
  v_add_f32 v225, v225, v206
  v_mfma_f32_16x16x32_bf16 v[212:215], a[136:139], a[64:67], v[212:215]
  ds_read_b64_tr_b16 a[170:171], v240 offset:30848
  v_add_f32 v225, v225, v207
  v_mfma_f32_16x16x32_bf16 v[212:215], a[132:135], a[60:63], v[212:215]
  v_cvt_pk_bf16_f32 v200, v204, v205
  v_cvt_pk_bf16_f32 v201, v206, v207
  v_mfma_f32_16x16x32_bf16 v[212:215], a[128:131], a[56:59], v[212:215]
  ds_read_b64_tr_b16 a[172:173], v241 offset:24704
  v_fma_f32 v208, v208, s22, v230
  v_mfma_f32_16x16x32_bf16 v[212:215], a[124:127], a[52:55], v[212:215]
  ds_read_b64_tr_b16 a[174:175], v241 offset:30848
  v_fma_f32 v209, v209, s22, v230
  v_mfma_f32_16x16x32_bf16 v[212:215], a[120:123], a[48:51], v[212:215]
  v_exp_f32 v208, v208
  v_mfma_f32_16x16x32_bf16 v[216:219], a[120:123], a[72:75], v[232:235]
  ds_read_b64_tr_b16 a[176:177], v238 offset:24832
  v_fma_f32 v210, v210, s22, v230
  v_mfma_f32_16x16x32_bf16 v[216:219], a[124:127], a[76:79], v[216:219]
  ds_read_b64_tr_b16 a[178:179], v238 offset:30976
  v_fma_f32 v211, v211, s22, v230
  v_mfma_f32_16x16x32_bf16 v[216:219], a[128:131], a[80:83], v[216:219]
  buffer_store_dwordx4 a[36:39], v246, s[16:19], s91 offen sc0 sc1 nt
  v_exp_f32 v209, v209
  v_mfma_f32_16x16x32_bf16 v[216:219], a[132:135], a[84:87], v[216:219]
  ds_read_b64_tr_b16 a[180:181], v239 offset:24832
  v_fma_f32 v212, v212, s22, v230
  v_mfma_f32_16x16x32_bf16 v[216:219], a[136:139], a[88:91], v[216:219]
  ds_read_b64_tr_b16 a[182:183], v239 offset:30976
  v_fma_f32 v213, v213, s22, v230
  v_mfma_f32_16x16x32_bf16 v[216:219], a[140:143], a[92:95], v[216:219]
  v_exp_f32 v210, v210
  v_mfma_f32_16x16x32_bf16 v[220:223], a[116:119], a[92:95], v[232:235]
  ds_read_b64_tr_b16 a[184:185], v240 offset:24832
  v_fma_f32 v214, v214, s22, v230
  v_mfma_f32_16x16x32_bf16 v[220:223], a[112:115], a[88:91], v[220:223]
  ds_read_b64_tr_b16 a[186:187], v240 offset:30976
  v_fma_f32 v215, v215, s22, v230
  v_mfma_f32_16x16x32_bf16 v[220:223], a[108:111], a[84:87], v[220:223]
  v_exp_f32 v211, v211
  v_mfma_f32_16x16x32_bf16 v[220:223], a[104:107], a[80:83], v[220:223]
  ds_read_b64_tr_b16 a[188:189], v241 offset:24832
  v_fma_f32 v216, v216, s22, v231
  v_mfma_f32_16x16x32_bf16 v[220:223], a[100:103], a[76:79], v[220:223]
  ds_read_b64_tr_b16 a[190:191], v241 offset:30976
  v_fma_f32 v217, v217, s22, v231
  v_mfma_f32_16x16x32_bf16 v[220:223], a[96:99], a[72:75], v[220:223]
  s_waitcnt lgkmcnt(5)
  v_exp_f32 v212, v212
  v_mfma_f32_16x16x32_bf16 v[0:3], a[144:147], v[192:195], v[0:3]
  ds_read_b128 a[96:99], v236 offset:24576
  v_fma_f32 v218, v218, s22, v231
  v_mfma_f32_16x16x32_bf16 v[48:51], a[144:147], v[200:203], v[48:51]
  v_exp_f32 v213, v213
  v_mfma_f32_16x16x32_bf16 v[52:55], a[148:151], v[200:203], v[52:55]
  ds_read_b128 a[100:103], v237 offset:24576
  v_fma_f32 v219, v219, s22, v231
  v_mfma_f32_16x16x32_bf16 v[4:7], a[148:151], v[192:195], v[4:7]
L_pg9:
  s_cbranch_execz L_pg13
  v_exp_f32 v214, v214
  v_mfma_f32_16x16x32_bf16 v[8:11], a[152:155], v[192:195], v[8:11]
  ds_read_b128 a[104:107], v236 offset:24704
  v_fma_f32 v220, v220, s22, v231
  v_mfma_f32_16x16x32_bf16 v[56:59], a[152:155], v[200:203], v[56:59]
  v_exp_f32 v215, v215
  v_mfma_f32_16x16x32_bf16 v[60:63], a[156:159], v[200:203], v[60:63]
  ds_read_b128 a[108:111], v237 offset:24704
  v_fma_f32 v221, v221, s22, v231
  v_mfma_f32_16x16x32_bf16 v[12:15], a[156:159], v[192:195], v[12:15]
  v_exp_f32 v216, v216
  v_mfma_f32_16x16x32_bf16 v[16:19], a[160:163], v[192:195], v[16:19]
  ds_read_b128 a[112:115], v236 offset:24832
  v_fma_f32 v222, v222, s22, v231
  v_mfma_f32_16x16x32_bf16 v[64:67], a[160:163], v[200:203], v[64:67]
  v_exp_f32 v217, v217
  v_mfma_f32_16x16x32_bf16 v[68:71], a[164:167], v[200:203], v[68:71]
  ds_read_b128 a[116:119], v237 offset:24832
  v_fma_f32 v223, v223, s22, v231
  v_mfma_f32_16x16x32_bf16 v[20:23], a[164:167], v[192:195], v[20:23]
  v_exp_f32 v218, v218
  v_mfma_f32_16x16x32_bf16 v[24:27], a[168:171], v[192:195], v[24:27]
  ds_read_b128 a[140:143], v237 offset:30976
  v_add_f32 v226, v226, v208
  v_mfma_f32_16x16x32_bf16 v[72:75], a[168:171], v[200:203], v[72:75]
  v_exp_f32 v219, v219
  v_mfma_f32_16x16x32_bf16 v[76:79], a[172:175], v[200:203], v[76:79]
  ds_read_b128 a[136:139], v236 offset:30976
  v_add_f32 v226, v226, v209
  v_mfma_f32_16x16x32_bf16 v[28:31], a[172:175], v[192:195], v[28:31]
  v_exp_f32 v220, v220
  v_mfma_f32_16x16x32_bf16 v[32:35], a[176:179], v[192:195], v[32:35]
  ds_read_b128 a[132:135], v237 offset:30848
  v_add_f32 v226, v226, v210
  v_mfma_f32_16x16x32_bf16 v[80:83], a[176:179], v[200:203], v[80:83]
  s_waitcnt lgkmcnt(4)
  v_exp_f32 v221, v221
  v_mfma_f32_16x16x32_bf16 v[84:87], a[180:183], v[200:203], v[84:87]
  ds_read_b128 a[128:131], v236 offset:30848
  v_add_f32 v226, v226, v211
  v_mfma_f32_16x16x32_bf16 v[36:39], a[180:183], v[192:195], v[36:39]
  v_exp_f32 v222, v222
  v_mfma_f32_16x16x32_bf16 v[40:43], a[184:187], v[192:195], v[40:43]
  ds_read_b128 a[124:127], v237 offset:30720
  v_add_f32 v226, v226, v212
  v_mfma_f32_16x16x32_bf16 v[88:91], a[184:187], v[200:203], v[88:91]
  v_exp_f32 v223, v223
  v_mfma_f32_16x16x32_bf16 v[92:95], a[188:191], v[200:203], v[92:95]
  ds_read_b128 a[120:123], v236 offset:30720
  v_add_f32 v226, v226, v213
  v_mfma_f32_16x16x32_bf16 v[44:47], a[188:191], v[192:195], v[44:47]
  v_add_f32 v226, v226, v214
  v_add_f32 v226, v226, v215
  v_mfma_f32_16x16x32_bf16 v[192:195], a[96:99], a[192:195], v[232:235]
  v_cvt_pk_bf16_f32 v208, v208, v209
  v_cvt_pk_bf16_f32 v209, v210, v211
  v_mfma_f32_16x16x32_bf16 v[192:195], a[100:103], a[196:199], v[192:195]
  v_cvt_pk_bf16_f32 v210, v212, v213
  v_cvt_pk_bf16_f32 v211, v214, v215
  v_mfma_f32_16x16x32_bf16 v[192:195], a[104:107], a[200:203], v[192:195]
  v_add_f32 v227, v227, v216
  v_add_f32 v227, v227, v217
  v_mfma_f32_16x16x32_bf16 v[192:195], a[108:111], a[204:207], v[192:195]
  s_waitcnt vmcnt(22) lgkmcnt(0)
  v_add_f32 v227, v227, v218
  v_add_f32 v227, v227, v219
  v_mfma_f32_16x16x32_bf16 v[192:195], a[112:115], a[208:211], v[192:195]
  s_barrier
  v_add_f32 v227, v227, v220
  v_add_f32 v227, v227, v221
  v_mfma_f32_16x16x32_bf16 v[192:195], a[116:119], a[212:215], v[192:195]
  s_add_u32 m0, s21, 86016
  v_add_f32 v227, v227, v222
  v_add_f32 v227, v227, v223
  v_mfma_f32_16x16x32_bf16 v[196:199], a[140:143], a[212:215], v[232:235]
  buffer_load_dwordx4 v242, s[12:15], s20 offen nt lds
  v_mfma_f32_16x16x32_bf16 v[196:199], a[136:139], a[208:211], v[196:199]
  v_cvt_pk_bf16_f32 v219, v218, v219
  v_cvt_pk_bf16_f32 v218, v216, v217
  v_mfma_f32_16x16x32_bf16 v[196:199], a[132:135], a[204:207], v[196:199]
  v_cvt_pk_bf16_f32 v216, v220, v221
  v_cvt_pk_bf16_f32 v217, v222, v223
  v_mfma_f32_16x16x32_bf16 v[196:199], a[128:131], a[200:203], v[196:199]
  v_fma_f32 v192, v192, s22, v228
  v_fma_f32 v193, v193, s22, v228
  v_mfma_f32_16x16x32_bf16 v[196:199], a[124:127], a[196:199], v[196:199]
  v_fma_f32 v194, v194, s22, v228
  v_fma_f32 v195, v195, s22, v228
  v_mfma_f32_16x16x32_bf16 v[196:199], a[120:123], a[192:195], v[196:199]
  buffer_load_dwordx4 v243, s[12:15], s20 offen offset:1024 nt lds
  v_mfma_f32_16x16x32_bf16 v[200:203], a[120:123], a[216:219], v[232:235]
  v_exp_f32 v192, v192
  v_mfma_f32_16x16x32_bf16 v[200:203], a[124:127], a[220:223], v[200:203]
  v_exp_f32 v193, v193
  v_mfma_f32_16x16x32_bf16 v[200:203], a[128:131], a[224:227], v[200:203]
  v_exp_f32 v194, v194
  v_mfma_f32_16x16x32_bf16 v[200:203], a[132:135], a[228:231], v[200:203]
  v_exp_f32 v195, v195
  v_mfma_f32_16x16x32_bf16 v[200:203], a[136:139], a[232:235], v[200:203]
  buffer_load_dwordx4 v244, s[12:15], s20 offen offset:2048 nt lds
  v_mfma_f32_16x16x32_bf16 v[200:203], a[140:143], a[236:239], v[200:203]
  v_fma_f32 v196, v196, s22, v228
  v_fma_f32 v197, v197, s22, v228
  v_mfma_f32_16x16x32_bf16 v[204:207], a[116:119], a[236:239], v[232:235]
  v_fma_f32 v198, v198, s22, v228
  v_fma_f32 v199, v199, s22, v228
  v_mfma_f32_16x16x32_bf16 v[204:207], a[112:115], a[232:235], v[204:207]
  s_add_u32 s20, s20, 12288
  v_exp_f32 v196, v196
  v_mfma_f32_16x16x32_bf16 v[204:207], a[108:111], a[228:231], v[204:207]
  s_add_u32 m0, s21, 24576
  v_exp_f32 v197, v197
  v_mfma_f32_16x16x32_bf16 v[204:207], a[104:107], a[224:227], v[204:207]
  buffer_load_dwordx4 v242, s[8:11], s20 offen nt lds
  v_mfma_f32_16x16x32_bf16 v[204:207], a[100:103], a[220:223], v[204:207]
  v_exp_f32 v198, v198
  v_mfma_f32_16x16x32_bf16 v[204:207], a[96:99], a[216:219], v[204:207]
  v_exp_f32 v199, v199
  v_mfma_f32_16x16x32_bf16 v[96:99], a[144:147], v[208:211], v[96:99]
  v_fma_f32 v200, v200, s22, v229
  v_fma_f32 v201, v201, s22, v229
  v_mfma_f32_16x16x32_bf16 v[144:147], a[144:147], v[216:219], v[144:147]
  v_fma_f32 v202, v202, s22, v229
  v_fma_f32 v203, v203, s22, v229
  v_mfma_f32_16x16x32_bf16 v[148:151], a[148:151], v[216:219], v[148:151]
  buffer_load_dwordx4 v243, s[8:11], s20 offen offset:1024 nt lds
  v_mfma_f32_16x16x32_bf16 v[100:103], a[148:151], v[208:211], v[100:103]
  v_exp_f32 v200, v200
  v_mfma_f32_16x16x32_bf16 v[104:107], a[152:155], v[208:211], v[104:107]
  v_exp_f32 v201, v201
  v_mfma_f32_16x16x32_bf16 v[152:155], a[152:155], v[216:219], v[152:155]
  v_exp_f32 v202, v202
  v_mfma_f32_16x16x32_bf16 v[156:159], a[156:159], v[216:219], v[156:159]
  v_exp_f32 v203, v203
  v_mfma_f32_16x16x32_bf16 v[108:111], a[156:159], v[208:211], v[108:111]
  buffer_load_dwordx4 v244, s[8:11], s20 offen offset:2048 nt lds
  v_mfma_f32_16x16x32_bf16 v[112:115], a[160:163], v[208:211], v[112:115]
  v_fma_f32 v204, v204, s22, v229
  v_fma_f32 v205, v205, s22, v229
  v_mfma_f32_16x16x32_bf16 v[160:163], a[160:163], v[216:219], v[160:163]
  v_fma_f32 v206, v206, s22, v229
  v_fma_f32 v207, v207, s22, v229
  v_mfma_f32_16x16x32_bf16 v[164:167], a[164:167], v[216:219], v[164:167]
  v_exp_f32 v204, v204
  v_mfma_f32_16x16x32_bf16 v[116:119], a[164:167], v[208:211], v[116:119]
  v_exp_f32 v205, v205
  v_mfma_f32_16x16x32_bf16 v[120:123], a[168:171], v[208:211], v[120:123]
  ds_read_b64_tr_b16 a[144:145], v238 offset:12288
  v_add_f32 v224, v224, v192
  v_mfma_f32_16x16x32_bf16 v[168:171], a[168:171], v[216:219], v[168:171]
  ds_read_b64_tr_b16 a[146:147], v238 offset:18432
  v_add_f32 v224, v224, v193
  v_mfma_f32_16x16x32_bf16 v[172:175], a[172:175], v[216:219], v[172:175]
  v_exp_f32 v206, v206
  v_mfma_f32_16x16x32_bf16 v[124:127], a[172:175], v[208:211], v[124:127]
  ds_read_b64_tr_b16 a[148:149], v239 offset:12288
  v_add_f32 v224, v224, v194
  v_mfma_f32_16x16x32_bf16 v[128:131], a[176:179], v[208:211], v[128:131]
  ds_read_b64_tr_b16 a[150:151], v239 offset:18432
  v_add_f32 v224, v224, v195
  v_mfma_f32_16x16x32_bf16 v[176:179], a[176:179], v[216:219], v[176:179]
  v_exp_f32 v207, v207
  v_mfma_f32_16x16x32_bf16 v[180:183], a[180:183], v[216:219], v[180:183]
  ds_read_b64_tr_b16 a[152:153], v240 offset:12288
  v_cvt_pk_bf16_f32 v192, v192, v193
  v_mfma_f32_16x16x32_bf16 v[132:135], a[180:183], v[208:211], v[132:135]
  ds_read_b64_tr_b16 a[154:155], v240 offset:18432
  v_cvt_pk_bf16_f32 v193, v194, v195
  v_mfma_f32_16x16x32_bf16 v[136:139], a[184:187], v[208:211], v[136:139]
  buffer_store_dwordx4 a[40:43], v246, s[16:19], s91 offen offset:1024 sc0 sc1 nt
  ds_read_b128 a[0:3], v251 offset:0
  v_add_f32 v224, v224, v196
  v_add_f32 v224, v224, v197
  v_mfma_f32_16x16x32_bf16 v[184:187], a[184:187], v[216:219], v[184:187]
  ds_read_b64_tr_b16 a[156:157], v241 offset:12288
  v_add_f32 v224, v224, v198
  v_mfma_f32_16x16x32_bf16 v[188:191], a[188:191], v[216:219], v[188:191]
  ds_read_b64_tr_b16 a[158:159], v241 offset:18432
  v_add_f32 v224, v224, v199
  v_mfma_f32_16x16x32_bf16 v[140:143], a[188:191], v[208:211], v[140:143]
  v_cvt_pk_bf16_f32 v194, v196, v197
  v_cvt_pk_bf16_f32 v195, v198, v199
  v_mfma_f32_16x16x32_bf16 v[208:211], a[96:99], a[48:51], v[232:235]
  ds_read_b64_tr_b16 a[160:161], v238 offset:12416
  v_add_f32 v225, v225, v200
  v_mfma_f32_16x16x32_bf16 v[208:211], a[100:103], a[52:55], v[208:211]
  ds_read_b64_tr_b16 a[162:163], v238 offset:18560
  v_add_f32 v225, v225, v201
  v_mfma_f32_16x16x32_bf16 v[208:211], a[104:107], a[56:59], v[208:211]
  v_add_f32 v225, v225, v202
  v_add_f32 v225, v225, v203
  v_mfma_f32_16x16x32_bf16 v[208:211], a[108:111], a[60:63], v[208:211]
  ds_read_b64_tr_b16 a[164:165], v239 offset:12416
  v_cvt_pk_bf16_f32 v203, v202, v203
  v_mfma_f32_16x16x32_bf16 v[208:211], a[112:115], a[64:67], v[208:211]
  ds_read_b64_tr_b16 a[166:167], v239 offset:18560
  v_cvt_pk_bf16_f32 v202, v200, v201
  v_mfma_f32_16x16x32_bf16 v[208:211], a[116:119], a[68:71], v[208:211]
  v_add_f32 v225, v225, v204
  v_add_f32 v225, v225, v205
  v_mfma_f32_16x16x32_bf16 v[212:215], a[140:143], a[68:71], v[232:235]
  ds_read_b64_tr_b16 a[168:169], v240 offset:12416
  v_add_f32 v225, v225, v206
  v_mfma_f32_16x16x32_bf16 v[212:215], a[136:139], a[64:67], v[212:215]
  ds_read_b64_tr_b16 a[170:171], v240 offset:18560
  v_add_f32 v225, v225, v207
  v_mfma_f32_16x16x32_bf16 v[212:215], a[132:135], a[60:63], v[212:215]
  v_cvt_pk_bf16_f32 v200, v204, v205
  v_cvt_pk_bf16_f32 v201, v206, v207
  v_mfma_f32_16x16x32_bf16 v[212:215], a[128:131], a[56:59], v[212:215]
  ds_read_b64_tr_b16 a[172:173], v241 offset:12416
  v_fma_f32 v208, v208, s22, v230
  v_mfma_f32_16x16x32_bf16 v[212:215], a[124:127], a[52:55], v[212:215]
  ds_read_b64_tr_b16 a[174:175], v241 offset:18560
  v_fma_f32 v209, v209, s22, v230
  v_mfma_f32_16x16x32_bf16 v[212:215], a[120:123], a[48:51], v[212:215]
  v_exp_f32 v208, v208
  v_mfma_f32_16x16x32_bf16 v[216:219], a[120:123], a[72:75], v[232:235]
  ds_read_b64_tr_b16 a[176:177], v238 offset:12544
  v_fma_f32 v210, v210, s22, v230
  v_mfma_f32_16x16x32_bf16 v[216:219], a[124:127], a[76:79], v[216:219]
  ds_read_b64_tr_b16 a[178:179], v238 offset:18688
  v_fma_f32 v211, v211, s22, v230
  v_mfma_f32_16x16x32_bf16 v[216:219], a[128:131], a[80:83], v[216:219]
  buffer_store_dwordx4 a[44:47], v246, s[16:19], s91 offen offset:2048 sc0 sc1 nt
  ds_read_b128 a[4:7], v252 offset:0
  v_exp_f32 v209, v209
  v_mfma_f32_16x16x32_bf16 v[216:219], a[132:135], a[84:87], v[216:219]
  ds_read_b64_tr_b16 a[180:181], v239 offset:12544
  v_fma_f32 v212, v212, s22, v230
  v_mfma_f32_16x16x32_bf16 v[216:219], a[136:139], a[88:91], v[216:219]
  ds_read_b64_tr_b16 a[182:183], v239 offset:18688
  v_fma_f32 v213, v213, s22, v230
  v_mfma_f32_16x16x32_bf16 v[216:219], a[140:143], a[92:95], v[216:219]
  v_exp_f32 v210, v210
  v_mfma_f32_16x16x32_bf16 v[220:223], a[116:119], a[92:95], v[232:235]
  ds_read_b64_tr_b16 a[184:185], v240 offset:12544
  v_fma_f32 v214, v214, s22, v230
  v_mfma_f32_16x16x32_bf16 v[220:223], a[112:115], a[88:91], v[220:223]
  ds_read_b64_tr_b16 a[186:187], v240 offset:18688
  v_fma_f32 v215, v215, s22, v230
  v_mfma_f32_16x16x32_bf16 v[220:223], a[108:111], a[84:87], v[220:223]
  v_exp_f32 v211, v211
  v_mfma_f32_16x16x32_bf16 v[220:223], a[104:107], a[80:83], v[220:223]
  ds_read_b64_tr_b16 a[188:189], v241 offset:12544
  v_fma_f32 v216, v216, s22, v231
  v_mfma_f32_16x16x32_bf16 v[220:223], a[100:103], a[76:79], v[220:223]
  ds_read_b64_tr_b16 a[190:191], v241 offset:18688
  v_fma_f32 v217, v217, s22, v231
  v_mfma_f32_16x16x32_bf16 v[220:223], a[96:99], a[72:75], v[220:223]
  s_waitcnt lgkmcnt(5)
  v_exp_f32 v212, v212
  v_mfma_f32_16x16x32_bf16 v[0:3], a[144:147], v[192:195], v[0:3]
  ds_read_b128 a[96:99], v236 offset:36864
  v_fma_f32 v218, v218, s22, v231
  v_mfma_f32_16x16x32_bf16 v[48:51], a[144:147], v[200:203], v[48:51]
  v_exp_f32 v213, v213
  v_mfma_f32_16x16x32_bf16 v[52:55], a[148:151], v[200:203], v[52:55]
  ds_read_b128 a[100:103], v237 offset:36864
  v_fma_f32 v219, v219, s22, v231
  v_mfma_f32_16x16x32_bf16 v[4:7], a[148:151], v[192:195], v[4:7]
  v_exp_f32 v214, v214
  v_mfma_f32_16x16x32_bf16 v[8:11], a[152:155], v[192:195], v[8:11]
  ds_read_b128 a[104:107], v236 offset:36992
  v_fma_f32 v220, v220, s22, v231
  v_mfma_f32_16x16x32_bf16 v[56:59], a[152:155], v[200:203], v[56:59]
  v_exp_f32 v215, v215
  v_mfma_f32_16x16x32_bf16 v[60:63], a[156:159], v[200:203], v[60:63]
  ds_read_b128 a[108:111], v237 offset:36992
  v_fma_f32 v221, v221, s22, v231
  v_mfma_f32_16x16x32_bf16 v[12:15], a[156:159], v[192:195], v[12:15]
  v_exp_f32 v216, v216
  v_mfma_f32_16x16x32_bf16 v[16:19], a[160:163], v[192:195], v[16:19]
  ds_read_b128 a[112:115], v236 offset:37120
  v_fma_f32 v222, v222, s22, v231
  v_mfma_f32_16x16x32_bf16 v[64:67], a[160:163], v[200:203], v[64:67]
  v_exp_f32 v217, v217
  v_mfma_f32_16x16x32_bf16 v[68:71], a[164:167], v[200:203], v[68:71]
  ds_read_b128 a[116:119], v237 offset:37120
  v_fma_f32 v223, v223, s22, v231
  v_mfma_f32_16x16x32_bf16 v[20:23], a[164:167], v[192:195], v[20:23]
  v_exp_f32 v218, v218
  v_mfma_f32_16x16x32_bf16 v[24:27], a[168:171], v[192:195], v[24:27]
  ds_read_b128 a[140:143], v237 offset:43264
  v_add_f32 v226, v226, v208
  v_mfma_f32_16x16x32_bf16 v[72:75], a[168:171], v[200:203], v[72:75]
  v_exp_f32 v219, v219
  v_mfma_f32_16x16x32_bf16 v[76:79], a[172:175], v[200:203], v[76:79]
  ds_read_b128 a[136:139], v236 offset:43264
  v_add_f32 v226, v226, v209
  v_mfma_f32_16x16x32_bf16 v[28:31], a[172:175], v[192:195], v[28:31]
  v_exp_f32 v220, v220
  v_mfma_f32_16x16x32_bf16 v[32:35], a[176:179], v[192:195], v[32:35]
  ds_read_b128 a[132:135], v237 offset:43136
  v_add_f32 v226, v226, v210
  v_mfma_f32_16x16x32_bf16 v[80:83], a[176:179], v[200:203], v[80:83]
  s_waitcnt lgkmcnt(4)
  v_exp_f32 v221, v221
  v_mfma_f32_16x16x32_bf16 v[84:87], a[180:183], v[200:203], v[84:87]
  ds_read_b128 a[128:131], v236 offset:43136
  v_add_f32 v226, v226, v211
  v_mfma_f32_16x16x32_bf16 v[36:39], a[180:183], v[192:195], v[36:39]
  v_exp_f32 v222, v222
  v_mfma_f32_16x16x32_bf16 v[40:43], a[184:187], v[192:195], v[40:43]
  ds_read_b128 a[124:127], v237 offset:43008
  v_add_f32 v226, v226, v212
  v_mfma_f32_16x16x32_bf16 v[88:91], a[184:187], v[200:203], v[88:91]
  v_exp_f32 v223, v223
  v_mfma_f32_16x16x32_bf16 v[92:95], a[188:191], v[200:203], v[92:95]
  ds_read_b128 a[120:123], v236 offset:43008
  v_add_f32 v226, v226, v213
  v_mfma_f32_16x16x32_bf16 v[44:47], a[188:191], v[192:195], v[44:47]
  v_add_f32 v226, v226, v214
  v_add_f32 v226, v226, v215
  v_mfma_f32_16x16x32_bf16 v[192:195], a[96:99], a[192:195], v[232:235]
  v_cvt_pk_bf16_f32 v208, v208, v209
  v_cvt_pk_bf16_f32 v209, v210, v211
  v_mfma_f32_16x16x32_bf16 v[192:195], a[100:103], a[196:199], v[192:195]
  v_cvt_pk_bf16_f32 v210, v212, v213
  v_cvt_pk_bf16_f32 v211, v214, v215
  v_mfma_f32_16x16x32_bf16 v[192:195], a[104:107], a[200:203], v[192:195]
  v_add_f32 v227, v227, v216
  v_add_f32 v227, v227, v217
  v_mfma_f32_16x16x32_bf16 v[192:195], a[108:111], a[204:207], v[192:195]
  s_waitcnt vmcnt(17) lgkmcnt(0)
  v_add_f32 v227, v227, v218
  v_add_f32 v227, v227, v219
  v_mfma_f32_16x16x32_bf16 v[192:195], a[112:115], a[208:211], v[192:195]
  s_barrier
  v_add_f32 v227, v227, v220
  v_add_f32 v227, v227, v221
  v_mfma_f32_16x16x32_bf16 v[192:195], a[116:119], a[212:215], v[192:195]
  s_add_u32 m0, s21, 73728
  v_add_f32 v227, v227, v222
  v_add_f32 v227, v227, v223
  v_mfma_f32_16x16x32_bf16 v[196:199], a[140:143], a[212:215], v[232:235]
  buffer_load_dwordx4 v242, s[12:15], s20 offen nt lds
  v_mfma_f32_16x16x32_bf16 v[196:199], a[136:139], a[208:211], v[196:199]
  v_cvt_pk_bf16_f32 v219, v218, v219
  v_cvt_pk_bf16_f32 v218, v216, v217
  v_mfma_f32_16x16x32_bf16 v[196:199], a[132:135], a[204:207], v[196:199]
  v_cvt_pk_bf16_f32 v216, v220, v221
  v_cvt_pk_bf16_f32 v217, v222, v223
  v_mfma_f32_16x16x32_bf16 v[196:199], a[128:131], a[200:203], v[196:199]
  v_fma_f32 v192, v192, s22, v228
  v_fma_f32 v193, v193, s22, v228
  v_mfma_f32_16x16x32_bf16 v[196:199], a[124:127], a[196:199], v[196:199]
  v_fma_f32 v194, v194, s22, v228
  v_fma_f32 v195, v195, s22, v228
  v_mfma_f32_16x16x32_bf16 v[196:199], a[120:123], a[192:195], v[196:199]
  buffer_load_dwordx4 v243, s[12:15], s20 offen offset:1024 nt lds
  v_mfma_f32_16x16x32_bf16 v[200:203], a[120:123], a[216:219], v[232:235]
  v_exp_f32 v192, v192
  v_mfma_f32_16x16x32_bf16 v[200:203], a[124:127], a[220:223], v[200:203]
  v_exp_f32 v193, v193
  v_mfma_f32_16x16x32_bf16 v[200:203], a[128:131], a[224:227], v[200:203]
  v_exp_f32 v194, v194
  v_mfma_f32_16x16x32_bf16 v[200:203], a[132:135], a[228:231], v[200:203]
  v_exp_f32 v195, v195
  v_mfma_f32_16x16x32_bf16 v[200:203], a[136:139], a[232:235], v[200:203]
  buffer_load_dwordx4 v244, s[12:15], s20 offen offset:2048 nt lds
  v_mfma_f32_16x16x32_bf16 v[200:203], a[140:143], a[236:239], v[200:203]
  v_fma_f32 v196, v196, s22, v228
  v_fma_f32 v197, v197, s22, v228
  v_mfma_f32_16x16x32_bf16 v[204:207], a[116:119], a[236:239], v[232:235]
  v_fma_f32 v198, v198, s22, v228
  v_fma_f32 v199, v199, s22, v228
  v_mfma_f32_16x16x32_bf16 v[204:207], a[112:115], a[232:235], v[204:207]
  s_add_u32 s20, s20, 12288
  v_exp_f32 v196, v196
  v_mfma_f32_16x16x32_bf16 v[204:207], a[108:111], a[228:231], v[204:207]
  s_add_u32 m0, s21, 36864
  v_exp_f32 v197, v197
  v_mfma_f32_16x16x32_bf16 v[204:207], a[104:107], a[224:227], v[204:207]
  buffer_load_dwordx4 v242, s[8:11], s20 offen nt lds
  v_mfma_f32_16x16x32_bf16 v[204:207], a[100:103], a[220:223], v[204:207]
  v_exp_f32 v198, v198
  v_mfma_f32_16x16x32_bf16 v[204:207], a[96:99], a[216:219], v[204:207]
  v_exp_f32 v199, v199
  v_mfma_f32_16x16x32_bf16 v[96:99], a[144:147], v[208:211], v[96:99]
  v_fma_f32 v200, v200, s22, v229
  v_fma_f32 v201, v201, s22, v229
  v_mfma_f32_16x16x32_bf16 v[144:147], a[144:147], v[216:219], v[144:147]
  v_fma_f32 v202, v202, s22, v229
  v_fma_f32 v203, v203, s22, v229
  v_mfma_f32_16x16x32_bf16 v[148:151], a[148:151], v[216:219], v[148:151]
  buffer_load_dwordx4 v243, s[8:11], s20 offen offset:1024 nt lds
  v_mfma_f32_16x16x32_bf16 v[100:103], a[148:151], v[208:211], v[100:103]
  v_exp_f32 v200, v200
  v_mfma_f32_16x16x32_bf16 v[104:107], a[152:155], v[208:211], v[104:107]
  v_exp_f32 v201, v201
  v_mfma_f32_16x16x32_bf16 v[152:155], a[152:155], v[216:219], v[152:155]
  v_exp_f32 v202, v202
  v_mfma_f32_16x16x32_bf16 v[156:159], a[156:159], v[216:219], v[156:159]
  v_exp_f32 v203, v203
  v_mfma_f32_16x16x32_bf16 v[108:111], a[156:159], v[208:211], v[108:111]
  buffer_load_dwordx4 v244, s[8:11], s20 offen offset:2048 nt lds
  v_mfma_f32_16x16x32_bf16 v[112:115], a[160:163], v[208:211], v[112:115]
  v_fma_f32 v204, v204, s22, v229
  v_fma_f32 v205, v205, s22, v229
  v_mfma_f32_16x16x32_bf16 v[160:163], a[160:163], v[216:219], v[160:163]
  v_fma_f32 v206, v206, s22, v229
  v_fma_f32 v207, v207, s22, v229
  v_mfma_f32_16x16x32_bf16 v[164:167], a[164:167], v[216:219], v[164:167]
  v_exp_f32 v204, v204
  v_mfma_f32_16x16x32_bf16 v[116:119], a[164:167], v[208:211], v[116:119]
  v_exp_f32 v205, v205
  v_mfma_f32_16x16x32_bf16 v[120:123], a[168:171], v[208:211], v[120:123]
  ds_read_b64_tr_b16 a[144:145], v238 offset:0
  v_add_f32 v224, v224, v192
  v_mfma_f32_16x16x32_bf16 v[168:171], a[168:171], v[216:219], v[168:171]
  ds_read_b64_tr_b16 a[146:147], v238 offset:6144
  v_add_f32 v224, v224, v193
  v_mfma_f32_16x16x32_bf16 v[172:175], a[172:175], v[216:219], v[172:175]
  v_exp_f32 v206, v206
  v_mfma_f32_16x16x32_bf16 v[124:127], a[172:175], v[208:211], v[124:127]
  ds_read_b64_tr_b16 a[148:149], v239 offset:0
  v_add_f32 v224, v224, v194
  v_mfma_f32_16x16x32_bf16 v[128:131], a[176:179], v[208:211], v[128:131]
  ds_read_b64_tr_b16 a[150:151], v239 offset:6144
  v_add_f32 v224, v224, v195
  v_mfma_f32_16x16x32_bf16 v[176:179], a[176:179], v[216:219], v[176:179]
  v_exp_f32 v207, v207
  v_mfma_f32_16x16x32_bf16 v[180:183], a[180:183], v[216:219], v[180:183]
  ds_read_b64_tr_b16 a[152:153], v240 offset:0
  v_cvt_pk_bf16_f32 v192, v192, v193
  v_mfma_f32_16x16x32_bf16 v[132:135], a[180:183], v[208:211], v[132:135]
  ds_read_b64_tr_b16 a[154:155], v240 offset:6144
  v_cvt_pk_bf16_f32 v193, v194, v195
  v_mfma_f32_16x16x32_bf16 v[136:139], a[184:187], v[208:211], v[136:139]
  buffer_store_dwordx4 a[0:3], v246, s[16:19], s92 offen sc0 sc1 nt
  ds_read_b128 a[8:11], v253 offset:0
  v_add_f32 v224, v224, v196
  v_add_f32 v224, v224, v197
  v_mfma_f32_16x16x32_bf16 v[184:187], a[184:187], v[216:219], v[184:187]
  ds_read_b64_tr_b16 a[156:157], v241 offset:0
  v_add_f32 v224, v224, v198
  v_mfma_f32_16x16x32_bf16 v[188:191], a[188:191], v[216:219], v[188:191]
  ds_read_b64_tr_b16 a[158:159], v241 offset:6144
  v_add_f32 v224, v224, v199
  v_mfma_f32_16x16x32_bf16 v[140:143], a[188:191], v[208:211], v[140:143]
  v_cvt_pk_bf16_f32 v194, v196, v197
  v_cvt_pk_bf16_f32 v195, v198, v199
  v_mfma_f32_16x16x32_bf16 v[208:211], a[96:99], a[48:51], v[232:235]
  ds_read_b64_tr_b16 a[160:161], v238 offset:128
  v_add_f32 v225, v225, v200
  v_mfma_f32_16x16x32_bf16 v[208:211], a[100:103], a[52:55], v[208:211]
  ds_read_b64_tr_b16 a[162:163], v238 offset:6272
  v_add_f32 v225, v225, v201
  v_mfma_f32_16x16x32_bf16 v[208:211], a[104:107], a[56:59], v[208:211]
  v_add_f32 v225, v225, v202
  v_add_f32 v225, v225, v203
  v_mfma_f32_16x16x32_bf16 v[208:211], a[108:111], a[60:63], v[208:211]
  ds_read_b64_tr_b16 a[164:165], v239 offset:128
  v_cvt_pk_bf16_f32 v203, v202, v203
  v_mfma_f32_16x16x32_bf16 v[208:211], a[112:115], a[64:67], v[208:211]
  ds_read_b64_tr_b16 a[166:167], v239 offset:6272
  v_cvt_pk_bf16_f32 v202, v200, v201
  v_mfma_f32_16x16x32_bf16 v[208:211], a[116:119], a[68:71], v[208:211]
  v_add_f32 v225, v225, v204
  v_add_f32 v225, v225, v205
  v_mfma_f32_16x16x32_bf16 v[212:215], a[140:143], a[68:71], v[232:235]
  ds_read_b64_tr_b16 a[168:169], v240 offset:128
  v_add_f32 v225, v225, v206
  v_mfma_f32_16x16x32_bf16 v[212:215], a[136:139], a[64:67], v[212:215]
  ds_read_b64_tr_b16 a[170:171], v240 offset:6272
  v_add_f32 v225, v225, v207
  v_mfma_f32_16x16x32_bf16 v[212:215], a[132:135], a[60:63], v[212:215]
  v_cvt_pk_bf16_f32 v200, v204, v205
  v_cvt_pk_bf16_f32 v201, v206, v207
  v_mfma_f32_16x16x32_bf16 v[212:215], a[128:131], a[56:59], v[212:215]
  ds_read_b64_tr_b16 a[172:173], v241 offset:128
  v_fma_f32 v208, v208, s22, v230
  v_mfma_f32_16x16x32_bf16 v[212:215], a[124:127], a[52:55], v[212:215]
  ds_read_b64_tr_b16 a[174:175], v241 offset:6272
  v_fma_f32 v209, v209, s22, v230
  v_mfma_f32_16x16x32_bf16 v[212:215], a[120:123], a[48:51], v[212:215]
  v_exp_f32 v208, v208
  v_mfma_f32_16x16x32_bf16 v[216:219], a[120:123], a[72:75], v[232:235]
  ds_read_b64_tr_b16 a[176:177], v238 offset:256
  v_fma_f32 v210, v210, s22, v230
  v_mfma_f32_16x16x32_bf16 v[216:219], a[124:127], a[76:79], v[216:219]
  ds_read_b64_tr_b16 a[178:179], v238 offset:6400
  v_fma_f32 v211, v211, s22, v230
  v_mfma_f32_16x16x32_bf16 v[216:219], a[128:131], a[80:83], v[216:219]
  buffer_store_dwordx4 a[4:7], v246, s[16:19], s92 offen offset:1024 sc0 sc1 nt
  ds_read_b128 a[12:15], v251 offset:3072
  v_exp_f32 v209, v209
  v_mfma_f32_16x16x32_bf16 v[216:219], a[132:135], a[84:87], v[216:219]
  ds_read_b64_tr_b16 a[180:181], v239 offset:256
  v_fma_f32 v212, v212, s22, v230
  v_mfma_f32_16x16x32_bf16 v[216:219], a[136:139], a[88:91], v[216:219]
  ds_read_b64_tr_b16 a[182:183], v239 offset:6400
  v_fma_f32 v213, v213, s22, v230
  v_mfma_f32_16x16x32_bf16 v[216:219], a[140:143], a[92:95], v[216:219]
  v_exp_f32 v210, v210
  v_mfma_f32_16x16x32_bf16 v[220:223], a[116:119], a[92:95], v[232:235]
  ds_read_b64_tr_b16 a[184:185], v240 offset:256
  v_fma_f32 v214, v214, s22, v230
  v_mfma_f32_16x16x32_bf16 v[220:223], a[112:115], a[88:91], v[220:223]
  ds_read_b64_tr_b16 a[186:187], v240 offset:6400
  v_fma_f32 v215, v215, s22, v230
  v_mfma_f32_16x16x32_bf16 v[220:223], a[108:111], a[84:87], v[220:223]
  v_exp_f32 v211, v211
  v_mfma_f32_16x16x32_bf16 v[220:223], a[104:107], a[80:83], v[220:223]
  ds_read_b64_tr_b16 a[188:189], v241 offset:256
  v_fma_f32 v216, v216, s22, v231
  v_mfma_f32_16x16x32_bf16 v[220:223], a[100:103], a[76:79], v[220:223]
  ds_read_b64_tr_b16 a[190:191], v241 offset:6400
  v_fma_f32 v217, v217, s22, v231
  v_mfma_f32_16x16x32_bf16 v[220:223], a[96:99], a[72:75], v[220:223]
  s_waitcnt lgkmcnt(5)
  v_exp_f32 v212, v212
  v_mfma_f32_16x16x32_bf16 v[0:3], a[144:147], v[192:195], v[0:3]
  ds_read_b128 a[96:99], v236 offset:0
  v_fma_f32 v218, v218, s22, v231
  v_mfma_f32_16x16x32_bf16 v[48:51], a[144:147], v[200:203], v[48:51]
  v_exp_f32 v213, v213
  v_mfma_f32_16x16x32_bf16 v[52:55], a[148:151], v[200:203], v[52:55]
  ds_read_b128 a[100:103], v237 offset:0
  v_fma_f32 v219, v219, s22, v231
  v_mfma_f32_16x16x32_bf16 v[4:7], a[148:151], v[192:195], v[4:7]
  v_exp_f32 v214, v214
  v_mfma_f32_16x16x32_bf16 v[8:11], a[152:155], v[192:195], v[8:11]
  ds_read_b128 a[104:107], v236 offset:128
  v_fma_f32 v220, v220, s22, v231
  v_mfma_f32_16x16x32_bf16 v[56:59], a[152:155], v[200:203], v[56:59]
  v_exp_f32 v215, v215
  v_mfma_f32_16x16x32_bf16 v[60:63], a[156:159], v[200:203], v[60:63]
  ds_read_b128 a[108:111], v237 offset:128
  v_fma_f32 v221, v221, s22, v231
  v_mfma_f32_16x16x32_bf16 v[12:15], a[156:159], v[192:195], v[12:15]
  v_exp_f32 v216, v216
  v_mfma_f32_16x16x32_bf16 v[16:19], a[160:163], v[192:195], v[16:19]
  ds_read_b128 a[112:115], v236 offset:256
  v_fma_f32 v222, v222, s22, v231
  v_mfma_f32_16x16x32_bf16 v[64:67], a[160:163], v[200:203], v[64:67]
  v_exp_f32 v217, v217
  v_mfma_f32_16x16x32_bf16 v[68:71], a[164:167], v[200:203], v[68:71]
  ds_read_b128 a[116:119], v237 offset:256
  v_fma_f32 v223, v223, s22, v231
  v_mfma_f32_16x16x32_bf16 v[20:23], a[164:167], v[192:195], v[20:23]
  v_exp_f32 v218, v218
  v_mfma_f32_16x16x32_bf16 v[24:27], a[168:171], v[192:195], v[24:27]
  ds_read_b128 a[140:143], v237 offset:6400
  v_add_f32 v226, v226, v208
  v_mfma_f32_16x16x32_bf16 v[72:75], a[168:171], v[200:203], v[72:75]
  v_exp_f32 v219, v219
  v_mfma_f32_16x16x32_bf16 v[76:79], a[172:175], v[200:203], v[76:79]
  ds_read_b128 a[136:139], v236 offset:6400
  v_add_f32 v226, v226, v209
  v_mfma_f32_16x16x32_bf16 v[28:31], a[172:175], v[192:195], v[28:31]
  v_exp_f32 v220, v220
  v_mfma_f32_16x16x32_bf16 v[32:35], a[176:179], v[192:195], v[32:35]
  ds_read_b128 a[132:135], v237 offset:6272
  v_add_f32 v226, v226, v210
  v_mfma_f32_16x16x32_bf16 v[80:83], a[176:179], v[200:203], v[80:83]
  s_waitcnt lgkmcnt(4)
  v_exp_f32 v221, v221
  v_mfma_f32_16x16x32_bf16 v[84:87], a[180:183], v[200:203], v[84:87]
  ds_read_b128 a[128:131], v236 offset:6272
  v_add_f32 v226, v226, v211
  v_mfma_f32_16x16x32_bf16 v[36:39], a[180:183], v[192:195], v[36:39]
  v_exp_f32 v222, v222
  v_mfma_f32_16x16x32_bf16 v[40:43], a[184:187], v[192:195], v[40:43]
  ds_read_b128 a[124:127], v237 offset:6144
  v_add_f32 v226, v226, v212
  v_mfma_f32_16x16x32_bf16 v[88:91], a[184:187], v[200:203], v[88:91]
  v_exp_f32 v223, v223
  v_mfma_f32_16x16x32_bf16 v[92:95], a[188:191], v[200:203], v[92:95]
  ds_read_b128 a[120:123], v236 offset:6144
  v_add_f32 v226, v226, v213
  v_mfma_f32_16x16x32_bf16 v[44:47], a[188:191], v[192:195], v[44:47]
  v_add_f32 v226, v226, v214
  v_add_f32 v226, v226, v215
  v_mfma_f32_16x16x32_bf16 v[192:195], a[96:99], a[192:195], v[232:235]
  v_cvt_pk_bf16_f32 v208, v208, v209
  v_cvt_pk_bf16_f32 v209, v210, v211
  v_mfma_f32_16x16x32_bf16 v[192:195], a[100:103], a[196:199], v[192:195]
  v_cvt_pk_bf16_f32 v210, v212, v213
  v_cvt_pk_bf16_f32 v211, v214, v215
  v_mfma_f32_16x16x32_bf16 v[192:195], a[104:107], a[200:203], v[192:195]
  v_add_f32 v227, v227, v216
  v_add_f32 v227, v227, v217
  v_mfma_f32_16x16x32_bf16 v[192:195], a[108:111], a[204:207], v[192:195]
  s_waitcnt vmcnt(18) lgkmcnt(0)
  v_add_f32 v227, v227, v218
  v_add_f32 v227, v227, v219
  v_mfma_f32_16x16x32_bf16 v[192:195], a[112:115], a[208:211], v[192:195]
  s_barrier
  v_add_f32 v227, v227, v220
  v_add_f32 v227, v227, v221
  v_mfma_f32_16x16x32_bf16 v[192:195], a[116:119], a[212:215], v[192:195]
  s_add_u32 m0, s21, 61440
  v_add_f32 v227, v227, v222
  v_add_f32 v227, v227, v223
  v_mfma_f32_16x16x32_bf16 v[196:199], a[140:143], a[212:215], v[232:235]
L_pg10:
  s_cbranch_execz L_pg14
  buffer_load_dwordx4 v242, s[12:15], s20 offen nt lds
  v_mfma_f32_16x16x32_bf16 v[196:199], a[136:139], a[208:211], v[196:199]
  v_cvt_pk_bf16_f32 v219, v218, v219
  v_cvt_pk_bf16_f32 v218, v216, v217
  v_mfma_f32_16x16x32_bf16 v[196:199], a[132:135], a[204:207], v[196:199]
  v_cvt_pk_bf16_f32 v216, v220, v221
  v_cvt_pk_bf16_f32 v217, v222, v223
  v_mfma_f32_16x16x32_bf16 v[196:199], a[128:131], a[200:203], v[196:199]
  v_fma_f32 v192, v192, s22, v228
  v_fma_f32 v193, v193, s22, v228
  v_mfma_f32_16x16x32_bf16 v[196:199], a[124:127], a[196:199], v[196:199]
  v_fma_f32 v194, v194, s22, v228
  v_fma_f32 v195, v195, s22, v228
  v_mfma_f32_16x16x32_bf16 v[196:199], a[120:123], a[192:195], v[196:199]
  buffer_load_dwordx4 v243, s[12:15], s20 offen offset:1024 nt lds
  v_mfma_f32_16x16x32_bf16 v[200:203], a[120:123], a[216:219], v[232:235]
  v_exp_f32 v192, v192
  v_mfma_f32_16x16x32_bf16 v[200:203], a[124:127], a[220:223], v[200:203]
  v_exp_f32 v193, v193
  v_mfma_f32_16x16x32_bf16 v[200:203], a[128:131], a[224:227], v[200:203]
  v_exp_f32 v194, v194
  v_mfma_f32_16x16x32_bf16 v[200:203], a[132:135], a[228:231], v[200:203]
  v_exp_f32 v195, v195
  v_mfma_f32_16x16x32_bf16 v[200:203], a[136:139], a[232:235], v[200:203]
  buffer_load_dwordx4 v244, s[12:15], s20 offen offset:2048 nt lds
  v_mfma_f32_16x16x32_bf16 v[200:203], a[140:143], a[236:239], v[200:203]
  v_fma_f32 v196, v196, s22, v228
  v_fma_f32 v197, v197, s22, v228
  v_mfma_f32_16x16x32_bf16 v[204:207], a[116:119], a[236:239], v[232:235]
  v_fma_f32 v198, v198, s22, v228
  v_fma_f32 v199, v199, s22, v228
  v_mfma_f32_16x16x32_bf16 v[204:207], a[112:115], a[232:235], v[204:207]
  s_add_u32 s20, s20, 12288
  v_exp_f32 v196, v196
  v_mfma_f32_16x16x32_bf16 v[204:207], a[108:111], a[228:231], v[204:207]
  s_add_u32 m0, s21, 0
  v_exp_f32 v197, v197
  v_mfma_f32_16x16x32_bf16 v[204:207], a[104:107], a[224:227], v[204:207]
  buffer_load_dwordx4 v242, s[8:11], s20 offen nt lds
  v_mfma_f32_16x16x32_bf16 v[204:207], a[100:103], a[220:223], v[204:207]
  v_exp_f32 v198, v198
  v_mfma_f32_16x16x32_bf16 v[204:207], a[96:99], a[216:219], v[204:207]
  v_exp_f32 v199, v199
  v_mfma_f32_16x16x32_bf16 v[96:99], a[144:147], v[208:211], v[96:99]
  v_fma_f32 v200, v200, s22, v229
  v_fma_f32 v201, v201, s22, v229
  v_mfma_f32_16x16x32_bf16 v[144:147], a[144:147], v[216:219], v[144:147]
  v_fma_f32 v202, v202, s22, v229
  v_fma_f32 v203, v203, s22, v229
  v_mfma_f32_16x16x32_bf16 v[148:151], a[148:151], v[216:219], v[148:151]
  buffer_load_dwordx4 v243, s[8:11], s20 offen offset:1024 nt lds
  v_mfma_f32_16x16x32_bf16 v[100:103], a[148:151], v[208:211], v[100:103]
  v_exp_f32 v200, v200
  v_mfma_f32_16x16x32_bf16 v[104:107], a[152:155], v[208:211], v[104:107]
  v_exp_f32 v201, v201
  v_mfma_f32_16x16x32_bf16 v[152:155], a[152:155], v[216:219], v[152:155]
  v_exp_f32 v202, v202
  v_mfma_f32_16x16x32_bf16 v[156:159], a[156:159], v[216:219], v[156:159]
  v_exp_f32 v203, v203
  v_mfma_f32_16x16x32_bf16 v[108:111], a[156:159], v[208:211], v[108:111]
  buffer_load_dwordx4 v244, s[8:11], s20 offen offset:2048 nt lds
  v_mfma_f32_16x16x32_bf16 v[112:115], a[160:163], v[208:211], v[112:115]
  v_fma_f32 v204, v204, s22, v229
  v_fma_f32 v205, v205, s22, v229
  v_mfma_f32_16x16x32_bf16 v[160:163], a[160:163], v[216:219], v[160:163]
  v_fma_f32 v206, v206, s22, v229
  v_fma_f32 v207, v207, s22, v229
  v_mfma_f32_16x16x32_bf16 v[164:167], a[164:167], v[216:219], v[164:167]
  v_exp_f32 v204, v204
  v_mfma_f32_16x16x32_bf16 v[116:119], a[164:167], v[208:211], v[116:119]
  v_exp_f32 v205, v205
  v_mfma_f32_16x16x32_bf16 v[120:123], a[168:171], v[208:211], v[120:123]
  ds_read_b64_tr_b16 a[144:145], v238 offset:36864
  v_add_f32 v224, v224, v192
  v_mfma_f32_16x16x32_bf16 v[168:171], a[168:171], v[216:219], v[168:171]
  ds_read_b64_tr_b16 a[146:147], v238 offset:43008
  v_add_f32 v224, v224, v193
  v_mfma_f32_16x16x32_bf16 v[172:175], a[172:175], v[216:219], v[172:175]
  v_exp_f32 v206, v206
  v_mfma_f32_16x16x32_bf16 v[124:127], a[172:175], v[208:211], v[124:127]
  ds_read_b64_tr_b16 a[148:149], v239 offset:36864
  v_add_f32 v224, v224, v194
  v_mfma_f32_16x16x32_bf16 v[128:131], a[176:179], v[208:211], v[128:131]
  ds_read_b64_tr_b16 a[150:151], v239 offset:43008
  v_add_f32 v224, v224, v195
  v_mfma_f32_16x16x32_bf16 v[176:179], a[176:179], v[216:219], v[176:179]
  v_exp_f32 v207, v207
  v_mfma_f32_16x16x32_bf16 v[180:183], a[180:183], v[216:219], v[180:183]
  ds_read_b64_tr_b16 a[152:153], v240 offset:36864
  v_cvt_pk_bf16_f32 v192, v192, v193
  v_mfma_f32_16x16x32_bf16 v[132:135], a[180:183], v[208:211], v[132:135]
  ds_read_b64_tr_b16 a[154:155], v240 offset:43008
  v_cvt_pk_bf16_f32 v193, v194, v195
  v_mfma_f32_16x16x32_bf16 v[136:139], a[184:187], v[208:211], v[136:139]
  buffer_store_dwordx4 a[8:11], v246, s[16:19], s92 offen offset:2048 sc0 sc1 nt
  ds_read_b128 a[16:19], v252 offset:3072
  v_add_f32 v224, v224, v196
  v_add_f32 v224, v224, v197
  v_mfma_f32_16x16x32_bf16 v[184:187], a[184:187], v[216:219], v[184:187]
  ds_read_b64_tr_b16 a[156:157], v241 offset:36864
  v_add_f32 v224, v224, v198
  v_mfma_f32_16x16x32_bf16 v[188:191], a[188:191], v[216:219], v[188:191]
  ds_read_b64_tr_b16 a[158:159], v241 offset:43008
  v_add_f32 v224, v224, v199
  v_mfma_f32_16x16x32_bf16 v[140:143], a[188:191], v[208:211], v[140:143]
  v_cvt_pk_bf16_f32 v194, v196, v197
  v_cvt_pk_bf16_f32 v195, v198, v199
  v_mfma_f32_16x16x32_bf16 v[208:211], a[96:99], a[48:51], v[232:235]
  ds_read_b64_tr_b16 a[160:161], v238 offset:36992
  v_add_f32 v225, v225, v200
  v_mfma_f32_16x16x32_bf16 v[208:211], a[100:103], a[52:55], v[208:211]
  ds_read_b64_tr_b16 a[162:163], v238 offset:43136
  v_add_f32 v225, v225, v201
  v_mfma_f32_16x16x32_bf16 v[208:211], a[104:107], a[56:59], v[208:211]
  v_add_f32 v225, v225, v202
  v_add_f32 v225, v225, v203
  v_mfma_f32_16x16x32_bf16 v[208:211], a[108:111], a[60:63], v[208:211]
  ds_read_b64_tr_b16 a[164:165], v239 offset:36992
  v_cvt_pk_bf16_f32 v203, v202, v203
  v_mfma_f32_16x16x32_bf16 v[208:211], a[112:115], a[64:67], v[208:211]
  ds_read_b64_tr_b16 a[166:167], v239 offset:43136
  v_cvt_pk_bf16_f32 v202, v200, v201
  v_mfma_f32_16x16x32_bf16 v[208:211], a[116:119], a[68:71], v[208:211]
  v_add_f32 v225, v225, v204
  v_add_f32 v225, v225, v205
  v_mfma_f32_16x16x32_bf16 v[212:215], a[140:143], a[68:71], v[232:235]
  ds_read_b64_tr_b16 a[168:169], v240 offset:36992
  v_add_f32 v225, v225, v206
  v_mfma_f32_16x16x32_bf16 v[212:215], a[136:139], a[64:67], v[212:215]
  ds_read_b64_tr_b16 a[170:171], v240 offset:43136
  v_add_f32 v225, v225, v207
  v_mfma_f32_16x16x32_bf16 v[212:215], a[132:135], a[60:63], v[212:215]
  v_cvt_pk_bf16_f32 v200, v204, v205
  v_cvt_pk_bf16_f32 v201, v206, v207
  v_mfma_f32_16x16x32_bf16 v[212:215], a[128:131], a[56:59], v[212:215]
  ds_read_b64_tr_b16 a[172:173], v241 offset:36992
  v_fma_f32 v208, v208, s22, v230
  v_mfma_f32_16x16x32_bf16 v[212:215], a[124:127], a[52:55], v[212:215]
  ds_read_b64_tr_b16 a[174:175], v241 offset:43136
  v_fma_f32 v209, v209, s22, v230
  v_mfma_f32_16x16x32_bf16 v[212:215], a[120:123], a[48:51], v[212:215]
  v_exp_f32 v208, v208
  v_mfma_f32_16x16x32_bf16 v[216:219], a[120:123], a[72:75], v[232:235]
  ds_read_b64_tr_b16 a[176:177], v238 offset:37120
  v_fma_f32 v210, v210, s22, v230
  v_mfma_f32_16x16x32_bf16 v[216:219], a[124:127], a[76:79], v[216:219]
  ds_read_b64_tr_b16 a[178:179], v238 offset:43264
  v_fma_f32 v211, v211, s22, v230
  v_mfma_f32_16x16x32_bf16 v[216:219], a[128:131], a[80:83], v[216:219]
  buffer_store_dwordx4 a[12:15], v246, s[16:19], s93 offen sc0 sc1 nt
  ds_read_b128 a[20:23], v253 offset:3072
  v_exp_f32 v209, v209
  v_mfma_f32_16x16x32_bf16 v[216:219], a[132:135], a[84:87], v[216:219]
  ds_read_b64_tr_b16 a[180:181], v239 offset:37120
  v_fma_f32 v212, v212, s22, v230
  v_mfma_f32_16x16x32_bf16 v[216:219], a[136:139], a[88:91], v[216:219]
  ds_read_b64_tr_b16 a[182:183], v239 offset:43264
  v_fma_f32 v213, v213, s22, v230
  v_mfma_f32_16x16x32_bf16 v[216:219], a[140:143], a[92:95], v[216:219]
  v_exp_f32 v210, v210
  v_mfma_f32_16x16x32_bf16 v[220:223], a[116:119], a[92:95], v[232:235]
  ds_read_b64_tr_b16 a[184:185], v240 offset:37120
  v_fma_f32 v214, v214, s22, v230
  v_mfma_f32_16x16x32_bf16 v[220:223], a[112:115], a[88:91], v[220:223]
  ds_read_b64_tr_b16 a[186:187], v240 offset:43264
  v_fma_f32 v215, v215, s22, v230
  v_mfma_f32_16x16x32_bf16 v[220:223], a[108:111], a[84:87], v[220:223]
  v_exp_f32 v211, v211
  v_mfma_f32_16x16x32_bf16 v[220:223], a[104:107], a[80:83], v[220:223]
  ds_read_b64_tr_b16 a[188:189], v241 offset:37120
  v_fma_f32 v216, v216, s22, v231
  v_mfma_f32_16x16x32_bf16 v[220:223], a[100:103], a[76:79], v[220:223]
  ds_read_b64_tr_b16 a[190:191], v241 offset:43264
  v_fma_f32 v217, v217, s22, v231
  v_mfma_f32_16x16x32_bf16 v[220:223], a[96:99], a[72:75], v[220:223]
  s_waitcnt lgkmcnt(5)
  v_exp_f32 v212, v212
  v_mfma_f32_16x16x32_bf16 v[0:3], a[144:147], v[192:195], v[0:3]
  ds_read_b128 a[96:99], v236 offset:12288
  v_fma_f32 v218, v218, s22, v231
  v_mfma_f32_16x16x32_bf16 v[48:51], a[144:147], v[200:203], v[48:51]
  v_exp_f32 v213, v213
  v_mfma_f32_16x16x32_bf16 v[52:55], a[148:151], v[200:203], v[52:55]
  ds_read_b128 a[100:103], v237 offset:12288
  v_fma_f32 v219, v219, s22, v231
  v_mfma_f32_16x16x32_bf16 v[4:7], a[148:151], v[192:195], v[4:7]
  v_exp_f32 v214, v214
  v_mfma_f32_16x16x32_bf16 v[8:11], a[152:155], v[192:195], v[8:11]
  ds_read_b128 a[104:107], v236 offset:12416
  v_fma_f32 v220, v220, s22, v231
  v_mfma_f32_16x16x32_bf16 v[56:59], a[152:155], v[200:203], v[56:59]
  v_exp_f32 v215, v215
  v_mfma_f32_16x16x32_bf16 v[60:63], a[156:159], v[200:203], v[60:63]
  ds_read_b128 a[108:111], v237 offset:12416
  v_fma_f32 v221, v221, s22, v231
  v_mfma_f32_16x16x32_bf16 v[12:15], a[156:159], v[192:195], v[12:15]
  v_exp_f32 v216, v216
  v_mfma_f32_16x16x32_bf16 v[16:19], a[160:163], v[192:195], v[16:19]
  ds_read_b128 a[112:115], v236 offset:12544
  v_fma_f32 v222, v222, s22, v231
  v_mfma_f32_16x16x32_bf16 v[64:67], a[160:163], v[200:203], v[64:67]
  v_exp_f32 v217, v217
  v_mfma_f32_16x16x32_bf16 v[68:71], a[164:167], v[200:203], v[68:71]
  ds_read_b128 a[116:119], v237 offset:12544
  v_fma_f32 v223, v223, s22, v231
  v_mfma_f32_16x16x32_bf16 v[20:23], a[164:167], v[192:195], v[20:23]
  v_exp_f32 v218, v218
  v_mfma_f32_16x16x32_bf16 v[24:27], a[168:171], v[192:195], v[24:27]
  ds_read_b128 a[140:143], v237 offset:18688
  v_add_f32 v226, v226, v208
  v_mfma_f32_16x16x32_bf16 v[72:75], a[168:171], v[200:203], v[72:75]
  v_exp_f32 v219, v219
  v_mfma_f32_16x16x32_bf16 v[76:79], a[172:175], v[200:203], v[76:79]
  ds_read_b128 a[136:139], v236 offset:18688
  v_add_f32 v226, v226, v209
  v_mfma_f32_16x16x32_bf16 v[28:31], a[172:175], v[192:195], v[28:31]
  v_exp_f32 v220, v220
  v_mfma_f32_16x16x32_bf16 v[32:35], a[176:179], v[192:195], v[32:35]
  ds_read_b128 a[132:135], v237 offset:18560
  v_add_f32 v226, v226, v210
  v_mfma_f32_16x16x32_bf16 v[80:83], a[176:179], v[200:203], v[80:83]
  s_waitcnt lgkmcnt(4)
  v_exp_f32 v221, v221
  v_mfma_f32_16x16x32_bf16 v[84:87], a[180:183], v[200:203], v[84:87]
  ds_read_b128 a[128:131], v236 offset:18560
  v_add_f32 v226, v226, v211
  v_mfma_f32_16x16x32_bf16 v[36:39], a[180:183], v[192:195], v[36:39]
  v_exp_f32 v222, v222
  v_mfma_f32_16x16x32_bf16 v[40:43], a[184:187], v[192:195], v[40:43]
  ds_read_b128 a[124:127], v237 offset:18432
  v_add_f32 v226, v226, v212
  v_mfma_f32_16x16x32_bf16 v[88:91], a[184:187], v[200:203], v[88:91]
  v_exp_f32 v223, v223
  v_mfma_f32_16x16x32_bf16 v[92:95], a[188:191], v[200:203], v[92:95]
  ds_read_b128 a[120:123], v236 offset:18432
  v_add_f32 v226, v226, v213
  v_mfma_f32_16x16x32_bf16 v[44:47], a[188:191], v[192:195], v[44:47]
  v_add_f32 v226, v226, v214
  v_add_f32 v226, v226, v215
  v_mfma_f32_16x16x32_bf16 v[192:195], a[96:99], a[192:195], v[232:235]
  v_cvt_pk_bf16_f32 v208, v208, v209
  v_cvt_pk_bf16_f32 v209, v210, v211
  v_mfma_f32_16x16x32_bf16 v[192:195], a[100:103], a[196:199], v[192:195]
  v_cvt_pk_bf16_f32 v210, v212, v213
  v_cvt_pk_bf16_f32 v211, v214, v215
  v_mfma_f32_16x16x32_bf16 v[192:195], a[104:107], a[200:203], v[192:195]
  v_add_f32 v227, v227, v216
  v_add_f32 v227, v227, v217
  v_mfma_f32_16x16x32_bf16 v[192:195], a[108:111], a[204:207], v[192:195]
  s_waitcnt vmcnt(18) lgkmcnt(0)
  v_add_f32 v227, v227, v218
  v_add_f32 v227, v227, v219
  v_mfma_f32_16x16x32_bf16 v[192:195], a[112:115], a[208:211], v[192:195]
  s_barrier
  v_add_f32 v227, v227, v220
  v_add_f32 v227, v227, v221
  v_mfma_f32_16x16x32_bf16 v[192:195], a[116:119], a[212:215], v[192:195]
  s_add_u32 m0, s21, 98304
  v_add_f32 v227, v227, v222
  v_add_f32 v227, v227, v223
  v_mfma_f32_16x16x32_bf16 v[196:199], a[140:143], a[212:215], v[232:235]
  buffer_load_dwordx4 v242, s[12:15], s20 offen nt lds
  v_mfma_f32_16x16x32_bf16 v[196:199], a[136:139], a[208:211], v[196:199]
  v_cvt_pk_bf16_f32 v219, v218, v219
  v_cvt_pk_bf16_f32 v218, v216, v217
  v_mfma_f32_16x16x32_bf16 v[196:199], a[132:135], a[204:207], v[196:199]
  v_cvt_pk_bf16_f32 v216, v220, v221
  v_cvt_pk_bf16_f32 v217, v222, v223
  v_mfma_f32_16x16x32_bf16 v[196:199], a[128:131], a[200:203], v[196:199]
  v_fma_f32 v192, v192, s22, v228
  v_fma_f32 v193, v193, s22, v228
  v_mfma_f32_16x16x32_bf16 v[196:199], a[124:127], a[196:199], v[196:199]
  v_fma_f32 v194, v194, s22, v228
  v_fma_f32 v195, v195, s22, v228
  v_mfma_f32_16x16x32_bf16 v[196:199], a[120:123], a[192:195], v[196:199]
  buffer_load_dwordx4 v243, s[12:15], s20 offen offset:1024 nt lds
  v_mfma_f32_16x16x32_bf16 v[200:203], a[120:123], a[216:219], v[232:235]
  v_exp_f32 v192, v192
  v_mfma_f32_16x16x32_bf16 v[200:203], a[124:127], a[220:223], v[200:203]
  v_exp_f32 v193, v193
  v_mfma_f32_16x16x32_bf16 v[200:203], a[128:131], a[224:227], v[200:203]
  v_exp_f32 v194, v194
  v_mfma_f32_16x16x32_bf16 v[200:203], a[132:135], a[228:231], v[200:203]
  v_exp_f32 v195, v195
  v_mfma_f32_16x16x32_bf16 v[200:203], a[136:139], a[232:235], v[200:203]
  buffer_load_dwordx4 v244, s[12:15], s20 offen offset:2048 nt lds
  v_mfma_f32_16x16x32_bf16 v[200:203], a[140:143], a[236:239], v[200:203]
  v_fma_f32 v196, v196, s22, v228
  v_fma_f32 v197, v197, s22, v228
  v_mfma_f32_16x16x32_bf16 v[204:207], a[116:119], a[236:239], v[232:235]
  v_fma_f32 v198, v198, s22, v228
  v_fma_f32 v199, v199, s22, v228
  v_mfma_f32_16x16x32_bf16 v[204:207], a[112:115], a[232:235], v[204:207]
  s_add_u32 s20, s20, 12288
  v_exp_f32 v196, v196
  v_mfma_f32_16x16x32_bf16 v[204:207], a[108:111], a[228:231], v[204:207]
  s_add_u32 m0, s21, 12288
  v_exp_f32 v197, v197
  v_mfma_f32_16x16x32_bf16 v[204:207], a[104:107], a[224:227], v[204:207]
  buffer_load_dwordx4 v242, s[8:11], s20 offen nt lds
  v_mfma_f32_16x16x32_bf16 v[204:207], a[100:103], a[220:223], v[204:207]
  v_exp_f32 v198, v198
  v_mfma_f32_16x16x32_bf16 v[204:207], a[96:99], a[216:219], v[204:207]
  v_exp_f32 v199, v199
  v_mfma_f32_16x16x32_bf16 v[96:99], a[144:147], v[208:211], v[96:99]
  v_fma_f32 v200, v200, s22, v229
  v_fma_f32 v201, v201, s22, v229
  v_mfma_f32_16x16x32_bf16 v[144:147], a[144:147], v[216:219], v[144:147]
  v_fma_f32 v202, v202, s22, v229
  v_fma_f32 v203, v203, s22, v229
  v_mfma_f32_16x16x32_bf16 v[148:151], a[148:151], v[216:219], v[148:151]
  buffer_load_dwordx4 v243, s[8:11], s20 offen offset:1024 nt lds
  v_mfma_f32_16x16x32_bf16 v[100:103], a[148:151], v[208:211], v[100:103]
  v_exp_f32 v200, v200
  v_mfma_f32_16x16x32_bf16 v[104:107], a[152:155], v[208:211], v[104:107]
  v_exp_f32 v201, v201
  v_mfma_f32_16x16x32_bf16 v[152:155], a[152:155], v[216:219], v[152:155]
  v_exp_f32 v202, v202
  v_mfma_f32_16x16x32_bf16 v[156:159], a[156:159], v[216:219], v[156:159]
  v_exp_f32 v203, v203
  v_mfma_f32_16x16x32_bf16 v[108:111], a[156:159], v[208:211], v[108:111]
  buffer_load_dwordx4 v244, s[8:11], s20 offen offset:2048 nt lds
  v_mfma_f32_16x16x32_bf16 v[112:115], a[160:163], v[208:211], v[112:115]
  v_fma_f32 v204, v204, s22, v229
  v_fma_f32 v205, v205, s22, v229
  v_mfma_f32_16x16x32_bf16 v[160:163], a[160:163], v[216:219], v[160:163]
  v_fma_f32 v206, v206, s22, v229
  v_fma_f32 v207, v207, s22, v229
  v_mfma_f32_16x16x32_bf16 v[164:167], a[164:167], v[216:219], v[164:167]
  v_exp_f32 v204, v204
  v_mfma_f32_16x16x32_bf16 v[116:119], a[164:167], v[208:211], v[116:119]
  v_exp_f32 v205, v205
  v_mfma_f32_16x16x32_bf16 v[120:123], a[168:171], v[208:211], v[120:123]
  ds_read_b64_tr_b16 a[144:145], v238 offset:24576
  v_add_f32 v224, v224, v192
  v_mfma_f32_16x16x32_bf16 v[168:171], a[168:171], v[216:219], v[168:171]
  ds_read_b64_tr_b16 a[146:147], v238 offset:30720
  v_add_f32 v224, v224, v193
  v_mfma_f32_16x16x32_bf16 v[172:175], a[172:175], v[216:219], v[172:175]
  v_exp_f32 v206, v206
  v_mfma_f32_16x16x32_bf16 v[124:127], a[172:175], v[208:211], v[124:127]
  ds_read_b64_tr_b16 a[148:149], v239 offset:24576
  v_add_f32 v224, v224, v194
  v_mfma_f32_16x16x32_bf16 v[128:131], a[176:179], v[208:211], v[128:131]
  ds_read_b64_tr_b16 a[150:151], v239 offset:30720
  v_add_f32 v224, v224, v195
  v_mfma_f32_16x16x32_bf16 v[176:179], a[176:179], v[216:219], v[176:179]
  v_exp_f32 v207, v207
  v_mfma_f32_16x16x32_bf16 v[180:183], a[180:183], v[216:219], v[180:183]
  ds_read_b64_tr_b16 a[152:153], v240 offset:24576
  v_cvt_pk_bf16_f32 v192, v192, v193
  v_mfma_f32_16x16x32_bf16 v[132:135], a[180:183], v[208:211], v[132:135]
  ds_read_b64_tr_b16 a[154:155], v240 offset:30720
  v_cvt_pk_bf16_f32 v193, v194, v195
  v_mfma_f32_16x16x32_bf16 v[136:139], a[184:187], v[208:211], v[136:139]
  buffer_store_dwordx4 a[16:19], v246, s[16:19], s93 offen offset:1024 sc0 sc1 nt
  ds_read_b128 a[24:27], v251 offset:6144
  v_add_f32 v224, v224, v196
  v_add_f32 v224, v224, v197
  v_mfma_f32_16x16x32_bf16 v[184:187], a[184:187], v[216:219], v[184:187]
  ds_read_b64_tr_b16 a[156:157], v241 offset:24576
  v_add_f32 v224, v224, v198
  v_mfma_f32_16x16x32_bf16 v[188:191], a[188:191], v[216:219], v[188:191]
  ds_read_b64_tr_b16 a[158:159], v241 offset:30720
  v_add_f32 v224, v224, v199
  v_mfma_f32_16x16x32_bf16 v[140:143], a[188:191], v[208:211], v[140:143]
  v_cvt_pk_bf16_f32 v194, v196, v197
  v_cvt_pk_bf16_f32 v195, v198, v199
  v_mfma_f32_16x16x32_bf16 v[208:211], a[96:99], a[48:51], v[232:235]
  ds_read_b64_tr_b16 a[160:161], v238 offset:24704
  v_add_f32 v225, v225, v200
  v_mfma_f32_16x16x32_bf16 v[208:211], a[100:103], a[52:55], v[208:211]
  ds_read_b64_tr_b16 a[162:163], v238 offset:30848
  v_add_f32 v225, v225, v201
  v_mfma_f32_16x16x32_bf16 v[208:211], a[104:107], a[56:59], v[208:211]
  v_add_f32 v225, v225, v202
  v_add_f32 v225, v225, v203
  v_mfma_f32_16x16x32_bf16 v[208:211], a[108:111], a[60:63], v[208:211]
  ds_read_b64_tr_b16 a[164:165], v239 offset:24704
  v_cvt_pk_bf16_f32 v203, v202, v203
  v_mfma_f32_16x16x32_bf16 v[208:211], a[112:115], a[64:67], v[208:211]
  ds_read_b64_tr_b16 a[166:167], v239 offset:30848
  v_cvt_pk_bf16_f32 v202, v200, v201
  v_mfma_f32_16x16x32_bf16 v[208:211], a[116:119], a[68:71], v[208:211]
  v_add_f32 v225, v225, v204
  v_add_f32 v225, v225, v205
  v_mfma_f32_16x16x32_bf16 v[212:215], a[140:143], a[68:71], v[232:235]
  ds_read_b64_tr_b16 a[168:169], v240 offset:24704
  v_add_f32 v225, v225, v206
  v_mfma_f32_16x16x32_bf16 v[212:215], a[136:139], a[64:67], v[212:215]
  ds_read_b64_tr_b16 a[170:171], v240 offset:30848
  v_add_f32 v225, v225, v207
  v_mfma_f32_16x16x32_bf16 v[212:215], a[132:135], a[60:63], v[212:215]
  v_cvt_pk_bf16_f32 v200, v204, v205
  v_cvt_pk_bf16_f32 v201, v206, v207
  v_mfma_f32_16x16x32_bf16 v[212:215], a[128:131], a[56:59], v[212:215]
  ds_read_b64_tr_b16 a[172:173], v241 offset:24704
  v_fma_f32 v208, v208, s22, v230
  v_mfma_f32_16x16x32_bf16 v[212:215], a[124:127], a[52:55], v[212:215]
  ds_read_b64_tr_b16 a[174:175], v241 offset:30848
  v_fma_f32 v209, v209, s22, v230
  v_mfma_f32_16x16x32_bf16 v[212:215], a[120:123], a[48:51], v[212:215]
  v_exp_f32 v208, v208
  v_mfma_f32_16x16x32_bf16 v[216:219], a[120:123], a[72:75], v[232:235]
  ds_read_b64_tr_b16 a[176:177], v238 offset:24832
  v_fma_f32 v210, v210, s22, v230
  v_mfma_f32_16x16x32_bf16 v[216:219], a[124:127], a[76:79], v[216:219]
  ds_read_b64_tr_b16 a[178:179], v238 offset:30976
  v_fma_f32 v211, v211, s22, v230
  v_mfma_f32_16x16x32_bf16 v[216:219], a[128:131], a[80:83], v[216:219]
  buffer_store_dwordx4 a[20:23], v246, s[16:19], s93 offen offset:2048 sc0 sc1 nt
  ds_read_b128 a[28:31], v252 offset:6144
  v_exp_f32 v209, v209
  v_mfma_f32_16x16x32_bf16 v[216:219], a[132:135], a[84:87], v[216:219]
  ds_read_b64_tr_b16 a[180:181], v239 offset:24832
  v_fma_f32 v212, v212, s22, v230
  v_mfma_f32_16x16x32_bf16 v[216:219], a[136:139], a[88:91], v[216:219]
  ds_read_b64_tr_b16 a[182:183], v239 offset:30976
  v_fma_f32 v213, v213, s22, v230
  v_mfma_f32_16x16x32_bf16 v[216:219], a[140:143], a[92:95], v[216:219]
  v_exp_f32 v210, v210
  v_mfma_f32_16x16x32_bf16 v[220:223], a[116:119], a[92:95], v[232:235]
  ds_read_b64_tr_b16 a[184:185], v240 offset:24832
  v_fma_f32 v214, v214, s22, v230
  v_mfma_f32_16x16x32_bf16 v[220:223], a[112:115], a[88:91], v[220:223]
  ds_read_b64_tr_b16 a[186:187], v240 offset:30976
  v_fma_f32 v215, v215, s22, v230
  v_mfma_f32_16x16x32_bf16 v[220:223], a[108:111], a[84:87], v[220:223]
  v_exp_f32 v211, v211
  v_mfma_f32_16x16x32_bf16 v[220:223], a[104:107], a[80:83], v[220:223]
  ds_read_b64_tr_b16 a[188:189], v241 offset:24832
  v_fma_f32 v216, v216, s22, v231
  v_mfma_f32_16x16x32_bf16 v[220:223], a[100:103], a[76:79], v[220:223]
  ds_read_b64_tr_b16 a[190:191], v241 offset:30976
  v_fma_f32 v217, v217, s22, v231
  v_mfma_f32_16x16x32_bf16 v[220:223], a[96:99], a[72:75], v[220:223]
  s_waitcnt lgkmcnt(5)
  v_exp_f32 v212, v212
  v_mfma_f32_16x16x32_bf16 v[0:3], a[144:147], v[192:195], v[0:3]
  ds_read_b128 a[96:99], v236 offset:24576
  v_fma_f32 v218, v218, s22, v231
  v_mfma_f32_16x16x32_bf16 v[48:51], a[144:147], v[200:203], v[48:51]
  v_exp_f32 v213, v213
  v_mfma_f32_16x16x32_bf16 v[52:55], a[148:151], v[200:203], v[52:55]
  ds_read_b128 a[100:103], v237 offset:24576
  v_fma_f32 v219, v219, s22, v231
  v_mfma_f32_16x16x32_bf16 v[4:7], a[148:151], v[192:195], v[4:7]
  v_exp_f32 v214, v214
  v_mfma_f32_16x16x32_bf16 v[8:11], a[152:155], v[192:195], v[8:11]
  ds_read_b128 a[104:107], v236 offset:24704
  v_fma_f32 v220, v220, s22, v231
  v_mfma_f32_16x16x32_bf16 v[56:59], a[152:155], v[200:203], v[56:59]
  v_exp_f32 v215, v215
  v_mfma_f32_16x16x32_bf16 v[60:63], a[156:159], v[200:203], v[60:63]
  ds_read_b128 a[108:111], v237 offset:24704
  v_fma_f32 v221, v221, s22, v231
  v_mfma_f32_16x16x32_bf16 v[12:15], a[156:159], v[192:195], v[12:15]
  v_exp_f32 v216, v216
  v_mfma_f32_16x16x32_bf16 v[16:19], a[160:163], v[192:195], v[16:19]
  ds_read_b128 a[112:115], v236 offset:24832
  v_fma_f32 v222, v222, s22, v231
  v_mfma_f32_16x16x32_bf16 v[64:67], a[160:163], v[200:203], v[64:67]
  v_exp_f32 v217, v217
  v_mfma_f32_16x16x32_bf16 v[68:71], a[164:167], v[200:203], v[68:71]
  ds_read_b128 a[116:119], v237 offset:24832
  v_fma_f32 v223, v223, s22, v231
  v_mfma_f32_16x16x32_bf16 v[20:23], a[164:167], v[192:195], v[20:23]
  v_exp_f32 v218, v218
  v_mfma_f32_16x16x32_bf16 v[24:27], a[168:171], v[192:195], v[24:27]
  ds_read_b128 a[140:143], v237 offset:30976
  v_add_f32 v226, v226, v208
  v_mfma_f32_16x16x32_bf16 v[72:75], a[168:171], v[200:203], v[72:75]
  v_exp_f32 v219, v219
  v_mfma_f32_16x16x32_bf16 v[76:79], a[172:175], v[200:203], v[76:79]
  ds_read_b128 a[136:139], v236 offset:30976
  v_add_f32 v226, v226, v209
  v_mfma_f32_16x16x32_bf16 v[28:31], a[172:175], v[192:195], v[28:31]
  v_exp_f32 v220, v220
  v_mfma_f32_16x16x32_bf16 v[32:35], a[176:179], v[192:195], v[32:35]
  ds_read_b128 a[132:135], v237 offset:30848
  v_add_f32 v226, v226, v210
  v_mfma_f32_16x16x32_bf16 v[80:83], a[176:179], v[200:203], v[80:83]
  s_waitcnt lgkmcnt(4)
  v_exp_f32 v221, v221
  v_mfma_f32_16x16x32_bf16 v[84:87], a[180:183], v[200:203], v[84:87]
  ds_read_b128 a[128:131], v236 offset:30848
  v_add_f32 v226, v226, v211
  v_mfma_f32_16x16x32_bf16 v[36:39], a[180:183], v[192:195], v[36:39]
  v_exp_f32 v222, v222
  v_mfma_f32_16x16x32_bf16 v[40:43], a[184:187], v[192:195], v[40:43]
  ds_read_b128 a[124:127], v237 offset:30720
  v_add_f32 v226, v226, v212
  v_mfma_f32_16x16x32_bf16 v[88:91], a[184:187], v[200:203], v[88:91]
  v_exp_f32 v223, v223
  v_mfma_f32_16x16x32_bf16 v[92:95], a[188:191], v[200:203], v[92:95]
  ds_read_b128 a[120:123], v236 offset:30720
  v_add_f32 v226, v226, v213
  v_mfma_f32_16x16x32_bf16 v[44:47], a[188:191], v[192:195], v[44:47]
  v_add_f32 v226, v226, v214
  v_add_f32 v226, v226, v215
  v_mfma_f32_16x16x32_bf16 v[192:195], a[96:99], a[192:195], v[232:235]
  v_cvt_pk_bf16_f32 v208, v208, v209
  v_cvt_pk_bf16_f32 v209, v210, v211
  v_mfma_f32_16x16x32_bf16 v[192:195], a[100:103], a[196:199], v[192:195]
  v_cvt_pk_bf16_f32 v210, v212, v213
  v_cvt_pk_bf16_f32 v211, v214, v215
  v_mfma_f32_16x16x32_bf16 v[192:195], a[104:107], a[200:203], v[192:195]
  v_add_f32 v227, v227, v216
  v_add_f32 v227, v227, v217
  v_mfma_f32_16x16x32_bf16 v[192:195], a[108:111], a[204:207], v[192:195]
  s_waitcnt vmcnt(18) lgkmcnt(0)
  v_add_f32 v227, v227, v218
  v_add_f32 v227, v227, v219
  v_mfma_f32_16x16x32_bf16 v[192:195], a[112:115], a[208:211], v[192:195]
  s_barrier
  v_add_f32 v227, v227, v220
  v_add_f32 v227, v227, v221
  v_mfma_f32_16x16x32_bf16 v[192:195], a[116:119], a[212:215], v[192:195]
  s_add_u32 m0, s21, 86016
  v_add_f32 v227, v227, v222
  v_add_f32 v227, v227, v223
  v_mfma_f32_16x16x32_bf16 v[196:199], a[140:143], a[212:215], v[232:235]
  buffer_load_dwordx4 v242, s[12:15], s20 offen nt lds
  v_mfma_f32_16x16x32_bf16 v[196:199], a[136:139], a[208:211], v[196:199]
  v_cvt_pk_bf16_f32 v219, v218, v219
  v_cvt_pk_bf16_f32 v218, v216, v217
  v_mfma_f32_16x16x32_bf16 v[196:199], a[132:135], a[204:207], v[196:199]
  v_cvt_pk_bf16_f32 v216, v220, v221
  v_cvt_pk_bf16_f32 v217, v222, v223
  v_mfma_f32_16x16x32_bf16 v[196:199], a[128:131], a[200:203], v[196:199]
  v_fma_f32 v192, v192, s22, v228
  v_fma_f32 v193, v193, s22, v228
  v_mfma_f32_16x16x32_bf16 v[196:199], a[124:127], a[196:199], v[196:199]
  v_fma_f32 v194, v194, s22, v228
  v_fma_f32 v195, v195, s22, v228
  v_mfma_f32_16x16x32_bf16 v[196:199], a[120:123], a[192:195], v[196:199]
  buffer_load_dwordx4 v243, s[12:15], s20 offen offset:1024 nt lds
  v_mfma_f32_16x16x32_bf16 v[200:203], a[120:123], a[216:219], v[232:235]
  v_exp_f32 v192, v192
  v_mfma_f32_16x16x32_bf16 v[200:203], a[124:127], a[220:223], v[200:203]
  v_exp_f32 v193, v193
  v_mfma_f32_16x16x32_bf16 v[200:203], a[128:131], a[224:227], v[200:203]
  v_exp_f32 v194, v194
  v_mfma_f32_16x16x32_bf16 v[200:203], a[132:135], a[228:231], v[200:203]
  v_exp_f32 v195, v195
  v_mfma_f32_16x16x32_bf16 v[200:203], a[136:139], a[232:235], v[200:203]
  buffer_load_dwordx4 v244, s[12:15], s20 offen offset:2048 nt lds
  v_mfma_f32_16x16x32_bf16 v[200:203], a[140:143], a[236:239], v[200:203]
  v_fma_f32 v196, v196, s22, v228
  v_fma_f32 v197, v197, s22, v228
  v_mfma_f32_16x16x32_bf16 v[204:207], a[116:119], a[236:239], v[232:235]
  v_fma_f32 v198, v198, s22, v228
  v_fma_f32 v199, v199, s22, v228
  v_mfma_f32_16x16x32_bf16 v[204:207], a[112:115], a[232:235], v[204:207]
  s_add_u32 s20, s20, 12288
  v_exp_f32 v196, v196
  v_mfma_f32_16x16x32_bf16 v[204:207], a[108:111], a[228:231], v[204:207]
  s_add_u32 m0, s21, 24576
  v_exp_f32 v197, v197
  v_mfma_f32_16x16x32_bf16 v[204:207], a[104:107], a[224:227], v[204:207]
  buffer_load_dwordx4 v242, s[8:11], s20 offen nt lds
  v_mfma_f32_16x16x32_bf16 v[204:207], a[100:103], a[220:223], v[204:207]
  v_exp_f32 v198, v198
  v_mfma_f32_16x16x32_bf16 v[204:207], a[96:99], a[216:219], v[204:207]
  v_exp_f32 v199, v199
  v_mfma_f32_16x16x32_bf16 v[96:99], a[144:147], v[208:211], v[96:99]
  v_fma_f32 v200, v200, s22, v229
  v_fma_f32 v201, v201, s22, v229
  v_mfma_f32_16x16x32_bf16 v[144:147], a[144:147], v[216:219], v[144:147]
  v_fma_f32 v202, v202, s22, v229
  v_fma_f32 v203, v203, s22, v229
  v_mfma_f32_16x16x32_bf16 v[148:151], a[148:151], v[216:219], v[148:151]
  buffer_load_dwordx4 v243, s[8:11], s20 offen offset:1024 nt lds
  v_mfma_f32_16x16x32_bf16 v[100:103], a[148:151], v[208:211], v[100:103]
  v_exp_f32 v200, v200
  v_mfma_f32_16x16x32_bf16 v[104:107], a[152:155], v[208:211], v[104:107]
  v_exp_f32 v201, v201
  v_mfma_f32_16x16x32_bf16 v[152:155], a[152:155], v[216:219], v[152:155]
  v_exp_f32 v202, v202
  v_mfma_f32_16x16x32_bf16 v[156:159], a[156:159], v[216:219], v[156:159]
  v_exp_f32 v203, v203
  v_mfma_f32_16x16x32_bf16 v[108:111], a[156:159], v[208:211], v[108:111]
  buffer_load_dwordx4 v244, s[8:11], s20 offen offset:2048 nt lds
  v_mfma_f32_16x16x32_bf16 v[112:115], a[160:163], v[208:211], v[112:115]
L_pg11:
  s_cbranch_execz L_pg15
  v_fma_f32 v204, v204, s22, v229
  v_fma_f32 v205, v205, s22, v229
  v_mfma_f32_16x16x32_bf16 v[160:163], a[160:163], v[216:219], v[160:163]
  v_fma_f32 v206, v206, s22, v229
  v_fma_f32 v207, v207, s22, v229
  v_mfma_f32_16x16x32_bf16 v[164:167], a[164:167], v[216:219], v[164:167]
  v_exp_f32 v204, v204
  v_mfma_f32_16x16x32_bf16 v[116:119], a[164:167], v[208:211], v[116:119]
  v_exp_f32 v205, v205
  v_mfma_f32_16x16x32_bf16 v[120:123], a[168:171], v[208:211], v[120:123]
  ds_read_b64_tr_b16 a[144:145], v238 offset:12288
  v_add_f32 v224, v224, v192
  v_mfma_f32_16x16x32_bf16 v[168:171], a[168:171], v[216:219], v[168:171]
  ds_read_b64_tr_b16 a[146:147], v238 offset:18432
  v_add_f32 v224, v224, v193
  v_mfma_f32_16x16x32_bf16 v[172:175], a[172:175], v[216:219], v[172:175]
  v_exp_f32 v206, v206
  v_mfma_f32_16x16x32_bf16 v[124:127], a[172:175], v[208:211], v[124:127]
  ds_read_b64_tr_b16 a[148:149], v239 offset:12288
  v_add_f32 v224, v224, v194
  v_mfma_f32_16x16x32_bf16 v[128:131], a[176:179], v[208:211], v[128:131]
  ds_read_b64_tr_b16 a[150:151], v239 offset:18432
  v_add_f32 v224, v224, v195
  v_mfma_f32_16x16x32_bf16 v[176:179], a[176:179], v[216:219], v[176:179]
  v_exp_f32 v207, v207
  v_mfma_f32_16x16x32_bf16 v[180:183], a[180:183], v[216:219], v[180:183]
  ds_read_b64_tr_b16 a[152:153], v240 offset:12288
  v_cvt_pk_bf16_f32 v192, v192, v193
  v_mfma_f32_16x16x32_bf16 v[132:135], a[180:183], v[208:211], v[132:135]
  ds_read_b64_tr_b16 a[154:155], v240 offset:18432
  v_cvt_pk_bf16_f32 v193, v194, v195
  v_mfma_f32_16x16x32_bf16 v[136:139], a[184:187], v[208:211], v[136:139]
  buffer_store_dwordx4 a[24:27], v246, s[16:19], s94 offen sc0 sc1 nt
  ds_read_b128 a[32:35], v253 offset:6144
  v_add_f32 v224, v224, v196
  v_add_f32 v224, v224, v197
  v_mfma_f32_16x16x32_bf16 v[184:187], a[184:187], v[216:219], v[184:187]
  ds_read_b64_tr_b16 a[156:157], v241 offset:12288
  v_add_f32 v224, v224, v198
  v_mfma_f32_16x16x32_bf16 v[188:191], a[188:191], v[216:219], v[188:191]
  ds_read_b64_tr_b16 a[158:159], v241 offset:18432
  v_add_f32 v224, v224, v199
  v_mfma_f32_16x16x32_bf16 v[140:143], a[188:191], v[208:211], v[140:143]
  v_cvt_pk_bf16_f32 v194, v196, v197
  v_cvt_pk_bf16_f32 v195, v198, v199
  v_mfma_f32_16x16x32_bf16 v[208:211], a[96:99], a[48:51], v[232:235]
  ds_read_b64_tr_b16 a[160:161], v238 offset:12416
  v_add_f32 v225, v225, v200
  v_mfma_f32_16x16x32_bf16 v[208:211], a[100:103], a[52:55], v[208:211]
  ds_read_b64_tr_b16 a[162:163], v238 offset:18560
  v_add_f32 v225, v225, v201
  v_mfma_f32_16x16x32_bf16 v[208:211], a[104:107], a[56:59], v[208:211]
  v_add_f32 v225, v225, v202
  v_add_f32 v225, v225, v203
  v_mfma_f32_16x16x32_bf16 v[208:211], a[108:111], a[60:63], v[208:211]
  ds_read_b64_tr_b16 a[164:165], v239 offset:12416
  v_cvt_pk_bf16_f32 v203, v202, v203
  v_mfma_f32_16x16x32_bf16 v[208:211], a[112:115], a[64:67], v[208:211]
  ds_read_b64_tr_b16 a[166:167], v239 offset:18560
  v_cvt_pk_bf16_f32 v202, v200, v201
  v_mfma_f32_16x16x32_bf16 v[208:211], a[116:119], a[68:71], v[208:211]
  v_add_f32 v225, v225, v204
  v_add_f32 v225, v225, v205
  v_mfma_f32_16x16x32_bf16 v[212:215], a[140:143], a[68:71], v[232:235]
  ds_read_b64_tr_b16 a[168:169], v240 offset:12416
  v_add_f32 v225, v225, v206
  v_mfma_f32_16x16x32_bf16 v[212:215], a[136:139], a[64:67], v[212:215]
  ds_read_b64_tr_b16 a[170:171], v240 offset:18560
  v_add_f32 v225, v225, v207
  v_mfma_f32_16x16x32_bf16 v[212:215], a[132:135], a[60:63], v[212:215]
  v_cvt_pk_bf16_f32 v200, v204, v205
  v_cvt_pk_bf16_f32 v201, v206, v207
  v_mfma_f32_16x16x32_bf16 v[212:215], a[128:131], a[56:59], v[212:215]
  ds_read_b64_tr_b16 a[172:173], v241 offset:12416
  v_fma_f32 v208, v208, s22, v230
  v_mfma_f32_16x16x32_bf16 v[212:215], a[124:127], a[52:55], v[212:215]
  ds_read_b64_tr_b16 a[174:175], v241 offset:18560
  v_fma_f32 v209, v209, s22, v230
  v_mfma_f32_16x16x32_bf16 v[212:215], a[120:123], a[48:51], v[212:215]
  v_exp_f32 v208, v208
  v_mfma_f32_16x16x32_bf16 v[216:219], a[120:123], a[72:75], v[232:235]
  ds_read_b64_tr_b16 a[176:177], v238 offset:12544
  v_fma_f32 v210, v210, s22, v230
  v_mfma_f32_16x16x32_bf16 v[216:219], a[124:127], a[76:79], v[216:219]
  ds_read_b64_tr_b16 a[178:179], v238 offset:18688
  v_fma_f32 v211, v211, s22, v230
  v_mfma_f32_16x16x32_bf16 v[216:219], a[128:131], a[80:83], v[216:219]
  buffer_store_dwordx4 a[28:31], v246, s[16:19], s94 offen offset:1024 sc0 sc1 nt
  ds_read_b128 a[36:39], v251 offset:9216
  v_exp_f32 v209, v209
  v_mfma_f32_16x16x32_bf16 v[216:219], a[132:135], a[84:87], v[216:219]
  ds_read_b64_tr_b16 a[180:181], v239 offset:12544
  v_fma_f32 v212, v212, s22, v230
  v_mfma_f32_16x16x32_bf16 v[216:219], a[136:139], a[88:91], v[216:219]
  ds_read_b64_tr_b16 a[182:183], v239 offset:18688
  v_fma_f32 v213, v213, s22, v230
  v_mfma_f32_16x16x32_bf16 v[216:219], a[140:143], a[92:95], v[216:219]
  v_exp_f32 v210, v210
  v_mfma_f32_16x16x32_bf16 v[220:223], a[116:119], a[92:95], v[232:235]
  ds_read_b64_tr_b16 a[184:185], v240 offset:12544
  v_fma_f32 v214, v214, s22, v230
  v_mfma_f32_16x16x32_bf16 v[220:223], a[112:115], a[88:91], v[220:223]
  ds_read_b64_tr_b16 a[186:187], v240 offset:18688
  v_fma_f32 v215, v215, s22, v230
  v_mfma_f32_16x16x32_bf16 v[220:223], a[108:111], a[84:87], v[220:223]
  v_exp_f32 v211, v211
  v_mfma_f32_16x16x32_bf16 v[220:223], a[104:107], a[80:83], v[220:223]
  ds_read_b64_tr_b16 a[188:189], v241 offset:12544
  v_fma_f32 v216, v216, s22, v231
  v_mfma_f32_16x16x32_bf16 v[220:223], a[100:103], a[76:79], v[220:223]
  ds_read_b64_tr_b16 a[190:191], v241 offset:18688
  v_fma_f32 v217, v217, s22, v231
  v_mfma_f32_16x16x32_bf16 v[220:223], a[96:99], a[72:75], v[220:223]
  s_waitcnt lgkmcnt(5)
  v_exp_f32 v212, v212
  v_mfma_f32_16x16x32_bf16 v[0:3], a[144:147], v[192:195], v[0:3]
  ds_read_b128 a[96:99], v236 offset:36864
  v_fma_f32 v218, v218, s22, v231
  v_mfma_f32_16x16x32_bf16 v[48:51], a[144:147], v[200:203], v[48:51]
  v_exp_f32 v213, v213
  v_mfma_f32_16x16x32_bf16 v[52:55], a[148:151], v[200:203], v[52:55]
  ds_read_b128 a[100:103], v237 offset:36864
  v_fma_f32 v219, v219, s22, v231
  v_mfma_f32_16x16x32_bf16 v[4:7], a[148:151], v[192:195], v[4:7]
  v_exp_f32 v214, v214
  v_mfma_f32_16x16x32_bf16 v[8:11], a[152:155], v[192:195], v[8:11]
  ds_read_b128 a[104:107], v236 offset:36992
  v_fma_f32 v220, v220, s22, v231
  v_mfma_f32_16x16x32_bf16 v[56:59], a[152:155], v[200:203], v[56:59]
  v_exp_f32 v215, v215
  v_mfma_f32_16x16x32_bf16 v[60:63], a[156:159], v[200:203], v[60:63]
  ds_read_b128 a[108:111], v237 offset:36992
  v_fma_f32 v221, v221, s22, v231
  v_mfma_f32_16x16x32_bf16 v[12:15], a[156:159], v[192:195], v[12:15]
  v_exp_f32 v216, v216
  v_mfma_f32_16x16x32_bf16 v[16:19], a[160:163], v[192:195], v[16:19]
  ds_read_b128 a[112:115], v236 offset:37120
  v_fma_f32 v222, v222, s22, v231
  v_mfma_f32_16x16x32_bf16 v[64:67], a[160:163], v[200:203], v[64:67]
  v_exp_f32 v217, v217
  v_mfma_f32_16x16x32_bf16 v[68:71], a[164:167], v[200:203], v[68:71]
  ds_read_b128 a[116:119], v237 offset:37120
  v_fma_f32 v223, v223, s22, v231
  v_mfma_f32_16x16x32_bf16 v[20:23], a[164:167], v[192:195], v[20:23]
  v_exp_f32 v218, v218
  v_mfma_f32_16x16x32_bf16 v[24:27], a[168:171], v[192:195], v[24:27]
  ds_read_b128 a[140:143], v237 offset:43264
  v_add_f32 v226, v226, v208
  v_mfma_f32_16x16x32_bf16 v[72:75], a[168:171], v[200:203], v[72:75]
  v_exp_f32 v219, v219
  v_mfma_f32_16x16x32_bf16 v[76:79], a[172:175], v[200:203], v[76:79]
  ds_read_b128 a[136:139], v236 offset:43264
  v_add_f32 v226, v226, v209
  v_mfma_f32_16x16x32_bf16 v[28:31], a[172:175], v[192:195], v[28:31]
  v_exp_f32 v220, v220
  v_mfma_f32_16x16x32_bf16 v[32:35], a[176:179], v[192:195], v[32:35]
  ds_read_b128 a[132:135], v237 offset:43136
  v_add_f32 v226, v226, v210
  v_mfma_f32_16x16x32_bf16 v[80:83], a[176:179], v[200:203], v[80:83]
  s_waitcnt lgkmcnt(4)
  v_exp_f32 v221, v221
  v_mfma_f32_16x16x32_bf16 v[84:87], a[180:183], v[200:203], v[84:87]
  ds_read_b128 a[128:131], v236 offset:43136
  v_add_f32 v226, v226, v211
  v_mfma_f32_16x16x32_bf16 v[36:39], a[180:183], v[192:195], v[36:39]
  v_exp_f32 v222, v222
  v_mfma_f32_16x16x32_bf16 v[40:43], a[184:187], v[192:195], v[40:43]
  ds_read_b128 a[124:127], v237 offset:43008
  v_add_f32 v226, v226, v212
  v_mfma_f32_16x16x32_bf16 v[88:91], a[184:187], v[200:203], v[88:91]
  v_exp_f32 v223, v223
  v_mfma_f32_16x16x32_bf16 v[92:95], a[188:191], v[200:203], v[92:95]
  ds_read_b128 a[120:123], v236 offset:43008
  v_add_f32 v226, v226, v213
  v_mfma_f32_16x16x32_bf16 v[44:47], a[188:191], v[192:195], v[44:47]
  v_add_f32 v226, v226, v214
  v_add_f32 v226, v226, v215
  v_mfma_f32_16x16x32_bf16 v[192:195], a[96:99], a[192:195], v[232:235]
  v_cvt_pk_bf16_f32 v208, v208, v209
  v_cvt_pk_bf16_f32 v209, v210, v211
  v_mfma_f32_16x16x32_bf16 v[192:195], a[100:103], a[196:199], v[192:195]
  v_cvt_pk_bf16_f32 v210, v212, v213
  v_cvt_pk_bf16_f32 v211, v214, v215
  v_mfma_f32_16x16x32_bf16 v[192:195], a[104:107], a[200:203], v[192:195]
  v_add_f32 v227, v227, v216
  v_add_f32 v227, v227, v217
  v_mfma_f32_16x16x32_bf16 v[192:195], a[108:111], a[204:207], v[192:195]
  s_waitcnt vmcnt(18) lgkmcnt(0)
  v_add_f32 v227, v227, v218
  v_add_f32 v227, v227, v219
  v_mfma_f32_16x16x32_bf16 v[192:195], a[112:115], a[208:211], v[192:195]
  s_barrier
  v_add_f32 v227, v227, v220
  v_add_f32 v227, v227, v221
  v_mfma_f32_16x16x32_bf16 v[192:195], a[116:119], a[212:215], v[192:195]
  s_add_u32 m0, s21, 73728
  v_add_f32 v227, v227, v222
  v_add_f32 v227, v227, v223
  v_mfma_f32_16x16x32_bf16 v[196:199], a[140:143], a[212:215], v[232:235]
  buffer_load_dwordx4 v242, s[12:15], s20 offen nt lds
  v_mfma_f32_16x16x32_bf16 v[196:199], a[136:139], a[208:211], v[196:199]
  v_cvt_pk_bf16_f32 v219, v218, v219
  v_cvt_pk_bf16_f32 v218, v216, v217
  v_mfma_f32_16x16x32_bf16 v[196:199], a[132:135], a[204:207], v[196:199]
  v_cvt_pk_bf16_f32 v216, v220, v221
  v_cvt_pk_bf16_f32 v217, v222, v223
  v_mfma_f32_16x16x32_bf16 v[196:199], a[128:131], a[200:203], v[196:199]
  v_fma_f32 v192, v192, s22, v228
  v_fma_f32 v193, v193, s22, v228
  v_mfma_f32_16x16x32_bf16 v[196:199], a[124:127], a[196:199], v[196:199]
  v_fma_f32 v194, v194, s22, v228
  v_fma_f32 v195, v195, s22, v228
  v_mfma_f32_16x16x32_bf16 v[196:199], a[120:123], a[192:195], v[196:199]
  buffer_load_dwordx4 v243, s[12:15], s20 offen offset:1024 nt lds
  v_mfma_f32_16x16x32_bf16 v[200:203], a[120:123], a[216:219], v[232:235]
  v_exp_f32 v192, v192
  v_mfma_f32_16x16x32_bf16 v[200:203], a[124:127], a[220:223], v[200:203]
  v_exp_f32 v193, v193
  v_mfma_f32_16x16x32_bf16 v[200:203], a[128:131], a[224:227], v[200:203]
  v_exp_f32 v194, v194
  v_mfma_f32_16x16x32_bf16 v[200:203], a[132:135], a[228:231], v[200:203]
  v_exp_f32 v195, v195
  v_mfma_f32_16x16x32_bf16 v[200:203], a[136:139], a[232:235], v[200:203]
  buffer_load_dwordx4 v244, s[12:15], s20 offen offset:2048 nt lds
  v_mfma_f32_16x16x32_bf16 v[200:203], a[140:143], a[236:239], v[200:203]
  v_fma_f32 v196, v196, s22, v228
  v_fma_f32 v197, v197, s22, v228
  v_mfma_f32_16x16x32_bf16 v[204:207], a[116:119], a[236:239], v[232:235]
  v_fma_f32 v198, v198, s22, v228
  v_fma_f32 v199, v199, s22, v228
  v_mfma_f32_16x16x32_bf16 v[204:207], a[112:115], a[232:235], v[204:207]
  s_add_u32 s20, s20, 12288
  v_exp_f32 v196, v196
  v_mfma_f32_16x16x32_bf16 v[204:207], a[108:111], a[228:231], v[204:207]
  s_add_u32 m0, s21, 36864
  v_exp_f32 v197, v197
  v_mfma_f32_16x16x32_bf16 v[204:207], a[104:107], a[224:227], v[204:207]
  buffer_load_dwordx4 v242, s[8:11], s20 offen nt lds
  v_mfma_f32_16x16x32_bf16 v[204:207], a[100:103], a[220:223], v[204:207]
  v_exp_f32 v198, v198
  v_mfma_f32_16x16x32_bf16 v[204:207], a[96:99], a[216:219], v[204:207]
  v_exp_f32 v199, v199
  v_mfma_f32_16x16x32_bf16 v[96:99], a[144:147], v[208:211], v[96:99]
  v_fma_f32 v200, v200, s22, v229
  v_fma_f32 v201, v201, s22, v229
  v_mfma_f32_16x16x32_bf16 v[144:147], a[144:147], v[216:219], v[144:147]
  v_fma_f32 v202, v202, s22, v229
  v_fma_f32 v203, v203, s22, v229
  v_mfma_f32_16x16x32_bf16 v[148:151], a[148:151], v[216:219], v[148:151]
  buffer_load_dwordx4 v243, s[8:11], s20 offen offset:1024 nt lds
  v_mfma_f32_16x16x32_bf16 v[100:103], a[148:151], v[208:211], v[100:103]
  v_exp_f32 v200, v200
  v_mfma_f32_16x16x32_bf16 v[104:107], a[152:155], v[208:211], v[104:107]
  v_exp_f32 v201, v201
  v_mfma_f32_16x16x32_bf16 v[152:155], a[152:155], v[216:219], v[152:155]
  v_exp_f32 v202, v202
  v_mfma_f32_16x16x32_bf16 v[156:159], a[156:159], v[216:219], v[156:159]
  v_exp_f32 v203, v203
  v_mfma_f32_16x16x32_bf16 v[108:111], a[156:159], v[208:211], v[108:111]
  buffer_load_dwordx4 v244, s[8:11], s20 offen offset:2048 nt lds
  v_mfma_f32_16x16x32_bf16 v[112:115], a[160:163], v[208:211], v[112:115]
  v_fma_f32 v204, v204, s22, v229
  v_fma_f32 v205, v205, s22, v229
  v_mfma_f32_16x16x32_bf16 v[160:163], a[160:163], v[216:219], v[160:163]
  v_fma_f32 v206, v206, s22, v229
  v_fma_f32 v207, v207, s22, v229
  v_mfma_f32_16x16x32_bf16 v[164:167], a[164:167], v[216:219], v[164:167]
  v_exp_f32 v204, v204
  v_mfma_f32_16x16x32_bf16 v[116:119], a[164:167], v[208:211], v[116:119]
  v_exp_f32 v205, v205
  v_mfma_f32_16x16x32_bf16 v[120:123], a[168:171], v[208:211], v[120:123]
  ds_read_b64_tr_b16 a[144:145], v238 offset:0
  v_add_f32 v224, v224, v192
  v_mfma_f32_16x16x32_bf16 v[168:171], a[168:171], v[216:219], v[168:171]
  ds_read_b64_tr_b16 a[146:147], v238 offset:6144
  v_add_f32 v224, v224, v193
  v_mfma_f32_16x16x32_bf16 v[172:175], a[172:175], v[216:219], v[172:175]
  v_exp_f32 v206, v206
  v_mfma_f32_16x16x32_bf16 v[124:127], a[172:175], v[208:211], v[124:127]
  ds_read_b64_tr_b16 a[148:149], v239 offset:0
  v_add_f32 v224, v224, v194
  v_mfma_f32_16x16x32_bf16 v[128:131], a[176:179], v[208:211], v[128:131]
  ds_read_b64_tr_b16 a[150:151], v239 offset:6144
  v_add_f32 v224, v224, v195
  v_mfma_f32_16x16x32_bf16 v[176:179], a[176:179], v[216:219], v[176:179]
  v_exp_f32 v207, v207
  v_mfma_f32_16x16x32_bf16 v[180:183], a[180:183], v[216:219], v[180:183]
  ds_read_b64_tr_b16 a[152:153], v240 offset:0
  v_cvt_pk_bf16_f32 v192, v192, v193
  v_mfma_f32_16x16x32_bf16 v[132:135], a[180:183], v[208:211], v[132:135]
  ds_read_b64_tr_b16 a[154:155], v240 offset:6144
  v_cvt_pk_bf16_f32 v193, v194, v195
  v_mfma_f32_16x16x32_bf16 v[136:139], a[184:187], v[208:211], v[136:139]
  buffer_store_dwordx4 a[32:35], v246, s[16:19], s94 offen offset:2048 sc0 sc1 nt
  ds_read_b128 a[40:43], v252 offset:9216
  v_add_f32 v224, v224, v196
  v_add_f32 v224, v224, v197
  v_mfma_f32_16x16x32_bf16 v[184:187], a[184:187], v[216:219], v[184:187]
  ds_read_b64_tr_b16 a[156:157], v241 offset:0
  v_add_f32 v224, v224, v198
  v_mfma_f32_16x16x32_bf16 v[188:191], a[188:191], v[216:219], v[188:191]
  ds_read_b64_tr_b16 a[158:159], v241 offset:6144
  v_add_f32 v224, v224, v199
  v_mfma_f32_16x16x32_bf16 v[140:143], a[188:191], v[208:211], v[140:143]
  v_cvt_pk_bf16_f32 v194, v196, v197
  v_cvt_pk_bf16_f32 v195, v198, v199
  v_mfma_f32_16x16x32_bf16 v[208:211], a[96:99], a[48:51], v[232:235]
  ds_read_b64_tr_b16 a[160:161], v238 offset:128
  v_add_f32 v225, v225, v200
  v_mfma_f32_16x16x32_bf16 v[208:211], a[100:103], a[52:55], v[208:211]
  ds_read_b64_tr_b16 a[162:163], v238 offset:6272
  v_add_f32 v225, v225, v201
  v_mfma_f32_16x16x32_bf16 v[208:211], a[104:107], a[56:59], v[208:211]
  v_add_f32 v225, v225, v202
  v_add_f32 v225, v225, v203
  v_mfma_f32_16x16x32_bf16 v[208:211], a[108:111], a[60:63], v[208:211]
  ds_read_b64_tr_b16 a[164:165], v239 offset:128
  v_cvt_pk_bf16_f32 v203, v202, v203
  v_mfma_f32_16x16x32_bf16 v[208:211], a[112:115], a[64:67], v[208:211]
  ds_read_b64_tr_b16 a[166:167], v239 offset:6272
  v_cvt_pk_bf16_f32 v202, v200, v201
  v_mfma_f32_16x16x32_bf16 v[208:211], a[116:119], a[68:71], v[208:211]
  v_add_f32 v225, v225, v204
  v_add_f32 v225, v225, v205
  v_mfma_f32_16x16x32_bf16 v[212:215], a[140:143], a[68:71], v[232:235]
  ds_read_b64_tr_b16 a[168:169], v240 offset:128
  v_add_f32 v225, v225, v206
  v_mfma_f32_16x16x32_bf16 v[212:215], a[136:139], a[64:67], v[212:215]
  ds_read_b64_tr_b16 a[170:171], v240 offset:6272
  v_add_f32 v225, v225, v207
  v_mfma_f32_16x16x32_bf16 v[212:215], a[132:135], a[60:63], v[212:215]
  v_cvt_pk_bf16_f32 v200, v204, v205
  v_cvt_pk_bf16_f32 v201, v206, v207
  v_mfma_f32_16x16x32_bf16 v[212:215], a[128:131], a[56:59], v[212:215]
  ds_read_b64_tr_b16 a[172:173], v241 offset:128
  v_fma_f32 v208, v208, s22, v230
  v_mfma_f32_16x16x32_bf16 v[212:215], a[124:127], a[52:55], v[212:215]
  ds_read_b64_tr_b16 a[174:175], v241 offset:6272
  v_fma_f32 v209, v209, s22, v230
  v_mfma_f32_16x16x32_bf16 v[212:215], a[120:123], a[48:51], v[212:215]
  v_exp_f32 v208, v208
  v_mfma_f32_16x16x32_bf16 v[216:219], a[120:123], a[72:75], v[232:235]
  ds_read_b64_tr_b16 a[176:177], v238 offset:256
  v_fma_f32 v210, v210, s22, v230
  v_mfma_f32_16x16x32_bf16 v[216:219], a[124:127], a[76:79], v[216:219]
  ds_read_b64_tr_b16 a[178:179], v238 offset:6400
  v_fma_f32 v211, v211, s22, v230
  v_mfma_f32_16x16x32_bf16 v[216:219], a[128:131], a[80:83], v[216:219]
  buffer_store_dwordx4 a[36:39], v246, s[16:19], s95 offen sc0 sc1 nt
  ds_read_b128 a[44:47], v253 offset:9216
  v_exp_f32 v209, v209
  v_mfma_f32_16x16x32_bf16 v[216:219], a[132:135], a[84:87], v[216:219]
  ds_read_b64_tr_b16 a[180:181], v239 offset:256
  v_fma_f32 v212, v212, s22, v230
  v_mfma_f32_16x16x32_bf16 v[216:219], a[136:139], a[88:91], v[216:219]
  ds_read_b64_tr_b16 a[182:183], v239 offset:6400
  v_fma_f32 v213, v213, s22, v230
  v_mfma_f32_16x16x32_bf16 v[216:219], a[140:143], a[92:95], v[216:219]
  v_exp_f32 v210, v210
  v_mfma_f32_16x16x32_bf16 v[220:223], a[116:119], a[92:95], v[232:235]
  ds_read_b64_tr_b16 a[184:185], v240 offset:256
  v_fma_f32 v214, v214, s22, v230
  v_mfma_f32_16x16x32_bf16 v[220:223], a[112:115], a[88:91], v[220:223]
  ds_read_b64_tr_b16 a[186:187], v240 offset:6400
  v_fma_f32 v215, v215, s22, v230
  v_mfma_f32_16x16x32_bf16 v[220:223], a[108:111], a[84:87], v[220:223]
  v_exp_f32 v211, v211
  v_mfma_f32_16x16x32_bf16 v[220:223], a[104:107], a[80:83], v[220:223]
  ds_read_b64_tr_b16 a[188:189], v241 offset:256
  v_fma_f32 v216, v216, s22, v231
  v_mfma_f32_16x16x32_bf16 v[220:223], a[100:103], a[76:79], v[220:223]
  ds_read_b64_tr_b16 a[190:191], v241 offset:6400
  v_fma_f32 v217, v217, s22, v231
  v_mfma_f32_16x16x32_bf16 v[220:223], a[96:99], a[72:75], v[220:223]
  s_waitcnt lgkmcnt(5)
  v_exp_f32 v212, v212
  v_mfma_f32_16x16x32_bf16 v[0:3], a[144:147], v[192:195], v[0:3]
  ds_read_b128 a[96:99], v236 offset:0
  v_fma_f32 v218, v218, s22, v231
  v_mfma_f32_16x16x32_bf16 v[48:51], a[144:147], v[200:203], v[48:51]
  v_exp_f32 v213, v213
  v_mfma_f32_16x16x32_bf16 v[52:55], a[148:151], v[200:203], v[52:55]
  ds_read_b128 a[100:103], v237 offset:0
  v_fma_f32 v219, v219, s22, v231
  v_mfma_f32_16x16x32_bf16 v[4:7], a[148:151], v[192:195], v[4:7]
  v_exp_f32 v214, v214
  v_mfma_f32_16x16x32_bf16 v[8:11], a[152:155], v[192:195], v[8:11]
  ds_read_b128 a[104:107], v236 offset:128
  v_fma_f32 v220, v220, s22, v231
  v_mfma_f32_16x16x32_bf16 v[56:59], a[152:155], v[200:203], v[56:59]
  v_exp_f32 v215, v215
  v_mfma_f32_16x16x32_bf16 v[60:63], a[156:159], v[200:203], v[60:63]
  ds_read_b128 a[108:111], v237 offset:128
  v_fma_f32 v221, v221, s22, v231
  v_mfma_f32_16x16x32_bf16 v[12:15], a[156:159], v[192:195], v[12:15]
  v_exp_f32 v216, v216
  v_mfma_f32_16x16x32_bf16 v[16:19], a[160:163], v[192:195], v[16:19]
  ds_read_b128 a[112:115], v236 offset:256
  v_fma_f32 v222, v222, s22, v231
  v_mfma_f32_16x16x32_bf16 v[64:67], a[160:163], v[200:203], v[64:67]
  v_exp_f32 v217, v217
  v_mfma_f32_16x16x32_bf16 v[68:71], a[164:167], v[200:203], v[68:71]
  ds_read_b128 a[116:119], v237 offset:256
  v_fma_f32 v223, v223, s22, v231
  v_mfma_f32_16x16x32_bf16 v[20:23], a[164:167], v[192:195], v[20:23]
  v_exp_f32 v218, v218
  v_mfma_f32_16x16x32_bf16 v[24:27], a[168:171], v[192:195], v[24:27]
  ds_read_b128 a[140:143], v237 offset:6400
  v_add_f32 v226, v226, v208
  v_mfma_f32_16x16x32_bf16 v[72:75], a[168:171], v[200:203], v[72:75]
  v_exp_f32 v219, v219
  v_mfma_f32_16x16x32_bf16 v[76:79], a[172:175], v[200:203], v[76:79]
  ds_read_b128 a[136:139], v236 offset:6400
  v_add_f32 v226, v226, v209
  v_mfma_f32_16x16x32_bf16 v[28:31], a[172:175], v[192:195], v[28:31]
  v_exp_f32 v220, v220
  v_mfma_f32_16x16x32_bf16 v[32:35], a[176:179], v[192:195], v[32:35]
  ds_read_b128 a[132:135], v237 offset:6272
  v_add_f32 v226, v226, v210
  v_mfma_f32_16x16x32_bf16 v[80:83], a[176:179], v[200:203], v[80:83]
  s_waitcnt lgkmcnt(4)
  v_exp_f32 v221, v221
  v_mfma_f32_16x16x32_bf16 v[84:87], a[180:183], v[200:203], v[84:87]
  ds_read_b128 a[128:131], v236 offset:6272
  v_add_f32 v226, v226, v211
  v_mfma_f32_16x16x32_bf16 v[36:39], a[180:183], v[192:195], v[36:39]
  v_exp_f32 v222, v222
  v_mfma_f32_16x16x32_bf16 v[40:43], a[184:187], v[192:195], v[40:43]
  ds_read_b128 a[124:127], v237 offset:6144
  v_add_f32 v226, v226, v212
  v_mfma_f32_16x16x32_bf16 v[88:91], a[184:187], v[200:203], v[88:91]
  v_exp_f32 v223, v223
  v_mfma_f32_16x16x32_bf16 v[92:95], a[188:191], v[200:203], v[92:95]
  ds_read_b128 a[120:123], v236 offset:6144
  v_add_f32 v226, v226, v213
  v_mfma_f32_16x16x32_bf16 v[44:47], a[188:191], v[192:195], v[44:47]
  v_add_f32 v226, v226, v214
  v_add_f32 v226, v226, v215
  v_mfma_f32_16x16x32_bf16 v[192:195], a[96:99], a[192:195], v[232:235]
  v_cvt_pk_bf16_f32 v208, v208, v209
  v_cvt_pk_bf16_f32 v209, v210, v211
  v_mfma_f32_16x16x32_bf16 v[192:195], a[100:103], a[196:199], v[192:195]
  v_cvt_pk_bf16_f32 v210, v212, v213
  v_cvt_pk_bf16_f32 v211, v214, v215
  v_mfma_f32_16x16x32_bf16 v[192:195], a[104:107], a[200:203], v[192:195]
  v_add_f32 v227, v227, v216
  v_add_f32 v227, v227, v217
  v_mfma_f32_16x16x32_bf16 v[192:195], a[108:111], a[204:207], v[192:195]
  s_waitcnt vmcnt(18) lgkmcnt(0)
  v_add_f32 v227, v227, v218
  v_add_f32 v227, v227, v219
  v_mfma_f32_16x16x32_bf16 v[192:195], a[112:115], a[208:211], v[192:195]
  s_barrier
  v_add_f32 v227, v227, v220
  v_add_f32 v227, v227, v221
  v_mfma_f32_16x16x32_bf16 v[192:195], a[116:119], a[212:215], v[192:195]
  s_add_u32 m0, s21, 61440
  v_add_f32 v227, v227, v222
  v_add_f32 v227, v227, v223
  v_mfma_f32_16x16x32_bf16 v[196:199], a[140:143], a[212:215], v[232:235]
  buffer_load_dwordx4 v242, s[12:15], s20 offen nt lds
  v_mfma_f32_16x16x32_bf16 v[196:199], a[136:139], a[208:211], v[196:199]
  v_cvt_pk_bf16_f32 v219, v218, v219
  v_cvt_pk_bf16_f32 v218, v216, v217
  v_mfma_f32_16x16x32_bf16 v[196:199], a[132:135], a[204:207], v[196:199]
  v_cvt_pk_bf16_f32 v216, v220, v221
  v_cvt_pk_bf16_f32 v217, v222, v223
  v_mfma_f32_16x16x32_bf16 v[196:199], a[128:131], a[200:203], v[196:199]
  v_fma_f32 v192, v192, s22, v228
  v_fma_f32 v193, v193, s22, v228
  v_mfma_f32_16x16x32_bf16 v[196:199], a[124:127], a[196:199], v[196:199]
  v_fma_f32 v194, v194, s22, v228
  v_fma_f32 v195, v195, s22, v228
  v_mfma_f32_16x16x32_bf16 v[196:199], a[120:123], a[192:195], v[196:199]
  buffer_load_dwordx4 v243, s[12:15], s20 offen offset:1024 nt lds
  v_mfma_f32_16x16x32_bf16 v[200:203], a[120:123], a[216:219], v[232:235]
  v_exp_f32 v192, v192
  v_mfma_f32_16x16x32_bf16 v[200:203], a[124:127], a[220:223], v[200:203]
  v_exp_f32 v193, v193
  v_mfma_f32_16x16x32_bf16 v[200:203], a[128:131], a[224:227], v[200:203]
  v_exp_f32 v194, v194
  v_mfma_f32_16x16x32_bf16 v[200:203], a[132:135], a[228:231], v[200:203]
  v_exp_f32 v195, v195
  v_mfma_f32_16x16x32_bf16 v[200:203], a[136:139], a[232:235], v[200:203]
  buffer_load_dwordx4 v244, s[12:15], s20 offen offset:2048 nt lds
  v_mfma_f32_16x16x32_bf16 v[200:203], a[140:143], a[236:239], v[200:203]
  v_fma_f32 v196, v196, s22, v228
  v_fma_f32 v197, v197, s22, v228
  v_mfma_f32_16x16x32_bf16 v[204:207], a[116:119], a[236:239], v[232:235]
  v_fma_f32 v198, v198, s22, v228
  v_fma_f32 v199, v199, s22, v228
  v_mfma_f32_16x16x32_bf16 v[204:207], a[112:115], a[232:235], v[204:207]
  s_add_u32 s20, s20, 12288
  v_exp_f32 v196, v196
  v_mfma_f32_16x16x32_bf16 v[204:207], a[108:111], a[228:231], v[204:207]
  s_add_u32 m0, s21, 0
  v_exp_f32 v197, v197
  v_mfma_f32_16x16x32_bf16 v[204:207], a[104:107], a[224:227], v[204:207]
  buffer_load_dwordx4 v242, s[8:11], s20 offen nt lds
  v_mfma_f32_16x16x32_bf16 v[204:207], a[100:103], a[220:223], v[204:207]
  v_exp_f32 v198, v198
  v_mfma_f32_16x16x32_bf16 v[204:207], a[96:99], a[216:219], v[204:207]
  v_exp_f32 v199, v199
  v_mfma_f32_16x16x32_bf16 v[96:99], a[144:147], v[208:211], v[96:99]
  v_fma_f32 v200, v200, s22, v229
  v_fma_f32 v201, v201, s22, v229
  v_mfma_f32_16x16x32_bf16 v[144:147], a[144:147], v[216:219], v[144:147]
  v_fma_f32 v202, v202, s22, v229
  v_fma_f32 v203, v203, s22, v229
  v_mfma_f32_16x16x32_bf16 v[148:151], a[148:151], v[216:219], v[148:151]
  buffer_load_dwordx4 v243, s[8:11], s20 offen offset:1024 nt lds
  v_mfma_f32_16x16x32_bf16 v[100:103], a[148:151], v[208:211], v[100:103]
  v_exp_f32 v200, v200
  v_mfma_f32_16x16x32_bf16 v[104:107], a[152:155], v[208:211], v[104:107]
  v_exp_f32 v201, v201
  v_mfma_f32_16x16x32_bf16 v[152:155], a[152:155], v[216:219], v[152:155]
  v_exp_f32 v202, v202
  v_mfma_f32_16x16x32_bf16 v[156:159], a[156:159], v[216:219], v[156:159]
  v_exp_f32 v203, v203
  v_mfma_f32_16x16x32_bf16 v[108:111], a[156:159], v[208:211], v[108:111]
  buffer_load_dwordx4 v244, s[8:11], s20 offen offset:2048 nt lds
  v_mfma_f32_16x16x32_bf16 v[112:115], a[160:163], v[208:211], v[112:115]
  v_fma_f32 v204, v204, s22, v229
  v_fma_f32 v205, v205, s22, v229
  v_mfma_f32_16x16x32_bf16 v[160:163], a[160:163], v[216:219], v[160:163]
  v_fma_f32 v206, v206, s22, v229
  v_fma_f32 v207, v207, s22, v229
  v_mfma_f32_16x16x32_bf16 v[164:167], a[164:167], v[216:219], v[164:167]
  v_exp_f32 v204, v204
  v_mfma_f32_16x16x32_bf16 v[116:119], a[164:167], v[208:211], v[116:119]
  v_exp_f32 v205, v205
  v_mfma_f32_16x16x32_bf16 v[120:123], a[168:171], v[208:211], v[120:123]
  ds_read_b64_tr_b16 a[144:145], v238 offset:36864
  v_add_f32 v224, v224, v192
  v_mfma_f32_16x16x32_bf16 v[168:171], a[168:171], v[216:219], v[168:171]
  ds_read_b64_tr_b16 a[146:147], v238 offset:43008
  v_add_f32 v224, v224, v193
  v_mfma_f32_16x16x32_bf16 v[172:175], a[172:175], v[216:219], v[172:175]
  v_exp_f32 v206, v206
  v_mfma_f32_16x16x32_bf16 v[124:127], a[172:175], v[208:211], v[124:127]
  ds_read_b64_tr_b16 a[148:149], v239 offset:36864
  v_add_f32 v224, v224, v194
  v_mfma_f32_16x16x32_bf16 v[128:131], a[176:179], v[208:211], v[128:131]
  ds_read_b64_tr_b16 a[150:151], v239 offset:43008
  v_add_f32 v224, v224, v195
  v_mfma_f32_16x16x32_bf16 v[176:179], a[176:179], v[216:219], v[176:179]
  v_exp_f32 v207, v207
  v_mfma_f32_16x16x32_bf16 v[180:183], a[180:183], v[216:219], v[180:183]
  ds_read_b64_tr_b16 a[152:153], v240 offset:36864
  v_cvt_pk_bf16_f32 v192, v192, v193
  v_mfma_f32_16x16x32_bf16 v[132:135], a[180:183], v[208:211], v[132:135]
  ds_read_b64_tr_b16 a[154:155], v240 offset:43008
  v_cvt_pk_bf16_f32 v193, v194, v195
  v_mfma_f32_16x16x32_bf16 v[136:139], a[184:187], v[208:211], v[136:139]
  buffer_store_dwordx4 a[40:43], v246, s[16:19], s95 offen offset:1024 sc0 sc1 nt
  v_add_f32 v224, v224, v196
  v_add_f32 v224, v224, v197
  v_mfma_f32_16x16x32_bf16 v[184:187], a[184:187], v[216:219], v[184:187]
  ds_read_b64_tr_b16 a[156:157], v241 offset:36864
  v_add_f32 v224, v224, v198
  v_mfma_f32_16x16x32_bf16 v[188:191], a[188:191], v[216:219], v[188:191]
  ds_read_b64_tr_b16 a[158:159], v241 offset:43008
  v_add_f32 v224, v224, v199
  v_mfma_f32_16x16x32_bf16 v[140:143], a[188:191], v[208:211], v[140:143]
  v_cvt_pk_bf16_f32 v194, v196, v197
  v_cvt_pk_bf16_f32 v195, v198, v199
  v_mfma_f32_16x16x32_bf16 v[208:211], a[96:99], a[48:51], v[232:235]
  ds_read_b64_tr_b16 a[160:161], v238 offset:36992
  v_add_f32 v225, v225, v200
  v_mfma_f32_16x16x32_bf16 v[208:211], a[100:103], a[52:55], v[208:211]
  ds_read_b64_tr_b16 a[162:163], v238 offset:43136
  v_add_f32 v225, v225, v201
  v_mfma_f32_16x16x32_bf16 v[208:211], a[104:107], a[56:59], v[208:211]
  v_add_f32 v225, v225, v202
  v_add_f32 v225, v225, v203
  v_mfma_f32_16x16x32_bf16 v[208:211], a[108:111], a[60:63], v[208:211]
  ds_read_b64_tr_b16 a[164:165], v239 offset:36992
  v_cvt_pk_bf16_f32 v203, v202, v203
  v_mfma_f32_16x16x32_bf16 v[208:211], a[112:115], a[64:67], v[208:211]
  ds_read_b64_tr_b16 a[166:167], v239 offset:43136
  v_cvt_pk_bf16_f32 v202, v200, v201
  v_mfma_f32_16x16x32_bf16 v[208:211], a[116:119], a[68:71], v[208:211]
  v_add_f32 v225, v225, v204
  v_add_f32 v225, v225, v205
  v_mfma_f32_16x16x32_bf16 v[212:215], a[140:143], a[68:71], v[232:235]
  ds_read_b64_tr_b16 a[168:169], v240 offset:36992
  v_add_f32 v225, v225, v206
  v_mfma_f32_16x16x32_bf16 v[212:215], a[136:139], a[64:67], v[212:215]
  ds_read_b64_tr_b16 a[170:171], v240 offset:43136
  v_add_f32 v225, v225, v207
  v_mfma_f32_16x16x32_bf16 v[212:215], a[132:135], a[60:63], v[212:215]
L_pg12:
  s_cbranch_execz L_pg16
  v_cvt_pk_bf16_f32 v200, v204, v205
  v_cvt_pk_bf16_f32 v201, v206, v207
  v_mfma_f32_16x16x32_bf16 v[212:215], a[128:131], a[56:59], v[212:215]
  ds_read_b64_tr_b16 a[172:173], v241 offset:36992
  v_fma_f32 v208, v208, s22, v230
  v_mfma_f32_16x16x32_bf16 v[212:215], a[124:127], a[52:55], v[212:215]
  ds_read_b64_tr_b16 a[174:175], v241 offset:43136
  v_fma_f32 v209, v209, s22, v230
  v_mfma_f32_16x16x32_bf16 v[212:215], a[120:123], a[48:51], v[212:215]
  v_exp_f32 v208, v208
  v_mfma_f32_16x16x32_bf16 v[216:219], a[120:123], a[72:75], v[232:235]
  ds_read_b64_tr_b16 a[176:177], v238 offset:37120
  v_fma_f32 v210, v210, s22, v230
  v_mfma_f32_16x16x32_bf16 v[216:219], a[124:127], a[76:79], v[216:219]
  ds_read_b64_tr_b16 a[178:179], v238 offset:43264
  v_fma_f32 v211, v211, s22, v230
  v_mfma_f32_16x16x32_bf16 v[216:219], a[128:131], a[80:83], v[216:219]
  buffer_store_dwordx4 a[44:47], v246, s[16:19], s95 offen offset:2048 sc0 sc1 nt
  v_exp_f32 v209, v209
  v_mfma_f32_16x16x32_bf16 v[216:219], a[132:135], a[84:87], v[216:219]
  ds_read_b64_tr_b16 a[180:181], v239 offset:37120
  v_fma_f32 v212, v212, s22, v230
  v_mfma_f32_16x16x32_bf16 v[216:219], a[136:139], a[88:91], v[216:219]
  ds_read_b64_tr_b16 a[182:183], v239 offset:43264
  v_fma_f32 v213, v213, s22, v230
  v_mfma_f32_16x16x32_bf16 v[216:219], a[140:143], a[92:95], v[216:219]
  v_exp_f32 v210, v210
  v_mfma_f32_16x16x32_bf16 v[220:223], a[116:119], a[92:95], v[232:235]
  ds_read_b64_tr_b16 a[184:185], v240 offset:37120
  v_fma_f32 v214, v214, s22, v230
  v_mfma_f32_16x16x32_bf16 v[220:223], a[112:115], a[88:91], v[220:223]
  ds_read_b64_tr_b16 a[186:187], v240 offset:43264
  v_fma_f32 v215, v215, s22, v230
  v_mfma_f32_16x16x32_bf16 v[220:223], a[108:111], a[84:87], v[220:223]
  v_exp_f32 v211, v211
  v_mfma_f32_16x16x32_bf16 v[220:223], a[104:107], a[80:83], v[220:223]
  ds_read_b64_tr_b16 a[188:189], v241 offset:37120
  v_fma_f32 v216, v216, s22, v231
  v_mfma_f32_16x16x32_bf16 v[220:223], a[100:103], a[76:79], v[220:223]
  ds_read_b64_tr_b16 a[190:191], v241 offset:43264
  v_fma_f32 v217, v217, s22, v231
  v_mfma_f32_16x16x32_bf16 v[220:223], a[96:99], a[72:75], v[220:223]
  s_waitcnt lgkmcnt(5)
  v_exp_f32 v212, v212
  v_mfma_f32_16x16x32_bf16 v[0:3], a[144:147], v[192:195], v[0:3]
  ds_read_b128 a[96:99], v236 offset:12288
  v_fma_f32 v218, v218, s22, v231
  v_mfma_f32_16x16x32_bf16 v[48:51], a[144:147], v[200:203], v[48:51]
  v_exp_f32 v213, v213
  v_mfma_f32_16x16x32_bf16 v[52:55], a[148:151], v[200:203], v[52:55]
  ds_read_b128 a[100:103], v237 offset:12288
  v_fma_f32 v219, v219, s22, v231
  v_mfma_f32_16x16x32_bf16 v[4:7], a[148:151], v[192:195], v[4:7]
  v_exp_f32 v214, v214
  v_mfma_f32_16x16x32_bf16 v[8:11], a[152:155], v[192:195], v[8:11]
  ds_read_b128 a[104:107], v236 offset:12416
  v_fma_f32 v220, v220, s22, v231
  v_mfma_f32_16x16x32_bf16 v[56:59], a[152:155], v[200:203], v[56:59]
  v_exp_f32 v215, v215
  v_mfma_f32_16x16x32_bf16 v[60:63], a[156:159], v[200:203], v[60:63]
  ds_read_b128 a[108:111], v237 offset:12416
  v_fma_f32 v221, v221, s22, v231
  v_mfma_f32_16x16x32_bf16 v[12:15], a[156:159], v[192:195], v[12:15]
  v_exp_f32 v216, v216
  v_mfma_f32_16x16x32_bf16 v[16:19], a[160:163], v[192:195], v[16:19]
  ds_read_b128 a[112:115], v236 offset:12544
  v_fma_f32 v222, v222, s22, v231
  v_mfma_f32_16x16x32_bf16 v[64:67], a[160:163], v[200:203], v[64:67]
  v_exp_f32 v217, v217
  v_mfma_f32_16x16x32_bf16 v[68:71], a[164:167], v[200:203], v[68:71]
  ds_read_b128 a[116:119], v237 offset:12544
  v_fma_f32 v223, v223, s22, v231
  v_mfma_f32_16x16x32_bf16 v[20:23], a[164:167], v[192:195], v[20:23]
  v_exp_f32 v218, v218
  v_mfma_f32_16x16x32_bf16 v[24:27], a[168:171], v[192:195], v[24:27]
  ds_read_b128 a[140:143], v237 offset:18688
  v_add_f32 v226, v226, v208
  v_mfma_f32_16x16x32_bf16 v[72:75], a[168:171], v[200:203], v[72:75]
  v_exp_f32 v219, v219
  v_mfma_f32_16x16x32_bf16 v[76:79], a[172:175], v[200:203], v[76:79]
  ds_read_b128 a[136:139], v236 offset:18688
  v_add_f32 v226, v226, v209
  v_mfma_f32_16x16x32_bf16 v[28:31], a[172:175], v[192:195], v[28:31]
  v_exp_f32 v220, v220
  v_mfma_f32_16x16x32_bf16 v[32:35], a[176:179], v[192:195], v[32:35]
  ds_read_b128 a[132:135], v237 offset:18560
  v_add_f32 v226, v226, v210
  v_mfma_f32_16x16x32_bf16 v[80:83], a[176:179], v[200:203], v[80:83]
  s_waitcnt lgkmcnt(4)
  v_exp_f32 v221, v221
  v_mfma_f32_16x16x32_bf16 v[84:87], a[180:183], v[200:203], v[84:87]
  ds_read_b128 a[128:131], v236 offset:18560
  v_add_f32 v226, v226, v211
  v_mfma_f32_16x16x32_bf16 v[36:39], a[180:183], v[192:195], v[36:39]
  v_exp_f32 v222, v222
  v_mfma_f32_16x16x32_bf16 v[40:43], a[184:187], v[192:195], v[40:43]
  ds_read_b128 a[124:127], v237 offset:18432
  v_add_f32 v226, v226, v212
  v_mfma_f32_16x16x32_bf16 v[88:91], a[184:187], v[200:203], v[88:91]
  v_exp_f32 v223, v223
  v_mfma_f32_16x16x32_bf16 v[92:95], a[188:191], v[200:203], v[92:95]
  ds_read_b128 a[120:123], v236 offset:18432
  v_add_f32 v226, v226, v213
  v_mfma_f32_16x16x32_bf16 v[44:47], a[188:191], v[192:195], v[44:47]
  v_add_f32 v226, v226, v214
  v_add_f32 v226, v226, v215
  v_mfma_f32_16x16x32_bf16 v[192:195], a[96:99], a[192:195], v[232:235]
  v_cvt_pk_bf16_f32 v208, v208, v209
  v_cvt_pk_bf16_f32 v209, v210, v211
  v_mfma_f32_16x16x32_bf16 v[192:195], a[100:103], a[196:199], v[192:195]
  v_cvt_pk_bf16_f32 v210, v212, v213
  v_cvt_pk_bf16_f32 v211, v214, v215
  v_mfma_f32_16x16x32_bf16 v[192:195], a[104:107], a[200:203], v[192:195]
  v_add_f32 v227, v227, v216
  v_add_f32 v227, v227, v217
  v_mfma_f32_16x16x32_bf16 v[192:195], a[108:111], a[204:207], v[192:195]
  s_waitcnt vmcnt(18) lgkmcnt(0)
  v_add_f32 v227, v227, v218
  v_add_f32 v227, v227, v219
  v_mfma_f32_16x16x32_bf16 v[192:195], a[112:115], a[208:211], v[192:195]
  s_barrier
  v_add_f32 v227, v227, v220
  v_add_f32 v227, v227, v221
  v_mfma_f32_16x16x32_bf16 v[192:195], a[116:119], a[212:215], v[192:195]
  s_add_u32 m0, s21, 110592
  v_add_f32 v227, v227, v222
  v_add_f32 v227, v227, v223
  v_mfma_f32_16x16x32_bf16 v[196:199], a[140:143], a[212:215], v[232:235]
  buffer_load_dwordx4 v242, s[12:15], s20 offen nt lds
  v_mfma_f32_16x16x32_bf16 v[196:199], a[136:139], a[208:211], v[196:199]
  v_cvt_pk_bf16_f32 v219, v218, v219
  v_cvt_pk_bf16_f32 v218, v216, v217
  v_mfma_f32_16x16x32_bf16 v[196:199], a[132:135], a[204:207], v[196:199]
  v_cvt_pk_bf16_f32 v216, v220, v221
  v_cvt_pk_bf16_f32 v217, v222, v223
  v_mfma_f32_16x16x32_bf16 v[196:199], a[128:131], a[200:203], v[196:199]
  v_fma_f32 v192, v192, s22, v228
  v_fma_f32 v193, v193, s22, v228
  v_mfma_f32_16x16x32_bf16 v[196:199], a[124:127], a[196:199], v[196:199]
  v_fma_f32 v194, v194, s22, v228
  v_fma_f32 v195, v195, s22, v228
  v_mfma_f32_16x16x32_bf16 v[196:199], a[120:123], a[192:195], v[196:199]
  buffer_load_dwordx4 v243, s[12:15], s20 offen offset:1024 nt lds
  v_mfma_f32_16x16x32_bf16 v[200:203], a[120:123], a[216:219], v[232:235]
  v_exp_f32 v192, v192
  v_mfma_f32_16x16x32_bf16 v[200:203], a[124:127], a[220:223], v[200:203]
  v_exp_f32 v193, v193
  v_mfma_f32_16x16x32_bf16 v[200:203], a[128:131], a[224:227], v[200:203]
  v_exp_f32 v194, v194
  v_mfma_f32_16x16x32_bf16 v[200:203], a[132:135], a[228:231], v[200:203]
  v_exp_f32 v195, v195
  v_mfma_f32_16x16x32_bf16 v[200:203], a[136:139], a[232:235], v[200:203]
  buffer_load_dwordx4 v244, s[12:15], s20 offen offset:2048 nt lds
  v_mfma_f32_16x16x32_bf16 v[200:203], a[140:143], a[236:239], v[200:203]
  v_fma_f32 v196, v196, s22, v228
  v_fma_f32 v197, v197, s22, v228
  v_mfma_f32_16x16x32_bf16 v[204:207], a[116:119], a[236:239], v[232:235]
  v_fma_f32 v198, v198, s22, v228
  v_fma_f32 v199, v199, s22, v228
  v_mfma_f32_16x16x32_bf16 v[204:207], a[112:115], a[232:235], v[204:207]
  s_add_u32 s20, s20, 12288
  v_exp_f32 v196, v196
  v_mfma_f32_16x16x32_bf16 v[204:207], a[108:111], a[228:231], v[204:207]
  s_add_u32 m0, s21, 12288
  v_exp_f32 v197, v197
  v_mfma_f32_16x16x32_bf16 v[204:207], a[104:107], a[224:227], v[204:207]
  buffer_load_dwordx4 v242, s[8:11], s20 offen nt lds
  v_mfma_f32_16x16x32_bf16 v[204:207], a[100:103], a[220:223], v[204:207]
  v_exp_f32 v198, v198
  v_mfma_f32_16x16x32_bf16 v[204:207], a[96:99], a[216:219], v[204:207]
  v_exp_f32 v199, v199
  v_mfma_f32_16x16x32_bf16 v[96:99], a[144:147], v[208:211], v[96:99]
  v_fma_f32 v200, v200, s22, v229
  v_fma_f32 v201, v201, s22, v229
  v_mfma_f32_16x16x32_bf16 v[144:147], a[144:147], v[216:219], v[144:147]
  v_fma_f32 v202, v202, s22, v229
  v_fma_f32 v203, v203, s22, v229
  v_mfma_f32_16x16x32_bf16 v[148:151], a[148:151], v[216:219], v[148:151]
  buffer_load_dwordx4 v243, s[8:11], s20 offen offset:1024 nt lds
  v_mfma_f32_16x16x32_bf16 v[100:103], a[148:151], v[208:211], v[100:103]
  v_exp_f32 v200, v200
  v_mfma_f32_16x16x32_bf16 v[104:107], a[152:155], v[208:211], v[104:107]
  v_exp_f32 v201, v201
  v_mfma_f32_16x16x32_bf16 v[152:155], a[152:155], v[216:219], v[152:155]
  v_exp_f32 v202, v202
  v_mfma_f32_16x16x32_bf16 v[156:159], a[156:159], v[216:219], v[156:159]
  v_exp_f32 v203, v203
  v_mfma_f32_16x16x32_bf16 v[108:111], a[156:159], v[208:211], v[108:111]
  buffer_load_dwordx4 v244, s[8:11], s20 offen offset:2048 nt lds
  v_mfma_f32_16x16x32_bf16 v[112:115], a[160:163], v[208:211], v[112:115]
  v_fma_f32 v204, v204, s22, v229
  v_fma_f32 v205, v205, s22, v229
  v_mfma_f32_16x16x32_bf16 v[160:163], a[160:163], v[216:219], v[160:163]
  v_fma_f32 v206, v206, s22, v229
  v_fma_f32 v207, v207, s22, v229
  v_mfma_f32_16x16x32_bf16 v[164:167], a[164:167], v[216:219], v[164:167]
  v_exp_f32 v204, v204
  v_mfma_f32_16x16x32_bf16 v[116:119], a[164:167], v[208:211], v[116:119]
  v_exp_f32 v205, v205
  v_mfma_f32_16x16x32_bf16 v[120:123], a[168:171], v[208:211], v[120:123]
  ds_read_b64_tr_b16 a[144:145], v238 offset:24576
  v_add_f32 v224, v224, v192
  v_mfma_f32_16x16x32_bf16 v[168:171], a[168:171], v[216:219], v[168:171]
  ds_read_b64_tr_b16 a[146:147], v238 offset:30720
  v_add_f32 v224, v224, v193
  v_mfma_f32_16x16x32_bf16 v[172:175], a[172:175], v[216:219], v[172:175]
  v_exp_f32 v206, v206
  v_mfma_f32_16x16x32_bf16 v[124:127], a[172:175], v[208:211], v[124:127]
  ds_read_b64_tr_b16 a[148:149], v239 offset:24576
  v_add_f32 v224, v224, v194
  v_mfma_f32_16x16x32_bf16 v[128:131], a[176:179], v[208:211], v[128:131]
  ds_read_b64_tr_b16 a[150:151], v239 offset:30720
  v_add_f32 v224, v224, v195
  v_mfma_f32_16x16x32_bf16 v[176:179], a[176:179], v[216:219], v[176:179]
  v_exp_f32 v207, v207
  v_mfma_f32_16x16x32_bf16 v[180:183], a[180:183], v[216:219], v[180:183]
  ds_read_b64_tr_b16 a[152:153], v240 offset:24576
  v_cvt_pk_bf16_f32 v192, v192, v193
  v_mfma_f32_16x16x32_bf16 v[132:135], a[180:183], v[208:211], v[132:135]
  ds_read_b64_tr_b16 a[154:155], v240 offset:30720
  v_cvt_pk_bf16_f32 v193, v194, v195
  v_mfma_f32_16x16x32_bf16 v[136:139], a[184:187], v[208:211], v[136:139]
  v_add_f32 v224, v224, v196
  v_add_f32 v224, v224, v197
  v_mfma_f32_16x16x32_bf16 v[184:187], a[184:187], v[216:219], v[184:187]
  ds_read_b64_tr_b16 a[156:157], v241 offset:24576
  v_add_f32 v224, v224, v198
  v_mfma_f32_16x16x32_bf16 v[188:191], a[188:191], v[216:219], v[188:191]
  s_add_u32 m0, s21, 98304
  ds_read_b64_tr_b16 a[158:159], v241 offset:30720
  v_add_f32 v224, v224, v199
  v_mfma_f32_16x16x32_bf16 v[140:143], a[188:191], v[208:211], v[140:143]
  buffer_load_dwordx4 v242, s[12:15], s20 offen nt lds
  v_cvt_pk_bf16_f32 v194, v196, v197
  v_cvt_pk_bf16_f32 v195, v198, v199
  v_mfma_f32_16x16x32_bf16 v[208:211], a[96:99], a[48:51], v[232:235]
  ds_read_b64_tr_b16 a[160:161], v238 offset:24704
  v_add_f32 v225, v225, v200
  v_mfma_f32_16x16x32_bf16 v[208:211], a[100:103], a[52:55], v[208:211]
  ds_read_b64_tr_b16 a[162:163], v238 offset:30848
  v_add_f32 v225, v225, v201
  v_mfma_f32_16x16x32_bf16 v[208:211], a[104:107], a[56:59], v[208:211]
  buffer_load_dwordx4 v243, s[12:15], s20 offen offset:1024 nt lds
  v_add_f32 v225, v225, v202
  v_add_f32 v225, v225, v203
  v_mfma_f32_16x16x32_bf16 v[208:211], a[108:111], a[60:63], v[208:211]
  ds_read_b64_tr_b16 a[164:165], v239 offset:24704
  v_cvt_pk_bf16_f32 v203, v202, v203
  v_mfma_f32_16x16x32_bf16 v[208:211], a[112:115], a[64:67], v[208:211]
  ds_read_b64_tr_b16 a[166:167], v239 offset:30848
  v_cvt_pk_bf16_f32 v202, v200, v201
  v_mfma_f32_16x16x32_bf16 v[208:211], a[116:119], a[68:71], v[208:211]
  buffer_load_dwordx4 v244, s[12:15], s20 offen offset:2048 nt lds
  v_add_f32 v225, v225, v204
  v_add_f32 v225, v225, v205
  v_mfma_f32_16x16x32_bf16 v[212:215], a[140:143], a[68:71], v[232:235]
  ds_read_b64_tr_b16 a[168:169], v240 offset:24704
  v_add_f32 v225, v225, v206
  v_mfma_f32_16x16x32_bf16 v[212:215], a[136:139], a[64:67], v[212:215]
  ds_read_b64_tr_b16 a[170:171], v240 offset:30848
  v_add_f32 v225, v225, v207
  v_mfma_f32_16x16x32_bf16 v[212:215], a[132:135], a[60:63], v[212:215]
  v_cvt_pk_bf16_f32 v200, v204, v205
  v_cvt_pk_bf16_f32 v201, v206, v207
  v_mfma_f32_16x16x32_bf16 v[212:215], a[128:131], a[56:59], v[212:215]
  ds_read_b64_tr_b16 a[172:173], v241 offset:24704
  v_fma_f32 v208, v208, s22, v230
  v_mfma_f32_16x16x32_bf16 v[212:215], a[124:127], a[52:55], v[212:215]
  ds_read_b64_tr_b16 a[174:175], v241 offset:30848
  v_fma_f32 v209, v209, s22, v230
  v_mfma_f32_16x16x32_bf16 v[212:215], a[120:123], a[48:51], v[212:215]
  v_exp_f32 v208, v208
  v_mfma_f32_16x16x32_bf16 v[216:219], a[120:123], a[72:75], v[232:235]
  ds_read_b64_tr_b16 a[176:177], v238 offset:24832
  v_fma_f32 v210, v210, s22, v230
  v_mfma_f32_16x16x32_bf16 v[216:219], a[124:127], a[76:79], v[216:219]
  ds_read_b64_tr_b16 a[178:179], v238 offset:30976
  v_fma_f32 v211, v211, s22, v230
  v_mfma_f32_16x16x32_bf16 v[216:219], a[128:131], a[80:83], v[216:219]
  v_exp_f32 v209, v209
  v_mfma_f32_16x16x32_bf16 v[216:219], a[132:135], a[84:87], v[216:219]
  ds_read_b64_tr_b16 a[180:181], v239 offset:24832
  v_fma_f32 v212, v212, s22, v230
  v_mfma_f32_16x16x32_bf16 v[216:219], a[136:139], a[88:91], v[216:219]
  ds_read_b64_tr_b16 a[182:183], v239 offset:30976
  v_fma_f32 v213, v213, s22, v230
  v_mfma_f32_16x16x32_bf16 v[216:219], a[140:143], a[92:95], v[216:219]
  v_exp_f32 v210, v210
  v_mfma_f32_16x16x32_bf16 v[220:223], a[116:119], a[92:95], v[232:235]
  ds_read_b64_tr_b16 a[184:185], v240 offset:24832
  v_fma_f32 v214, v214, s22, v230
  v_mfma_f32_16x16x32_bf16 v[220:223], a[112:115], a[88:91], v[220:223]
  ds_read_b64_tr_b16 a[186:187], v240 offset:30976
  v_fma_f32 v215, v215, s22, v230
  v_mfma_f32_16x16x32_bf16 v[220:223], a[108:111], a[84:87], v[220:223]
  v_exp_f32 v211, v211
  v_mfma_f32_16x16x32_bf16 v[220:223], a[104:107], a[80:83], v[220:223]
  ds_read_b64_tr_b16 a[188:189], v241 offset:24832
  v_fma_f32 v216, v216, s22, v231
  v_mfma_f32_16x16x32_bf16 v[220:223], a[100:103], a[76:79], v[220:223]
  ds_read_b64_tr_b16 a[190:191], v241 offset:30976
  v_fma_f32 v217, v217, s22, v231
  v_mfma_f32_16x16x32_bf16 v[220:223], a[96:99], a[72:75], v[220:223]
  s_waitcnt lgkmcnt(5)
  v_exp_f32 v212, v212
  v_mfma_f32_16x16x32_bf16 v[0:3], a[144:147], v[192:195], v[0:3]
  ds_read_b128 a[96:99], v236 offset:24576
  v_fma_f32 v218, v218, s22, v231
  v_mfma_f32_16x16x32_bf16 v[48:51], a[144:147], v[200:203], v[48:51]
  v_exp_f32 v213, v213
  v_mfma_f32_16x16x32_bf16 v[52:55], a[148:151], v[200:203], v[52:55]
  ds_read_b128 a[100:103], v237 offset:24576
  v_fma_f32 v219, v219, s22, v231
  v_mfma_f32_16x16x32_bf16 v[4:7], a[148:151], v[192:195], v[4:7]
  v_exp_f32 v214, v214
  v_mfma_f32_16x16x32_bf16 v[8:11], a[152:155], v[192:195], v[8:11]
  ds_read_b128 a[104:107], v236 offset:24704
  v_fma_f32 v220, v220, s22, v231
  v_mfma_f32_16x16x32_bf16 v[56:59], a[152:155], v[200:203], v[56:59]
  v_exp_f32 v215, v215
  v_mfma_f32_16x16x32_bf16 v[60:63], a[156:159], v[200:203], v[60:63]
  ds_read_b128 a[108:111], v237 offset:24704
  v_fma_f32 v221, v221, s22, v231
  v_mfma_f32_16x16x32_bf16 v[12:15], a[156:159], v[192:195], v[12:15]
  v_exp_f32 v216, v216
  v_mfma_f32_16x16x32_bf16 v[16:19], a[160:163], v[192:195], v[16:19]
  ds_read_b128 a[112:115], v236 offset:24832
  v_fma_f32 v222, v222, s22, v231
  v_mfma_f32_16x16x32_bf16 v[64:67], a[160:163], v[200:203], v[64:67]
  v_exp_f32 v217, v217
  v_mfma_f32_16x16x32_bf16 v[68:71], a[164:167], v[200:203], v[68:71]
  ds_read_b128 a[116:119], v237 offset:24832
  v_fma_f32 v223, v223, s22, v231
  v_mfma_f32_16x16x32_bf16 v[20:23], a[164:167], v[192:195], v[20:23]
  v_exp_f32 v218, v218
  v_mfma_f32_16x16x32_bf16 v[24:27], a[168:171], v[192:195], v[24:27]
  ds_read_b128 a[140:143], v237 offset:30976
  v_add_f32 v226, v226, v208
  v_mfma_f32_16x16x32_bf16 v[72:75], a[168:171], v[200:203], v[72:75]
  v_exp_f32 v219, v219
  v_mfma_f32_16x16x32_bf16 v[76:79], a[172:175], v[200:203], v[76:79]
  ds_read_b128 a[136:139], v236 offset:30976
  v_add_f32 v226, v226, v209
  v_mfma_f32_16x16x32_bf16 v[28:31], a[172:175], v[192:195], v[28:31]
  v_exp_f32 v220, v220
  v_mfma_f32_16x16x32_bf16 v[32:35], a[176:179], v[192:195], v[32:35]
  ds_read_b128 a[132:135], v237 offset:30848
  v_add_f32 v226, v226, v210
  v_mfma_f32_16x16x32_bf16 v[80:83], a[176:179], v[200:203], v[80:83]
  s_waitcnt lgkmcnt(4)
  v_exp_f32 v221, v221
  v_mfma_f32_16x16x32_bf16 v[84:87], a[180:183], v[200:203], v[84:87]
  ds_read_b128 a[128:131], v236 offset:30848
  v_add_f32 v226, v226, v211
  v_mfma_f32_16x16x32_bf16 v[36:39], a[180:183], v[192:195], v[36:39]
  v_exp_f32 v222, v222
  v_mfma_f32_16x16x32_bf16 v[40:43], a[184:187], v[192:195], v[40:43]
  ds_read_b128 a[124:127], v237 offset:30720
  v_add_f32 v226, v226, v212
  v_mfma_f32_16x16x32_bf16 v[88:91], a[184:187], v[200:203], v[88:91]
  v_exp_f32 v223, v223
  v_mfma_f32_16x16x32_bf16 v[92:95], a[188:191], v[200:203], v[92:95]
  ds_read_b128 a[120:123], v236 offset:30720
  v_add_f32 v226, v226, v213
  v_mfma_f32_16x16x32_bf16 v[44:47], a[188:191], v[192:195], v[44:47]
  v_add_f32 v226, v226, v214
  v_add_f32 v226, v226, v215
  v_mfma_f32_16x16x32_bf16 v[192:195], a[96:99], a[192:195], v[232:235]
  v_cvt_pk_bf16_f32 v208, v208, v209
  v_cvt_pk_bf16_f32 v209, v210, v211
  v_mfma_f32_16x16x32_bf16 v[192:195], a[100:103], a[196:199], v[192:195]
  v_cvt_pk_bf16_f32 v210, v212, v213
  v_cvt_pk_bf16_f32 v211, v214, v215
  v_mfma_f32_16x16x32_bf16 v[192:195], a[104:107], a[200:203], v[192:195]
  s_add_u32 s20, s20, 12288
  v_add_f32 v227, v227, v216
  v_add_f32 v227, v227, v217
  v_mfma_f32_16x16x32_bf16 v[192:195], a[108:111], a[204:207], v[192:195]
  s_waitcnt vmcnt(19) lgkmcnt(0)
  v_add_f32 v227, v227, v218
  v_add_f32 v227, v227, v219
  v_mfma_f32_16x16x32_bf16 v[192:195], a[112:115], a[208:211], v[192:195]
  s_barrier
  v_add_f32 v227, v227, v220
  v_add_f32 v227, v227, v221
  v_mfma_f32_16x16x32_bf16 v[192:195], a[116:119], a[212:215], v[192:195]
  s_add_u32 m0, s21, 24576
  v_add_f32 v227, v227, v222
  v_add_f32 v227, v227, v223
  v_mfma_f32_16x16x32_bf16 v[196:199], a[140:143], a[212:215], v[232:235]
  buffer_load_dwordx4 v242, s[8:11], s20 offen nt lds
  v_mfma_f32_16x16x32_bf16 v[196:199], a[136:139], a[208:211], v[196:199]
  v_cvt_pk_bf16_f32 v219, v218, v219
  v_cvt_pk_bf16_f32 v218, v216, v217
  v_mfma_f32_16x16x32_bf16 v[196:199], a[132:135], a[204:207], v[196:199]
  v_cvt_pk_bf16_f32 v216, v220, v221
  v_cvt_pk_bf16_f32 v217, v222, v223
  v_mfma_f32_16x16x32_bf16 v[196:199], a[128:131], a[200:203], v[196:199]
  v_fma_f32 v192, v192, s22, v228
  v_fma_f32 v193, v193, s22, v228
  v_mfma_f32_16x16x32_bf16 v[196:199], a[124:127], a[196:199], v[196:199]
  v_fma_f32 v194, v194, s22, v228
  v_fma_f32 v195, v195, s22, v228
  v_mfma_f32_16x16x32_bf16 v[196:199], a[120:123], a[192:195], v[196:199]
  buffer_load_dwordx4 v243, s[8:11], s20 offen offset:1024 nt lds
  v_mfma_f32_16x16x32_bf16 v[200:203], a[120:123], a[216:219], v[232:235]
  v_exp_f32 v192, v192
  v_mfma_f32_16x16x32_bf16 v[200:203], a[124:127], a[220:223], v[200:203]
  v_exp_f32 v193, v193
  v_mfma_f32_16x16x32_bf16 v[200:203], a[128:131], a[224:227], v[200:203]
  v_exp_f32 v194, v194
  v_mfma_f32_16x16x32_bf16 v[200:203], a[132:135], a[228:231], v[200:203]
  v_exp_f32 v195, v195
  v_mfma_f32_16x16x32_bf16 v[200:203], a[136:139], a[232:235], v[200:203]
  buffer_load_dwordx4 v244, s[8:11], s20 offen offset:2048 nt lds
  v_mfma_f32_16x16x32_bf16 v[200:203], a[140:143], a[236:239], v[200:203]
  v_fma_f32 v196, v196, s22, v228
  v_fma_f32 v197, v197, s22, v228
  v_mfma_f32_16x16x32_bf16 v[204:207], a[116:119], a[236:239], v[232:235]
  v_fma_f32 v198, v198, s22, v228
  v_fma_f32 v199, v199, s22, v228
  v_mfma_f32_16x16x32_bf16 v[204:207], a[112:115], a[232:235], v[204:207]
  v_exp_f32 v196, v196
  v_mfma_f32_16x16x32_bf16 v[204:207], a[108:111], a[228:231], v[204:207]
  s_add_u32 m0, s21, 86016
  v_exp_f32 v197, v197
  v_mfma_f32_16x16x32_bf16 v[204:207], a[104:107], a[224:227], v[204:207]
  buffer_load_dwordx4 v242, s[12:15], s20 offen nt lds
  v_mfma_f32_16x16x32_bf16 v[204:207], a[100:103], a[220:223], v[204:207]
  v_exp_f32 v198, v198
  v_mfma_f32_16x16x32_bf16 v[204:207], a[96:99], a[216:219], v[204:207]
  v_exp_f32 v199, v199
  v_mfma_f32_16x16x32_bf16 v[96:99], a[144:147], v[208:211], v[96:99]
  v_fma_f32 v200, v200, s22, v229
  v_fma_f32 v201, v201, s22, v229
  v_mfma_f32_16x16x32_bf16 v[144:147], a[144:147], v[216:219], v[144:147]
  v_fma_f32 v202, v202, s22, v229
  v_fma_f32 v203, v203, s22, v229
  v_mfma_f32_16x16x32_bf16 v[148:151], a[148:151], v[216:219], v[148:151]
  buffer_load_dwordx4 v243, s[12:15], s20 offen offset:1024 nt lds
  v_mfma_f32_16x16x32_bf16 v[100:103], a[148:151], v[208:211], v[100:103]
  v_exp_f32 v200, v200
  v_mfma_f32_16x16x32_bf16 v[104:107], a[152:155], v[208:211], v[104:107]
  v_exp_f32 v201, v201
  v_mfma_f32_16x16x32_bf16 v[152:155], a[152:155], v[216:219], v[152:155]
  v_exp_f32 v202, v202
  v_mfma_f32_16x16x32_bf16 v[156:159], a[156:159], v[216:219], v[156:159]
  v_exp_f32 v203, v203
  v_mfma_f32_16x16x32_bf16 v[108:111], a[156:159], v[208:211], v[108:111]
  buffer_load_dwordx4 v244, s[12:15], s20 offen offset:2048 nt lds
  v_mfma_f32_16x16x32_bf16 v[112:115], a[160:163], v[208:211], v[112:115]
  v_fma_f32 v204, v204, s22, v229
  v_fma_f32 v205, v205, s22, v229
  v_mfma_f32_16x16x32_bf16 v[160:163], a[160:163], v[216:219], v[160:163]
  v_fma_f32 v206, v206, s22, v229
  v_fma_f32 v207, v207, s22, v229
  v_mfma_f32_16x16x32_bf16 v[164:167], a[164:167], v[216:219], v[164:167]
  v_exp_f32 v204, v204
  v_mfma_f32_16x16x32_bf16 v[116:119], a[164:167], v[208:211], v[116:119]
  v_exp_f32 v205, v205
  v_mfma_f32_16x16x32_bf16 v[120:123], a[168:171], v[208:211], v[120:123]
  ds_read_b64_tr_b16 a[144:145], v238 offset:12288
  v_add_f32 v224, v224, v192
  v_mfma_f32_16x16x32_bf16 v[168:171], a[168:171], v[216:219], v[168:171]
  ds_read_b64_tr_b16 a[146:147], v238 offset:18432
  v_add_f32 v224, v224, v193
  v_mfma_f32_16x16x32_bf16 v[172:175], a[172:175], v[216:219], v[172:175]
  v_exp_f32 v206, v206
  v_mfma_f32_16x16x32_bf16 v[124:127], a[172:175], v[208:211], v[124:127]
  ds_read_b64_tr_b16 a[148:149], v239 offset:12288
  v_add_f32 v224, v224, v194
  v_mfma_f32_16x16x32_bf16 v[128:131], a[176:179], v[208:211], v[128:131]
  ds_read_b64_tr_b16 a[150:151], v239 offset:18432
  v_add_f32 v224, v224, v195
  v_mfma_f32_16x16x32_bf16 v[176:179], a[176:179], v[216:219], v[176:179]
  v_exp_f32 v207, v207
  v_mfma_f32_16x16x32_bf16 v[180:183], a[180:183], v[216:219], v[180:183]
  ds_read_b64_tr_b16 a[152:153], v240 offset:12288
  v_cvt_pk_bf16_f32 v192, v192, v193
  v_mfma_f32_16x16x32_bf16 v[132:135], a[180:183], v[208:211], v[132:135]
  ds_read_b64_tr_b16 a[154:155], v240 offset:18432
  v_cvt_pk_bf16_f32 v193, v194, v195
  v_mfma_f32_16x16x32_bf16 v[136:139], a[184:187], v[208:211], v[136:139]
  v_add_f32 v224, v224, v196
  v_add_f32 v224, v224, v197
  v_mfma_f32_16x16x32_bf16 v[184:187], a[184:187], v[216:219], v[184:187]
  s_add_u32 s20, s20, 12288
  ds_read_b64_tr_b16 a[156:157], v241 offset:12288
  v_add_f32 v224, v224, v198
  v_mfma_f32_16x16x32_bf16 v[188:191], a[188:191], v[216:219], v[188:191]
  s_add_u32 m0, s21, 49152
  ds_read_b64_tr_b16 a[158:159], v241 offset:18432
  v_add_f32 v224, v224, v199
  v_mfma_f32_16x16x32_bf16 v[140:143], a[188:191], v[208:211], v[140:143]
  buffer_load_dwordx4 v242, s[8:11], s20 offen nt lds
  v_cvt_pk_bf16_f32 v194, v196, v197
  v_cvt_pk_bf16_f32 v195, v198, v199
  v_mfma_f32_16x16x32_bf16 v[208:211], a[96:99], a[48:51], v[232:235]
  ds_read_b64_tr_b16 a[160:161], v238 offset:12416
  v_add_f32 v225, v225, v200
  v_mfma_f32_16x16x32_bf16 v[208:211], a[100:103], a[52:55], v[208:211]
  ds_read_b64_tr_b16 a[162:163], v238 offset:18560
  v_add_f32 v225, v225, v201
  v_mfma_f32_16x16x32_bf16 v[208:211], a[104:107], a[56:59], v[208:211]
  buffer_load_dwordx4 v243, s[8:11], s20 offen offset:1024 nt lds
  v_add_f32 v225, v225, v202
  v_add_f32 v225, v225, v203
  v_mfma_f32_16x16x32_bf16 v[208:211], a[108:111], a[60:63], v[208:211]
  ds_read_b64_tr_b16 a[164:165], v239 offset:12416
  v_cvt_pk_bf16_f32 v203, v202, v203
  v_mfma_f32_16x16x32_bf16 v[208:211], a[112:115], a[64:67], v[208:211]
  ds_read_b64_tr_b16 a[166:167], v239 offset:18560
  v_cvt_pk_bf16_f32 v202, v200, v201
  v_mfma_f32_16x16x32_bf16 v[208:211], a[116:119], a[68:71], v[208:211]
  buffer_load_dwordx4 v244, s[8:11], s20 offen offset:2048 nt lds
  v_add_f32 v225, v225, v204
  v_add_f32 v225, v225, v205
  v_mfma_f32_16x16x32_bf16 v[212:215], a[140:143], a[68:71], v[232:235]
  ds_read_b64_tr_b16 a[168:169], v240 offset:12416
  v_add_f32 v225, v225, v206
  v_mfma_f32_16x16x32_bf16 v[212:215], a[136:139], a[64:67], v[212:215]
  ds_read_b64_tr_b16 a[170:171], v240 offset:18560
  v_add_f32 v225, v225, v207
  v_mfma_f32_16x16x32_bf16 v[212:215], a[132:135], a[60:63], v[212:215]
  v_cvt_pk_bf16_f32 v200, v204, v205
  v_cvt_pk_bf16_f32 v201, v206, v207
  v_mfma_f32_16x16x32_bf16 v[212:215], a[128:131], a[56:59], v[212:215]
  ds_read_b64_tr_b16 a[172:173], v241 offset:12416
  v_fma_f32 v208, v208, s22, v230
  v_mfma_f32_16x16x32_bf16 v[212:215], a[124:127], a[52:55], v[212:215]
  ds_read_b64_tr_b16 a[174:175], v241 offset:18560
  v_fma_f32 v209, v209, s22, v230
  v_mfma_f32_16x16x32_bf16 v[212:215], a[120:123], a[48:51], v[212:215]
  v_exp_f32 v208, v208
  v_mfma_f32_16x16x32_bf16 v[216:219], a[120:123], a[72:75], v[232:235]
  ds_read_b64_tr_b16 a[176:177], v238 offset:12544
  v_fma_f32 v210, v210, s22, v230
  v_mfma_f32_16x16x32_bf16 v[216:219], a[124:127], a[76:79], v[216:219]
  ds_read_b64_tr_b16 a[178:179], v238 offset:18688
  v_fma_f32 v211, v211, s22, v230
  v_mfma_f32_16x16x32_bf16 v[216:219], a[128:131], a[80:83], v[216:219]
  v_exp_f32 v209, v209
  v_mfma_f32_16x16x32_bf16 v[216:219], a[132:135], a[84:87], v[216:219]
  ds_read_b64_tr_b16 a[180:181], v239 offset:12544
  v_fma_f32 v212, v212, s22, v230
  v_mfma_f32_16x16x32_bf16 v[216:219], a[136:139], a[88:91], v[216:219]
  ds_read_b64_tr_b16 a[182:183], v239 offset:18688
  v_fma_f32 v213, v213, s22, v230
  v_mfma_f32_16x16x32_bf16 v[216:219], a[140:143], a[92:95], v[216:219]
  v_exp_f32 v210, v210
  v_mfma_f32_16x16x32_bf16 v[220:223], a[116:119], a[92:95], v[232:235]
  ds_read_b64_tr_b16 a[184:185], v240 offset:12544
  v_fma_f32 v214, v214, s22, v230
  v_mfma_f32_16x16x32_bf16 v[220:223], a[112:115], a[88:91], v[220:223]
  ds_read_b64_tr_b16 a[186:187], v240 offset:18688
  v_fma_f32 v215, v215, s22, v230
  v_mfma_f32_16x16x32_bf16 v[220:223], a[108:111], a[84:87], v[220:223]
  v_exp_f32 v211, v211
  v_mfma_f32_16x16x32_bf16 v[220:223], a[104:107], a[80:83], v[220:223]
  ds_read_b64_tr_b16 a[188:189], v241 offset:12544
  v_fma_f32 v216, v216, s22, v231
  v_mfma_f32_16x16x32_bf16 v[220:223], a[100:103], a[76:79], v[220:223]
  ds_read_b64_tr_b16 a[190:191], v241 offset:18688
  v_fma_f32 v217, v217, s22, v231
  v_mfma_f32_16x16x32_bf16 v[220:223], a[96:99], a[72:75], v[220:223]
  s_waitcnt lgkmcnt(5)
  v_exp_f32 v212, v212
  v_mfma_f32_16x16x32_bf16 v[0:3], a[144:147], v[192:195], v[0:3]
  ds_read_b128 a[96:99], v236 offset:36864
  v_fma_f32 v218, v218, s22, v231
  v_mfma_f32_16x16x32_bf16 v[48:51], a[144:147], v[200:203], v[48:51]
  v_exp_f32 v213, v213
  v_mfma_f32_16x16x32_bf16 v[52:55], a[148:151], v[200:203], v[52:55]
  ds_read_b128 a[100:103], v237 offset:36864
  v_fma_f32 v219, v219, s22, v231
  v_mfma_f32_16x16x32_bf16 v[4:7], a[148:151], v[192:195], v[4:7]
  v_exp_f32 v214, v214
  v_mfma_f32_16x16x32_bf16 v[8:11], a[152:155], v[192:195], v[8:11]
  ds_read_b128 a[104:107], v236 offset:36992
  v_fma_f32 v220, v220, s22, v231
  v_mfma_f32_16x16x32_bf16 v[56:59], a[152:155], v[200:203], v[56:59]
  v_exp_f32 v215, v215
  v_mfma_f32_16x16x32_bf16 v[60:63], a[156:159], v[200:203], v[60:63]
L_pg13:
  s_cbranch_execz L_ret
  ds_read_b128 a[108:111], v237 offset:36992
  v_fma_f32 v221, v221, s22, v231
  v_mfma_f32_16x16x32_bf16 v[12:15], a[156:159], v[192:195], v[12:15]
  v_exp_f32 v216, v216
  v_mfma_f32_16x16x32_bf16 v[16:19], a[160:163], v[192:195], v[16:19]
  ds_read_b128 a[112:115], v236 offset:37120
  v_fma_f32 v222, v222, s22, v231
  v_mfma_f32_16x16x32_bf16 v[64:67], a[160:163], v[200:203], v[64:67]
  v_exp_f32 v217, v217
  v_mfma_f32_16x16x32_bf16 v[68:71], a[164:167], v[200:203], v[68:71]
  ds_read_b128 a[116:119], v237 offset:37120
  v_fma_f32 v223, v223, s22, v231
  v_mfma_f32_16x16x32_bf16 v[20:23], a[164:167], v[192:195], v[20:23]
  v_exp_f32 v218, v218
  v_mfma_f32_16x16x32_bf16 v[24:27], a[168:171], v[192:195], v[24:27]
  ds_read_b128 a[140:143], v237 offset:43264
  v_add_f32 v226, v226, v208
  v_mfma_f32_16x16x32_bf16 v[72:75], a[168:171], v[200:203], v[72:75]
  v_exp_f32 v219, v219
  v_mfma_f32_16x16x32_bf16 v[76:79], a[172:175], v[200:203], v[76:79]
  ds_read_b128 a[136:139], v236 offset:43264
  v_add_f32 v226, v226, v209
  v_mfma_f32_16x16x32_bf16 v[28:31], a[172:175], v[192:195], v[28:31]
  v_exp_f32 v220, v220
  v_mfma_f32_16x16x32_bf16 v[32:35], a[176:179], v[192:195], v[32:35]
  ds_read_b128 a[132:135], v237 offset:43136
  v_add_f32 v226, v226, v210
  v_mfma_f32_16x16x32_bf16 v[80:83], a[176:179], v[200:203], v[80:83]
  s_waitcnt lgkmcnt(4)
  v_exp_f32 v221, v221
  v_mfma_f32_16x16x32_bf16 v[84:87], a[180:183], v[200:203], v[84:87]
  ds_read_b128 a[128:131], v236 offset:43136
  v_add_f32 v226, v226, v211
  v_mfma_f32_16x16x32_bf16 v[36:39], a[180:183], v[192:195], v[36:39]
  v_exp_f32 v222, v222
  v_mfma_f32_16x16x32_bf16 v[40:43], a[184:187], v[192:195], v[40:43]
  ds_read_b128 a[124:127], v237 offset:43008
  v_add_f32 v226, v226, v212
  v_mfma_f32_16x16x32_bf16 v[88:91], a[184:187], v[200:203], v[88:91]
  v_exp_f32 v223, v223
  v_mfma_f32_16x16x32_bf16 v[92:95], a[188:191], v[200:203], v[92:95]
  ds_read_b128 a[120:123], v236 offset:43008
  v_add_f32 v226, v226, v213
  v_mfma_f32_16x16x32_bf16 v[44:47], a[188:191], v[192:195], v[44:47]
  v_add_f32 v226, v226, v214
  v_add_f32 v226, v226, v215
  v_mfma_f32_16x16x32_bf16 v[192:195], a[96:99], a[192:195], v[232:235]
  v_cvt_pk_bf16_f32 v208, v208, v209
  v_cvt_pk_bf16_f32 v209, v210, v211
  v_mfma_f32_16x16x32_bf16 v[192:195], a[100:103], a[196:199], v[192:195]
  v_cvt_pk_bf16_f32 v210, v212, v213
  v_cvt_pk_bf16_f32 v211, v214, v215
  v_mfma_f32_16x16x32_bf16 v[192:195], a[104:107], a[200:203], v[192:195]
  v_add_f32 v227, v227, v216
  v_add_f32 v227, v227, v217
  v_mfma_f32_16x16x32_bf16 v[192:195], a[108:111], a[204:207], v[192:195]
  s_waitcnt vmcnt(20) lgkmcnt(0)
  v_add_f32 v227, v227, v218
  v_add_f32 v227, v227, v219
  v_mfma_f32_16x16x32_bf16 v[192:195], a[112:115], a[208:211], v[192:195]
  s_barrier
  v_add_f32 v227, v227, v220
  v_add_f32 v227, v227, v221
  v_mfma_f32_16x16x32_bf16 v[192:195], a[116:119], a[212:215], v[192:195]
  s_add_u32 m0, s21, 73728
  v_add_f32 v227, v227, v222
  v_add_f32 v227, v227, v223
  v_mfma_f32_16x16x32_bf16 v[196:199], a[140:143], a[212:215], v[232:235]
  buffer_load_dwordx4 v242, s[12:15], s20 offen nt lds
  v_mfma_f32_16x16x32_bf16 v[196:199], a[136:139], a[208:211], v[196:199]
  v_cvt_pk_bf16_f32 v219, v218, v219
  v_cvt_pk_bf16_f32 v218, v216, v217
  v_mfma_f32_16x16x32_bf16 v[196:199], a[132:135], a[204:207], v[196:199]
  v_cvt_pk_bf16_f32 v216, v220, v221
  v_cvt_pk_bf16_f32 v217, v222, v223
  v_mfma_f32_16x16x32_bf16 v[196:199], a[128:131], a[200:203], v[196:199]
  v_fma_f32 v192, v192, s22, v228
  v_fma_f32 v193, v193, s22, v228
  v_mfma_f32_16x16x32_bf16 v[196:199], a[124:127], a[196:199], v[196:199]
  v_fma_f32 v194, v194, s22, v228
  v_fma_f32 v195, v195, s22, v228
  v_mfma_f32_16x16x32_bf16 v[196:199], a[120:123], a[192:195], v[196:199]
  buffer_load_dwordx4 v243, s[12:15], s20 offen offset:1024 nt lds
  v_mfma_f32_16x16x32_bf16 v[200:203], a[120:123], a[216:219], v[232:235]
  v_exp_f32 v192, v192
  v_mfma_f32_16x16x32_bf16 v[200:203], a[124:127], a[220:223], v[200:203]
  v_exp_f32 v193, v193
  v_mfma_f32_16x16x32_bf16 v[200:203], a[128:131], a[224:227], v[200:203]
  v_exp_f32 v194, v194
  v_mfma_f32_16x16x32_bf16 v[200:203], a[132:135], a[228:231], v[200:203]
  v_exp_f32 v195, v195
  v_mfma_f32_16x16x32_bf16 v[200:203], a[136:139], a[232:235], v[200:203]
  buffer_load_dwordx4 v244, s[12:15], s20 offen offset:2048 nt lds
  v_mfma_f32_16x16x32_bf16 v[200:203], a[140:143], a[236:239], v[200:203]
  v_fma_f32 v196, v196, s22, v228
  v_fma_f32 v197, v197, s22, v228
  v_mfma_f32_16x16x32_bf16 v[204:207], a[116:119], a[236:239], v[232:235]
  v_fma_f32 v198, v198, s22, v228
  v_fma_f32 v199, v199, s22, v228
  v_mfma_f32_16x16x32_bf16 v[204:207], a[112:115], a[232:235], v[204:207]
  v_exp_f32 v196, v196
  v_mfma_f32_16x16x32_bf16 v[204:207], a[108:111], a[228:231], v[204:207]
  v_exp_f32 v197, v197
  v_mfma_f32_16x16x32_bf16 v[204:207], a[104:107], a[224:227], v[204:207]
  v_lshrrev_b32 v242, 7, v246
  v_lshl_add_u32 v243, v242, 8, v246
  v_mfma_f32_16x16x32_bf16 v[204:207], a[100:103], a[220:223], v[204:207]
  v_exp_f32 v198, v198
  v_mfma_f32_16x16x32_bf16 v[204:207], a[96:99], a[216:219], v[204:207]
  v_exp_f32 v199, v199
  v_mfma_f32_16x16x32_bf16 v[96:99], a[144:147], v[208:211], v[96:99]
  v_fma_f32 v200, v200, s22, v229
  v_fma_f32 v201, v201, s22, v229
  v_mfma_f32_16x16x32_bf16 v[144:147], a[144:147], v[216:219], v[144:147]
  v_fma_f32 v202, v202, s22, v229
  v_fma_f32 v203, v203, s22, v229
  v_mfma_f32_16x16x32_bf16 v[148:151], a[148:151], v[216:219], v[148:151]
  v_lshlrev_b32 v242, 4, v242
  v_xad_u32 v242, v242, v243, s30
  v_mfma_f32_16x16x32_bf16 v[100:103], a[148:151], v[208:211], v[100:103]
  v_exp_f32 v200, v200
  v_mfma_f32_16x16x32_bf16 v[104:107], a[152:155], v[208:211], v[104:107]
  v_exp_f32 v201, v201
  v_mfma_f32_16x16x32_bf16 v[152:155], a[152:155], v[216:219], v[152:155]
  v_exp_f32 v202, v202
  v_mfma_f32_16x16x32_bf16 v[156:159], a[156:159], v[216:219], v[156:159]
  v_exp_f32 v203, v203
  v_mfma_f32_16x16x32_bf16 v[108:111], a[156:159], v[208:211], v[108:111]
  v_mfma_f32_16x16x32_bf16 v[112:115], a[160:163], v[208:211], v[112:115]
  v_fma_f32 v204, v204, s22, v229
  v_fma_f32 v205, v205, s22, v229
  v_mfma_f32_16x16x32_bf16 v[160:163], a[160:163], v[216:219], v[160:163]
  v_fma_f32 v206, v206, s22, v229
  v_fma_f32 v207, v207, s22, v229
  v_mfma_f32_16x16x32_bf16 v[164:167], a[164:167], v[216:219], v[164:167]
  v_exp_f32 v204, v204
  v_mfma_f32_16x16x32_bf16 v[116:119], a[164:167], v[208:211], v[116:119]
  v_exp_f32 v205, v205
  v_mfma_f32_16x16x32_bf16 v[120:123], a[168:171], v[208:211], v[120:123]
  ds_read_b64_tr_b16 a[144:145], v238 offset:0
  v_add_f32 v224, v224, v192
  v_mfma_f32_16x16x32_bf16 v[168:171], a[168:171], v[216:219], v[168:171]
  ds_read_b64_tr_b16 a[146:147], v238 offset:6144
  v_add_f32 v224, v224, v193
  v_mfma_f32_16x16x32_bf16 v[172:175], a[172:175], v[216:219], v[172:175]
  v_exp_f32 v206, v206
  v_mfma_f32_16x16x32_bf16 v[124:127], a[172:175], v[208:211], v[124:127]
  ds_read_b64_tr_b16 a[148:149], v239 offset:0
  v_add_f32 v224, v224, v194
  v_mfma_f32_16x16x32_bf16 v[128:131], a[176:179], v[208:211], v[128:131]
  ds_read_b64_tr_b16 a[150:151], v239 offset:6144
  v_add_f32 v224, v224, v195
  v_mfma_f32_16x16x32_bf16 v[176:179], a[176:179], v[216:219], v[176:179]
  v_exp_f32 v207, v207
  v_mfma_f32_16x16x32_bf16 v[180:183], a[180:183], v[216:219], v[180:183]
  ds_read_b64_tr_b16 a[152:153], v240 offset:0
  v_cvt_pk_bf16_f32 v192, v192, v193
  v_mfma_f32_16x16x32_bf16 v[132:135], a[180:183], v[208:211], v[132:135]
  ds_read_b64_tr_b16 a[154:155], v240 offset:6144
  v_cvt_pk_bf16_f32 v193, v194, v195
  v_mfma_f32_16x16x32_bf16 v[136:139], a[184:187], v[208:211], v[136:139]
  v_add_f32 v224, v224, v196
  v_add_f32 v224, v224, v197
  v_mfma_f32_16x16x32_bf16 v[184:187], a[184:187], v[216:219], v[184:187]
  ds_read_b64_tr_b16 a[156:157], v241 offset:0
  v_add_f32 v224, v224, v198
  v_mfma_f32_16x16x32_bf16 v[188:191], a[188:191], v[216:219], v[188:191]
  ds_read_b64_tr_b16 a[158:159], v241 offset:6144
  v_add_f32 v224, v224, v199
  v_mfma_f32_16x16x32_bf16 v[140:143], a[188:191], v[208:211], v[140:143]
  v_cvt_pk_bf16_f32 v194, v196, v197
  v_cvt_pk_bf16_f32 v195, v198, v199
  v_mfma_f32_16x16x32_bf16 v[208:211], a[96:99], a[48:51], v[232:235]
  ds_read_b64_tr_b16 a[160:161], v238 offset:128
  v_add_f32 v225, v225, v200
  v_mfma_f32_16x16x32_bf16 v[208:211], a[100:103], a[52:55], v[208:211]
  ds_read_b64_tr_b16 a[162:163], v238 offset:6272
  v_add_f32 v225, v225, v201
  v_mfma_f32_16x16x32_bf16 v[208:211], a[104:107], a[56:59], v[208:211]
  v_add_f32 v225, v225, v202
  v_add_f32 v225, v225, v203
  v_mfma_f32_16x16x32_bf16 v[208:211], a[108:111], a[60:63], v[208:211]
  ds_read_b64_tr_b16 a[164:165], v239 offset:128
  v_cvt_pk_bf16_f32 v203, v202, v203
  v_mfma_f32_16x16x32_bf16 v[208:211], a[112:115], a[64:67], v[208:211]
  ds_read_b64_tr_b16 a[166:167], v239 offset:6272
  v_cvt_pk_bf16_f32 v202, v200, v201
  v_mfma_f32_16x16x32_bf16 v[208:211], a[116:119], a[68:71], v[208:211]
  v_add_f32 v225, v225, v204
  v_add_f32 v225, v225, v205
  v_mfma_f32_16x16x32_bf16 v[212:215], a[140:143], a[68:71], v[232:235]
  ds_read_b64_tr_b16 a[168:169], v240 offset:128
  v_add_f32 v225, v225, v206
  v_mfma_f32_16x16x32_bf16 v[212:215], a[136:139], a[64:67], v[212:215]
  ds_read_b64_tr_b16 a[170:171], v240 offset:6272
  v_add_f32 v225, v225, v207
  v_mfma_f32_16x16x32_bf16 v[212:215], a[132:135], a[60:63], v[212:215]
  v_cvt_pk_bf16_f32 v200, v204, v205
  v_cvt_pk_bf16_f32 v201, v206, v207
  v_mfma_f32_16x16x32_bf16 v[212:215], a[128:131], a[56:59], v[212:215]
  ds_read_b64_tr_b16 a[172:173], v241 offset:128
  v_fma_f32 v208, v208, s22, v230
  v_mfma_f32_16x16x32_bf16 v[212:215], a[124:127], a[52:55], v[212:215]
  ds_read_b64_tr_b16 a[174:175], v241 offset:6272
  v_fma_f32 v209, v209, s22, v230
  v_mfma_f32_16x16x32_bf16 v[212:215], a[120:123], a[48:51], v[212:215]
  v_exp_f32 v208, v208
  v_mfma_f32_16x16x32_bf16 v[216:219], a[120:123], a[72:75], v[232:235]
  ds_read_b64_tr_b16 a[176:177], v238 offset:256
  v_fma_f32 v210, v210, s22, v230
  v_mfma_f32_16x16x32_bf16 v[216:219], a[124:127], a[76:79], v[216:219]
  ds_read_b64_tr_b16 a[178:179], v238 offset:6400
  v_fma_f32 v211, v211, s22, v230
  v_mfma_f32_16x16x32_bf16 v[216:219], a[128:131], a[80:83], v[216:219]
  v_exp_f32 v209, v209
  v_mfma_f32_16x16x32_bf16 v[216:219], a[132:135], a[84:87], v[216:219]
  ds_read_b64_tr_b16 a[180:181], v239 offset:256
  v_fma_f32 v212, v212, s22, v230
  v_mfma_f32_16x16x32_bf16 v[216:219], a[136:139], a[88:91], v[216:219]
  ds_read_b64_tr_b16 a[182:183], v239 offset:6400
  v_fma_f32 v213, v213, s22, v230
  v_mfma_f32_16x16x32_bf16 v[216:219], a[140:143], a[92:95], v[216:219]
  v_exp_f32 v210, v210
  v_mfma_f32_16x16x32_bf16 v[220:223], a[116:119], a[92:95], v[232:235]
  ds_read_b64_tr_b16 a[184:185], v240 offset:256
  v_fma_f32 v214, v214, s22, v230
  v_mfma_f32_16x16x32_bf16 v[220:223], a[112:115], a[88:91], v[220:223]
  ds_read_b64_tr_b16 a[186:187], v240 offset:6400
  v_fma_f32 v215, v215, s22, v230
  v_mfma_f32_16x16x32_bf16 v[220:223], a[108:111], a[84:87], v[220:223]
  v_exp_f32 v211, v211
  v_mfma_f32_16x16x32_bf16 v[220:223], a[104:107], a[80:83], v[220:223]
  ds_read_b64_tr_b16 a[188:189], v241 offset:256
  v_fma_f32 v216, v216, s22, v231
  v_mfma_f32_16x16x32_bf16 v[220:223], a[100:103], a[76:79], v[220:223]
  ds_read_b64_tr_b16 a[190:191], v241 offset:6400
  v_fma_f32 v217, v217, s22, v231
  v_mfma_f32_16x16x32_bf16 v[220:223], a[96:99], a[72:75], v[220:223]
  s_waitcnt lgkmcnt(5)
  v_exp_f32 v212, v212
  v_mfma_f32_16x16x32_bf16 v[0:3], a[144:147], v[192:195], v[0:3]
  ds_read_b128 a[96:99], v236 offset:0
  v_fma_f32 v218, v218, s22, v231
  v_mfma_f32_16x16x32_bf16 v[48:51], a[144:147], v[200:203], v[48:51]
  v_exp_f32 v213, v213
  v_mfma_f32_16x16x32_bf16 v[52:55], a[148:151], v[200:203], v[52:55]
  ds_read_b128 a[100:103], v237 offset:0
  v_fma_f32 v219, v219, s22, v231
  v_mfma_f32_16x16x32_bf16 v[4:7], a[148:151], v[192:195], v[4:7]
  v_exp_f32 v214, v214
  v_mfma_f32_16x16x32_bf16 v[8:11], a[152:155], v[192:195], v[8:11]
  ds_read_b128 a[104:107], v236 offset:128
  v_fma_f32 v220, v220, s22, v231
  v_mfma_f32_16x16x32_bf16 v[56:59], a[152:155], v[200:203], v[56:59]
  v_exp_f32 v215, v215
  v_mfma_f32_16x16x32_bf16 v[60:63], a[156:159], v[200:203], v[60:63]
  ds_read_b128 a[108:111], v237 offset:128
  v_fma_f32 v221, v221, s22, v231
  v_mfma_f32_16x16x32_bf16 v[12:15], a[156:159], v[192:195], v[12:15]
  v_exp_f32 v216, v216
  v_mfma_f32_16x16x32_bf16 v[16:19], a[160:163], v[192:195], v[16:19]
  ds_read_b128 a[112:115], v236 offset:256
  v_fma_f32 v222, v222, s22, v231
  v_mfma_f32_16x16x32_bf16 v[64:67], a[160:163], v[200:203], v[64:67]
  v_exp_f32 v217, v217
  v_mfma_f32_16x16x32_bf16 v[68:71], a[164:167], v[200:203], v[68:71]
  ds_read_b128 a[116:119], v237 offset:256
  v_fma_f32 v223, v223, s22, v231
  v_mfma_f32_16x16x32_bf16 v[20:23], a[164:167], v[192:195], v[20:23]
  v_exp_f32 v218, v218
  v_mfma_f32_16x16x32_bf16 v[24:27], a[168:171], v[192:195], v[24:27]
  ds_read_b128 a[140:143], v237 offset:6400
  v_add_f32 v226, v226, v208
  v_mfma_f32_16x16x32_bf16 v[72:75], a[168:171], v[200:203], v[72:75]
  v_exp_f32 v219, v219
  v_mfma_f32_16x16x32_bf16 v[76:79], a[172:175], v[200:203], v[76:79]
  ds_read_b128 a[136:139], v236 offset:6400
  v_add_f32 v226, v226, v209
  v_mfma_f32_16x16x32_bf16 v[28:31], a[172:175], v[192:195], v[28:31]
  v_exp_f32 v220, v220
  v_mfma_f32_16x16x32_bf16 v[32:35], a[176:179], v[192:195], v[32:35]
  ds_read_b128 a[132:135], v237 offset:6272
  v_add_f32 v226, v226, v210
  v_mfma_f32_16x16x32_bf16 v[80:83], a[176:179], v[200:203], v[80:83]
  s_waitcnt lgkmcnt(4)
  v_exp_f32 v221, v221
  v_mfma_f32_16x16x32_bf16 v[84:87], a[180:183], v[200:203], v[84:87]
  ds_read_b128 a[128:131], v236 offset:6272
  v_add_f32 v226, v226, v211
  v_mfma_f32_16x16x32_bf16 v[36:39], a[180:183], v[192:195], v[36:39]
  v_exp_f32 v222, v222
  v_mfma_f32_16x16x32_bf16 v[40:43], a[184:187], v[192:195], v[40:43]
  ds_read_b128 a[124:127], v237 offset:6144
  v_add_f32 v226, v226, v212
  v_mfma_f32_16x16x32_bf16 v[88:91], a[184:187], v[200:203], v[88:91]
  v_exp_f32 v223, v223
  v_mfma_f32_16x16x32_bf16 v[92:95], a[188:191], v[200:203], v[92:95]
  ds_read_b128 a[120:123], v236 offset:6144
  v_add_f32 v226, v226, v213
  v_mfma_f32_16x16x32_bf16 v[44:47], a[188:191], v[192:195], v[44:47]
  v_add_f32 v226, v226, v214
  v_add_f32 v226, v226, v215
  v_mfma_f32_16x16x32_bf16 v[192:195], a[96:99], a[192:195], v[232:235]
  v_cvt_pk_bf16_f32 v208, v208, v209
  v_cvt_pk_bf16_f32 v209, v210, v211
  v_mfma_f32_16x16x32_bf16 v[192:195], a[100:103], a[196:199], v[192:195]
  v_cvt_pk_bf16_f32 v210, v212, v213
  v_cvt_pk_bf16_f32 v211, v214, v215
  v_mfma_f32_16x16x32_bf16 v[192:195], a[104:107], a[200:203], v[192:195]
  v_add_f32 v227, v227, v216
  v_add_f32 v227, v227, v217
  v_mfma_f32_16x16x32_bf16 v[192:195], a[108:111], a[204:207], v[192:195]
  s_waitcnt vmcnt(9) lgkmcnt(0)
  v_add_f32 v227, v227, v218
  v_add_f32 v227, v227, v219
  v_mfma_f32_16x16x32_bf16 v[192:195], a[112:115], a[208:211], v[192:195]
  s_barrier
  v_add_f32 v227, v227, v220
  v_add_f32 v227, v227, v221
  v_mfma_f32_16x16x32_bf16 v[192:195], a[116:119], a[212:215], v[192:195]
  v_add_f32 v227, v227, v222
  v_add_f32 v227, v227, v223
  v_mfma_f32_16x16x32_bf16 v[196:199], a[140:143], a[212:215], v[232:235]
  ds_read_b128 a[0:3], v236 offset:24576
  ds_read_b128 a[4:7], v237 offset:24576
  v_mfma_f32_16x16x32_bf16 v[196:199], a[136:139], a[208:211], v[196:199]
  v_cvt_pk_bf16_f32 v219, v218, v219
  v_cvt_pk_bf16_f32 v218, v216, v217
  v_mfma_f32_16x16x32_bf16 v[196:199], a[132:135], a[204:207], v[196:199]
  v_cvt_pk_bf16_f32 v216, v220, v221
  v_cvt_pk_bf16_f32 v217, v222, v223
  v_mfma_f32_16x16x32_bf16 v[196:199], a[128:131], a[200:203], v[196:199]
  v_fma_f32 v192, v192, s22, v228
  v_fma_f32 v193, v193, s22, v228
  v_mfma_f32_16x16x32_bf16 v[196:199], a[124:127], a[196:199], v[196:199]
  v_fma_f32 v194, v194, s22, v228
  v_fma_f32 v195, v195, s22, v228
  v_mfma_f32_16x16x32_bf16 v[196:199], a[120:123], a[192:195], v[196:199]
  ds_read_b128 a[8:11], v236 offset:24704
  ds_read_b128 a[12:15], v237 offset:24704
  v_mfma_f32_16x16x32_bf16 v[200:203], a[120:123], a[216:219], v[232:235]
  v_exp_f32 v192, v192
  v_mfma_f32_16x16x32_bf16 v[200:203], a[124:127], a[220:223], v[200:203]
  v_exp_f32 v193, v193
  v_mfma_f32_16x16x32_bf16 v[200:203], a[128:131], a[224:227], v[200:203]
  v_exp_f32 v194, v194
  v_mfma_f32_16x16x32_bf16 v[200:203], a[132:135], a[228:231], v[200:203]
  v_exp_f32 v195, v195
  v_mfma_f32_16x16x32_bf16 v[200:203], a[136:139], a[232:235], v[200:203]
  ds_read_b128 a[16:19], v236 offset:24832
  ds_read_b128 a[20:23], v237 offset:24832
  v_mfma_f32_16x16x32_bf16 v[200:203], a[140:143], a[236:239], v[200:203]
  v_fma_f32 v196, v196, s22, v228
  v_fma_f32 v197, v197, s22, v228
  v_mfma_f32_16x16x32_bf16 v[204:207], a[116:119], a[236:239], v[232:235]
  v_fma_f32 v198, v198, s22, v228
  v_fma_f32 v199, v199, s22, v228
  v_mfma_f32_16x16x32_bf16 v[204:207], a[112:115], a[232:235], v[204:207]
  v_exp_f32 v196, v196
  v_mfma_f32_16x16x32_bf16 v[204:207], a[108:111], a[228:231], v[204:207]
  v_exp_f32 v197, v197
  v_mfma_f32_16x16x32_bf16 v[204:207], a[104:107], a[224:227], v[204:207]
  ds_read_b128 a[44:47], v237 offset:30976
  ds_read_b128 a[40:43], v236 offset:30976
  v_mfma_f32_16x16x32_bf16 v[204:207], a[100:103], a[220:223], v[204:207]
  v_exp_f32 v198, v198
  v_mfma_f32_16x16x32_bf16 v[204:207], a[96:99], a[216:219], v[204:207]
  v_exp_f32 v199, v199
  v_mfma_f32_16x16x32_bf16 v[96:99], a[144:147], v[208:211], v[96:99]
  v_fma_f32 v200, v200, s22, v229
  v_fma_f32 v201, v201, s22, v229
  v_mfma_f32_16x16x32_bf16 v[144:147], a[144:147], v[216:219], v[144:147]
  v_fma_f32 v202, v202, s22, v229
  v_fma_f32 v203, v203, s22, v229
  v_mfma_f32_16x16x32_bf16 v[148:151], a[148:151], v[216:219], v[148:151]
  ds_read_b128 a[36:39], v237 offset:30848
  ds_read_b128 a[32:35], v236 offset:30848
  v_mfma_f32_16x16x32_bf16 v[100:103], a[148:151], v[208:211], v[100:103]
  v_exp_f32 v200, v200
  v_mfma_f32_16x16x32_bf16 v[104:107], a[152:155], v[208:211], v[104:107]
  v_exp_f32 v201, v201
  v_mfma_f32_16x16x32_bf16 v[152:155], a[152:155], v[216:219], v[152:155]
  v_exp_f32 v202, v202
  v_mfma_f32_16x16x32_bf16 v[156:159], a[156:159], v[216:219], v[156:159]
  v_exp_f32 v203, v203
  v_mfma_f32_16x16x32_bf16 v[108:111], a[156:159], v[208:211], v[108:111]
  ds_read_b128 a[28:31], v237 offset:30720
  ds_read_b128 a[24:27], v236 offset:30720
  v_mfma_f32_16x16x32_bf16 v[112:115], a[160:163], v[208:211], v[112:115]
  v_fma_f32 v204, v204, s22, v229
  v_fma_f32 v205, v205, s22, v229
  v_mfma_f32_16x16x32_bf16 v[160:163], a[160:163], v[216:219], v[160:163]
  v_fma_f32 v206, v206, s22, v229
  v_fma_f32 v207, v207, s22, v229
  v_mfma_f32_16x16x32_bf16 v[164:167], a[164:167], v[216:219], v[164:167]
  v_exp_f32 v204, v204
  v_mfma_f32_16x16x32_bf16 v[116:119], a[164:167], v[208:211], v[116:119]
  v_exp_f32 v205, v205
  v_mfma_f32_16x16x32_bf16 v[120:123], a[168:171], v[208:211], v[120:123]
  ds_read_b64_tr_b16 a[144:145], v238 offset:49152
  v_add_f32 v224, v224, v192
  v_mfma_f32_16x16x32_bf16 v[168:171], a[168:171], v[216:219], v[168:171]
  ds_read_b64_tr_b16 a[146:147], v238 offset:55296
  v_add_f32 v224, v224, v193
  v_mfma_f32_16x16x32_bf16 v[172:175], a[172:175], v[216:219], v[172:175]
  v_exp_f32 v206, v206
  v_mfma_f32_16x16x32_bf16 v[124:127], a[172:175], v[208:211], v[124:127]
  ds_read_b64_tr_b16 a[148:149], v239 offset:49152
  v_add_f32 v224, v224, v194
  v_mfma_f32_16x16x32_bf16 v[128:131], a[176:179], v[208:211], v[128:131]
  ds_read_b64_tr_b16 a[150:151], v239 offset:55296
  v_add_f32 v224, v224, v195
  v_mfma_f32_16x16x32_bf16 v[176:179], a[176:179], v[216:219], v[176:179]
  v_exp_f32 v207, v207
  v_mfma_f32_16x16x32_bf16 v[180:183], a[180:183], v[216:219], v[180:183]
  ds_read_b64_tr_b16 a[152:153], v240 offset:49152
  v_cvt_pk_bf16_f32 v192, v192, v193
  v_mfma_f32_16x16x32_bf16 v[132:135], a[180:183], v[208:211], v[132:135]
  ds_read_b64_tr_b16 a[154:155], v240 offset:55296
  v_cvt_pk_bf16_f32 v193, v194, v195
  v_mfma_f32_16x16x32_bf16 v[136:139], a[184:187], v[208:211], v[136:139]
  v_add_f32 v224, v224, v196
  v_add_f32 v224, v224, v197
  v_mfma_f32_16x16x32_bf16 v[184:187], a[184:187], v[216:219], v[184:187]
  ds_read_b64_tr_b16 a[156:157], v241 offset:49152
  v_add_f32 v224, v224, v198
  v_mfma_f32_16x16x32_bf16 v[188:191], a[188:191], v[216:219], v[188:191]
  ds_read_b64_tr_b16 a[158:159], v241 offset:55296
  v_add_f32 v224, v224, v199
  v_mfma_f32_16x16x32_bf16 v[140:143], a[188:191], v[208:211], v[140:143]
  v_cvt_pk_bf16_f32 v194, v196, v197
  v_cvt_pk_bf16_f32 v195, v198, v199
  v_mfma_f32_16x16x32_bf16 v[208:211], a[96:99], a[48:51], v[232:235]
  ds_read_b64_tr_b16 a[160:161], v238 offset:49280
  v_add_f32 v225, v225, v200
  v_mfma_f32_16x16x32_bf16 v[208:211], a[100:103], a[52:55], v[208:211]
  ds_read_b64_tr_b16 a[162:163], v238 offset:55424
  v_add_f32 v225, v225, v201
  v_mfma_f32_16x16x32_bf16 v[208:211], a[104:107], a[56:59], v[208:211]
  v_add_f32 v225, v225, v202
  v_add_f32 v225, v225, v203
  v_mfma_f32_16x16x32_bf16 v[208:211], a[108:111], a[60:63], v[208:211]
  ds_read_b64_tr_b16 a[164:165], v239 offset:49280
  v_cvt_pk_bf16_f32 v203, v202, v203
  v_mfma_f32_16x16x32_bf16 v[208:211], a[112:115], a[64:67], v[208:211]
  ds_read_b64_tr_b16 a[166:167], v239 offset:55424
  v_cvt_pk_bf16_f32 v202, v200, v201
  v_mfma_f32_16x16x32_bf16 v[208:211], a[116:119], a[68:71], v[208:211]
  v_add_f32 v225, v225, v204
  v_add_f32 v225, v225, v205
  v_mfma_f32_16x16x32_bf16 v[212:215], a[140:143], a[68:71], v[232:235]
  ds_read_b64_tr_b16 a[168:169], v240 offset:49280
  v_add_f32 v225, v225, v206
  v_mfma_f32_16x16x32_bf16 v[212:215], a[136:139], a[64:67], v[212:215]
  ds_read_b64_tr_b16 a[170:171], v240 offset:55424
  v_add_f32 v225, v225, v207
  v_mfma_f32_16x16x32_bf16 v[212:215], a[132:135], a[60:63], v[212:215]
  v_cvt_pk_bf16_f32 v200, v204, v205
  v_cvt_pk_bf16_f32 v201, v206, v207
  v_mfma_f32_16x16x32_bf16 v[212:215], a[128:131], a[56:59], v[212:215]
  ds_read_b64_tr_b16 a[172:173], v241 offset:49280
  v_fma_f32 v208, v208, s22, v230
  v_mfma_f32_16x16x32_bf16 v[212:215], a[124:127], a[52:55], v[212:215]
  ds_read_b64_tr_b16 a[174:175], v241 offset:55424
  v_fma_f32 v209, v209, s22, v230
  v_mfma_f32_16x16x32_bf16 v[212:215], a[120:123], a[48:51], v[212:215]
  v_exp_f32 v208, v208
  v_mfma_f32_16x16x32_bf16 v[216:219], a[120:123], a[72:75], v[232:235]
  ds_read_b64_tr_b16 a[176:177], v238 offset:49408
  v_fma_f32 v210, v210, s22, v230
  v_mfma_f32_16x16x32_bf16 v[216:219], a[124:127], a[76:79], v[216:219]
  ds_read_b64_tr_b16 a[178:179], v238 offset:55552
  v_fma_f32 v211, v211, s22, v230
  v_mfma_f32_16x16x32_bf16 v[216:219], a[128:131], a[80:83], v[216:219]
  v_exp_f32 v209, v209
  v_mfma_f32_16x16x32_bf16 v[216:219], a[132:135], a[84:87], v[216:219]
  ds_read_b64_tr_b16 a[180:181], v239 offset:49408
  v_fma_f32 v212, v212, s22, v230
  v_mfma_f32_16x16x32_bf16 v[216:219], a[136:139], a[88:91], v[216:219]
  ds_read_b64_tr_b16 a[182:183], v239 offset:55552
  v_fma_f32 v213, v213, s22, v230
  v_mfma_f32_16x16x32_bf16 v[216:219], a[140:143], a[92:95], v[216:219]
  v_exp_f32 v210, v210
  v_mfma_f32_16x16x32_bf16 v[220:223], a[116:119], a[92:95], v[232:235]
  ds_read_b64_tr_b16 a[184:185], v240 offset:49408
  v_fma_f32 v214, v214, s22, v230
  v_mfma_f32_16x16x32_bf16 v[220:223], a[112:115], a[88:91], v[220:223]
  ds_read_b64_tr_b16 a[186:187], v240 offset:55552
  v_fma_f32 v215, v215, s22, v230
  v_mfma_f32_16x16x32_bf16 v[220:223], a[108:111], a[84:87], v[220:223]
  v_exp_f32 v211, v211
  v_mfma_f32_16x16x32_bf16 v[220:223], a[104:107], a[80:83], v[220:223]
  ds_read_b64_tr_b16 a[188:189], v241 offset:49408
  v_fma_f32 v216, v216, s22, v231
  v_mfma_f32_16x16x32_bf16 v[220:223], a[100:103], a[76:79], v[220:223]
  ds_read_b64_tr_b16 a[190:191], v241 offset:55552
  v_fma_f32 v217, v217, s22, v231
  v_mfma_f32_16x16x32_bf16 v[220:223], a[96:99], a[72:75], v[220:223]
  s_waitcnt lgkmcnt(5)
  v_exp_f32 v212, v212
  v_mfma_f32_16x16x32_bf16 v[0:3], a[144:147], v[192:195], v[0:3]
  ds_read_b128 a[96:99], v236 offset:12288
  v_fma_f32 v218, v218, s22, v231
  v_mfma_f32_16x16x32_bf16 v[48:51], a[144:147], v[200:203], v[48:51]
  v_exp_f32 v213, v213
  v_mfma_f32_16x16x32_bf16 v[52:55], a[148:151], v[200:203], v[52:55]
  ds_read_b128 a[100:103], v237 offset:12288
  v_fma_f32 v219, v219, s22, v231
  v_mfma_f32_16x16x32_bf16 v[4:7], a[148:151], v[192:195], v[4:7]
  v_exp_f32 v214, v214
  v_mfma_f32_16x16x32_bf16 v[8:11], a[152:155], v[192:195], v[8:11]
  ds_read_b128 a[104:107], v236 offset:12416
  v_fma_f32 v220, v220, s22, v231
  v_mfma_f32_16x16x32_bf16 v[56:59], a[152:155], v[200:203], v[56:59]
  v_exp_f32 v215, v215
  v_mfma_f32_16x16x32_bf16 v[60:63], a[156:159], v[200:203], v[60:63]
  ds_read_b128 a[108:111], v237 offset:12416
  v_fma_f32 v221, v221, s22, v231
  v_mfma_f32_16x16x32_bf16 v[12:15], a[156:159], v[192:195], v[12:15]
  v_exp_f32 v216, v216
  v_mfma_f32_16x16x32_bf16 v[16:19], a[160:163], v[192:195], v[16:19]
  ds_read_b128 a[112:115], v236 offset:12544
  v_fma_f32 v222, v222, s22, v231
  v_mfma_f32_16x16x32_bf16 v[64:67], a[160:163], v[200:203], v[64:67]
  v_exp_f32 v217, v217
  v_mfma_f32_16x16x32_bf16 v[68:71], a[164:167], v[200:203], v[68:71]
  ds_read_b128 a[116:119], v237 offset:12544
  v_fma_f32 v223, v223, s22, v231
  v_mfma_f32_16x16x32_bf16 v[20:23], a[164:167], v[192:195], v[20:23]
  v_exp_f32 v218, v218
  v_mfma_f32_16x16x32_bf16 v[24:27], a[168:171], v[192:195], v[24:27]
  ds_read_b128 a[140:143], v237 offset:18688
  v_add_f32 v226, v226, v208
  v_mfma_f32_16x16x32_bf16 v[72:75], a[168:171], v[200:203], v[72:75]
  v_exp_f32 v219, v219
  v_mfma_f32_16x16x32_bf16 v[76:79], a[172:175], v[200:203], v[76:79]
  ds_read_b128 a[136:139], v236 offset:18688
  v_add_f32 v226, v226, v209
  v_mfma_f32_16x16x32_bf16 v[28:31], a[172:175], v[192:195], v[28:31]
  v_exp_f32 v220, v220
  v_mfma_f32_16x16x32_bf16 v[32:35], a[176:179], v[192:195], v[32:35]
  ds_read_b128 a[132:135], v237 offset:18560
  v_add_f32 v226, v226, v210
  v_mfma_f32_16x16x32_bf16 v[80:83], a[176:179], v[200:203], v[80:83]
  s_waitcnt lgkmcnt(4)
  v_exp_f32 v221, v221
  v_mfma_f32_16x16x32_bf16 v[84:87], a[180:183], v[200:203], v[84:87]
  ds_read_b128 a[128:131], v236 offset:18560
  v_add_f32 v226, v226, v211
  v_mfma_f32_16x16x32_bf16 v[36:39], a[180:183], v[192:195], v[36:39]
  v_exp_f32 v222, v222
  v_mfma_f32_16x16x32_bf16 v[40:43], a[184:187], v[192:195], v[40:43]
  ds_read_b128 a[124:127], v237 offset:18432
  v_add_f32 v226, v226, v212
  v_mfma_f32_16x16x32_bf16 v[88:91], a[184:187], v[200:203], v[88:91]
  v_exp_f32 v223, v223
  v_mfma_f32_16x16x32_bf16 v[92:95], a[188:191], v[200:203], v[92:95]
  ds_read_b128 a[120:123], v236 offset:18432
  v_add_f32 v226, v226, v213
  v_mfma_f32_16x16x32_bf16 v[44:47], a[188:191], v[192:195], v[44:47]
  v_add_f32 v226, v226, v214
  v_add_f32 v226, v226, v215
  v_mfma_f32_16x16x32_bf16 v[192:195], a[96:99], a[192:195], v[232:235]
  v_cvt_pk_bf16_f32 v208, v208, v209
  v_cvt_pk_bf16_f32 v209, v210, v211
  v_mfma_f32_16x16x32_bf16 v[192:195], a[100:103], a[196:199], v[192:195]
  v_cvt_pk_bf16_f32 v210, v212, v213
  v_cvt_pk_bf16_f32 v211, v214, v215
  v_mfma_f32_16x16x32_bf16 v[192:195], a[104:107], a[200:203], v[192:195]
  v_add_f32 v227, v227, v216
  v_add_f32 v227, v227, v217
  v_mfma_f32_16x16x32_bf16 v[192:195], a[108:111], a[204:207], v[192:195]
  s_waitcnt vmcnt(3) lgkmcnt(0)
  v_add_f32 v227, v227, v218
  v_add_f32 v227, v227, v219
  v_mfma_f32_16x16x32_bf16 v[192:195], a[112:115], a[208:211], v[192:195]
  s_barrier
  v_add_f32 v227, v227, v220
  v_add_f32 v227, v227, v221
  v_mfma_f32_16x16x32_bf16 v[192:195], a[116:119], a[212:215], v[192:195]
  v_add_f32 v227, v227, v222
  v_add_f32 v227, v227, v223
  v_mfma_f32_16x16x32_bf16 v[196:199], a[140:143], a[212:215], v[232:235]
  ds_read_b64_tr_b16 a[240:241], v238 offset:24576
  ds_read_b64_tr_b16 a[242:243], v238 offset:30720
  v_mfma_f32_16x16x32_bf16 v[196:199], a[136:139], a[208:211], v[196:199]
  v_cvt_pk_bf16_f32 v219, v218, v219
  v_cvt_pk_bf16_f32 v218, v216, v217
  v_mfma_f32_16x16x32_bf16 v[196:199], a[132:135], a[204:207], v[196:199]
  s_add_u32 s88, s23, 196608
  v_cvt_pk_bf16_f32 v216, v220, v221
  v_cvt_pk_bf16_f32 v217, v222, v223
  v_mfma_f32_16x16x32_bf16 v[196:199], a[128:131], a[200:203], v[196:199]
  s_add_u32 s89, s23, 199680
  v_fma_f32 v192, v192, s22, v228
  v_fma_f32 v193, v193, s22, v228
  v_mfma_f32_16x16x32_bf16 v[196:199], a[124:127], a[196:199], v[196:199]
  s_add_u32 s90, s23, 202752
  v_fma_f32 v194, v194, s22, v228
L_pg14:
  s_cbranch_execz L_ret
  v_fma_f32 v195, v195, s22, v228
  v_mfma_f32_16x16x32_bf16 v[196:199], a[120:123], a[192:195], v[196:199]
  s_add_u32 s91, s23, 205824
  ds_read_b64_tr_b16 a[244:245], v239 offset:24576
  ds_read_b64_tr_b16 a[246:247], v239 offset:30720
  v_mfma_f32_16x16x32_bf16 v[200:203], a[120:123], a[216:219], v[232:235]
  s_add_u32 s92, s23, 208896
  v_exp_f32 v192, v192
  v_mfma_f32_16x16x32_bf16 v[200:203], a[124:127], a[220:223], v[200:203]
  s_add_u32 s93, s23, 211968
  v_exp_f32 v193, v193
  v_mfma_f32_16x16x32_bf16 v[200:203], a[128:131], a[224:227], v[200:203]
  s_add_u32 s94, s23, 215040
  v_exp_f32 v194, v194
  v_mfma_f32_16x16x32_bf16 v[200:203], a[132:135], a[228:231], v[200:203]
  s_add_u32 s95, s23, 218112
  v_exp_f32 v195, v195
  v_mfma_f32_16x16x32_bf16 v[200:203], a[136:139], a[232:235], v[200:203]
  ds_read_b64_tr_b16 a[248:249], v240 offset:24576
  ds_read_b64_tr_b16 a[250:251], v240 offset:30720
  v_mfma_f32_16x16x32_bf16 v[200:203], a[140:143], a[236:239], v[200:203]
  v_fma_f32 v196, v196, s22, v228
  v_fma_f32 v197, v197, s22, v228
  v_mfma_f32_16x16x32_bf16 v[204:207], a[116:119], a[236:239], v[232:235]
  v_fma_f32 v198, v198, s22, v228
  v_fma_f32 v199, v199, s22, v228
  v_mfma_f32_16x16x32_bf16 v[204:207], a[112:115], a[232:235], v[204:207]
  v_exp_f32 v196, v196
  v_mfma_f32_16x16x32_bf16 v[204:207], a[108:111], a[228:231], v[204:207]
  v_exp_f32 v197, v197
  v_mfma_f32_16x16x32_bf16 v[204:207], a[104:107], a[224:227], v[204:207]
  ds_read_b128 a[120:123], v236 offset:55296
  ds_read_b128 a[124:127], v237 offset:55296
  v_mfma_f32_16x16x32_bf16 v[204:207], a[100:103], a[220:223], v[204:207]
  v_exp_f32 v198, v198
  v_mfma_f32_16x16x32_bf16 v[204:207], a[96:99], a[216:219], v[204:207]
  v_exp_f32 v199, v199
  v_mfma_f32_16x16x32_bf16 v[96:99], a[144:147], v[208:211], v[96:99]
  v_fma_f32 v200, v200, s22, v229
  v_fma_f32 v201, v201, s22, v229
  v_mfma_f32_16x16x32_bf16 v[144:147], a[144:147], v[216:219], v[144:147]
  v_fma_f32 v202, v202, s22, v229
  v_fma_f32 v203, v203, s22, v229
  v_mfma_f32_16x16x32_bf16 v[148:151], a[148:151], v[216:219], v[148:151]
  ds_read_b128 a[128:131], v236 offset:55424
  ds_read_b128 a[132:135], v237 offset:55424
  v_mfma_f32_16x16x32_bf16 v[100:103], a[148:151], v[208:211], v[100:103]
  v_exp_f32 v200, v200
  v_mfma_f32_16x16x32_bf16 v[104:107], a[152:155], v[208:211], v[104:107]
  v_exp_f32 v201, v201
  v_mfma_f32_16x16x32_bf16 v[152:155], a[152:155], v[216:219], v[152:155]
  v_exp_f32 v202, v202
  v_mfma_f32_16x16x32_bf16 v[156:159], a[156:159], v[216:219], v[156:159]
  v_exp_f32 v203, v203
  v_mfma_f32_16x16x32_bf16 v[108:111], a[156:159], v[208:211], v[108:111]
  ds_read_b128 a[136:139], v236 offset:55552
  ds_read_b128 a[140:143], v237 offset:55552
  v_mfma_f32_16x16x32_bf16 v[112:115], a[160:163], v[208:211], v[112:115]
  v_fma_f32 v204, v204, s22, v229
  v_fma_f32 v205, v205, s22, v229
  v_mfma_f32_16x16x32_bf16 v[160:163], a[160:163], v[216:219], v[160:163]
  v_fma_f32 v206, v206, s22, v229
  v_fma_f32 v207, v207, s22, v229
  v_mfma_f32_16x16x32_bf16 v[164:167], a[164:167], v[216:219], v[164:167]
  v_exp_f32 v204, v204
  v_mfma_f32_16x16x32_bf16 v[116:119], a[164:167], v[208:211], v[116:119]
  v_exp_f32 v205, v205
  v_mfma_f32_16x16x32_bf16 v[120:123], a[168:171], v[208:211], v[120:123]
  ds_read_b128 a[116:119], v237 offset:49408
  v_add_f32 v224, v224, v192
  v_mfma_f32_16x16x32_bf16 v[168:171], a[168:171], v[216:219], v[168:171]
  ds_read_b128 a[112:115], v236 offset:49408
  v_add_f32 v224, v224, v193
  v_mfma_f32_16x16x32_bf16 v[172:175], a[172:175], v[216:219], v[172:175]
  v_exp_f32 v206, v206
  v_mfma_f32_16x16x32_bf16 v[124:127], a[172:175], v[208:211], v[124:127]
  ds_read_b128 a[108:111], v237 offset:49280
  v_add_f32 v224, v224, v194
  v_mfma_f32_16x16x32_bf16 v[128:131], a[176:179], v[208:211], v[128:131]
  ds_read_b128 a[104:107], v236 offset:49280
  v_add_f32 v224, v224, v195
  v_mfma_f32_16x16x32_bf16 v[176:179], a[176:179], v[216:219], v[176:179]
  v_exp_f32 v207, v207
  v_mfma_f32_16x16x32_bf16 v[180:183], a[180:183], v[216:219], v[180:183]
  ds_read_b128 a[100:103], v237 offset:49152
  v_cvt_pk_bf16_f32 v192, v192, v193
  v_mfma_f32_16x16x32_bf16 v[132:135], a[180:183], v[208:211], v[132:135]
  ds_read_b128 a[96:99], v236 offset:49152
  v_cvt_pk_bf16_f32 v193, v194, v195
  v_mfma_f32_16x16x32_bf16 v[136:139], a[184:187], v[208:211], v[136:139]
  v_add_f32 v224, v224, v196
  v_add_f32 v224, v224, v197
  v_mfma_f32_16x16x32_bf16 v[184:187], a[184:187], v[216:219], v[184:187]
  ds_read_b64_tr_b16 a[144:145], v238 offset:36864
  v_add_f32 v224, v224, v198
  v_mfma_f32_16x16x32_bf16 v[188:191], a[188:191], v[216:219], v[188:191]
  ds_read_b64_tr_b16 a[146:147], v238 offset:43008
  v_add_f32 v224, v224, v199
  v_mfma_f32_16x16x32_bf16 v[140:143], a[188:191], v[208:211], v[140:143]
  v_cvt_pk_bf16_f32 v194, v196, v197
  v_cvt_pk_bf16_f32 v195, v198, v199
  v_mfma_f32_16x16x32_bf16 v[208:211], a[0:3], a[192:195], v[232:235]
  ds_read_b64_tr_b16 a[148:149], v239 offset:36864
  v_add_f32 v225, v225, v200
  v_mfma_f32_16x16x32_bf16 v[208:211], a[4:7], a[196:199], v[208:211]
  ds_read_b64_tr_b16 a[150:151], v239 offset:43008
  v_add_f32 v225, v225, v201
  v_mfma_f32_16x16x32_bf16 v[208:211], a[8:11], a[200:203], v[208:211]
  v_add_f32 v225, v225, v202
  v_add_f32 v225, v225, v203
  v_mfma_f32_16x16x32_bf16 v[208:211], a[12:15], a[204:207], v[208:211]
  ds_read_b64_tr_b16 a[152:153], v240 offset:36864
  v_cvt_pk_bf16_f32 v203, v202, v203
  v_mfma_f32_16x16x32_bf16 v[208:211], a[16:19], a[208:211], v[208:211]
  ds_read_b64_tr_b16 a[154:155], v240 offset:43008
  v_cvt_pk_bf16_f32 v202, v200, v201
  v_mfma_f32_16x16x32_bf16 v[208:211], a[20:23], a[212:215], v[208:211]
  v_add_f32 v225, v225, v204
  v_add_f32 v225, v225, v205
  v_mfma_f32_16x16x32_bf16 v[212:215], a[44:47], a[212:215], v[232:235]
  ds_read_b64_tr_b16 a[156:157], v241 offset:36864
  v_add_f32 v225, v225, v206
  v_mfma_f32_16x16x32_bf16 v[212:215], a[40:43], a[208:211], v[212:215]
  ds_read_b64_tr_b16 a[158:159], v241 offset:43008
  v_add_f32 v225, v225, v207
  v_mfma_f32_16x16x32_bf16 v[212:215], a[36:39], a[204:207], v[212:215]
  v_cvt_pk_bf16_f32 v200, v204, v205
  v_cvt_pk_bf16_f32 v201, v206, v207
  v_mfma_f32_16x16x32_bf16 v[212:215], a[32:35], a[200:203], v[212:215]
  ds_read_b64_tr_b16 a[160:161], v238 offset:36992
  v_fma_f32 v208, v208, s22, v228
  v_mfma_f32_16x16x32_bf16 v[212:215], a[28:31], a[196:199], v[212:215]
  ds_read_b64_tr_b16 a[162:163], v238 offset:43136
  v_fma_f32 v209, v209, s22, v228
  v_mfma_f32_16x16x32_bf16 v[212:215], a[24:27], a[192:195], v[212:215]
  s_waitcnt lgkmcnt(4)
  v_exp_f32 v208, v208
  v_mfma_f32_16x16x32_bf16 v[216:219], a[120:123], a[192:195], v[232:235]
  ds_read_b64_tr_b16 a[164:165], v239 offset:36992
  v_fma_f32 v210, v210, s22, v228
  v_mfma_f32_16x16x32_bf16 v[216:219], a[124:127], a[196:199], v[216:219]
  ds_read_b64_tr_b16 a[166:167], v239 offset:43136
  v_fma_f32 v211, v211, s22, v228
  v_mfma_f32_16x16x32_bf16 v[216:219], a[128:131], a[200:203], v[216:219]
  v_exp_f32 v209, v209
  v_mfma_f32_16x16x32_bf16 v[216:219], a[132:135], a[204:207], v[216:219]
  ds_read_b64_tr_b16 a[168:169], v240 offset:36992
  v_fma_f32 v212, v212, s22, v228
  v_mfma_f32_16x16x32_bf16 v[216:219], a[136:139], a[208:211], v[216:219]
  ds_read_b64_tr_b16 a[170:171], v240 offset:43136
  v_fma_f32 v213, v213, s22, v228
  v_mfma_f32_16x16x32_bf16 v[216:219], a[140:143], a[212:215], v[216:219]
  v_exp_f32 v210, v210
  v_mfma_f32_16x16x32_bf16 v[220:223], a[116:119], a[212:215], v[232:235]
  ds_read_b64_tr_b16 a[172:173], v241 offset:36992
  v_fma_f32 v214, v214, s22, v228
  v_mfma_f32_16x16x32_bf16 v[220:223], a[112:115], a[208:211], v[220:223]
  ds_read_b64_tr_b16 a[174:175], v241 offset:43136
  v_fma_f32 v215, v215, s22, v228
  v_mfma_f32_16x16x32_bf16 v[220:223], a[108:111], a[204:207], v[220:223]
  v_exp_f32 v211, v211
  v_mfma_f32_16x16x32_bf16 v[220:223], a[104:107], a[200:203], v[220:223]
  ds_read_b64_tr_b16 a[176:177], v238 offset:37120
  v_fma_f32 v216, v216, s22, v228
  v_mfma_f32_16x16x32_bf16 v[220:223], a[100:103], a[196:199], v[220:223]
  ds_read_b64_tr_b16 a[178:179], v238 offset:43264
  v_fma_f32 v217, v217, s22, v228
  v_mfma_f32_16x16x32_bf16 v[220:223], a[96:99], a[192:195], v[220:223]
  v_exp_f32 v212, v212
  v_mfma_f32_16x16x32_bf16 v[0:3], a[144:147], v[192:195], v[0:3]
  ds_read_b64_tr_b16 a[180:181], v239 offset:37120
  v_fma_f32 v218, v218, s22, v228
  v_mfma_f32_16x16x32_bf16 v[48:51], a[144:147], v[200:203], v[48:51]
  v_exp_f32 v213, v213
  v_mfma_f32_16x16x32_bf16 v[52:55], a[148:151], v[200:203], v[52:55]
  ds_read_b64_tr_b16 a[182:183], v239 offset:43264
  v_fma_f32 v219, v219, s22, v228
  v_mfma_f32_16x16x32_bf16 v[4:7], a[148:151], v[192:195], v[4:7]
  v_exp_f32 v214, v214
  v_mfma_f32_16x16x32_bf16 v[8:11], a[152:155], v[192:195], v[8:11]
  ds_read_b64_tr_b16 a[184:185], v240 offset:37120
  v_fma_f32 v220, v220, s22, v228
  v_mfma_f32_16x16x32_bf16 v[56:59], a[152:155], v[200:203], v[56:59]
  s_waitcnt lgkmcnt(4)
  v_exp_f32 v215, v215
  v_mfma_f32_16x16x32_bf16 v[60:63], a[156:159], v[200:203], v[60:63]
  ds_read_b64_tr_b16 a[186:187], v240 offset:43264
  v_fma_f32 v221, v221, s22, v228
  v_mfma_f32_16x16x32_bf16 v[12:15], a[156:159], v[192:195], v[12:15]
  v_exp_f32 v216, v216
  v_mfma_f32_16x16x32_bf16 v[16:19], a[160:163], v[192:195], v[16:19]
  ds_read_b64_tr_b16 a[188:189], v241 offset:37120
  v_fma_f32 v222, v222, s22, v228
  v_mfma_f32_16x16x32_bf16 v[64:67], a[160:163], v[200:203], v[64:67]
  v_exp_f32 v217, v217
  v_mfma_f32_16x16x32_bf16 v[68:71], a[164:167], v[200:203], v[68:71]
  ds_read_b64_tr_b16 a[190:191], v241 offset:43264
  v_fma_f32 v223, v223, s22, v228
  v_mfma_f32_16x16x32_bf16 v[20:23], a[164:167], v[192:195], v[20:23]
  v_exp_f32 v218, v218
  v_mfma_f32_16x16x32_bf16 v[24:27], a[168:171], v[192:195], v[24:27]
  ds_read_b64_tr_b16 a[252:253], v241 offset:24576
  v_add_f32 v224, v224, v208
  v_mfma_f32_16x16x32_bf16 v[72:75], a[168:171], v[200:203], v[72:75]
  v_exp_f32 v219, v219
  v_mfma_f32_16x16x32_bf16 v[76:79], a[172:175], v[200:203], v[76:79]
  ds_read_b64_tr_b16 a[254:255], v241 offset:30720
  v_add_f32 v224, v224, v209
  v_mfma_f32_16x16x32_bf16 v[28:31], a[172:175], v[192:195], v[28:31]
  s_waitcnt lgkmcnt(4)
  v_exp_f32 v220, v220
  v_mfma_f32_16x16x32_bf16 v[32:35], a[176:179], v[192:195], v[32:35]
  ds_read_b64_tr_b16 a[192:193], v238 offset:24704
  v_add_f32 v224, v224, v210
  v_mfma_f32_16x16x32_bf16 v[80:83], a[176:179], v[200:203], v[80:83]
  v_exp_f32 v221, v221
  v_mfma_f32_16x16x32_bf16 v[84:87], a[180:183], v[200:203], v[84:87]
  ds_read_b64_tr_b16 a[194:195], v238 offset:30848
  v_add_f32 v224, v224, v211
  v_mfma_f32_16x16x32_bf16 v[36:39], a[180:183], v[192:195], v[36:39]
  v_exp_f32 v222, v222
  v_mfma_f32_16x16x32_bf16 v[40:43], a[184:187], v[192:195], v[40:43]
  ds_read_b64_tr_b16 a[196:197], v239 offset:24704
  v_add_f32 v224, v224, v212
  v_mfma_f32_16x16x32_bf16 v[88:91], a[184:187], v[200:203], v[88:91]
  s_waitcnt vmcnt(0) lgkmcnt(4)
  v_exp_f32 v223, v223
  v_mfma_f32_16x16x32_bf16 v[92:95], a[188:191], v[200:203], v[92:95]
  s_barrier
  ds_read_b64_tr_b16 a[198:199], v239 offset:30848
  v_add_f32 v224, v224, v213
  v_mfma_f32_16x16x32_bf16 v[44:47], a[188:191], v[192:195], v[44:47]
  v_add_f32 v224, v224, v214
  v_add_f32 v224, v224, v215
  v_mfma_f32_16x16x32_bf16 v[192:195], a[0:3], a[216:219], v[232:235]
  ds_read_b64_tr_b16 a[200:201], v240 offset:24704
  v_cvt_pk_bf16_f32 v208, v208, v209
  v_mfma_f32_16x16x32_bf16 v[192:195], a[4:7], a[220:223], v[192:195]
  ds_read_b64_tr_b16 a[202:203], v240 offset:30848
  v_cvt_pk_bf16_f32 v209, v210, v211
  v_mfma_f32_16x16x32_bf16 v[192:195], a[8:11], a[224:227], v[192:195]
  ds_read_b64_tr_b16 a[204:205], v241 offset:24704
  v_cvt_pk_bf16_f32 v210, v212, v213
  v_mfma_f32_16x16x32_bf16 v[192:195], a[12:15], a[228:231], v[192:195]
  ds_read_b64_tr_b16 a[206:207], v241 offset:30848
  v_cvt_pk_bf16_f32 v211, v214, v215
  v_mfma_f32_16x16x32_bf16 v[192:195], a[16:19], a[232:235], v[192:195]
  ds_read_b64_tr_b16 a[208:209], v238 offset:24832
  v_add_f32 v224, v224, v216
  v_mfma_f32_16x16x32_bf16 v[192:195], a[20:23], a[236:239], v[192:195]
  ds_read_b64_tr_b16 a[210:211], v238 offset:30976
  v_add_f32 v224, v224, v217
  v_mfma_f32_16x16x32_bf16 v[196:199], a[44:47], a[236:239], v[232:235]
  ds_read_b64_tr_b16 a[212:213], v239 offset:24832
  v_add_f32 v224, v224, v218
  v_mfma_f32_16x16x32_bf16 v[196:199], a[40:43], a[232:235], v[196:199]
  ds_read_b64_tr_b16 a[214:215], v239 offset:30976
  v_add_f32 v224, v224, v219
  v_mfma_f32_16x16x32_bf16 v[196:199], a[36:39], a[228:231], v[196:199]
  ds_read_b64_tr_b16 a[144:145], v238 offset:12288
  v_add_f32 v224, v224, v220
  v_mfma_f32_16x16x32_bf16 v[196:199], a[32:35], a[224:227], v[196:199]
  ds_read_b64_tr_b16 a[146:147], v238 offset:18432
  v_add_f32 v224, v224, v221
  v_mfma_f32_16x16x32_bf16 v[196:199], a[28:31], a[220:223], v[196:199]
  ds_read_b64_tr_b16 a[148:149], v239 offset:12288
  v_add_f32 v224, v224, v222
  v_mfma_f32_16x16x32_bf16 v[196:199], a[24:27], a[216:219], v[196:199]
  ds_read_b64_tr_b16 a[150:151], v239 offset:18432
  v_add_f32 v224, v224, v223
  v_mfma_f32_16x16x32_bf16 v[200:203], a[120:123], a[216:219], v[232:235]
  ds_read_b64_tr_b16 a[152:153], v240 offset:12288
  v_mov_b32 v228, v224
  v_mfma_f32_16x16x32_bf16 v[200:203], a[124:127], a[220:223], v[200:203]
  ds_read_b64_tr_b16 a[154:155], v240 offset:18432
  v_cvt_pk_bf16_f32 v219, v218, v219
  v_mfma_f32_16x16x32_bf16 v[200:203], a[128:131], a[224:227], v[200:203]
  ds_read_b64_tr_b16 a[156:157], v241 offset:12288
  v_cvt_pk_bf16_f32 v218, v216, v217
  v_mfma_f32_16x16x32_bf16 v[200:203], a[132:135], a[228:231], v[200:203]
  ds_read_b64_tr_b16 a[158:159], v241 offset:18432
  v_permlane16_swap_b32 v224, v228
  v_mfma_f32_16x16x32_bf16 v[200:203], a[136:139], a[232:235], v[200:203]
  ds_read_b64_tr_b16 a[160:161], v238 offset:12416
  v_add_f32 v224, v224, v228
  v_mfma_f32_16x16x32_bf16 v[200:203], a[140:143], a[236:239], v[200:203]
  ds_read_b64_tr_b16 a[162:163], v238 offset:18560
  v_mov_b32 v228, v224
  v_mfma_f32_16x16x32_bf16 v[204:207], a[116:119], a[236:239], v[232:235]
  ds_read_b64_tr_b16 a[164:165], v239 offset:12416
  v_cvt_pk_bf16_f32 v216, v220, v221
  v_mfma_f32_16x16x32_bf16 v[204:207], a[112:115], a[232:235], v[204:207]
  ds_read_b64_tr_b16 a[166:167], v239 offset:18560
  v_cvt_pk_bf16_f32 v217, v222, v223
  v_mfma_f32_16x16x32_bf16 v[204:207], a[108:111], a[228:231], v[204:207]
  ds_read_b64_tr_b16 a[168:169], v240 offset:12416
  v_permlane32_swap_b32 v224, v228
  v_mfma_f32_16x16x32_bf16 v[204:207], a[104:107], a[224:227], v[204:207]
  ds_read_b64_tr_b16 a[170:171], v240 offset:18560
  v_add_f32 v228, v224, v228
  v_mfma_f32_16x16x32_bf16 v[204:207], a[100:103], a[220:223], v[204:207]
  ds_read_b64_tr_b16 a[172:173], v241 offset:12416
  v_rcp_f32 v224, v228
  v_mfma_f32_16x16x32_bf16 v[204:207], a[96:99], a[216:219], v[204:207]
  ds_read_b64_tr_b16 a[174:175], v241 offset:18560
  v_cmp_ngt_f32_e64 s[52:53], s28, v228
  v_mfma_f32_16x16x32_bf16 v[0:3], a[240:243], v[208:211], v[0:3]
  ds_read_b64_tr_b16 a[216:217], v240 offset:24832
  ds_read_b64_tr_b16 a[218:219], v240 offset:30976
  v_mul_f32_e64 v228, -v224, s3
  v_mfma_f32_16x16x32_bf16 v[4:7], a[244:247], v[208:211], v[4:7]
  ds_read_b64_tr_b16 a[220:221], v241 offset:24832
  ds_read_b64_tr_b16 a[222:223], v241 offset:30976
  v_fma_f32 v192, v192, s22, v229
  v_mfma_f32_16x16x32_bf16 v[8:11], a[248:251], v[208:211], v[8:11]
  s_waitcnt lgkmcnt(7)
  ds_read_b64_tr_b16 a[176:177], v238 offset:12544
  v_fma_f32 v193, v193, s22, v229
  v_mfma_f32_16x16x32_bf16 v[12:15], a[252:255], v[208:211], v[12:15]
  ds_read_b64_tr_b16 a[178:179], v238 offset:18688
  v_fma_f32 v194, v194, s22, v229
  v_mfma_f32_16x16x32_bf16 v[16:19], a[192:195], v[208:211], v[16:19]
  ds_read_b64_tr_b16 a[180:181], v239 offset:12544
  v_fma_f32 v195, v195, s22, v229
  v_mfma_f32_16x16x32_bf16 v[20:23], a[196:199], v[208:211], v[20:23]
  ds_read_b64_tr_b16 a[182:183], v239 offset:18688
  v_exp_f32 v192, v192
  v_mfma_f32_16x16x32_bf16 v[24:27], a[200:203], v[208:211], v[24:27]
  ds_read_b64_tr_b16 a[184:185], v240 offset:12544
  v_exp_f32 v193, v193
  v_mfma_f32_16x16x32_bf16 v[28:31], a[204:207], v[208:211], v[28:31]
  ds_read_b64_tr_b16 a[186:187], v240 offset:18688
  v_exp_f32 v194, v194
  v_mfma_f32_16x16x32_bf16 v[32:35], a[208:211], v[208:211], v[32:35]
  ds_read_b64_tr_b16 a[188:189], v241 offset:12544
  v_exp_f32 v195, v195
  v_mfma_f32_16x16x32_bf16 v[36:39], a[212:215], v[208:211], v[36:39]
  s_waitcnt lgkmcnt(6)
  ds_read_b64_tr_b16 a[190:191], v241 offset:18688
  v_fma_f32 v196, v196, s22, v229
  v_mfma_f32_16x16x32_bf16 v[40:43], a[216:219], v[208:211], v[40:43]
  v_fma_f32 v197, v197, s22, v229
  v_fma_f32 v198, v198, s22, v229
  v_mfma_f32_16x16x32_bf16 v[44:47], a[220:223], v[208:211], v[44:47]
  v_fma_f32 v199, v199, s22, v229
  v_exp_f32 v196, v196
  v_mfma_f32_16x16x32_bf16 v[0:3], a[144:147], v[216:219], v[0:3]
  v_exp_f32 v197, v197
  v_mfma_f32_16x16x32_bf16 v[4:7], a[148:151], v[216:219], v[4:7]
  v_exp_f32 v198, v198
  v_exp_f32 v199, v199
  v_add_f32 v225, v225, v192
  s_nop 2
  v_pk_fma_f32 v[0:1], v[0:1], v[224:225], v[228:229] op_sel:[0,0,0] op_sel_hi:[1,0,0]
  v_pk_fma_f32 v[2:3], v[2:3], v[224:225], v[228:229] op_sel:[0,0,0] op_sel_hi:[1,0,0]
  v_add_f32 v225, v225, v193
  v_mfma_f32_16x16x32_bf16 v[8:11], a[152:155], v[216:219], v[8:11]
  v_add_f32 v225, v225, v194
  v_add_f32 v225, v225, v195
  v_cvt_pk_bf16_f32 v192, v192, v193
  v_cvt_pk_bf16_f32 v193, v194, v195
  v_cvt_pk_bf16_f32 v0, v0, v1
  v_pk_fma_f32 v[4:5], v[4:5], v[224:225], v[228:229] op_sel:[0,0,0] op_sel_hi:[1,0,0]
  v_pk_fma_f32 v[6:7], v[6:7], v[224:225], v[228:229] op_sel:[0,0,0] op_sel_hi:[1,0,0]
  v_cvt_pk_bf16_f32 v1, v2, v3
  v_mfma_f32_16x16x32_bf16 v[12:15], a[156:159], v[216:219], v[12:15]
  ds_write_b64 v247, v[0:1] offset:0
  v_fma_f32 v200, v200, s22, v229
  v_cvt_pk_bf16_f32 v4, v4, v5
  v_cvt_pk_bf16_f32 v5, v6, v7
  v_pk_fma_f32 v[8:9], v[8:9], v[224:225], v[228:229] op_sel:[0,0,0] op_sel_hi:[1,0,0]
  v_pk_fma_f32 v[10:11], v[10:11], v[224:225], v[228:229] op_sel:[0,0,0] op_sel_hi:[1,0,0]
  v_max3_f32 v3, |v2|, |v3|, |v6|
  v_mfma_f32_16x16x32_bf16 v[16:19], a[160:163], v[216:219], v[16:19]
  ds_write_b64 v248, v[4:5] offset:0
  v_fma_f32 v201, v201, s22, v229
  v_cvt_pk_bf16_f32 v8, v8, v9
  v_cvt_pk_bf16_f32 v9, v10, v11
  v_pk_fma_f32 v[12:13], v[12:13], v[224:225], v[228:229] op_sel:[0,0,0] op_sel_hi:[1,0,0]
  v_pk_fma_f32 v[14:15], v[14:15], v[224:225], v[228:229] op_sel:[0,0,0] op_sel_hi:[1,0,0]
  v_cmp_nle_f32_e64 s[46:47], s85, v3
  v_mfma_f32_16x16x32_bf16 v[20:23], a[164:167], v[216:219], v[20:23]
  ds_write_b64 v249, v[8:9] offset:0
  v_fma_f32 v202, v202, s22, v229
  v_cvt_pk_bf16_f32 v12, v12, v13
  v_pk_fma_f32 v[16:17], v[16:17], v[224:225], v[228:229] op_sel:[0,0,0] op_sel_hi:[1,0,0]
  v_pk_fma_f32 v[18:19], v[18:19], v[224:225], v[228:229] op_sel:[0,0,0] op_sel_hi:[1,0,0]
  v_cvt_pk_bf16_f32 v13, v14, v15
  v_mfma_f32_16x16x32_bf16 v[24:27], a[168:171], v[216:219], v[24:27]
  ds_write_b64 v250, v[12:13] offset:0
  v_fma_f32 v203, v203, s22, v229
  v_cvt_pk_bf16_f32 v16, v16, v17
  v_pk_fma_f32 v[20:21], v[20:21], v[224:225], v[228:229] op_sel:[0,0,0] op_sel_hi:[1,0,0]
  v_pk_fma_f32 v[22:23], v[22:23], v[224:225], v[228:229] op_sel:[0,0,0] op_sel_hi:[1,0,0]
  v_cvt_pk_bf16_f32 v17, v18, v19
  v_mfma_f32_16x16x32_bf16 v[28:31], a[172:175], v[216:219], v[28:31]
  s_waitcnt lgkmcnt(2)
  ds_read_b128 v[8:11], v242 offset:0
  ds_write_b64 v247, v[16:17] offset:128
  v_exp_f32 v200, v200
  v_cvt_pk_bf16_f32 v20, v20, v21
  v_pk_fma_f32 v[24:25], v[24:25], v[224:225], v[228:229] op_sel:[0,0,0] op_sel_hi:[1,0,0]
  v_pk_fma_f32 v[26:27], v[26:27], v[224:225], v[228:229] op_sel:[0,0,0] op_sel_hi:[1,0,0]
  v_cvt_pk_bf16_f32 v21, v22, v23
  v_mfma_f32_16x16x32_bf16 v[32:35], a[176:179], v[216:219], v[32:35]
  ds_read_b128 v[12:15], v242 offset:3072
  ds_write_b64 v248, v[20:21] offset:128
  v_exp_f32 v201, v201
  v_cvt_pk_bf16_f32 v24, v24, v25
  v_pk_fma_f32 v[28:29], v[28:29], v[224:225], v[228:229] op_sel:[0,0,0] op_sel_hi:[1,0,0]
  v_pk_fma_f32 v[30:31], v[30:31], v[224:225], v[228:229] op_sel:[0,0,0] op_sel_hi:[1,0,0]
  v_cvt_pk_bf16_f32 v25, v26, v27
  v_mfma_f32_16x16x32_bf16 v[36:39], a[180:183], v[216:219], v[36:39]
  s_waitcnt lgkmcnt(3)
  buffer_store_dwordx4 v[8:11], v243, s[16:19], s88 offen sc0 sc1 nt
  ds_write_b64 v249, v[24:25] offset:128
  v_exp_f32 v202, v202
  v_cvt_pk_bf16_f32 v28, v28, v29
  v_pk_fma_f32 v[32:33], v[32:33], v[224:225], v[228:229] op_sel:[0,0,0] op_sel_hi:[1,0,0]
  v_pk_fma_f32 v[34:35], v[34:35], v[224:225], v[228:229] op_sel:[0,0,0] op_sel_hi:[1,0,0]
  v_cvt_pk_bf16_f32 v29, v30, v31
  v_mfma_f32_16x16x32_bf16 v[40:43], a[184:187], v[216:219], v[40:43]
  ds_write_b64 v250, v[28:29] offset:128
  v_exp_f32 v203, v203
  v_cvt_pk_bf16_f32 v32, v32, v33
  v_pk_fma_f32 v[36:37], v[36:37], v[224:225], v[228:229] op_sel:[0,0,0] op_sel_hi:[1,0,0]
  v_pk_fma_f32 v[38:39], v[38:39], v[224:225], v[228:229] op_sel:[0,0,0] op_sel_hi:[1,0,0]
  v_cvt_pk_bf16_f32 v33, v34, v35
  v_mfma_f32_16x16x32_bf16 v[44:47], a[188:191], v[216:219], v[44:47]
  s_waitcnt lgkmcnt(2)
  buffer_store_dwordx4 v[12:15], v243, s[16:19], s89 offen sc0 sc1 nt
  ds_read_b128 v[16:19], v242 offset:128
  ds_write_b64 v247, v[32:33] offset:256
  v_add_f32 v225, v225, v196
  v_cvt_pk_bf16_f32 v36, v36, v37
  v_pk_fma_f32 v[40:41], v[40:41], v[224:225], v[228:229] op_sel:[0,0,0] op_sel_hi:[1,0,0]
  v_pk_fma_f32 v[42:43], v[42:43], v[224:225], v[228:229] op_sel:[0,0,0] op_sel_hi:[1,0,0]
  v_cvt_pk_bf16_f32 v37, v38, v39
  v_mfma_f32_16x16x32_bf16 v[208:211], a[96:99], a[48:51], v[232:235]
  ds_read_b128 v[20:23], v242 offset:3200
  ds_write_b64 v248, v[36:37] offset:256
  v_add_f32 v225, v225, v197
  v_cvt_pk_bf16_f32 v40, v40, v41
  v_pk_fma_f32 v[44:45], v[44:45], v[224:225], v[228:229] op_sel:[0,0,0] op_sel_hi:[1,0,0]
  v_pk_fma_f32 v[46:47], v[46:47], v[224:225], v[228:229] op_sel:[0,0,0] op_sel_hi:[1,0,0]
  v_cvt_pk_bf16_f32 v41, v42, v43
  v_mfma_f32_16x16x32_bf16 v[208:211], a[100:103], a[52:55], v[208:211]
  s_waitcnt lgkmcnt(3)
  buffer_store_dwordx4 v[16:19], v243, s[16:19], s88 offen offset:128 sc0 sc1 nt
  ds_write_b64 v249, v[40:41] offset:256
  v_add_f32 v225, v225, v198
  v_cvt_pk_bf16_f32 v44, v44, v45
  v_cvt_pk_bf16_f32 v45, v46, v47
  v_mfma_f32_16x16x32_bf16 v[208:211], a[104:107], a[56:59], v[208:211]
  ds_write_b64 v250, v[44:45] offset:256
  v_add_f32 v225, v225, v199
  v_mfma_f32_16x16x32_bf16 v[208:211], a[108:111], a[60:63], v[208:211]
  s_waitcnt lgkmcnt(3)
  buffer_store_dwordx4 v[20:23], v243, s[16:19], s89 offen offset:128 sc0 sc1 nt
  ds_read_b128 v[24:27], v242 offset:256
  v_cvt_pk_bf16_f32 v194, v196, v197
  v_cvt_pk_bf16_f32 v195, v198, v199
  v_mfma_f32_16x16x32_bf16 v[208:211], a[112:115], a[64:67], v[208:211]
  ds_read_b128 v[28:31], v242 offset:3328
  v_fma_f32 v204, v204, s22, v229
  v_fma_f32 v205, v205, s22, v229
  v_mfma_f32_16x16x32_bf16 v[208:211], a[116:119], a[68:71], v[208:211]
  s_waitcnt lgkmcnt(1)
  buffer_store_dwordx4 v[24:27], v243, s[16:19], s88 offen offset:256 sc0 sc1 nt
  v_fma_f32 v206, v206, s22, v229
  v_fma_f32 v207, v207, s22, v229
  v_exp_f32 v204, v204
  v_mfma_f32_16x16x32_bf16 v[212:215], a[140:143], a[68:71], v[232:235]
  v_exp_f32 v205, v205
  v_mfma_f32_16x16x32_bf16 v[212:215], a[136:139], a[64:67], v[212:215]
  s_waitcnt lgkmcnt(0)
  buffer_store_dwordx4 v[28:31], v243, s[16:19], s89 offen offset:256 sc0 sc1 nt
  v_exp_f32 v206, v206
  v_exp_f32 v207, v207
  v_mfma_f32_16x16x32_bf16 v[212:215], a[132:135], a[60:63], v[212:215]
  v_add_f32 v225, v225, v200
  v_add_f32 v225, v225, v201
  v_mfma_f32_16x16x32_bf16 v[212:215], a[128:131], a[56:59], v[212:215]
  v_add_f32 v225, v225, v202
  v_add_f32 v225, v225, v203
  v_mfma_f32_16x16x32_bf16 v[212:215], a[124:127], a[52:55], v[212:215]
  v_cvt_pk_bf16_f32 v203, v202, v203
  v_cvt_pk_bf16_f32 v202, v200, v201
  v_mfma_f32_16x16x32_bf16 v[212:215], a[120:123], a[48:51], v[212:215]
  v_add_f32 v225, v225, v204
  v_add_f32 v225, v225, v205
  v_mfma_f32_16x16x32_bf16 v[216:219], a[120:123], a[72:75], v[232:235]
  v_add_f32 v225, v225, v206
  v_add_f32 v225, v225, v207
  v_mfma_f32_16x16x32_bf16 v[216:219], a[124:127], a[76:79], v[216:219]
  v_mov_b32 v229, v225
  v_cvt_pk_bf16_f32 v200, v204, v205
  v_mfma_f32_16x16x32_bf16 v[216:219], a[128:131], a[80:83], v[216:219]
  v_permlane16_swap_b32 v225, v229
  v_mfma_f32_16x16x32_bf16 v[216:219], a[132:135], a[84:87], v[216:219]
  v_add_f32 v225, v225, v229
  v_mov_b32 v229, v225
  v_mfma_f32_16x16x32_bf16 v[216:219], a[136:139], a[88:91], v[216:219]
  v_cvt_pk_bf16_f32 v201, v206, v207
  v_permlane32_swap_b32 v225, v229
  v_mfma_f32_16x16x32_bf16 v[216:219], a[140:143], a[92:95], v[216:219]
  v_add_f32 v229, v225, v229
  v_rcp_f32 v225, v229
  v_mfma_f32_16x16x32_bf16 v[220:223], a[116:119], a[92:95], v[232:235]
  v_cmp_ngt_f32_e64 s[54:55], s28, v229
  v_mul_f32_e64 v229, -v225, s3
  v_mfma_f32_16x16x32_bf16 v[220:223], a[112:115], a[88:91], v[220:223]
  v_fma_f32 v208, v208, s22, v230
  v_fma_f32 v209, v209, s22, v230
  v_mfma_f32_16x16x32_bf16 v[220:223], a[108:111], a[84:87], v[220:223]
  v_fma_f32 v210, v210, s22, v230
  v_fma_f32 v211, v211, s22, v230
  v_mfma_f32_16x16x32_bf16 v[220:223], a[104:107], a[80:83], v[220:223]
  v_exp_f32 v208, v208
  v_mfma_f32_16x16x32_bf16 v[220:223], a[100:103], a[76:79], v[220:223]
  v_exp_f32 v209, v209
  v_mfma_f32_16x16x32_bf16 v[220:223], a[96:99], a[72:75], v[220:223]
  v_exp_f32 v210, v210
  v_mfma_f32_16x16x32_bf16 v[48:51], a[240:243], v[192:195], v[48:51]
  ds_read_b128 a[120:123], v236 offset:18432
  v_exp_f32 v211, v211
  v_mfma_f32_16x16x32_bf16 v[52:55], a[244:247], v[192:195], v[52:55]
  ds_read_b128 a[124:127], v237 offset:18432
  v_fma_f32 v212, v212, s22, v230
  v_mfma_f32_16x16x32_bf16 v[56:59], a[248:251], v[192:195], v[56:59]
  ds_read_b128 a[128:131], v236 offset:18560
  v_fma_f32 v213, v213, s22, v230
  v_mfma_f32_16x16x32_bf16 v[60:63], a[252:255], v[192:195], v[60:63]
  ds_read_b128 a[132:135], v237 offset:18560
  v_fma_f32 v214, v214, s22, v230
  v_mfma_f32_16x16x32_bf16 v[64:67], a[192:195], v[192:195], v[64:67]
  ds_read_b128 a[136:139], v236 offset:18688
  v_fma_f32 v215, v215, s22, v230
  v_mfma_f32_16x16x32_bf16 v[68:71], a[196:199], v[192:195], v[68:71]
  ds_read_b128 a[140:143], v237 offset:18688
  v_exp_f32 v212, v212
  v_mfma_f32_16x16x32_bf16 v[72:75], a[200:203], v[192:195], v[72:75]
  ds_read_b128 a[116:119], v237 offset:12544
  v_exp_f32 v213, v213
  v_mfma_f32_16x16x32_bf16 v[76:79], a[204:207], v[192:195], v[76:79]
  ds_read_b128 a[112:115], v236 offset:12544
  v_exp_f32 v214, v214
  v_mfma_f32_16x16x32_bf16 v[80:83], a[208:211], v[192:195], v[80:83]
  ds_read_b128 a[108:111], v237 offset:12416
  v_exp_f32 v215, v215
  v_mfma_f32_16x16x32_bf16 v[84:87], a[212:215], v[192:195], v[84:87]
  ds_read_b128 a[104:107], v236 offset:12416
  v_add_f32 v226, v226, v208
  v_mfma_f32_16x16x32_bf16 v[88:91], a[216:219], v[192:195], v[88:91]
  ds_read_b128 a[100:103], v237 offset:12288
  v_add_f32 v226, v226, v209
  v_mfma_f32_16x16x32_bf16 v[92:95], a[220:223], v[192:195], v[92:95]
  ds_read_b128 a[96:99], v236 offset:12288
  v_add_f32 v226, v226, v210
  v_mfma_f32_16x16x32_bf16 v[48:51], a[144:147], v[200:203], v[48:51]
  v_add_f32 v226, v226, v211
  v_cvt_pk_bf16_f32 v208, v208, v209
  v_mfma_f32_16x16x32_bf16 v[52:55], a[148:151], v[200:203], v[52:55]
  v_cvt_pk_bf16_f32 v209, v210, v211
  v_fma_f32 v216, v216, s22, v231
  v_fma_f32 v217, v217, s22, v231
  v_fma_f32 v218, v218, s22, v231
  v_fma_f32 v219, v219, s22, v231
  v_pk_fma_f32 v[48:49], v[48:49], v[224:225], v[228:229] op_sel:[0,1,1] op_sel_hi:[1,1,1]
  v_pk_fma_f32 v[50:51], v[50:51], v[224:225], v[228:229] op_sel:[0,1,1] op_sel_hi:[1,1,1]
  v_exp_f32 v216, v216
  v_mfma_f32_16x16x32_bf16 v[56:59], a[152:155], v[200:203], v[56:59]
  v_exp_f32 v217, v217
  v_exp_f32 v218, v218
  v_cvt_pk_bf16_f32 v48, v48, v49
  v_pk_fma_f32 v[52:53], v[52:53], v[224:225], v[228:229] op_sel:[0,1,1] op_sel_hi:[1,1,1]
  v_pk_fma_f32 v[54:55], v[54:55], v[224:225], v[228:229] op_sel:[0,1,1] op_sel_hi:[1,1,1]
  v_cvt_pk_bf16_f32 v49, v50, v51
  v_mfma_f32_16x16x32_bf16 v[60:63], a[156:159], v[200:203], v[60:63]
L_pg15:
  s_cbranch_execz L_ret
  ds_write_b64 v247, v[48:49] offset:6144
  v_exp_f32 v219, v219
  v_cvt_pk_bf16_f32 v52, v52, v53
  v_cvt_pk_bf16_f32 v53, v54, v55
  v_pk_fma_f32 v[56:57], v[56:57], v[224:225], v[228:229] op_sel:[0,1,1] op_sel_hi:[1,1,1]
  v_pk_fma_f32 v[58:59], v[58:59], v[224:225], v[228:229] op_sel:[0,1,1] op_sel_hi:[1,1,1]
  v_max3_f32 v51, |v50|, |v51|, |v54|
  v_mfma_f32_16x16x32_bf16 v[64:67], a[160:163], v[200:203], v[64:67]
  ds_write_b64 v248, v[52:53] offset:6144
  v_add_f32 v226, v226, v212
  v_cvt_pk_bf16_f32 v56, v56, v57
  v_cvt_pk_bf16_f32 v57, v58, v59
  v_pk_fma_f32 v[60:61], v[60:61], v[224:225], v[228:229] op_sel:[0,1,1] op_sel_hi:[1,1,1]
  v_pk_fma_f32 v[62:63], v[62:63], v[224:225], v[228:229] op_sel:[0,1,1] op_sel_hi:[1,1,1]
  v_cmp_nle_f32_e64 s[50:51], s85, v51
  v_mfma_f32_16x16x32_bf16 v[68:71], a[164:167], v[200:203], v[68:71]
  ds_write_b64 v249, v[56:57] offset:6144
  v_add_f32 v226, v226, v213
  v_cvt_pk_bf16_f32 v60, v60, v61
  v_pk_fma_f32 v[64:65], v[64:65], v[224:225], v[228:229] op_sel:[0,1,1] op_sel_hi:[1,1,1]
  v_pk_fma_f32 v[66:67], v[66:67], v[224:225], v[228:229] op_sel:[0,1,1] op_sel_hi:[1,1,1]
  v_cvt_pk_bf16_f32 v61, v62, v63
  v_mfma_f32_16x16x32_bf16 v[72:75], a[168:171], v[200:203], v[72:75]
  ds_write_b64 v250, v[60:61] offset:6144
  v_add_f32 v226, v226, v214
  v_cvt_pk_bf16_f32 v64, v64, v65
  v_pk_fma_f32 v[68:69], v[68:69], v[224:225], v[228:229] op_sel:[0,1,1] op_sel_hi:[1,1,1]
  v_pk_fma_f32 v[70:71], v[70:71], v[224:225], v[228:229] op_sel:[0,1,1] op_sel_hi:[1,1,1]
  v_cvt_pk_bf16_f32 v65, v66, v67
  v_mfma_f32_16x16x32_bf16 v[76:79], a[172:175], v[200:203], v[76:79]
  ds_read_b128 v[56:59], v242 offset:6144
  ds_write_b64 v247, v[64:65] offset:6272
  v_add_f32 v226, v226, v215
  v_cvt_pk_bf16_f32 v68, v68, v69
  v_pk_fma_f32 v[72:73], v[72:73], v[224:225], v[228:229] op_sel:[0,1,1] op_sel_hi:[1,1,1]
  v_pk_fma_f32 v[74:75], v[74:75], v[224:225], v[228:229] op_sel:[0,1,1] op_sel_hi:[1,1,1]
  v_cvt_pk_bf16_f32 v69, v70, v71
  v_mfma_f32_16x16x32_bf16 v[80:83], a[176:179], v[200:203], v[80:83]
  ds_read_b128 v[60:63], v242 offset:9216
  ds_write_b64 v248, v[68:69] offset:6272
  v_cvt_pk_bf16_f32 v210, v212, v213
  v_cvt_pk_bf16_f32 v72, v72, v73
  v_pk_fma_f32 v[76:77], v[76:77], v[224:225], v[228:229] op_sel:[0,1,1] op_sel_hi:[1,1,1]
  v_pk_fma_f32 v[78:79], v[78:79], v[224:225], v[228:229] op_sel:[0,1,1] op_sel_hi:[1,1,1]
  v_cvt_pk_bf16_f32 v73, v74, v75
  v_mfma_f32_16x16x32_bf16 v[84:87], a[180:183], v[200:203], v[84:87]
  s_waitcnt lgkmcnt(3)
  buffer_store_dwordx4 v[56:59], v243, s[16:19], s90 offen sc0 sc1 nt
  ds_write_b64 v249, v[72:73] offset:6272
  v_cvt_pk_bf16_f32 v211, v214, v215
  v_cvt_pk_bf16_f32 v76, v76, v77
  v_pk_fma_f32 v[80:81], v[80:81], v[224:225], v[228:229] op_sel:[0,1,1] op_sel_hi:[1,1,1]
  v_pk_fma_f32 v[82:83], v[82:83], v[224:225], v[228:229] op_sel:[0,1,1] op_sel_hi:[1,1,1]
  v_cvt_pk_bf16_f32 v77, v78, v79
  v_mfma_f32_16x16x32_bf16 v[88:91], a[184:187], v[200:203], v[88:91]
  ds_write_b64 v250, v[76:77] offset:6272
  v_fma_f32 v220, v220, s22, v231
  v_cvt_pk_bf16_f32 v80, v80, v81
  v_pk_fma_f32 v[84:85], v[84:85], v[224:225], v[228:229] op_sel:[0,1,1] op_sel_hi:[1,1,1]
  v_pk_fma_f32 v[86:87], v[86:87], v[224:225], v[228:229] op_sel:[0,1,1] op_sel_hi:[1,1,1]
  v_cvt_pk_bf16_f32 v81, v82, v83
  v_mfma_f32_16x16x32_bf16 v[92:95], a[188:191], v[200:203], v[92:95]
  s_waitcnt lgkmcnt(2)
  buffer_store_dwordx4 v[60:63], v243, s[16:19], s91 offen sc0 sc1 nt
  ds_read_b128 v[64:67], v242 offset:6272
  ds_write_b64 v247, v[80:81] offset:6400
  v_fma_f32 v221, v221, s22, v231
  v_cvt_pk_bf16_f32 v84, v84, v85
  v_pk_fma_f32 v[88:89], v[88:89], v[224:225], v[228:229] op_sel:[0,1,1] op_sel_hi:[1,1,1]
  v_pk_fma_f32 v[90:91], v[90:91], v[224:225], v[228:229] op_sel:[0,1,1] op_sel_hi:[1,1,1]
  v_cvt_pk_bf16_f32 v85, v86, v87
  v_mfma_f32_16x16x32_bf16 v[192:195], a[0:3], a[48:51], v[232:235]
  ds_read_b128 v[68:71], v242 offset:9344
  ds_write_b64 v248, v[84:85] offset:6400
  v_fma_f32 v222, v222, s22, v231
  v_cvt_pk_bf16_f32 v88, v88, v89
  v_pk_fma_f32 v[92:93], v[92:93], v[224:225], v[228:229] op_sel:[0,1,1] op_sel_hi:[1,1,1]
  v_pk_fma_f32 v[94:95], v[94:95], v[224:225], v[228:229] op_sel:[0,1,1] op_sel_hi:[1,1,1]
  v_cvt_pk_bf16_f32 v89, v90, v91
  v_mfma_f32_16x16x32_bf16 v[192:195], a[4:7], a[52:55], v[192:195]
  s_waitcnt lgkmcnt(3)
  buffer_store_dwordx4 v[64:67], v243, s[16:19], s90 offen offset:128 sc0 sc1 nt
  ds_write_b64 v249, v[88:89] offset:6400
  v_fma_f32 v223, v223, s22, v231
  v_cvt_pk_bf16_f32 v92, v92, v93
  v_cvt_pk_bf16_f32 v93, v94, v95
  v_mfma_f32_16x16x32_bf16 v[192:195], a[8:11], a[56:59], v[192:195]
  ds_write_b64 v250, v[92:93] offset:6400
  v_exp_f32 v220, v220
  v_mfma_f32_16x16x32_bf16 v[192:195], a[12:15], a[60:63], v[192:195]
  s_waitcnt lgkmcnt(3)
  buffer_store_dwordx4 v[68:71], v243, s[16:19], s91 offen offset:128 sc0 sc1 nt
  ds_read_b128 v[72:75], v242 offset:6400
  v_exp_f32 v221, v221
  v_mfma_f32_16x16x32_bf16 v[192:195], a[16:19], a[64:67], v[192:195]
  ds_read_b128 v[76:79], v242 offset:9472
  v_exp_f32 v222, v222
  v_mfma_f32_16x16x32_bf16 v[192:195], a[20:23], a[68:71], v[192:195]
  s_waitcnt lgkmcnt(1)
  buffer_store_dwordx4 v[72:75], v243, s[16:19], s90 offen offset:256 sc0 sc1 nt
  v_exp_f32 v223, v223
  v_add_f32 v227, v227, v216
  v_mfma_f32_16x16x32_bf16 v[196:199], a[44:47], a[68:71], v[232:235]
  v_add_f32 v227, v227, v217
  v_add_f32 v227, v227, v218
  v_mfma_f32_16x16x32_bf16 v[196:199], a[40:43], a[64:67], v[196:199]
  s_waitcnt lgkmcnt(0)
  buffer_store_dwordx4 v[76:79], v243, s[16:19], s91 offen offset:256 sc0 sc1 nt
  v_add_f32 v227, v227, v219
  v_cvt_pk_bf16_f32 v219, v218, v219
  v_cvt_pk_bf16_f32 v218, v216, v217
  v_mfma_f32_16x16x32_bf16 v[196:199], a[36:39], a[60:63], v[196:199]
  v_add_f32 v227, v227, v220
  v_add_f32 v227, v227, v221
  v_mfma_f32_16x16x32_bf16 v[196:199], a[32:35], a[56:59], v[196:199]
  v_add_f32 v227, v227, v222
  v_add_f32 v227, v227, v223
  v_mfma_f32_16x16x32_bf16 v[196:199], a[28:31], a[52:55], v[196:199]
  v_cvt_pk_bf16_f32 v216, v220, v221
  v_cvt_pk_bf16_f32 v217, v222, v223
  v_mfma_f32_16x16x32_bf16 v[196:199], a[24:27], a[48:51], v[196:199]
  v_fma_f32 v192, v192, s22, v230
  v_fma_f32 v193, v193, s22, v230
  v_mfma_f32_16x16x32_bf16 v[200:203], a[120:123], a[48:51], v[232:235]
  v_fma_f32 v194, v194, s22, v230
  v_fma_f32 v195, v195, s22, v230
  v_mfma_f32_16x16x32_bf16 v[200:203], a[124:127], a[52:55], v[200:203]
  v_exp_f32 v192, v192
  v_mfma_f32_16x16x32_bf16 v[200:203], a[128:131], a[56:59], v[200:203]
  v_exp_f32 v193, v193
  v_mfma_f32_16x16x32_bf16 v[200:203], a[132:135], a[60:63], v[200:203]
  v_exp_f32 v194, v194
  v_mfma_f32_16x16x32_bf16 v[200:203], a[136:139], a[64:67], v[200:203]
  v_exp_f32 v195, v195
  v_mfma_f32_16x16x32_bf16 v[200:203], a[140:143], a[68:71], v[200:203]
  v_fma_f32 v196, v196, s22, v230
  v_fma_f32 v197, v197, s22, v230
  v_mfma_f32_16x16x32_bf16 v[204:207], a[116:119], a[68:71], v[232:235]
  v_fma_f32 v198, v198, s22, v230
  v_fma_f32 v199, v199, s22, v230
  v_mfma_f32_16x16x32_bf16 v[204:207], a[112:115], a[64:67], v[204:207]
  v_exp_f32 v196, v196
  v_mfma_f32_16x16x32_bf16 v[204:207], a[108:111], a[60:63], v[204:207]
  v_exp_f32 v197, v197
  v_mfma_f32_16x16x32_bf16 v[204:207], a[104:107], a[56:59], v[204:207]
  v_exp_f32 v198, v198
  v_mfma_f32_16x16x32_bf16 v[204:207], a[100:103], a[52:55], v[204:207]
  v_exp_f32 v199, v199
  v_mfma_f32_16x16x32_bf16 v[204:207], a[96:99], a[48:51], v[204:207]
  v_add_f32 v226, v226, v192
  v_add_f32 v226, v226, v193
  v_mfma_f32_16x16x32_bf16 v[96:99], a[144:147], v[208:211], v[96:99]
  v_add_f32 v226, v226, v194
  v_add_f32 v226, v226, v195
  v_mfma_f32_16x16x32_bf16 v[144:147], a[144:147], v[216:219], v[144:147]
  v_cvt_pk_bf16_f32 v192, v192, v193
  v_cvt_pk_bf16_f32 v193, v194, v195
  v_mfma_f32_16x16x32_bf16 v[148:151], a[148:151], v[216:219], v[148:151]
  v_fma_f32 v200, v200, s22, v230
  v_fma_f32 v201, v201, s22, v230
  v_mfma_f32_16x16x32_bf16 v[100:103], a[148:151], v[208:211], v[100:103]
  v_fma_f32 v202, v202, s22, v230
  v_fma_f32 v203, v203, s22, v230
  v_mfma_f32_16x16x32_bf16 v[104:107], a[152:155], v[208:211], v[104:107]
  ds_read_b64_tr_b16 a[144:145], v238 offset:36864
  v_exp_f32 v200, v200
  v_mfma_f32_16x16x32_bf16 v[152:155], a[152:155], v[216:219], v[152:155]
  ds_read_b64_tr_b16 a[146:147], v238 offset:43008
  v_exp_f32 v201, v201
  v_mfma_f32_16x16x32_bf16 v[156:159], a[156:159], v[216:219], v[156:159]
  v_exp_f32 v202, v202
  v_mfma_f32_16x16x32_bf16 v[108:111], a[156:159], v[208:211], v[108:111]
  ds_read_b64_tr_b16 a[148:149], v239 offset:36864
  v_exp_f32 v203, v203
  v_mfma_f32_16x16x32_bf16 v[112:115], a[160:163], v[208:211], v[112:115]
  ds_read_b64_tr_b16 a[150:151], v239 offset:43008
  v_add_f32 v226, v226, v196
  v_mfma_f32_16x16x32_bf16 v[160:163], a[160:163], v[216:219], v[160:163]
  v_add_f32 v226, v226, v197
  v_add_f32 v226, v226, v198
  v_mfma_f32_16x16x32_bf16 v[164:167], a[164:167], v[216:219], v[164:167]
  ds_read_b64_tr_b16 a[152:153], v240 offset:36864
  v_add_f32 v226, v226, v199
  v_mfma_f32_16x16x32_bf16 v[116:119], a[164:167], v[208:211], v[116:119]
  ds_read_b64_tr_b16 a[154:155], v240 offset:43008
  v_cvt_pk_bf16_f32 v194, v196, v197
  v_mfma_f32_16x16x32_bf16 v[120:123], a[168:171], v[208:211], v[120:123]
  v_cvt_pk_bf16_f32 v195, v198, v199
  v_fma_f32 v204, v204, s22, v230
  v_mfma_f32_16x16x32_bf16 v[168:171], a[168:171], v[216:219], v[168:171]
  ds_read_b64_tr_b16 a[156:157], v241 offset:36864
  v_fma_f32 v205, v205, s22, v230
  v_mfma_f32_16x16x32_bf16 v[172:175], a[172:175], v[216:219], v[172:175]
  ds_read_b64_tr_b16 a[158:159], v241 offset:43008
  v_fma_f32 v206, v206, s22, v230
  v_mfma_f32_16x16x32_bf16 v[124:127], a[172:175], v[208:211], v[124:127]
  v_fma_f32 v207, v207, s22, v230
  v_exp_f32 v204, v204
  v_mfma_f32_16x16x32_bf16 v[128:131], a[176:179], v[208:211], v[128:131]
  ds_read_b64_tr_b16 a[160:161], v238 offset:36992
  v_exp_f32 v205, v205
  v_mfma_f32_16x16x32_bf16 v[176:179], a[176:179], v[216:219], v[176:179]
  ds_read_b64_tr_b16 a[162:163], v238 offset:43136
  v_exp_f32 v206, v206
  v_mfma_f32_16x16x32_bf16 v[180:183], a[180:183], v[216:219], v[180:183]
  v_exp_f32 v207, v207
  v_mfma_f32_16x16x32_bf16 v[132:135], a[180:183], v[208:211], v[132:135]
  ds_read_b64_tr_b16 a[164:165], v239 offset:36992
  v_add_f32 v226, v226, v200
  v_mfma_f32_16x16x32_bf16 v[136:139], a[184:187], v[208:211], v[136:139]
  ds_read_b64_tr_b16 a[166:167], v239 offset:43136
  v_add_f32 v226, v226, v201
  v_mfma_f32_16x16x32_bf16 v[184:187], a[184:187], v[216:219], v[184:187]
  v_add_f32 v226, v226, v202
  v_add_f32 v226, v226, v203
  v_mfma_f32_16x16x32_bf16 v[188:191], a[188:191], v[216:219], v[188:191]
  ds_read_b64_tr_b16 a[168:169], v240 offset:36992
  v_cvt_pk_bf16_f32 v203, v202, v203
  v_mfma_f32_16x16x32_bf16 v[140:143], a[188:191], v[208:211], v[140:143]
  ds_read_b64_tr_b16 a[170:171], v240 offset:43136
  v_cvt_pk_bf16_f32 v202, v200, v201
  v_mfma_f32_16x16x32_bf16 v[208:211], a[0:3], a[72:75], v[232:235]
  v_add_f32 v226, v226, v204
  v_add_f32 v226, v226, v205
  v_mfma_f32_16x16x32_bf16 v[208:211], a[4:7], a[76:79], v[208:211]
  ds_read_b64_tr_b16 a[172:173], v241 offset:36992
  v_add_f32 v226, v226, v206
  v_mfma_f32_16x16x32_bf16 v[208:211], a[8:11], a[80:83], v[208:211]
  ds_read_b64_tr_b16 a[174:175], v241 offset:43136
  v_add_f32 v226, v226, v207
  v_mfma_f32_16x16x32_bf16 v[208:211], a[12:15], a[84:87], v[208:211]
  v_mov_b32 v230, v226
  v_cvt_pk_bf16_f32 v200, v204, v205
  v_mfma_f32_16x16x32_bf16 v[208:211], a[16:19], a[88:91], v[208:211]
  ds_read_b64_tr_b16 a[176:177], v238 offset:37120
  v_permlane16_swap_b32 v226, v230
  v_mfma_f32_16x16x32_bf16 v[208:211], a[20:23], a[92:95], v[208:211]
  ds_read_b64_tr_b16 a[178:179], v238 offset:43264
  v_add_f32 v226, v226, v230
  v_mov_b32 v230, v226
  v_mfma_f32_16x16x32_bf16 v[212:215], a[44:47], a[92:95], v[232:235]
  v_cvt_pk_bf16_f32 v201, v206, v207
  v_permlane32_swap_b32 v226, v230
  v_mfma_f32_16x16x32_bf16 v[212:215], a[40:43], a[88:91], v[212:215]
  ds_read_b64_tr_b16 a[180:181], v239 offset:37120
  v_add_f32 v230, v226, v230
  v_rcp_f32 v226, v230
  v_mfma_f32_16x16x32_bf16 v[212:215], a[36:39], a[84:87], v[212:215]
  ds_read_b64_tr_b16 a[182:183], v239 offset:43264
  v_cmp_ngt_f32_e64 s[56:57], s28, v230
  v_mul_f32_e64 v230, -v226, s3
  v_mfma_f32_16x16x32_bf16 v[212:215], a[32:35], a[80:83], v[212:215]
  v_fma_f32 v208, v208, s22, v231
  v_fma_f32 v209, v209, s22, v231
  v_mfma_f32_16x16x32_bf16 v[212:215], a[28:31], a[76:79], v[212:215]
  ds_read_b64_tr_b16 a[184:185], v240 offset:37120
  v_fma_f32 v210, v210, s22, v231
  v_fma_f32 v211, v211, s22, v231
  v_mfma_f32_16x16x32_bf16 v[212:215], a[24:27], a[72:75], v[212:215]
  ds_read_b64_tr_b16 a[186:187], v240 offset:43264
  v_exp_f32 v208, v208
  v_mfma_f32_16x16x32_bf16 v[216:219], a[120:123], a[72:75], v[232:235]
  v_exp_f32 v209, v209
  v_mfma_f32_16x16x32_bf16 v[216:219], a[124:127], a[76:79], v[216:219]
  ds_read_b64_tr_b16 a[188:189], v241 offset:37120
  v_exp_f32 v210, v210
  v_mfma_f32_16x16x32_bf16 v[216:219], a[128:131], a[80:83], v[216:219]
  ds_read_b64_tr_b16 a[190:191], v241 offset:43264
  v_exp_f32 v211, v211
  v_mfma_f32_16x16x32_bf16 v[216:219], a[132:135], a[84:87], v[216:219]
  v_fma_f32 v212, v212, s22, v231
  v_fma_f32 v213, v213, s22, v231
  v_mfma_f32_16x16x32_bf16 v[216:219], a[136:139], a[88:91], v[216:219]
  v_fma_f32 v214, v214, s22, v231
  v_fma_f32 v215, v215, s22, v231
  v_mfma_f32_16x16x32_bf16 v[216:219], a[140:143], a[92:95], v[216:219]
  v_exp_f32 v212, v212
  v_mfma_f32_16x16x32_bf16 v[220:223], a[116:119], a[92:95], v[232:235]
  v_exp_f32 v213, v213
  v_mfma_f32_16x16x32_bf16 v[220:223], a[112:115], a[88:91], v[220:223]
  v_exp_f32 v214, v214
  v_mfma_f32_16x16x32_bf16 v[220:223], a[108:111], a[84:87], v[220:223]
  v_exp_f32 v215, v215
  v_mfma_f32_16x16x32_bf16 v[220:223], a[104:107], a[80:83], v[220:223]
  v_add_f32 v227, v227, v208
  v_add_f32 v227, v227, v209
  v_mfma_f32_16x16x32_bf16 v[220:223], a[100:103], a[76:79], v[220:223]
  v_add_f32 v227, v227, v210
  v_add_f32 v227, v227, v211
  v_mfma_f32_16x16x32_bf16 v[220:223], a[96:99], a[72:75], v[220:223]
  v_cvt_pk_bf16_f32 v208, v208, v209
  v_cvt_pk_bf16_f32 v209, v210, v211
  v_mfma_f32_16x16x32_bf16 v[96:99], a[240:243], v[192:195], v[96:99]
  v_fma_f32 v216, v216, s22, v231
  v_fma_f32 v217, v217, s22, v231
  v_mfma_f32_16x16x32_bf16 v[100:103], a[244:247], v[192:195], v[100:103]
  v_fma_f32 v218, v218, s22, v231
  v_fma_f32 v219, v219, s22, v231
  v_mfma_f32_16x16x32_bf16 v[104:107], a[248:251], v[192:195], v[104:107]
  v_exp_f32 v216, v216
  v_mfma_f32_16x16x32_bf16 v[108:111], a[252:255], v[192:195], v[108:111]
  v_exp_f32 v217, v217
  v_mfma_f32_16x16x32_bf16 v[112:115], a[192:195], v[192:195], v[112:115]
  v_exp_f32 v218, v218
  v_mfma_f32_16x16x32_bf16 v[116:119], a[196:199], v[192:195], v[116:119]
  v_exp_f32 v219, v219
  v_mfma_f32_16x16x32_bf16 v[120:123], a[200:203], v[192:195], v[120:123]
  v_add_f32 v227, v227, v212
  v_add_f32 v227, v227, v213
  v_mfma_f32_16x16x32_bf16 v[124:127], a[204:207], v[192:195], v[124:127]
  v_add_f32 v227, v227, v214
  v_add_f32 v227, v227, v215
  v_mfma_f32_16x16x32_bf16 v[128:131], a[208:211], v[192:195], v[128:131]
  v_cvt_pk_bf16_f32 v210, v212, v213
  v_cvt_pk_bf16_f32 v211, v214, v215
  v_mfma_f32_16x16x32_bf16 v[132:135], a[212:215], v[192:195], v[132:135]
  v_fma_f32 v220, v220, s22, v231
  v_fma_f32 v221, v221, s22, v231
  v_mfma_f32_16x16x32_bf16 v[136:139], a[216:219], v[192:195], v[136:139]
  v_fma_f32 v222, v222, s22, v231
  v_fma_f32 v223, v223, s22, v231
  v_mfma_f32_16x16x32_bf16 v[140:143], a[220:223], v[192:195], v[140:143]
  s_waitcnt lgkmcnt(0)
  v_exp_f32 v220, v220
  v_mfma_f32_16x16x32_bf16 v[96:99], a[144:147], v[200:203], v[96:99]
  v_exp_f32 v221, v221
  v_exp_f32 v222, v222
  v_mfma_f32_16x16x32_bf16 v[100:103], a[148:151], v[200:203], v[100:103]
  v_exp_f32 v223, v223
  v_add_f32 v227, v227, v216
  v_add_f32 v227, v227, v217
  v_add_f32 v227, v227, v218
  s_nop 0
  v_pk_fma_f32 v[96:97], v[96:97], v[226:227], v[230:231] op_sel:[0,0,0] op_sel_hi:[1,0,0]
  v_pk_fma_f32 v[98:99], v[98:99], v[226:227], v[230:231] op_sel:[0,0,0] op_sel_hi:[1,0,0]
  v_add_f32 v227, v227, v219
  v_mfma_f32_16x16x32_bf16 v[104:107], a[152:155], v[200:203], v[104:107]
  v_cvt_pk_bf16_f32 v219, v218, v219
  v_cvt_pk_bf16_f32 v218, v216, v217
  v_add_f32 v227, v227, v220
  v_add_f32 v227, v227, v221
  v_cvt_pk_bf16_f32 v96, v96, v97
  v_pk_fma_f32 v[100:101], v[100:101], v[226:227], v[230:231] op_sel:[0,0,0] op_sel_hi:[1,0,0]
  v_pk_fma_f32 v[102:103], v[102:103], v[226:227], v[230:231] op_sel:[0,0,0] op_sel_hi:[1,0,0]
  v_cvt_pk_bf16_f32 v97, v98, v99
  v_mfma_f32_16x16x32_bf16 v[108:111], a[156:159], v[200:203], v[108:111]
  ds_write_b64 v247, v[96:97] offset:0
  v_add_f32 v227, v227, v222
  v_add_f32 v227, v227, v223
  v_cvt_pk_bf16_f32 v100, v100, v101
  v_cvt_pk_bf16_f32 v101, v102, v103
  v_pk_fma_f32 v[104:105], v[104:105], v[226:227], v[230:231] op_sel:[0,0,0] op_sel_hi:[1,0,0]
  v_pk_fma_f32 v[106:107], v[106:107], v[226:227], v[230:231] op_sel:[0,0,0] op_sel_hi:[1,0,0]
  v_max3_f32 v99, |v98|, |v99|, |v102|
  v_mfma_f32_16x16x32_bf16 v[112:115], a[160:163], v[200:203], v[112:115]
  ds_write_b64 v248, v[100:101] offset:0
  v_mov_b32 v231, v227
  v_cvt_pk_bf16_f32 v216, v220, v221
  v_cvt_pk_bf16_f32 v104, v104, v105
  v_cvt_pk_bf16_f32 v105, v106, v107
  v_pk_fma_f32 v[108:109], v[108:109], v[226:227], v[230:231] op_sel:[0,0,0] op_sel_hi:[1,0,0]
  v_pk_fma_f32 v[110:111], v[110:111], v[226:227], v[230:231] op_sel:[0,0,0] op_sel_hi:[1,0,0]
  v_cmp_nle_f32_e64 s[100:101], s85, v99
  v_mfma_f32_16x16x32_bf16 v[116:119], a[164:167], v[200:203], v[116:119]
  ds_write_b64 v249, v[104:105] offset:0
  v_permlane16_swap_b32 v227, v231
  v_cvt_pk_bf16_f32 v108, v108, v109
  v_pk_fma_f32 v[112:113], v[112:113], v[226:227], v[230:231] op_sel:[0,0,0] op_sel_hi:[1,0,0]
  v_pk_fma_f32 v[114:115], v[114:115], v[226:227], v[230:231] op_sel:[0,0,0] op_sel_hi:[1,0,0]
  v_cvt_pk_bf16_f32 v109, v110, v111
  v_mfma_f32_16x16x32_bf16 v[120:123], a[168:171], v[200:203], v[120:123]
  ds_write_b64 v250, v[108:109] offset:0
  v_add_f32 v227, v227, v231
  v_mov_b32 v231, v227
  v_cvt_pk_bf16_f32 v112, v112, v113
  v_pk_fma_f32 v[116:117], v[116:117], v[226:227], v[230:231] op_sel:[0,0,0] op_sel_hi:[1,0,0]
  v_pk_fma_f32 v[118:119], v[118:119], v[226:227], v[230:231] op_sel:[0,0,0] op_sel_hi:[1,0,0]
  v_cvt_pk_bf16_f32 v113, v114, v115
  v_mfma_f32_16x16x32_bf16 v[124:127], a[172:175], v[200:203], v[124:127]
  ds_read_b128 v[104:107], v242 offset:0
  ds_write_b64 v247, v[112:113] offset:128
  v_cvt_pk_bf16_f32 v217, v222, v223
  v_permlane32_swap_b32 v227, v231
  v_cvt_pk_bf16_f32 v116, v116, v117
  v_pk_fma_f32 v[120:121], v[120:121], v[226:227], v[230:231] op_sel:[0,0,0] op_sel_hi:[1,0,0]
  v_pk_fma_f32 v[122:123], v[122:123], v[226:227], v[230:231] op_sel:[0,0,0] op_sel_hi:[1,0,0]
  v_cvt_pk_bf16_f32 v117, v118, v119
  v_mfma_f32_16x16x32_bf16 v[128:131], a[176:179], v[200:203], v[128:131]
  ds_read_b128 v[108:111], v242 offset:3072
  ds_write_b64 v248, v[116:117] offset:128
  v_add_f32 v231, v227, v231
  v_cvt_pk_bf16_f32 v120, v120, v121
  v_pk_fma_f32 v[124:125], v[124:125], v[226:227], v[230:231] op_sel:[0,0,0] op_sel_hi:[1,0,0]
  v_pk_fma_f32 v[126:127], v[126:127], v[226:227], v[230:231] op_sel:[0,0,0] op_sel_hi:[1,0,0]
  v_cvt_pk_bf16_f32 v121, v122, v123
  v_mfma_f32_16x16x32_bf16 v[132:135], a[180:183], v[200:203], v[132:135]
  s_waitcnt lgkmcnt(3)
  buffer_store_dwordx4 v[104:107], v243, s[16:19], s92 offen sc0 sc1 nt
  ds_write_b64 v249, v[120:121] offset:128
  v_rcp_f32 v227, v231
  v_cvt_pk_bf16_f32 v124, v124, v125
  v_pk_fma_f32 v[128:129], v[128:129], v[226:227], v[230:231] op_sel:[0,0,0] op_sel_hi:[1,0,0]
  v_pk_fma_f32 v[130:131], v[130:131], v[226:227], v[230:231] op_sel:[0,0,0] op_sel_hi:[1,0,0]
  v_cvt_pk_bf16_f32 v125, v126, v127
  v_mfma_f32_16x16x32_bf16 v[136:139], a[184:187], v[200:203], v[136:139]
  ds_write_b64 v250, v[124:125] offset:128
  v_cmp_ngt_f32_e64 s[58:59], s28, v231
  v_cvt_pk_bf16_f32 v128, v128, v129
  v_pk_fma_f32 v[132:133], v[132:133], v[226:227], v[230:231] op_sel:[0,0,0] op_sel_hi:[1,0,0]
  v_pk_fma_f32 v[134:135], v[134:135], v[226:227], v[230:231] op_sel:[0,0,0] op_sel_hi:[1,0,0]
  v_cvt_pk_bf16_f32 v129, v130, v131
  v_mfma_f32_16x16x32_bf16 v[140:143], a[188:191], v[200:203], v[140:143]
  s_waitcnt lgkmcnt(2)
  buffer_store_dwordx4 v[108:111], v243, s[16:19], s93 offen sc0 sc1 nt
  ds_read_b128 v[112:115], v242 offset:128
  ds_write_b64 v247, v[128:129] offset:256
  v_mul_f32_e64 v231, -v227, s3
  v_cvt_pk_bf16_f32 v132, v132, v133
  v_pk_fma_f32 v[136:137], v[136:137], v[226:227], v[230:231] op_sel:[0,0,0] op_sel_hi:[1,0,0]
  v_pk_fma_f32 v[138:139], v[138:139], v[226:227], v[230:231] op_sel:[0,0,0] op_sel_hi:[1,0,0]
  v_cvt_pk_bf16_f32 v133, v134, v135
  v_mfma_f32_16x16x32_bf16 v[144:147], a[240:243], v[208:211], v[144:147]
  ds_read_b128 v[116:119], v242 offset:3200
  ds_write_b64 v248, v[132:133] offset:256
  v_cvt_pk_bf16_f32 v136, v136, v137
  v_pk_fma_f32 v[140:141], v[140:141], v[226:227], v[230:231] op_sel:[0,0,0] op_sel_hi:[1,0,0]
  v_pk_fma_f32 v[142:143], v[142:143], v[226:227], v[230:231] op_sel:[0,0,0] op_sel_hi:[1,0,0]
  v_cvt_pk_bf16_f32 v137, v138, v139
  v_mfma_f32_16x16x32_bf16 v[144:147], a[144:147], v[216:219], v[144:147]
  s_waitcnt lgkmcnt(3)
  buffer_store_dwordx4 v[112:115], v243, s[16:19], s92 offen offset:128 sc0 sc1 nt
  ds_write_b64 v249, v[136:137] offset:256
  v_cvt_pk_bf16_f32 v140, v140, v141
  v_cvt_pk_bf16_f32 v141, v142, v143
  v_mfma_f32_16x16x32_bf16 v[148:151], a[244:247], v[208:211], v[148:151]
  ds_write_b64 v250, v[140:141] offset:256
  v_mfma_f32_16x16x32_bf16 v[148:151], a[148:151], v[216:219], v[148:151]
  ds_read_b128 v[120:123], v242 offset:256
  v_pk_fma_f32 v[144:145], v[144:145], v[226:227], v[230:231] op_sel:[0,1,1] op_sel_hi:[1,1,1]
  v_pk_fma_f32 v[146:147], v[146:147], v[226:227], v[230:231] op_sel:[0,1,1] op_sel_hi:[1,1,1]
  v_cvt_pk_bf16_f32 v144, v144, v145
  v_mfma_f32_16x16x32_bf16 v[152:155], a[248:251], v[208:211], v[152:155]
  ds_read_b128 v[124:127], v242 offset:3328
  v_cvt_pk_bf16_f32 v145, v146, v147
  v_mfma_f32_16x16x32_bf16 v[152:155], a[152:155], v[216:219], v[152:155]
  s_waitcnt lgkmcnt(4)
  buffer_store_dwordx4 v[116:119], v243, s[16:19], s93 offen offset:128 sc0 sc1 nt
  ds_write_b64 v247, v[144:145] offset:6144
  v_pk_fma_f32 v[148:149], v[148:149], v[226:227], v[230:231] op_sel:[0,1,1] op_sel_hi:[1,1,1]
  v_pk_fma_f32 v[150:151], v[150:151], v[226:227], v[230:231] op_sel:[0,1,1] op_sel_hi:[1,1,1]
  v_cvt_pk_bf16_f32 v148, v148, v149
  v_mfma_f32_16x16x32_bf16 v[156:159], a[252:255], v[208:211], v[156:159]
  v_cvt_pk_bf16_f32 v149, v150, v151
  v_mfma_f32_16x16x32_bf16 v[156:159], a[156:159], v[216:219], v[156:159]
  s_waitcnt lgkmcnt(2)
  buffer_store_dwordx4 v[120:123], v243, s[16:19], s92 offen offset:256 sc0 sc1 nt
  ds_write_b64 v248, v[148:149] offset:6144
  v_pk_fma_f32 v[152:153], v[152:153], v[226:227], v[230:231] op_sel:[0,1,1] op_sel_hi:[1,1,1]
  v_pk_fma_f32 v[154:155], v[154:155], v[226:227], v[230:231] op_sel:[0,1,1] op_sel_hi:[1,1,1]
  v_cvt_pk_bf16_f32 v152, v152, v153
  v_mfma_f32_16x16x32_bf16 v[160:163], a[192:195], v[208:211], v[160:163]
  v_cvt_pk_bf16_f32 v153, v154, v155
  v_mfma_f32_16x16x32_bf16 v[160:163], a[160:163], v[216:219], v[160:163]
  s_waitcnt lgkmcnt(2)
  buffer_store_dwordx4 v[124:127], v243, s[16:19], s93 offen offset:256 sc0 sc1 nt
  ds_write_b64 v249, v[152:153] offset:6144
  v_pk_fma_f32 v[156:157], v[156:157], v[226:227], v[230:231] op_sel:[0,1,1] op_sel_hi:[1,1,1]
  v_pk_fma_f32 v[158:159], v[158:159], v[226:227], v[230:231] op_sel:[0,1,1] op_sel_hi:[1,1,1]
  v_cvt_pk_bf16_f32 v156, v156, v157
  v_mfma_f32_16x16x32_bf16 v[164:167], a[196:199], v[208:211], v[164:167]
  v_cvt_pk_bf16_f32 v157, v158, v159
  v_mfma_f32_16x16x32_bf16 v[164:167], a[164:167], v[216:219], v[164:167]
  ds_write_b64 v250, v[156:157] offset:6144
  v_pk_fma_f32 v[160:161], v[160:161], v[226:227], v[230:231] op_sel:[0,1,1] op_sel_hi:[1,1,1]
  v_pk_fma_f32 v[162:163], v[162:163], v[226:227], v[230:231] op_sel:[0,1,1] op_sel_hi:[1,1,1]
  v_cvt_pk_bf16_f32 v160, v160, v161
  v_mfma_f32_16x16x32_bf16 v[168:171], a[200:203], v[208:211], v[168:171]
  ds_read_b128 v[152:155], v242 offset:6144
  v_cvt_pk_bf16_f32 v161, v162, v163
  v_mfma_f32_16x16x32_bf16 v[168:171], a[168:171], v[216:219], v[168:171]
  ds_write_b64 v247, v[160:161] offset:6272
  v_pk_fma_f32 v[164:165], v[164:165], v[226:227], v[230:231] op_sel:[0,1,1] op_sel_hi:[1,1,1]
  v_pk_fma_f32 v[166:167], v[166:167], v[226:227], v[230:231] op_sel:[0,1,1] op_sel_hi:[1,1,1]
  v_cvt_pk_bf16_f32 v164, v164, v165
  v_mfma_f32_16x16x32_bf16 v[172:175], a[204:207], v[208:211], v[172:175]
  ds_read_b128 v[156:159], v242 offset:9216
  v_cvt_pk_bf16_f32 v165, v166, v167
  v_mfma_f32_16x16x32_bf16 v[172:175], a[172:175], v[216:219], v[172:175]
  s_waitcnt lgkmcnt(2)
  buffer_store_dwordx4 v[152:155], v243, s[16:19], s94 offen sc0 sc1 nt
  ds_write_b64 v248, v[164:165] offset:6272
  v_pk_fma_f32 v[168:169], v[168:169], v[226:227], v[230:231] op_sel:[0,1,1] op_sel_hi:[1,1,1]
  v_pk_fma_f32 v[170:171], v[170:171], v[226:227], v[230:231] op_sel:[0,1,1] op_sel_hi:[1,1,1]
  v_cvt_pk_bf16_f32 v168, v168, v169
  v_mfma_f32_16x16x32_bf16 v[176:179], a[208:211], v[208:211], v[176:179]
  v_cvt_pk_bf16_f32 v169, v170, v171
  v_max3_f32 v147, |v146|, |v147|, |v150|
  v_mfma_f32_16x16x32_bf16 v[176:179], a[176:179], v[216:219], v[176:179]
  s_waitcnt lgkmcnt(1)
  buffer_store_dwordx4 v[156:159], v243, s[16:19], s95 offen sc0 sc1 nt
  ds_write_b64 v249, v[168:169] offset:6272
  v_pk_fma_f32 v[172:173], v[172:173], v[226:227], v[230:231] op_sel:[0,1,1] op_sel_hi:[1,1,1]
  v_pk_fma_f32 v[174:175], v[174:175], v[226:227], v[230:231] op_sel:[0,1,1] op_sel_hi:[1,1,1]
  v_cvt_pk_bf16_f32 v172, v172, v173
  v_mfma_f32_16x16x32_bf16 v[180:183], a[212:215], v[208:211], v[180:183]
  v_cvt_pk_bf16_f32 v173, v174, v175
  v_cmp_nle_f32_e64 s[86:87], s85, v147
  v_mfma_f32_16x16x32_bf16 v[180:183], a[180:183], v[216:219], v[180:183]
  ds_write_b64 v250, v[172:173] offset:6272
  v_pk_fma_f32 v[176:177], v[176:177], v[226:227], v[230:231] op_sel:[0,1,1] op_sel_hi:[1,1,1]
  v_pk_fma_f32 v[178:179], v[178:179], v[226:227], v[230:231] op_sel:[0,1,1] op_sel_hi:[1,1,1]
  v_cvt_pk_bf16_f32 v176, v176, v177
  v_mfma_f32_16x16x32_bf16 v[184:187], a[216:219], v[208:211], v[184:187]
  ds_read_b128 v[160:163], v242 offset:6272
  v_cvt_pk_bf16_f32 v177, v178, v179
  v_mfma_f32_16x16x32_bf16 v[184:187], a[184:187], v[216:219], v[184:187]
  ds_write_b64 v247, v[176:177] offset:6400
  v_pk_fma_f32 v[180:181], v[180:181], v[226:227], v[230:231] op_sel:[0,1,1] op_sel_hi:[1,1,1]
  v_pk_fma_f32 v[182:183], v[182:183], v[226:227], v[230:231] op_sel:[0,1,1] op_sel_hi:[1,1,1]
  v_cvt_pk_bf16_f32 v180, v180, v181
  v_mfma_f32_16x16x32_bf16 v[188:191], a[220:223], v[208:211], v[188:191]
  ds_read_b128 v[164:167], v242 offset:9344
  v_cvt_pk_bf16_f32 v181, v182, v183
  v_mfma_f32_16x16x32_bf16 v[188:191], a[188:191], v[216:219], v[188:191]
  s_waitcnt lgkmcnt(2)
  buffer_store_dwordx4 v[160:163], v243, s[16:19], s94 offen offset:128 sc0 sc1 nt
  ds_write_b64 v248, v[180:181] offset:6400
  v_pk_fma_f32 v[184:185], v[184:185], v[226:227], v[230:231] op_sel:[0,1,1] op_sel_hi:[1,1,1]
  v_pk_fma_f32 v[186:187], v[186:187], v[226:227], v[230:231] op_sel:[0,1,1] op_sel_hi:[1,1,1]
  v_cvt_pk_bf16_f32 v184, v184, v185
  v_cvt_pk_bf16_f32 v185, v186, v187
  s_nop 0
  v_pk_fma_f32 v[188:189], v[188:189], v[226:227], v[230:231] op_sel:[0,1,1] op_sel_hi:[1,1,1]
  v_pk_fma_f32 v[190:191], v[190:191], v[226:227], v[230:231] op_sel:[0,1,1] op_sel_hi:[1,1,1]
  v_cvt_pk_bf16_f32 v188, v188, v189
  v_cvt_pk_bf16_f32 v189, v190, v191
  ds_write_b64 v249, v[184:185] offset:6400
  ds_write_b64 v250, v[188:189] offset:6400
  ds_read_b128 v[168:171], v242 offset:6400
  ds_read_b128 v[172:175], v242 offset:9472
  s_waitcnt lgkmcnt(5)
  buffer_store_dwordx4 v[164:167], v243, s[16:19], s95 offen offset:128 sc0 sc1 nt
  s_waitcnt lgkmcnt(1)
  buffer_store_dwordx4 v[168:171], v243, s[16:19], s94 offen offset:256 sc0 sc1 nt
  s_waitcnt lgkmcnt(0)
  buffer_store_dwordx4 v[172:175], v243, s[16:19], s95 offen offset:256 sc0 sc1 nt
  s_mov_b32 s70, 0
  s_and_b32 s36, s36, s37
  s_lshr_b32 s37, s36, 16
  s_and_b32 s36, s36, s37
  s_or_b32 s44, s44, s36
  s_and_b32 s38, s38, s39
  s_lshr_b32 s39, s38, 16
  s_and_b32 s38, s38, s39
  s_or_b32 s44, s44, s38
  s_or_b64 s[72:73], s[44:45], s[44:45]
  s_cselect_b32 s71, 1, 0
  s_or_b32 s70, s70, s71
  s_and_b32 s40, s40, s41
  s_lshr_b32 s41, s40, 16
  s_and_b32 s40, s40, s41
  s_or_b32 s48, s48, s40
  s_and_b32 s42, s42, s43
  s_lshr_b32 s43, s42, 16
  s_and_b32 s42, s42, s43
  s_or_b32 s48, s48, s42
  s_or_b64 s[72:73], s[48:49], s[48:49]
  s_cselect_b32 s71, 2, 0
  s_or_b32 s70, s70, s71
  s_and_b32 s46, s46, s47
  s_lshr_b32 s47, s46, 16
  s_and_b32 s46, s46, s47
  s_or_b32 s52, s52, s46
  s_and_b32 s50, s50, s51
  s_lshr_b32 s51, s50, 16
  s_and_b32 s50, s50, s51
  s_or_b32 s52, s52, s50
  s_or_b64 s[72:73], s[52:53], s[54:55]
  s_cselect_b32 s71, 4, 0
  s_or_b32 s70, s70, s71
  s_and_b32 s100, s100, s101
  s_lshr_b32 s101, s100, 16
  s_and_b32 s100, s100, s101
  s_or_b32 s56, s56, s100
  s_and_b32 s86, s86, s87
  s_lshr_b32 s87, s86, 16
L_pg16:
  s_cbranch_execz L_ret
  s_and_b32 s86, s86, s87
  s_or_b32 s56, s56, s86
  s_or_b64 s[72:73], s[56:57], s[58:59]
  s_cselect_b32 s71, 8, 0
  s_or_b32 s70, s70, s71
  s_cbranch_scc1 L_slow
L_end:
  s_endpgm
L_slow:
  s_waitcnt vmcnt(0) lgkmcnt(0)
  v_mbcnt_lo_u32_b32 v236, -1, 0
  v_mbcnt_hi_u32_b32 v236, -1, v236
  v_and_b32 v237, 15, v236
  v_lshrrev_b32 v239, 4, v236
  v_lshrrev_b32 v238, 2, v237
  v_lshl_add_u32 v238, v239, 2, v238
  v_mul_u32_u24 v238, 384, v238
  v_and_b32 v237, 3, v237
  v_lshl_add_u32 v238, v237, 3, v238
  s_mov_b32 s69, s30
  v_add_u32 v238, s69, v238
  s_mov_b32 s68, 0
L_slow_combo:
  s_bitcmp1_b32 s70, s68
  s_cbranch_scc0 L_slow_next
  s_lshr_b32 s71, s68, 1
  s_and_b32 s72, s68, 1
  s_mul_i32 s71, s71, 196608
  s_mul_i32 s72, s72, 12288
  s_add_u32 s24, s23, s71
  s_add_u32 s24, s24, s72
  s_add_u32 s25, s24, 6144
  s_add_u32 s73, s31, s71
  buffer_load_dwordx4 a[0:3], v245, s[4:7], s24 offen
  buffer_load_dwordx4 a[4:7], v245, s[4:7], s24 offen offset:64
  buffer_load_dwordx4 a[8:11], v245, s[4:7], s24 offen offset:128
  buffer_load_dwordx4 a[12:15], v245, s[4:7], s24 offen offset:192
  buffer_load_dwordx4 a[16:19], v245, s[4:7], s24 offen offset:256
  buffer_load_dwordx4 a[20:23], v245, s[4:7], s24 offen offset:320
  v_mov_b32 v228, 0xff800000
  buffer_load_dwordx4 a[24:27], v245, s[4:7], s25 offen
  buffer_load_dwordx4 a[28:31], v245, s[4:7], s25 offen offset:64
  buffer_load_dwordx4 a[32:35], v245, s[4:7], s25 offen offset:128
  buffer_load_dwordx4 a[36:39], v245, s[4:7], s25 offen offset:192
  buffer_load_dwordx4 a[40:43], v245, s[4:7], s25 offen offset:256
  buffer_load_dwordx4 a[44:47], v245, s[4:7], s25 offen offset:320
  v_mov_b32 v229, 0xff800000
  v_mov_b32 v0, 0
  v_mov_b32 v1, 0
  v_mov_b32 v2, 0
  v_mov_b32 v3, 0
  v_mov_b32 v4, 0
  v_mov_b32 v5, 0
  v_mov_b32 v6, 0
  v_mov_b32 v7, 0
  v_mov_b32 v8, 0
  v_mov_b32 v9, 0
  v_mov_b32 v10, 0
  v_mov_b32 v11, 0
  v_mov_b32 v12, 0
  v_mov_b32 v13, 0
  v_mov_b32 v14, 0
  v_mov_b32 v15, 0
  v_mov_b32 v16, 0
  v_mov_b32 v17, 0
  v_mov_b32 v18, 0
  v_mov_b32 v19, 0
  v_mov_b32 v20, 0
  v_mov_b32 v21, 0
  v_mov_b32 v22, 0
  v_mov_b32 v23, 0
  v_mov_b32 v24, 0
  v_mov_b32 v25, 0
  v_mov_b32 v26, 0
  v_mov_b32 v27, 0
  v_mov_b32 v28, 0
  v_mov_b32 v29, 0
  v_mov_b32 v30, 0
  v_mov_b32 v31, 0
  v_mov_b32 v32, 0
  v_mov_b32 v33, 0
  v_mov_b32 v34, 0
  v_mov_b32 v35, 0
  v_mov_b32 v36, 0
  v_mov_b32 v37, 0
  v_mov_b32 v38, 0
  v_mov_b32 v39, 0
  v_mov_b32 v40, 0
  v_mov_b32 v41, 0
  v_mov_b32 v42, 0
  v_mov_b32 v43, 0
  v_mov_b32 v44, 0
  v_mov_b32 v45, 0
  v_mov_b32 v46, 0
  v_mov_b32 v47, 0
  v_mov_b32 v48, 0
  v_mov_b32 v49, 0
  v_mov_b32 v50, 0
  v_mov_b32 v51, 0
  v_mov_b32 v52, 0
  v_mov_b32 v53, 0
  v_mov_b32 v54, 0
  v_mov_b32 v55, 0
  v_mov_b32 v56, 0
  v_mov_b32 v57, 0
  v_mov_b32 v58, 0
  v_mov_b32 v59, 0
  v_mov_b32 v60, 0
  v_mov_b32 v61, 0
  v_mov_b32 v62, 0
  v_mov_b32 v63, 0
  v_mov_b32 v64, 0
  v_mov_b32 v65, 0
  v_mov_b32 v66, 0
  v_mov_b32 v67, 0
  v_mov_b32 v68, 0
  v_mov_b32 v69, 0
  v_mov_b32 v70, 0
  v_mov_b32 v71, 0
  v_mov_b32 v72, 0
  v_mov_b32 v73, 0
  v_mov_b32 v74, 0
  v_mov_b32 v75, 0
  v_mov_b32 v76, 0
  v_mov_b32 v77, 0
  v_mov_b32 v78, 0
  v_mov_b32 v79, 0
  v_mov_b32 v80, 0
  v_mov_b32 v81, 0
  v_mov_b32 v82, 0
  v_mov_b32 v83, 0
  v_mov_b32 v84, 0
  v_mov_b32 v85, 0
  v_mov_b32 v86, 0
  v_mov_b32 v87, 0
  v_mov_b32 v88, 0
  v_mov_b32 v89, 0
  v_mov_b32 v90, 0
  v_mov_b32 v91, 0
  v_mov_b32 v92, 0
  v_mov_b32 v93, 0
  v_mov_b32 v94, 0
  v_mov_b32 v95, 0
  s_waitcnt vmcnt(0)
  s_mov_b32 s74, 0
L_slow_pass:
  s_mov_b32 s75, s73
  s_add_u32 s76, s73, 196608
L_slow_tile:
  s_add_u32 s77, s75, 6144
  buffer_load_dwordx4 a[96:99], v245, s[8:11], s75 offen
  buffer_load_dwordx4 a[100:103], v245, s[8:11], s75 offen offset:64
  buffer_load_dwordx4 a[104:107], v245, s[8:11], s75 offen offset:128
  buffer_load_dwordx4 a[108:111], v245, s[8:11], s75 offen offset:192
  buffer_load_dwordx4 a[112:115], v245, s[8:11], s75 offen offset:256
  buffer_load_dwordx4 a[116:119], v245, s[8:11], s75 offen offset:320
  buffer_load_dwordx4 a[120:123], v245, s[8:11], s77 offen
  buffer_load_dwordx4 a[124:127], v245, s[8:11], s77 offen offset:64
  buffer_load_dwordx4 a[128:131], v245, s[8:11], s77 offen offset:128
  buffer_load_dwordx4 a[132:135], v245, s[8:11], s77 offen offset:192
  buffer_load_dwordx4 a[136:139], v245, s[8:11], s77 offen offset:256
  buffer_load_dwordx4 a[140:143], v245, s[8:11], s77 offen offset:320
  s_mov_b32 m0, s69
  s_mov_b32 s77, s75
  buffer_load_dwordx4 v246, s[12:15], s77 offen lds
  buffer_load_dwordx4 v246, s[12:15], s77 offen offset:1024 lds
  buffer_load_dwordx4 v246, s[12:15], s77 offen offset:2048 lds
  buffer_load_dwordx4 v246, s[12:15], s77 offen offset:3072 lds
  s_add_u32 m0, m0, 4096
  s_add_u32 s77, s77, 4096
  buffer_load_dwordx4 v246, s[12:15], s77 offen lds
  buffer_load_dwordx4 v246, s[12:15], s77 offen offset:1024 lds
  buffer_load_dwordx4 v246, s[12:15], s77 offen offset:2048 lds
  buffer_load_dwordx4 v246, s[12:15], s77 offen offset:3072 lds
  s_add_u32 m0, m0, 4096
  s_add_u32 s77, s77, 4096
  buffer_load_dwordx4 v246, s[12:15], s77 offen lds
  buffer_load_dwordx4 v246, s[12:15], s77 offen offset:1024 lds
  buffer_load_dwordx4 v246, s[12:15], s77 offen offset:2048 lds
  buffer_load_dwordx4 v246, s[12:15], s77 offen offset:3072 lds
  s_waitcnt vmcnt(0)
  v_mfma_f32_16x16x32_bf16 v[192:195], a[96:99], a[0:3], v[232:235]
  v_mfma_f32_16x16x32_bf16 v[192:195], a[100:103], a[4:7], v[192:195]
  v_mfma_f32_16x16x32_bf16 v[192:195], a[104:107], a[8:11], v[192:195]
  v_mfma_f32_16x16x32_bf16 v[192:195], a[108:111], a[12:15], v[192:195]
  v_mfma_f32_16x16x32_bf16 v[192:195], a[112:115], a[16:19], v[192:195]
  v_mfma_f32_16x16x32_bf16 v[192:195], a[116:119], a[20:23], v[192:195]
  v_mfma_f32_16x16x32_bf16 v[196:199], a[140:143], a[20:23], v[232:235]
  v_mfma_f32_16x16x32_bf16 v[196:199], a[136:139], a[16:19], v[196:199]
  v_mfma_f32_16x16x32_bf16 v[196:199], a[132:135], a[12:15], v[196:199]
  v_mfma_f32_16x16x32_bf16 v[196:199], a[128:131], a[8:11], v[196:199]
  v_mfma_f32_16x16x32_bf16 v[196:199], a[124:127], a[4:7], v[196:199]
  v_mfma_f32_16x16x32_bf16 v[196:199], a[120:123], a[0:3], v[196:199]
  v_mfma_f32_16x16x32_bf16 v[200:203], a[120:123], a[24:27], v[232:235]
  v_mfma_f32_16x16x32_bf16 v[200:203], a[124:127], a[28:31], v[200:203]
  v_mfma_f32_16x16x32_bf16 v[200:203], a[128:131], a[32:35], v[200:203]
  v_mfma_f32_16x16x32_bf16 v[200:203], a[132:135], a[36:39], v[200:203]
  v_mfma_f32_16x16x32_bf16 v[200:203], a[136:139], a[40:43], v[200:203]
  v_mfma_f32_16x16x32_bf16 v[200:203], a[140:143], a[44:47], v[200:203]
  v_mfma_f32_16x16x32_bf16 v[204:207], a[116:119], a[44:47], v[232:235]
  v_mfma_f32_16x16x32_bf16 v[204:207], a[112:115], a[40:43], v[204:207]
  v_mfma_f32_16x16x32_bf16 v[204:207], a[108:111], a[36:39], v[204:207]
  v_mfma_f32_16x16x32_bf16 v[204:207], a[104:107], a[32:35], v[204:207]
  v_mfma_f32_16x16x32_bf16 v[204:207], a[100:103], a[28:31], v[204:207]
  v_mfma_f32_16x16x32_bf16 v[204:207], a[96:99], a[24:27], v[204:207]
  s_nop 7
  s_cmp_eq_u32 s74, 0
  s_cbranch_scc0 L_slow_p2
  v_max3_f32 v228, v228, v192, v193
  v_max3_f32 v228, v228, v194, v195
  v_max3_f32 v228, v228, v196, v197
  v_max3_f32 v228, v228, v198, v199
  v_max3_f32 v229, v229, v200, v201
  v_max3_f32 v229, v229, v202, v203
  v_max3_f32 v229, v229, v204, v205
  v_max3_f32 v229, v229, v206, v207
  s_branch L_slow_tile_end
L_slow_p2:
  ds_read_b64_tr_b16 a[144:145], v238 offset:0
  ds_read_b64_tr_b16 a[146:147], v238 offset:6144
  ds_read_b64_tr_b16 a[148:149], v238 offset:32
  ds_read_b64_tr_b16 a[150:151], v238 offset:6176
  ds_read_b64_tr_b16 a[152:153], v238 offset:64
  ds_read_b64_tr_b16 a[154:155], v238 offset:6208
  ds_read_b64_tr_b16 a[156:157], v238 offset:96
  ds_read_b64_tr_b16 a[158:159], v238 offset:6240
  ds_read_b64_tr_b16 a[160:161], v238 offset:128
  ds_read_b64_tr_b16 a[162:163], v238 offset:6272
  ds_read_b64_tr_b16 a[164:165], v238 offset:160
  ds_read_b64_tr_b16 a[166:167], v238 offset:6304
  s_waitcnt lgkmcnt(0)
  ds_read_b64_tr_b16 a[168:169], v238 offset:192
  ds_read_b64_tr_b16 a[170:171], v238 offset:6336
  ds_read_b64_tr_b16 a[172:173], v238 offset:224
  ds_read_b64_tr_b16 a[174:175], v238 offset:6368
  ds_read_b64_tr_b16 a[176:177], v238 offset:256
  ds_read_b64_tr_b16 a[178:179], v238 offset:6400
  ds_read_b64_tr_b16 a[180:181], v238 offset:288
  ds_read_b64_tr_b16 a[182:183], v238 offset:6432
  ds_read_b64_tr_b16 a[184:185], v238 offset:320
  ds_read_b64_tr_b16 a[186:187], v238 offset:6464
  ds_read_b64_tr_b16 a[188:189], v238 offset:352
  ds_read_b64_tr_b16 a[190:191], v238 offset:6496
  v_fma_f32 v192, v192, s22, v228
  v_fma_f32 v193, v193, s22, v228
  v_fma_f32 v194, v194, s22, v228
  v_fma_f32 v195, v195, s22, v228
  v_fma_f32 v196, v196, s22, v228
  v_fma_f32 v197, v197, s22, v228
  v_fma_f32 v198, v198, s22, v228
  v_fma_f32 v199, v199, s22, v228
  v_fma_f32 v200, v200, s22, v229
  v_fma_f32 v201, v201, s22, v229
  v_fma_f32 v202, v202, s22, v229
  v_fma_f32 v203, v203, s22, v229
  v_fma_f32 v204, v204, s22, v229
  v_fma_f32 v205, v205, s22, v229
  v_fma_f32 v206, v206, s22, v229
  v_fma_f32 v207, v207, s22, v229
  v_exp_f32 v192, v192
  v_exp_f32 v193, v193
  v_exp_f32 v194, v194
  v_exp_f32 v195, v195
  v_exp_f32 v196, v196
  v_exp_f32 v197, v197
  v_exp_f32 v198, v198
  v_exp_f32 v199, v199
  v_exp_f32 v200, v200
  v_exp_f32 v201, v201
  v_exp_f32 v202, v202
  v_exp_f32 v203, v203
  v_exp_f32 v204, v204
  v_exp_f32 v205, v205
  v_exp_f32 v206, v206
  v_exp_f32 v207, v207
  s_nop 0
  v_add_f32 v224, v224, v192
  v_add_f32 v224, v224, v193
  v_add_f32 v224, v224, v194
  v_add_f32 v224, v224, v195
  v_add_f32 v224, v224, v196
  v_add_f32 v224, v224, v197
  v_add_f32 v224, v224, v198
  v_add_f32 v224, v224, v199
  v_add_f32 v225, v225, v200
  v_add_f32 v225, v225, v201
  v_add_f32 v225, v225, v202
  v_add_f32 v225, v225, v203
  v_add_f32 v225, v225, v204
  v_add_f32 v225, v225, v205
  v_add_f32 v225, v225, v206
  v_add_f32 v225, v225, v207
  v_cvt_pk_bf16_f32 v192, v192, v193
  v_cvt_pk_bf16_f32 v193, v194, v195
  v_cvt_pk_bf16_f32 v194, v196, v197
  v_cvt_pk_bf16_f32 v195, v198, v199
  v_cvt_pk_bf16_f32 v203, v202, v203
  v_cvt_pk_bf16_f32 v202, v200, v201
  v_cvt_pk_bf16_f32 v200, v204, v205
  v_cvt_pk_bf16_f32 v201, v206, v207
  s_waitcnt lgkmcnt(0)
  s_nop 1
  v_mfma_f32_16x16x32_bf16 v[0:3], a[144:147], v[192:195], v[0:3]
  v_mfma_f32_16x16x32_bf16 v[48:51], a[144:147], v[200:203], v[48:51]
  v_mfma_f32_16x16x32_bf16 v[52:55], a[148:151], v[200:203], v[52:55]
  v_mfma_f32_16x16x32_bf16 v[4:7], a[148:151], v[192:195], v[4:7]
  v_mfma_f32_16x16x32_bf16 v[8:11], a[152:155], v[192:195], v[8:11]
  v_mfma_f32_16x16x32_bf16 v[56:59], a[152:155], v[200:203], v[56:59]
  v_mfma_f32_16x16x32_bf16 v[60:63], a[156:159], v[200:203], v[60:63]
  v_mfma_f32_16x16x32_bf16 v[12:15], a[156:159], v[192:195], v[12:15]
  v_mfma_f32_16x16x32_bf16 v[16:19], a[160:163], v[192:195], v[16:19]
  v_mfma_f32_16x16x32_bf16 v[64:67], a[160:163], v[200:203], v[64:67]
  v_mfma_f32_16x16x32_bf16 v[68:71], a[164:167], v[200:203], v[68:71]
  v_mfma_f32_16x16x32_bf16 v[20:23], a[164:167], v[192:195], v[20:23]
  v_mfma_f32_16x16x32_bf16 v[24:27], a[168:171], v[192:195], v[24:27]
  v_mfma_f32_16x16x32_bf16 v[72:75], a[168:171], v[200:203], v[72:75]
  v_mfma_f32_16x16x32_bf16 v[76:79], a[172:175], v[200:203], v[76:79]
  v_mfma_f32_16x16x32_bf16 v[28:31], a[172:175], v[192:195], v[28:31]
  v_mfma_f32_16x16x32_bf16 v[32:35], a[176:179], v[192:195], v[32:35]
  v_mfma_f32_16x16x32_bf16 v[80:83], a[176:179], v[200:203], v[80:83]
  v_mfma_f32_16x16x32_bf16 v[84:87], a[180:183], v[200:203], v[84:87]
  v_mfma_f32_16x16x32_bf16 v[36:39], a[180:183], v[192:195], v[36:39]
  v_mfma_f32_16x16x32_bf16 v[40:43], a[184:187], v[192:195], v[40:43]
  v_mfma_f32_16x16x32_bf16 v[88:91], a[184:187], v[200:203], v[88:91]
  v_mfma_f32_16x16x32_bf16 v[92:95], a[188:191], v[200:203], v[92:95]
  v_mfma_f32_16x16x32_bf16 v[44:47], a[188:191], v[192:195], v[44:47]
L_slow_tile_end:
  s_nop 7
  s_add_u32 s75, s75, 12288
  s_cmp_lt_u32 s75, s76
  s_cbranch_scc1 L_slow_tile
  s_cmp_eq_u32 s74, 0
  s_cbranch_scc0 L_slow_fin
  v_mov_b32 v224, v228
  s_nop 1
  v_permlane16_swap_b32 v228, v224
  v_max_f32 v228, v228, v224
  v_mov_b32 v224, v228
  s_nop 1
  v_permlane32_swap_b32 v228, v224
  v_max_f32 v228, v228, v224
  v_mul_f32_e64 v228, v228, -s22
  v_mov_b32 v224, 0
  v_mov_b32 v225, v229
  s_nop 1
  v_permlane16_swap_b32 v229, v225
  v_max_f32 v229, v229, v225
  v_mov_b32 v225, v229
  s_nop 1
  v_permlane32_swap_b32 v229, v225
  v_max_f32 v229, v229, v225
  v_mul_f32_e64 v229, v229, -s22
  v_mov_b32 v225, 0
  s_mov_b32 s74, 1
  s_branch L_slow_pass
L_slow_fin:
  s_add_u32 s88, s24, 0
  s_add_u32 s89, s24, 3072
  s_add_u32 s90, s24, 6144
  s_add_u32 s91, s24, 9216
  v_permlane16_swap_b32 v224, v225
  v_add_f32 v224, v224, v225
  v_mov_b32 v225, v224
  s_nop 1
  v_permlane32_swap_b32 v224, v225
  v_add_f32 v225, v224, v225
  v_rcp_f32 v212, v225
  v_cmp_ngt_f32_e64 s[44:45], s28, v225
  v_mov_b32 v213, v212
  s_nop 1
  v_permlane16_swap_b32 v212, v213
  v_mul_f32 v0, v0, v212
  v_mul_f32 v1, v1, v212
  v_mul_f32 v2, v2, v212
  v_mul_f32 v3, v3, v212
  v_mul_f32 v4, v4, v212
  v_mul_f32 v5, v5, v212
  v_mul_f32 v6, v6, v212
  v_mul_f32 v7, v7, v212
  v_cvt_pk_bf16_f32 v0, v0, v1
  v_cvt_pk_bf16_f32 v1, v2, v3
  v_cvt_pk_bf16_f32 v4, v4, v5
  v_cvt_pk_bf16_f32 v5, v6, v7
  v_mul_f32 v8, v8, v212
  v_mul_f32 v9, v9, v212
  v_mul_f32 v10, v10, v212
  v_mul_f32 v11, v11, v212
  v_mul_f32 v12, v12, v212
  v_mul_f32 v13, v13, v212
  v_mul_f32 v14, v14, v212
  v_mul_f32 v15, v15, v212
  ds_write_b64 v247, v[0:1] offset:0
  ds_write_b64 v248, v[4:5] offset:0
  v_cvt_pk_bf16_f32 v8, v8, v9
  v_cvt_pk_bf16_f32 v9, v10, v11
  v_cvt_pk_bf16_f32 v12, v12, v13
  v_cvt_pk_bf16_f32 v13, v14, v15
  v_mul_f32 v16, v16, v212
  v_mul_f32 v17, v17, v212
  v_mul_f32 v18, v18, v212
  v_mul_f32 v19, v19, v212
  v_mul_f32 v20, v20, v212
  v_mul_f32 v21, v21, v212
  v_mul_f32 v22, v22, v212
  v_mul_f32 v23, v23, v212
  ds_write_b64 v249, v[8:9] offset:0
  ds_write_b64 v250, v[12:13] offset:0
  v_cvt_pk_bf16_f32 v16, v16, v17
  v_cvt_pk_bf16_f32 v17, v18, v19
  v_cvt_pk_bf16_f32 v20, v20, v21
  v_cvt_pk_bf16_f32 v21, v22, v23
  v_mul_f32 v24, v24, v212
  v_mul_f32 v25, v25, v212
  v_mul_f32 v26, v26, v212
  v_mul_f32 v27, v27, v212
  v_mul_f32 v28, v28, v212
  v_mul_f32 v29, v29, v212
  v_mul_f32 v30, v30, v212
  v_mul_f32 v31, v31, v212
  ds_write_b64 v247, v[16:17] offset:128
  ds_write_b64 v248, v[20:21] offset:128
  v_cvt_pk_bf16_f32 v24, v24, v25
  v_cvt_pk_bf16_f32 v25, v26, v27
  v_cvt_pk_bf16_f32 v28, v28, v29
  v_cvt_pk_bf16_f32 v29, v30, v31
  v_mul_f32 v32, v32, v212
  v_mul_f32 v33, v33, v212
  v_mul_f32 v34, v34, v212
  v_mul_f32 v35, v35, v212
  v_mul_f32 v36, v36, v212
  v_mul_f32 v37, v37, v212
  v_mul_f32 v38, v38, v212
  v_mul_f32 v39, v39, v212
  ds_write_b64 v249, v[24:25] offset:128
  ds_write_b64 v250, v[28:29] offset:128
  v_cvt_pk_bf16_f32 v32, v32, v33
  v_cvt_pk_bf16_f32 v33, v34, v35
  v_cvt_pk_bf16_f32 v36, v36, v37
  v_cvt_pk_bf16_f32 v37, v38, v39
  v_mul_f32 v40, v40, v212
  v_mul_f32 v41, v41, v212
  v_mul_f32 v42, v42, v212
  v_mul_f32 v43, v43, v212
  v_mul_f32 v44, v44, v212
  v_mul_f32 v45, v45, v212
  v_mul_f32 v46, v46, v212
  v_mul_f32 v47, v47, v212
  ds_write_b64 v247, v[32:33] offset:256
  ds_write_b64 v248, v[36:37] offset:256
  v_cvt_pk_bf16_f32 v40, v40, v41
  v_cvt_pk_bf16_f32 v41, v42, v43
  v_cvt_pk_bf16_f32 v44, v44, v45
  v_cvt_pk_bf16_f32 v45, v46, v47
  ds_write_b64 v249, v[40:41] offset:256
  ds_write_b64 v250, v[44:45] offset:256
  v_mul_f32 v48, v48, v213
  v_mul_f32 v49, v49, v213
  v_mul_f32 v50, v50, v213
  v_mul_f32 v51, v51, v213
  v_mul_f32 v52, v52, v213
  v_mul_f32 v53, v53, v213
  v_mul_f32 v54, v54, v213
  v_mul_f32 v55, v55, v213
  v_cvt_pk_bf16_f32 v48, v48, v49
  v_cvt_pk_bf16_f32 v49, v50, v51
  v_cvt_pk_bf16_f32 v52, v52, v53
  v_cvt_pk_bf16_f32 v53, v54, v55
  v_mul_f32 v56, v56, v213
  v_mul_f32 v57, v57, v213
  v_mul_f32 v58, v58, v213
  v_mul_f32 v59, v59, v213
  v_mul_f32 v60, v60, v213
  v_mul_f32 v61, v61, v213
  v_mul_f32 v62, v62, v213
  v_mul_f32 v63, v63, v213
  ds_write_b64 v247, v[48:49] offset:6144
  ds_write_b64 v248, v[52:53] offset:6144
  v_cvt_pk_bf16_f32 v56, v56, v57
  v_cvt_pk_bf16_f32 v57, v58, v59
  v_cvt_pk_bf16_f32 v60, v60, v61
  v_cvt_pk_bf16_f32 v61, v62, v63
  v_mul_f32 v64, v64, v213
  v_mul_f32 v65, v65, v213
  v_mul_f32 v66, v66, v213
  v_mul_f32 v67, v67, v213
  v_mul_f32 v68, v68, v213
  v_mul_f32 v69, v69, v213
  v_mul_f32 v70, v70, v213
  v_mul_f32 v71, v71, v213
  ds_write_b64 v249, v[56:57] offset:6144
  ds_write_b64 v250, v[60:61] offset:6144
  v_cvt_pk_bf16_f32 v64, v64, v65
  v_cvt_pk_bf16_f32 v65, v66, v67
  v_cvt_pk_bf16_f32 v68, v68, v69
  v_cvt_pk_bf16_f32 v69, v70, v71
  v_mul_f32 v72, v72, v213
  v_mul_f32 v73, v73, v213
  v_mul_f32 v74, v74, v213
  v_mul_f32 v75, v75, v213
  v_mul_f32 v76, v76, v213
  v_mul_f32 v77, v77, v213
  v_mul_f32 v78, v78, v213
  v_mul_f32 v79, v79, v213
  ds_write_b64 v247, v[64:65] offset:6272
  ds_write_b64 v248, v[68:69] offset:6272
  v_cvt_pk_bf16_f32 v72, v72, v73
  v_cvt_pk_bf16_f32 v73, v74, v75
  v_cvt_pk_bf16_f32 v76, v76, v77
  v_cvt_pk_bf16_f32 v77, v78, v79
  v_mul_f32 v80, v80, v213
  v_mul_f32 v81, v81, v213
  v_mul_f32 v82, v82, v213
  v_mul_f32 v83, v83, v213
  v_mul_f32 v84, v84, v213
  v_mul_f32 v85, v85, v213
  v_mul_f32 v86, v86, v213
  v_mul_f32 v87, v87, v213
  ds_write_b64 v249, v[72:73] offset:6272
  ds_write_b64 v250, v[76:77] offset:6272
  v_cvt_pk_bf16_f32 v80, v80, v81
  v_cvt_pk_bf16_f32 v81, v82, v83
  v_cvt_pk_bf16_f32 v84, v84, v85
  v_cvt_pk_bf16_f32 v85, v86, v87
  v_mul_f32 v88, v88, v213
  v_mul_f32 v89, v89, v213
  v_mul_f32 v90, v90, v213
  v_mul_f32 v91, v91, v213
  v_mul_f32 v92, v92, v213
  v_mul_f32 v93, v93, v213
  v_mul_f32 v94, v94, v213
  v_mul_f32 v95, v95, v213
  ds_write_b64 v247, v[80:81] offset:6400
  ds_write_b64 v248, v[84:85] offset:6400
  v_cvt_pk_bf16_f32 v88, v88, v89
  v_cvt_pk_bf16_f32 v89, v90, v91
  v_cvt_pk_bf16_f32 v92, v92, v93
  v_cvt_pk_bf16_f32 v93, v94, v95
  ds_write_b64 v249, v[88:89] offset:6400
  ds_write_b64 v250, v[92:93] offset:6400
  ds_read_b128 a[0:3], v251 offset:0
  ds_read_b128 a[4:7], v252 offset:0
  ds_read_b128 a[8:11], v253 offset:0
  ds_read_b128 a[12:15], v251 offset:3072
  ds_read_b128 a[16:19], v252 offset:3072
  ds_read_b128 a[20:23], v253 offset:3072
  ds_read_b128 a[24:27], v251 offset:6144
  ds_read_b128 a[28:31], v252 offset:6144
  ds_read_b128 a[32:35], v253 offset:6144
  ds_read_b128 a[36:39], v251 offset:9216
  ds_read_b128 a[40:43], v252 offset:9216
  ds_read_b128 a[44:47], v253 offset:9216
  s_waitcnt lgkmcnt(0)
  buffer_store_dwordx4 a[0:3], v246, s[16:19], s88 offen
  buffer_store_dwordx4 a[4:7], v246, s[16:19], s88 offen offset:1024
  buffer_store_dwordx4 a[8:11], v246, s[16:19], s88 offen offset:2048
  buffer_store_dwordx4 a[12:15], v246, s[16:19], s89 offen
  buffer_store_dwordx4 a[16:19], v246, s[16:19], s89 offen offset:1024
  buffer_store_dwordx4 a[20:23], v246, s[16:19], s89 offen offset:2048
  buffer_store_dwordx4 a[24:27], v246, s[16:19], s90 offen
  buffer_store_dwordx4 a[28:31], v246, s[16:19], s90 offen offset:1024
  buffer_store_dwordx4 a[32:35], v246, s[16:19], s90 offen offset:2048
  buffer_store_dwordx4 a[36:39], v246, s[16:19], s91 offen
  buffer_store_dwordx4 a[40:43], v246, s[16:19], s91 offen offset:1024
  buffer_store_dwordx4 a[44:47], v246, s[16:19], s91 offen offset:2048
  s_waitcnt vmcnt(0)
L_slow_next:
  s_add_u32 s68, s68, 1
  s_cmp_lt_u32 s68, 4
  s_cbranch_scc1 L_slow_combo
  s_endpgm
.section .rodata,"a"
.p2align 6
.amdhsa_kernel standalone__mha_softmax__near_ridge_kernel
  .amdhsa_next_free_vgpr 512
  .amdhsa_next_free_sgpr 102
  .amdhsa_accum_offset 256
  .amdhsa_group_segment_fixed_size 0
  .amdhsa_kernarg_size 48
  .amdhsa_user_sgpr_count 2
  .amdhsa_user_sgpr_kernarg_segment_ptr 1
  .amdhsa_system_sgpr_workgroup_id_x 1
.end_amdhsa_kernel
```
